```python
import torch

def _softmax(x, axis=-1):
    return torch.softmax(x, dim=axis)

def _gelu(x):
    return torch.nn.functional.gelu(x, approximate='tanh')

def _silu(x):
    return torch.nn.functional.silu(x)

def _sigmoid(x):
    return torch.sigmoid(x)

def _layernorm(x, axis=-1, eps=1e-05):
    m = x.mean(dim=axis, keepdim=True)
    v = x.var(dim=axis, keepdim=True, unbiased=False)
    return (x - m) / torch.sqrt(v + eps)

def _scatter_add(tgt, idx, src, axis=0):
    return tgt.clone().index_add_(axis, idx, src)

def _segment_sum(src, seg, n):
    out = torch.zeros((n,) + src.shape[1:], dtype=src.dtype)
    return out.index_add_(0, seg, src)

def _pad(x, pw):
    flat = tuple((v for pair in reversed(pw) for v in pair))
    return torch.nn.functional.pad(x, flat)
kernel_name = 'concat_heads__linear_attn_block__memory_aug_recurrent_mem_tr__prompt'

def setup_inputs():

    _w = lambda a: (lambda t: t.to(torch.bfloat16) if t.is_floating_point() else t)(torch.as_tensor(a))

    def _A_setup():
        B, S, D = (1, 2048, 640)
        return {'x': _w((lambda *s: torch.randn(*s, dtype=torch.bfloat16) * 0.05)(B, S, D)), 'wqkv': _w((lambda *s: torch.randn(*s, dtype=torch.bfloat16) * 1.6)(D, 3 * D)), 'wo': _w((lambda *s: torch.randn(*s, dtype=torch.bfloat16) * 0.1)(D, D))}
    _A_in = _A_setup()

    def _B_setup():
        B, S, Dm = (1, 2048, 640)
        H, Dh = (32, 192)
        M, seg = (8, 32)
        seg = min(seg, S)
        S = S // seg * seg
        return {'x': _w((lambda *s: torch.randn(*s, dtype=torch.bfloat16) * 0.05)(B, S, Dm)), 'mem0': _w((lambda *s: torch.randn(*s, dtype=torch.bfloat16) * 0.8)(B, M, Dm)), 'Wq': _w((lambda *s: torch.randn(*s, dtype=torch.bfloat16) * 1.6)(Dm, H, Dh) * Dm ** (-0.5)), 'Wk': _w((lambda *s: torch.randn(*s, dtype=torch.bfloat16) * 1.6)(Dm, H, Dh) * Dm ** (-0.5)), 'Wv': _w((lambda *s: torch.randn(*s, dtype=torch.bfloat16) * 0.8)(Dm, H, Dh) * Dm ** (-0.5)), 'Wo': _w((lambda *s: torch.randn(*s, dtype=torch.bfloat16) * 0.8)(H, Dh, Dm) * (H * Dh) ** (-0.5)), 'seg_len': seg}
    _B_in = _B_setup()
    return {'A_x': _A_in['x'], 'A_wqkv': _A_in['wqkv'], 'A_wo': _A_in['wo'], 'B_x': _B_in['x'], 'B_mem0': _B_in['mem0'], 'B_Wq': _B_in['Wq'], 'B_Wk': _B_in['Wk'], 'B_Wv': _B_in['Wv'], 'B_Wo': _B_in['Wo'], 'B_seg_len': _B_in['seg_len']}

def reference(A_x, A_wqkv, A_wo, B_x, B_mem0, B_Wq, B_Wk, B_Wv, B_Wo, B_seg_len):

    def _A_ref(x, wqkv, wo):
        B, S, D = x.shape
        H = 32
        Dh = D // H
        qkv = (lambda x, *d: x.permute(*d))((x @ wqkv).reshape(B, S, 3, H, Dh), 2, 0, 3, 1, 4)
        q, k, v = (qkv[0], qkv[1], qkv[2])
        phi = lambda t: torch.where(t > 0, t + 1, torch.exp(t)) + 1e-06
        pq, pk = (phi(q), phi(k))
        kv = torch.einsum('bhsd,bhse->bhde', pk, v)
        z = torch.einsum('bhsd->bhd', pk)
        num = torch.einsum('bhqd,bhde->bhqe', pq, kv)
        den = torch.einsum('bhqd,bhd->bhq', pq, z)[..., None] + 1e-06
        o = num / den
        return (lambda x, *d: x.permute(*d))(o, 0, 2, 1, 3).reshape(B, S, D) @ wo

    def _B_ref(x, mem0, Wq, Wk, Wv, Wo, seg_len):
        B, S, Dm = x.shape
        H, Dh = (Wq.shape[1], Wq.shape[2])
        M = mem0.shape[1]
        scale = Dh ** (-0.5)
        n_seg = S // seg_len
        L = M + seg_len
        idx = torch.arange(L)
        mask = (idx[:, None] < M) | (idx[:, None] >= idx[None, :])
        mem = mem0
        outs = []
        for s in range(n_seg):
            xs = x[:, s * seg_len:(s + 1) * seg_len, :].clone()
            h = torch.concatenate([mem, xs], axis=1)
            q = torch.einsum('btd,dhe->bhte', h, Wq)
            k = torch.einsum('btd,dhe->bhte', h, Wk)
            v = torch.einsum('btd,dhe->bhte', h, Wv)
            scores = torch.einsum('bhqe,bhke->bhqk', q, k) * scale
            scores = torch.where(mask[None, None], scores, -1000000000.0)
            p = _softmax(scores, axis=-1)
            o = torch.einsum('bhqk,bhke->bhqe', p, v)
            o = torch.einsum('bhte,hed->btd', o, Wo)
            mem = o[:, :M, :].clone()
            outs.append(o[:, M:, :])
        return torch.concatenate(outs, axis=1)
    a = _A_ref(A_x, A_wqkv, A_wo)
    b = _B_ref(B_x, B_mem0, B_Wq, B_Wk, B_Wv, B_Wo, B_seg_len)
    return torch.concatenate([a, b], axis=-1)
```

```asm
; @launch grid=(256,1,1) block=(256,1,1) lds=163840
.amdgcn_target "amdgcn-amd-amdhsa--gfx950"
.text
.globl concat_heads__linear_attn_block__memory_aug_recurrent_mem_tr__prompt_kernel
.p2align 8
.type concat_heads__linear_attn_block__memory_aug_recurrent_mem_tr__prompt_kernel,@function
concat_heads__linear_attn_block__memory_aug_recurrent_mem_tr__prompt_kernel:
    s_cmp_ge_u32 s2, 256
    s_cbranch_scc1 L_exit
    s_mov_b32 s96, s0
    s_mov_b32 s97, s1
    s_load_dwordx2 s[4:5], s[0:1], 96
    s_load_dwordx2 s[90:91], s[0:1], 88
    s_getreg_b32 s93, hwreg(HW_REG_XCC_ID)
    s_and_b32 s93, s93, 7
    v_lshrrev_b32 v1, 6, v0
    s_nop 0
    v_readfirstlane_b32 s16, v1
    v_and_b32 v0, 63, v0
    s_getpc_b64 s[40:41]
L_pc0:
    s_add_u32 s40, s40, L_table-L_pc0
    s_addc_u32 s41, s41, 0
    s_waitcnt lgkmcnt(0)
    s_mov_b32 s6, 268435456
    s_mov_b32 s7, 0x00020000
    s_mov_b32 s87, s2
    v_mov_b32 v73, 0
    v_mov_b32 v74, 0
    v_mov_b32 v75, 0
    v_mov_b32 v76, 0
    v_mov_b32 v77, 0
    v_mov_b32 v78, 0
    s_cmp_eq_u32 s16, 0
    s_cbranch_scc0 Lc_1_a
    s_lshr_b32 s20, s93, 1
    s_lshl_b32 s20, s20, 6
    v_mov_b32 v2, s20
    s_and_b32 s21, s93, 1
    s_xor_b32 s22, s21, 1
    v_mov_b32 v4, s22
    v_mov_b32 v5, s21
    s_mov_b64 exec, 1
    global_atomic_add_x2 v[6:7], v2, v[4:5], s[90:91] sc0
    s_mov_b64 exec, -1
    s_lshl_b32 s20, s2, 7
    s_add_u32 s20, s20, 125829120
    v_lshlrev_b32 v2, 2, v0
    v_mov_b32 v3, 0
    s_mov_b32 exec_hi, 0
    buffer_store_dword v3, v2, s[4:7], s20 offen sc1
    s_mov_b64 exec, -1
    s_waitcnt vmcnt(1)
    s_cmp_eq_u32 s21, 0
    v_readfirstlane_b32 s22, v6
    v_readfirstlane_b32 s23, v7
    s_nop 3
    s_cselect_b32 s92, s22, s23
    s_cmp_lt_u32 s93, 2
    s_cselect_b32 s22, 1, 0
    s_cmp_lt_u32 s92, 32
    s_cselect_b32 s23, 1, 0
    s_and_b32 s22, s22, s23
    s_cmp_eq_u32 s22, 0
    s_cbranch_scc1 Ls_2
    s_waitcnt vmcnt(0)
    v_mov_b32 v8, 200
    v_mov_b32 v9, 1
    s_mov_b64 exec, 1
    global_atomic_add v8, v9, s[90:91]
    s_mov_b64 exec, -1
Ls_2:
    v_mov_b32 v2, 138496
    v_mov_b32 v4, s92
    ds_write_b32 v2, v4 offset:64
    s_waitcnt lgkmcnt(0)
Lc_1_a:
    s_barrier
    v_mov_b32 v2, 138496
    ds_read_b32 v4, v2 offset:64
    s_waitcnt lgkmcnt(0)
    v_readfirstlane_b32 s92, v4
    s_nop 3
    s_cmp_lt_u32 s93, 2
    s_cselect_b32 s22, 1, 0
    s_cmp_lt_u32 s92, 32
    s_cselect_b32 s23, 1, 0
    s_and_b32 s33, s22, s23
    s_cmp_eq_u32 s33, 0
    s_cbranch_scc1 Ls_3
    s_mov_b32 s14, s93
    s_mov_b32 s15, s92
    s_lshr_b32 s20, s15, 1
    s_lshl_b32 s12, s14, 4
    s_add_u32 s12, s12, s20
    s_and_b32 s13, s15, 1
    s_mul_i32 s20, s16, 384
    s_add_u32 s20, s20, 0
    v_add_u32 v88, s20, v0
    v_mul_u32_u24 v89, 43691, v88
    v_lshrrev_b32 v89, 19, v89
    v_mul_u32_u24 v90, 12, v89
    v_sub_u32 v88, v88, v90
    v_bfe_u32 v90, v89, 4, 1
    v_lshlrev_b32 v90, 1, v90
    v_xor_b32 v88, v88, v90
    v_mul_u32_u24 v73, 12288, v89
    v_lshlrev_b32 v88, 4, v88
    v_add_u32 v73, v73, v88
    s_mul_i32 s20, s16, 384
    s_add_u32 s20, s20, 64
    v_add_u32 v88, s20, v0
    v_mul_u32_u24 v89, 43691, v88
    v_lshrrev_b32 v89, 19, v89
    v_mul_u32_u24 v90, 12, v89
    v_sub_u32 v88, v88, v90
    v_bfe_u32 v90, v89, 4, 1
    v_lshlrev_b32 v90, 1, v90
    v_xor_b32 v88, v88, v90
    v_mul_u32_u24 v74, 12288, v89
    v_lshlrev_b32 v88, 4, v88
    v_add_u32 v74, v74, v88
    s_mul_i32 s20, s16, 384
    s_add_u32 s20, s20, 128
    v_add_u32 v88, s20, v0
    v_mul_u32_u24 v89, 43691, v88
    v_lshrrev_b32 v89, 19, v89
    v_mul_u32_u24 v90, 12, v89
    v_sub_u32 v88, v88, v90
    v_bfe_u32 v90, v89, 4, 1
    v_lshlrev_b32 v90, 1, v90
    v_xor_b32 v88, v88, v90
    v_mul_u32_u24 v75, 12288, v89
    v_lshlrev_b32 v88, 4, v88
    v_add_u32 v75, v75, v88
    s_mul_i32 s20, s16, 384
    s_add_u32 s20, s20, 192
    v_add_u32 v88, s20, v0
    v_mul_u32_u24 v89, 43691, v88
    v_lshrrev_b32 v89, 19, v89
    v_mul_u32_u24 v90, 12, v89
    v_sub_u32 v88, v88, v90
    v_bfe_u32 v90, v89, 4, 1
    v_lshlrev_b32 v90, 1, v90
    v_xor_b32 v88, v88, v90
    v_mul_u32_u24 v76, 12288, v89
    v_lshlrev_b32 v88, 4, v88
    v_add_u32 v76, v76, v88
    s_mul_i32 s20, s16, 384
    s_add_u32 s20, s20, 256
    v_add_u32 v88, s20, v0
    v_mul_u32_u24 v89, 43691, v88
    v_lshrrev_b32 v89, 19, v89
    v_mul_u32_u24 v90, 12, v89
    v_sub_u32 v88, v88, v90
    v_bfe_u32 v90, v89, 4, 1
    v_lshlrev_b32 v90, 1, v90
    v_xor_b32 v88, v88, v90
    v_mul_u32_u24 v77, 12288, v89
    v_lshlrev_b32 v88, 4, v88
    v_add_u32 v77, v77, v88
    s_mul_i32 s20, s16, 384
    s_add_u32 s20, s20, 320
    v_add_u32 v88, s20, v0
    v_mul_u32_u24 v89, 43691, v88
    v_lshrrev_b32 v89, 19, v89
    v_mul_u32_u24 v90, 12, v89
    v_sub_u32 v88, v88, v90
    v_bfe_u32 v90, v89, 4, 1
    v_lshlrev_b32 v90, 1, v90
    v_xor_b32 v88, v88, v90
    v_mul_u32_u24 v78, 12288, v89
    v_lshlrev_b32 v88, 4, v88
    v_add_u32 v78, v78, v88
    s_load_dwordx2 s[8:9], s[96:97], 40
    s_mov_b32 s10, 7864320
    s_mov_b32 s11, 0x00020000
    s_waitcnt lgkmcnt(0)
    s_mul_i32 s20, s12, 384
    s_mul_i32 s21, s13, 192
    s_add_u32 s20, s20, s21
    s_add_u32 s20, s20, 0
    s_mul_i32 s21, s16, 6144
    s_add_u32 s21, s21, 98304
    s_mov_b32 m0, s21
    s_add_u32 s21, s21, 1024
    buffer_load_dwordx4 v73, s[8:11], s20 offen lds
    s_mov_b32 m0, s21
    s_add_u32 s21, s21, 1024
    buffer_load_dwordx4 v74, s[8:11], s20 offen lds
    s_mov_b32 m0, s21
    s_add_u32 s21, s21, 1024
    buffer_load_dwordx4 v75, s[8:11], s20 offen lds
    s_mov_b32 m0, s21
    s_add_u32 s21, s21, 1024
    buffer_load_dwordx4 v76, s[8:11], s20 offen lds
    s_mov_b32 m0, s21
    s_add_u32 s21, s21, 1024
    buffer_load_dwordx4 v77, s[8:11], s20 offen lds
    s_mov_b32 m0, s21
    s_add_u32 s21, s21, 1024
    buffer_load_dwordx4 v78, s[8:11], s20 offen lds
    s_load_dwordx2 s[8:9], s[96:97], 40
    s_mov_b32 s10, 7864320
    s_mov_b32 s11, 0x00020000
    s_waitcnt lgkmcnt(0)
    s_mul_i32 s20, s12, 384
    s_mul_i32 s21, s13, 192
    s_add_u32 s20, s20, s21
    s_add_u32 s20, s20, 1572864
    s_mul_i32 s21, s16, 6144
    s_add_u32 s21, s21, 0
    s_mov_b32 m0, s21
    s_add_u32 s21, s21, 1024
    buffer_load_dwordx4 v73, s[8:11], s20 offen lds
    s_mov_b32 m0, s21
    s_add_u32 s21, s21, 1024
    buffer_load_dwordx4 v74, s[8:11], s20 offen lds
    s_mov_b32 m0, s21
    s_add_u32 s21, s21, 1024
    buffer_load_dwordx4 v75, s[8:11], s20 offen lds
    s_mov_b32 m0, s21
    s_add_u32 s21, s21, 1024
    buffer_load_dwordx4 v76, s[8:11], s20 offen lds
    s_mov_b32 m0, s21
    s_add_u32 s21, s21, 1024
    buffer_load_dwordx4 v77, s[8:11], s20 offen lds
    s_mov_b32 m0, s21
    s_add_u32 s21, s21, 1024
    buffer_load_dwordx4 v78, s[8:11], s20 offen lds
    s_load_dwordx2 s[8:9], s[96:97], 40
    s_mov_b32 s10, 7864320
    s_mov_b32 s11, 0x00020000
    s_waitcnt lgkmcnt(0)
    s_mul_i32 s20, s12, 384
    s_mul_i32 s21, s13, 192
    s_add_u32 s20, s20, s21
    s_add_u32 s20, s20, 3145728
    s_mul_i32 s21, s16, 6144
    s_add_u32 s21, s21, 24576
    s_mov_b32 m0, s21
    s_add_u32 s21, s21, 1024
    buffer_load_dwordx4 v73, s[8:11], s20 offen lds
    s_mov_b32 m0, s21
    s_add_u32 s21, s21, 1024
    buffer_load_dwordx4 v74, s[8:11], s20 offen lds
    s_mov_b32 m0, s21
    s_add_u32 s21, s21, 1024
    buffer_load_dwordx4 v75, s[8:11], s20 offen lds
    s_mov_b32 m0, s21
    s_add_u32 s21, s21, 1024
    buffer_load_dwordx4 v76, s[8:11], s20 offen lds
    s_mov_b32 m0, s21
    s_add_u32 s21, s21, 1024
    buffer_load_dwordx4 v77, s[8:11], s20 offen lds
    s_mov_b32 m0, s21
    s_add_u32 s21, s21, 1024
    buffer_load_dwordx4 v78, s[8:11], s20 offen lds
    s_load_dwordx2 s[8:9], s[96:97], 40
    s_mov_b32 s10, 7864320
    s_mov_b32 s11, 0x00020000
    s_waitcnt lgkmcnt(0)
    s_mul_i32 s20, s12, 384
    s_mul_i32 s21, s13, 192
    s_add_u32 s20, s20, s21
    s_add_u32 s20, s20, 4718592
    s_mul_i32 s21, s16, 6144
    s_add_u32 s21, s21, 49152
    s_mov_b32 m0, s21
    s_add_u32 s21, s21, 1024
    buffer_load_dwordx4 v73, s[8:11], s20 offen lds
    s_mov_b32 m0, s21
    s_add_u32 s21, s21, 1024
    buffer_load_dwordx4 v74, s[8:11], s20 offen lds
    s_mov_b32 m0, s21
    s_add_u32 s21, s21, 1024
    buffer_load_dwordx4 v75, s[8:11], s20 offen lds
    s_mov_b32 m0, s21
    s_add_u32 s21, s21, 1024
    buffer_load_dwordx4 v76, s[8:11], s20 offen lds
    s_mov_b32 m0, s21
    s_add_u32 s21, s21, 1024
    buffer_load_dwordx4 v77, s[8:11], s20 offen lds
    s_mov_b32 m0, s21
    s_add_u32 s21, s21, 1024
    buffer_load_dwordx4 v78, s[8:11], s20 offen lds
    s_load_dwordx2 s[8:9], s[96:97], 40
    s_mov_b32 s10, 7864320
    s_mov_b32 s11, 0x00020000
    s_waitcnt lgkmcnt(0)
    s_mul_i32 s20, s12, 384
    s_mul_i32 s21, s13, 192
    s_add_u32 s20, s20, s21
    s_add_u32 s20, s20, 6291456
    s_mul_i32 s21, s16, 6144
    s_add_u32 s21, s21, 73728
    s_mov_b32 m0, s21
    s_add_u32 s21, s21, 1024
    buffer_load_dwordx4 v73, s[8:11], s20 offen lds
    s_mov_b32 m0, s21
    s_add_u32 s21, s21, 1024
    buffer_load_dwordx4 v74, s[8:11], s20 offen lds
    s_mov_b32 m0, s21
    s_add_u32 s21, s21, 1024
    buffer_load_dwordx4 v75, s[8:11], s20 offen lds
    s_mov_b32 m0, s21
    s_add_u32 s21, s21, 1024
    buffer_load_dwordx4 v76, s[8:11], s20 offen lds
    s_mov_b32 m0, s21
    s_add_u32 s21, s21, 1024
    buffer_load_dwordx4 v77, s[8:11], s20 offen lds
    s_mov_b32 m0, s21
    s_add_u32 s21, s21, 1024
    buffer_load_dwordx4 v78, s[8:11], s20 offen lds
Ls_3:
    s_cmp_eq_u32 s16, 0
    s_cbranch_scc0 Lc_1
    v_and_b32 v2, 3, v0
    v_lshlrev_b32 v2, 6, v2
    s_mov_b32 s24, 0
Lc_4:
    global_load_dwordx2 v[6:7], v2, s[90:91] sc1
    s_waitcnt vmcnt(0)
    v_readlane_b32 s64, v6, 0
    v_readlane_b32 s65, v7, 0
    v_readlane_b32 s66, v6, 1
    v_readlane_b32 s67, v7, 1
    v_readlane_b32 s68, v6, 2
    v_readlane_b32 s69, v7, 2
    v_readlane_b32 s70, v6, 3
    v_readlane_b32 s71, v7, 3
    s_nop 3
    s_add_u32 s20, s64, s65
    s_add_u32 s20, s20, s66
    s_add_u32 s20, s20, s67
    s_add_u32 s20, s20, s68
    s_add_u32 s20, s20, s69
    s_add_u32 s20, s20, s70
    s_add_u32 s20, s20, s71
    s_cmp_eq_u32 s20, 256
    s_cbranch_scc1 Lc_5
    s_sleep 2
    s_add_u32 s24, s24, 1
    s_cmp_lt_u32 s24, 400000
    s_cbranch_scc1 Lc_4
    s_branch L_abort
Lc_5:
    s_cmp_eq_u32 s33, 1
    s_cbranch_scc1 Ls_6
    v_mov_b32 v8, 200
    v_mov_b32 v9, 1
    s_mov_b64 exec, 1
    global_atomic_add v8, v9, s[90:91]
    s_mov_b64 exec, -1
Ls_6:
    v_mov_b32 v2, 138496
    v_mov_b32 v4, s92
    ds_write_b32 v2, v4
    v_mov_b32 v4, s64
    ds_write_b32 v2, v4 offset:4
    v_mov_b32 v4, s65
    ds_write_b32 v2, v4 offset:8
    v_mov_b32 v4, s66
    ds_write_b32 v2, v4 offset:12
    v_mov_b32 v4, s67
    ds_write_b32 v2, v4 offset:16
    v_mov_b32 v4, s68
    ds_write_b32 v2, v4 offset:20
    v_mov_b32 v4, s69
    ds_write_b32 v2, v4 offset:24
    v_mov_b32 v4, s70
    ds_write_b32 v2, v4 offset:28
    v_mov_b32 v4, s71
    ds_write_b32 v2, v4 offset:32
    s_waitcnt lgkmcnt(0)
Lc_1:
    s_barrier
    v_mov_b32 v2, 138496
    ds_read_b32 v4, v2
    ds_read_b32 v5, v2 offset:4
    ds_read_b32 v6, v2 offset:8
    ds_read_b32 v7, v2 offset:12
    ds_read_b32 v8, v2 offset:16
    ds_read_b32 v9, v2 offset:20
    ds_read_b32 v10, v2 offset:24
    ds_read_b32 v11, v2 offset:28
    ds_read_b32 v12, v2 offset:32
    s_waitcnt lgkmcnt(0)
    v_readfirstlane_b32 s92, v4
    v_readfirstlane_b32 s64, v5
    v_readfirstlane_b32 s65, v6
    v_readfirstlane_b32 s66, v7
    v_readfirstlane_b32 s67, v8
    v_readfirstlane_b32 s68, v9
    v_readfirstlane_b32 s69, v10
    v_readfirstlane_b32 s70, v11
    v_readfirstlane_b32 s71, v12
    s_nop 3
    s_barrier
    s_min_u32 s20, s64, s65
    s_cmp_ge_u32 s20, 32
    s_cselect_b32 s25, 1, 0
    s_cmp_eq_u32 s33, 0
    s_cbranch_scc1 Ls_7
    s_cmp_eq_u32 s25, 1
    s_cbranch_scc1 Ls_7
    s_waitcnt vmcnt(0)
    s_barrier
    s_mov_b32 s33, 0
Ls_7:
    s_mov_b32 s21, 0
    s_cmp_gt_u32 s93, 0
    s_cselect_b32 s22, s64, 0
    s_add_u32 s21, s21, s22
    s_cmp_gt_u32 s93, 1
    s_cselect_b32 s22, s65, 0
    s_add_u32 s21, s21, s22
    s_cmp_gt_u32 s93, 2
    s_cselect_b32 s22, s66, 0
    s_add_u32 s21, s21, s22
    s_cmp_gt_u32 s93, 3
    s_cselect_b32 s22, s67, 0
    s_add_u32 s21, s21, s22
    s_cmp_gt_u32 s93, 4
    s_cselect_b32 s22, s68, 0
    s_add_u32 s21, s21, s22
    s_cmp_gt_u32 s93, 5
    s_cselect_b32 s22, s69, 0
    s_add_u32 s21, s21, s22
    s_cmp_gt_u32 s93, 6
    s_cselect_b32 s22, s70, 0
    s_add_u32 s21, s21, s22
    s_add_u32 s21, s21, s92
    s_cmp_eq_u32 s25, 0
    s_cbranch_scc1 Lc_8
    s_mov_b32 s14, s93
    s_mov_b32 s15, s92
    s_cmp_lt_u32 s93, 2
    s_cselect_b32 s22, 1, 0
    s_cmp_lt_u32 s92, 32
    s_cselect_b32 s23, 1, 0
    s_and_b32 s22, s22, s23
    s_cmp_eq_u32 s22, 1
    s_cbranch_scc1 L_role_chain
    s_cmp_eq_u32 s93, 0
    s_cselect_b32 s22, 32, 64
    s_sub_u32 s94, s21, s22
    s_branch L_role_worker
Lc_8:
    s_cmp_lt_u32 s21, 64
    s_cbranch_scc0 Lc_9
    s_lshr_b32 s14, s21, 5
    s_and_b32 s15, s21, 31
    s_branch L_role_chain
Lc_9:
    s_sub_u32 s94, s21, 64
    s_branch L_role_worker
L_role_chain:
    v_mov_b32 v9, 0
    v_mov_b32 v11, 0
    v_mov_b32 v17, 0
    v_mov_b32 v24, 0
    v_mov_b32 v148, 0
    v_mov_b32 v149, 0
    v_mov_b32 v150, 0
    v_mov_b32 v151, 0
    s_lshr_b32 s20, s15, 1
    s_lshl_b32 s12, s14, 4
    s_add_u32 s12, s12, s20
    s_and_b32 s13, s15, 1
    s_lshl_b32 s31, s14, 5
    s_add_u32 s31, s31, s15
    s_mov_b32 s34, 0xffffffff
    s_mov_b32 s35, 0
    s_mov_b32 s36, 0x0000ffff
    s_mov_b32 s37, 0x0000ffff
    s_mov_b32 s38, 0x00ff00ff
    s_mov_b32 s39, 0x00ff00ff
    s_lshl_b32 s20, s15, 1
    s_add_u32 s20, s20, s16
    s_add_u32 s21, s15, 64
    s_cmp_lt_u32 s16, 2
    s_cselect_b32 s99, s20, s21
    s_cselect_b32 s88, 1, 0
    s_cmp_eq_u32 s16, 2
    s_cselect_b32 s20, 1, 0
    s_cmp_lt_u32 s15, 16
    s_cselect_b32 s21, 1, 0
    s_and_b32 s20, s20, s21
    s_or_b32 s88, s88, s20
    s_min_u32 s99, s99, 79
    s_mov_b32 s56, 0xffff
    s_mov_b32 s57, 0
    s_mov_b32 s100, 0xffffffff
    s_mov_b32 s101, 0
    s_lshl_b32 s20, s14, 14
    s_add_u32 s58, s20, 327680
    s_xor_b32 s20, s14, 0
    s_mul_i32 s20, s20, 80
    s_add_u32 s20, s20, s99
    s_lshl_b32 s20, s20, 8
    s_lshr_b32 s21, s20, 13
    s_lshl_b32 s21, s21, 14
    s_and_b32 s20, s20, 8191
    s_add_u32 s20, s20, s21
    s_add_u32 s59, s20, 127926272
    s_xor_b32 s20, s14, 1
    s_mul_i32 s20, s20, 80
    s_add_u32 s20, s20, s99
    s_lshl_b32 s20, s20, 8
    s_lshr_b32 s21, s20, 13
    s_lshl_b32 s21, s21, 14
    s_and_b32 s20, s20, 8191
    s_add_u32 s20, s20, s21
    s_add_u32 s60, s20, 127926272
    s_cmp_eq_u32 s33, 1
    s_cbranch_scc1 Lsp_10
    s_mul_i32 s20, s16, 384
    s_add_u32 s20, s20, 0
    v_add_u32 v88, s20, v0
    v_mul_u32_u24 v89, 43691, v88
    v_lshrrev_b32 v89, 19, v89
    v_mul_u32_u24 v90, 12, v89
    v_sub_u32 v88, v88, v90
    v_bfe_u32 v90, v89, 4, 1
    v_lshlrev_b32 v90, 1, v90
    v_xor_b32 v88, v88, v90
    v_mul_u32_u24 v73, 12288, v89
    v_lshlrev_b32 v88, 4, v88
    v_add_u32 v73, v73, v88
    s_mul_i32 s20, s16, 384
    s_add_u32 s20, s20, 64
    v_add_u32 v88, s20, v0
    v_mul_u32_u24 v89, 43691, v88
    v_lshrrev_b32 v89, 19, v89
    v_mul_u32_u24 v90, 12, v89
    v_sub_u32 v88, v88, v90
    v_bfe_u32 v90, v89, 4, 1
    v_lshlrev_b32 v90, 1, v90
    v_xor_b32 v88, v88, v90
    v_mul_u32_u24 v74, 12288, v89
    v_lshlrev_b32 v88, 4, v88
    v_add_u32 v74, v74, v88
    s_mul_i32 s20, s16, 384
    s_add_u32 s20, s20, 128
    v_add_u32 v88, s20, v0
    v_mul_u32_u24 v89, 43691, v88
    v_lshrrev_b32 v89, 19, v89
    v_mul_u32_u24 v90, 12, v89
    v_sub_u32 v88, v88, v90
    v_bfe_u32 v90, v89, 4, 1
    v_lshlrev_b32 v90, 1, v90
    v_xor_b32 v88, v88, v90
    v_mul_u32_u24 v75, 12288, v89
    v_lshlrev_b32 v88, 4, v88
    v_add_u32 v75, v75, v88
    s_mul_i32 s20, s16, 384
    s_add_u32 s20, s20, 192
    v_add_u32 v88, s20, v0
    v_mul_u32_u24 v89, 43691, v88
    v_lshrrev_b32 v89, 19, v89
    v_mul_u32_u24 v90, 12, v89
    v_sub_u32 v88, v88, v90
    v_bfe_u32 v90, v89, 4, 1
    v_lshlrev_b32 v90, 1, v90
    v_xor_b32 v88, v88, v90
    v_mul_u32_u24 v76, 12288, v89
    v_lshlrev_b32 v88, 4, v88
    v_add_u32 v76, v76, v88
    s_mul_i32 s20, s16, 384
    s_add_u32 s20, s20, 256
    v_add_u32 v88, s20, v0
    v_mul_u32_u24 v89, 43691, v88
    v_lshrrev_b32 v89, 19, v89
    v_mul_u32_u24 v90, 12, v89
    v_sub_u32 v88, v88, v90
    v_bfe_u32 v90, v89, 4, 1
    v_lshlrev_b32 v90, 1, v90
    v_xor_b32 v88, v88, v90
    v_mul_u32_u24 v77, 12288, v89
    v_lshlrev_b32 v88, 4, v88
    v_add_u32 v77, v77, v88
    s_mul_i32 s20, s16, 384
    s_add_u32 s20, s20, 320
    v_add_u32 v88, s20, v0
    v_mul_u32_u24 v89, 43691, v88
    v_lshrrev_b32 v89, 19, v89
    v_mul_u32_u24 v90, 12, v89
    v_sub_u32 v88, v88, v90
    v_bfe_u32 v90, v89, 4, 1
    v_lshlrev_b32 v90, 1, v90
    v_xor_b32 v88, v88, v90
    v_mul_u32_u24 v78, 12288, v89
    v_lshlrev_b32 v88, 4, v88
    v_add_u32 v78, v78, v88
    s_load_dwordx2 s[8:9], s[96:97], 40
    s_mov_b32 s10, 7864320
    s_mov_b32 s11, 0x00020000
    s_waitcnt lgkmcnt(0)
    s_mul_i32 s20, s12, 384
    s_mul_i32 s21, s13, 192
    s_add_u32 s20, s20, s21
    s_add_u32 s20, s20, 0
    s_mul_i32 s21, s16, 6144
    s_add_u32 s21, s21, 98304
    s_mov_b32 m0, s21
    s_add_u32 s21, s21, 1024
    buffer_load_dwordx4 v73, s[8:11], s20 offen lds
    s_mov_b32 m0, s21
    s_add_u32 s21, s21, 1024
    buffer_load_dwordx4 v74, s[8:11], s20 offen lds
    s_mov_b32 m0, s21
    s_add_u32 s21, s21, 1024
    buffer_load_dwordx4 v75, s[8:11], s20 offen lds
    s_mov_b32 m0, s21
    s_add_u32 s21, s21, 1024
    buffer_load_dwordx4 v76, s[8:11], s20 offen lds
    s_mov_b32 m0, s21
    s_add_u32 s21, s21, 1024
    buffer_load_dwordx4 v77, s[8:11], s20 offen lds
    s_mov_b32 m0, s21
    s_add_u32 s21, s21, 1024
    buffer_load_dwordx4 v78, s[8:11], s20 offen lds
    s_load_dwordx2 s[8:9], s[96:97], 40
    s_mov_b32 s10, 7864320
    s_mov_b32 s11, 0x00020000
    s_waitcnt lgkmcnt(0)
    s_mul_i32 s20, s12, 384
    s_mul_i32 s21, s13, 192
    s_add_u32 s20, s20, s21
    s_add_u32 s20, s20, 1572864
    s_mul_i32 s21, s16, 6144
    s_add_u32 s21, s21, 0
    s_mov_b32 m0, s21
    s_add_u32 s21, s21, 1024
    buffer_load_dwordx4 v73, s[8:11], s20 offen lds
    s_mov_b32 m0, s21
    s_add_u32 s21, s21, 1024
    buffer_load_dwordx4 v74, s[8:11], s20 offen lds
    s_mov_b32 m0, s21
    s_add_u32 s21, s21, 1024
    buffer_load_dwordx4 v75, s[8:11], s20 offen lds
    s_mov_b32 m0, s21
    s_add_u32 s21, s21, 1024
    buffer_load_dwordx4 v76, s[8:11], s20 offen lds
    s_mov_b32 m0, s21
    s_add_u32 s21, s21, 1024
    buffer_load_dwordx4 v77, s[8:11], s20 offen lds
    s_mov_b32 m0, s21
    s_add_u32 s21, s21, 1024
    buffer_load_dwordx4 v78, s[8:11], s20 offen lds
    s_load_dwordx2 s[8:9], s[96:97], 40
    s_mov_b32 s10, 7864320
    s_mov_b32 s11, 0x00020000
    s_waitcnt lgkmcnt(0)
    s_mul_i32 s20, s12, 384
    s_mul_i32 s21, s13, 192
    s_add_u32 s20, s20, s21
    s_add_u32 s20, s20, 3145728
    s_mul_i32 s21, s16, 6144
    s_add_u32 s21, s21, 24576
    s_mov_b32 m0, s21
    s_add_u32 s21, s21, 1024
    buffer_load_dwordx4 v73, s[8:11], s20 offen lds
    s_mov_b32 m0, s21
    s_add_u32 s21, s21, 1024
    buffer_load_dwordx4 v74, s[8:11], s20 offen lds
    s_mov_b32 m0, s21
    s_add_u32 s21, s21, 1024
    buffer_load_dwordx4 v75, s[8:11], s20 offen lds
    s_mov_b32 m0, s21
    s_add_u32 s21, s21, 1024
    buffer_load_dwordx4 v76, s[8:11], s20 offen lds
    s_mov_b32 m0, s21
    s_add_u32 s21, s21, 1024
    buffer_load_dwordx4 v77, s[8:11], s20 offen lds
    s_mov_b32 m0, s21
    s_add_u32 s21, s21, 1024
    buffer_load_dwordx4 v78, s[8:11], s20 offen lds
    s_load_dwordx2 s[8:9], s[96:97], 40
    s_mov_b32 s10, 7864320
    s_mov_b32 s11, 0x00020000
    s_waitcnt lgkmcnt(0)
    s_mul_i32 s20, s12, 384
    s_mul_i32 s21, s13, 192
    s_add_u32 s20, s20, s21
    s_add_u32 s20, s20, 4718592
    s_mul_i32 s21, s16, 6144
    s_add_u32 s21, s21, 49152
    s_mov_b32 m0, s21
    s_add_u32 s21, s21, 1024
    buffer_load_dwordx4 v73, s[8:11], s20 offen lds
    s_mov_b32 m0, s21
    s_add_u32 s21, s21, 1024
    buffer_load_dwordx4 v74, s[8:11], s20 offen lds
    s_mov_b32 m0, s21
    s_add_u32 s21, s21, 1024
    buffer_load_dwordx4 v75, s[8:11], s20 offen lds
    s_mov_b32 m0, s21
    s_add_u32 s21, s21, 1024
    buffer_load_dwordx4 v76, s[8:11], s20 offen lds
    s_mov_b32 m0, s21
    s_add_u32 s21, s21, 1024
    buffer_load_dwordx4 v77, s[8:11], s20 offen lds
    s_mov_b32 m0, s21
    s_add_u32 s21, s21, 1024
    buffer_load_dwordx4 v78, s[8:11], s20 offen lds
    s_load_dwordx2 s[8:9], s[96:97], 40
    s_mov_b32 s10, 7864320
    s_mov_b32 s11, 0x00020000
    s_waitcnt lgkmcnt(0)
    s_mul_i32 s20, s12, 384
    s_mul_i32 s21, s13, 192
    s_add_u32 s20, s20, s21
    s_add_u32 s20, s20, 6291456
    s_mul_i32 s21, s16, 6144
    s_add_u32 s21, s21, 73728
    s_mov_b32 m0, s21
    s_add_u32 s21, s21, 1024
    buffer_load_dwordx4 v73, s[8:11], s20 offen lds
    s_mov_b32 m0, s21
    s_add_u32 s21, s21, 1024
    buffer_load_dwordx4 v74, s[8:11], s20 offen lds
    s_mov_b32 m0, s21
    s_add_u32 s21, s21, 1024
    buffer_load_dwordx4 v75, s[8:11], s20 offen lds
    s_mov_b32 m0, s21
    s_add_u32 s21, s21, 1024
    buffer_load_dwordx4 v76, s[8:11], s20 offen lds
    s_mov_b32 m0, s21
    s_add_u32 s21, s21, 1024
    buffer_load_dwordx4 v77, s[8:11], s20 offen lds
    s_mov_b32 m0, s21
    s_add_u32 s21, s21, 1024
    buffer_load_dwordx4 v78, s[8:11], s20 offen lds
Lsp_10:
    s_lshl_b32 s20, s16, 8
    v_lshlrev_b32 v68, 2, v0
    v_add_u32 v68, s20, v68
    s_mov_b32 s42, s40
    s_mov_b32 s43, s41
    global_load_dword v5, v68, s[42:43]
    s_add_u32 s42, s42, 1024
    s_addc_u32 s43, s43, 0
    global_load_dword v6, v68, s[42:43]
    s_add_u32 s42, s42, 1024
    s_addc_u32 s43, s43, 0
    global_load_dword v7, v68, s[42:43]
    s_add_u32 s42, s42, 1024
    s_addc_u32 s43, s43, 0
    global_load_dword v8, v68, s[42:43]
    s_add_u32 s42, s42, 1024
    s_addc_u32 s43, s43, 0
    global_load_dword v9, v68, s[42:43]
    s_add_u32 s42, s42, 1024
    s_addc_u32 s43, s43, 0
    global_load_dword v12, v68, s[42:43]
    s_add_u32 s42, s42, 1024
    s_addc_u32 s43, s43, 0
    global_load_dword v13, v68, s[42:43]
    s_add_u32 s42, s42, 1024
    s_addc_u32 s43, s43, 0
    global_load_dword v27, v68, s[42:43]
    s_add_u32 s42, s42, 1024
    s_addc_u32 s43, s43, 0
    global_load_dword v28, v68, s[42:43]
    s_add_u32 s42, s42, 1024
    s_addc_u32 s43, s43, 0
    global_load_dword v17, v68, s[42:43]
    s_add_u32 s42, s42, 1024
    s_addc_u32 s43, s43, 0
    global_load_dword v18, v68, s[42:43]
    s_add_u32 s42, s42, 1024
    s_addc_u32 s43, s43, 0
    global_load_dword v19, v68, s[42:43]
    s_add_u32 s42, s42, 1024
    s_addc_u32 s43, s43, 0
    global_load_dword v20, v68, s[42:43]
    s_add_u32 s42, s42, 1024
    s_addc_u32 s43, s43, 0
    global_load_dword v21, v68, s[42:43]
    s_add_u32 s42, s42, 1024
    s_addc_u32 s43, s43, 0
    global_load_dword v22, v68, s[42:43]
    s_add_u32 s42, s42, 1024
    s_addc_u32 s43, s43, 0
    global_load_dword v23, v68, s[42:43]
    s_add_u32 s42, s42, 1024
    s_addc_u32 s43, s43, 0
    global_load_dword v24, v68, s[42:43]
    s_add_u32 s42, s42, 1024
    s_addc_u32 s43, s43, 0
    global_load_dword v25, v68, s[42:43]
    s_add_u32 s42, s42, 1024
    s_addc_u32 s43, s43, 0
    global_load_dword v26, v68, s[42:43]
    s_add_u32 s42, s42, 1024
    s_addc_u32 s43, s43, 0
    global_load_dword v70, v68, s[42:43]
    s_add_u32 s42, s42, 1024
    s_addc_u32 s43, s43, 0
    global_load_dword v71, v68, s[42:43]
    s_add_u32 s42, s42, 1024
    s_addc_u32 s43, s43, 0
    global_load_dword v72, v68, s[42:43]
    s_add_u32 s42, s42, 1024
    s_addc_u32 s43, s43, 0
    global_load_dword v98, v68, s[42:43]
    s_add_u32 s42, s42, 1024
    s_addc_u32 s43, s43, 0
    global_load_dword v99, v68, s[42:43]
    s_add_u32 s42, s42, 1024
    s_addc_u32 s43, s43, 0
    global_load_dword v100, v68, s[42:43]
    s_add_u32 s42, s42, 1024
    s_addc_u32 s43, s43, 0
    global_load_dword v101, v68, s[42:43]
    s_add_u32 s42, s42, 1024
    s_addc_u32 s43, s43, 0
    global_load_dword v102, v68, s[42:43]
    s_add_u32 s42, s42, 1024
    s_addc_u32 s43, s43, 0
    global_load_dword v103, v68, s[42:43]
    s_add_u32 s42, s42, 1024
    s_addc_u32 s43, s43, 0
    global_load_dword v79, v68, s[42:43]
    s_add_u32 s42, s42, 1024
    s_addc_u32 s43, s43, 0
    global_load_dword v80, v68, s[42:43]
    s_add_u32 s42, s42, 1024
    s_addc_u32 s43, s43, 0
    global_load_dword v81, v68, s[42:43]
    s_add_u32 s42, s42, 1024
    s_addc_u32 s43, s43, 0
    global_load_dword v82, v68, s[42:43]
    s_add_u32 s42, s42, 1024
    s_addc_u32 s43, s43, 0
    global_load_dword v83, v68, s[42:43]
    s_add_u32 s42, s42, 1024
    s_addc_u32 s43, s43, 0
    global_load_dword v84, v68, s[42:43]
    s_add_u32 s42, s42, 1024
    s_addc_u32 s43, s43, 0
    v_lshlrev_b32 v1, 4, v0
    s_mul_i32 s20, s16, 2560
    s_add_u32 s20, s20, 122880
    v_add_u32 v2, s20, v1
    v_add_u32 v4, 122880, v1
    v_lshlrev_b32 v16, 3, v0
    v_add_u32 v16, 134144, v16
    v_and_b32 v30, 1, v0
    v_cmp_eq_u32 vcc, 1, v30
    v_mov_b32 v30, 0x4444
    v_mov_b32 v69, 0xeeee
    s_nop 1
    v_cndmask_b32 v30, v30, v69, vcc
    v_mov_b32 v31, 0x05040100
    v_mov_b32 v69, 0x03020706
    v_cndmask_b32 v31, v31, v69, vcc
    s_waitcnt vmcnt(0)
    v_add_u32 v10, 61440, v8
    v_add_u32 v11, 61440, v9
    s_lshl_b32 s20, s31, 11
    s_add_u32 s20, s20, 0
    v_add_u32 v13, s20, v13
    s_xor_b32 s20, s31, 1
    s_lshl_b32 s20, s20, 11
    s_add_u32 s20, s20, 0
    v_add_u32 v15, s20, v1
    s_mul_i32 s20, s14, 327680
    s_add_u32 s20, s20, 393216
    s_mul_i32 s21, s13, 81920
    s_add_u32 s21, s21, s20
    s_and_b32 s22, s12, 15
    s_mul_i32 s23, s13, 40
    s_add_u32 s22, s22, s23
    v_lshrrev_b32 v89, 11, v24
    v_add_u32 v89, s22, v89
    v_and_b32 v89, 15, v89
    v_lshlrev_b32 v89, 7, v89
    v_add_u32 v24, v24, v89
    v_add_u32 v24, s21, v24
    v_lshrrev_b32 v89, 11, v25
    v_add_u32 v89, s22, v89
    v_and_b32 v89, 15, v89
    v_lshlrev_b32 v89, 7, v89
    v_add_u32 v25, v25, v89
    v_add_u32 v25, s21, v25
    v_lshrrev_b32 v89, 11, v26
    v_add_u32 v89, s22, v89
    v_and_b32 v89, 15, v89
    v_lshlrev_b32 v89, 7, v89
    v_add_u32 v26, v26, v89
    v_add_u32 v26, s21, v26
    s_lshl_b32 s21, s99, 11
    s_add_u32 s21, s21, s20
    v_add_u32 v27, s21, v27
    v_bfe_u32 v88, v0, 3, 1
    v_lshlrev_b32 v88, 6, v88
    v_bfe_u32 v89, v0, 4, 1
    v_lshlrev_b32 v89, 5, v89
    v_add_u32 v88, v88, v89
    v_and_b32 v89, 7, v0
    v_lshlrev_b32 v89, 2, v89
    v_add_u32 v88, v88, v89
    s_lshl_b32 s21, s99, 7
    v_add_u32 v28, s21, v88
    s_mul_i32 s20, s16, 2560
    v_add_u32 v3, s20, v1
    v_lshlrev_b32 v29, 4, v0
    s_mul_i32 s20, s13, 1536
    v_add_u32 v19, s20, v19
    v_mov_b32 v98, 0x3f803f80
    v_mov_b32 v99, 0
    v_mov_b32 v100, -1
    v_accvgpr_write_b32 a240, v98
    v_accvgpr_write_b32 a241, v98
    v_accvgpr_write_b32 a242, v98
    v_accvgpr_write_b32 a243, v98
    v_accvgpr_write_b32 a244, v99
    v_accvgpr_write_b32 a245, v99
    v_accvgpr_write_b32 a246, v99
    v_accvgpr_write_b32 a247, v99
    v_accvgpr_write_b32 a248, v100
    v_accvgpr_write_b32 a249, v100
    v_accvgpr_write_b32 a250, v100
    v_accvgpr_write_b32 a251, v100
    v_and_b32 v101, 15, v0
    v_mov_b32 v102, 0
    v_mov_b32 v103, 0x3f80
    v_mov_b32 v104, 0x3f800000
    v_cmp_eq_u32 vcc, 0, v101
    s_nop 1
    v_cndmask_b32 v105, v102, v103, vcc
    v_cmp_eq_u32 vcc, 1, v101
    s_nop 1
    v_cndmask_b32 v105, v105, v104, vcc
    v_accvgpr_write_b32 a252, v105
    v_mov_b32 v102, 0
    v_mov_b32 v103, 0x3f80
    v_mov_b32 v104, 0x3f800000
    v_cmp_eq_u32 vcc, 2, v101
    s_nop 1
    v_cndmask_b32 v105, v102, v103, vcc
    v_cmp_eq_u32 vcc, 3, v101
    s_nop 1
    v_cndmask_b32 v105, v105, v104, vcc
    v_accvgpr_write_b32 a253, v105
    v_mov_b32 v102, 0
    v_mov_b32 v103, 0x3f80
    v_mov_b32 v104, 0x3f800000
    v_cmp_eq_u32 vcc, 0, v101
    s_nop 1
    v_cndmask_b32 v105, v102, v103, vcc
    v_cmp_eq_u32 vcc, 1, v101
    s_nop 1
    v_cndmask_b32 v105, v105, v104, vcc
    v_accvgpr_write_b32 a254, v105
    v_mov_b32 v102, 0
    v_mov_b32 v103, 0x3f80
    v_mov_b32 v104, 0x3f800000
    v_cmp_eq_u32 vcc, 2, v101
    s_nop 1
    v_cndmask_b32 v105, v102, v103, vcc
    v_cmp_eq_u32 vcc, 3, v101
    s_nop 1
    v_cndmask_b32 v105, v105, v104, vcc
    v_accvgpr_write_b32 a255, v105
    s_mov_b64 exec, s[36:37]
    v_accvgpr_write_b32 a244, v98
    v_accvgpr_write_b32 a245, v98
    s_mov_b64 exec, -1
    s_cmp_eq_u32 s16, 0
    s_cbranch_scc0 Li_13
    v_mov_b32 v98, 0xf149f2ca
    v_mov_b32 v99, 0xf149f2ca
    v_mov_b32 v100, 0xf149f2ca
    v_mov_b32 v101, 0xf149f2ca
    s_lshl_b32 s20, s31, 11
    s_add_u32 s20, s20, 0
    v_add_u32 v102, s20, v1
    s_mov_b32 s19, 117440512
    s_cmp_eq_u32 s25, 0
    s_cbranch_scc1 Lst_14
    buffer_store_dwordx4 v[98:101], v102, s[4:7], s19 offen
    s_branch Lst_15
Lst_14:
    buffer_store_dwordx4 v[98:101], v102, s[4:7], s19 offen sc1
Lst_15:
    s_cmp_eq_u32 s25, 0
    s_cbranch_scc1 Lst_16
    buffer_store_dwordx4 v[98:101], v102, s[4:7], s19 offen offset:1024
    s_branch Lst_17
Lst_16:
    buffer_store_dwordx4 v[98:101], v102, s[4:7], s19 offen offset:1024 sc1
Lst_17:
    s_mov_b32 s19, 119537664
    s_cmp_eq_u32 s25, 0
    s_cbranch_scc1 Lst_18
    buffer_store_dwordx4 v[98:101], v102, s[4:7], s19 offen
    s_branch Lst_19
Lst_18:
    buffer_store_dwordx4 v[98:101], v102, s[4:7], s19 offen sc1
Lst_19:
    s_cmp_eq_u32 s25, 0
    s_cbranch_scc1 Lst_20
    buffer_store_dwordx4 v[98:101], v102, s[4:7], s19 offen offset:1024
    s_branch Lst_21
Lst_20:
    buffer_store_dwordx4 v[98:101], v102, s[4:7], s19 offen offset:1024 sc1
Lst_21:
    s_mov_b32 s19, 121634816
    s_cmp_eq_u32 s25, 0
    s_cbranch_scc1 Lst_22
    buffer_store_dwordx4 v[98:101], v102, s[4:7], s19 offen
    s_branch Lst_23
Lst_22:
    buffer_store_dwordx4 v[98:101], v102, s[4:7], s19 offen sc1
Lst_23:
    s_cmp_eq_u32 s25, 0
    s_cbranch_scc1 Lst_24
    buffer_store_dwordx4 v[98:101], v102, s[4:7], s19 offen offset:1024
    s_branch Lst_25
Lst_24:
    buffer_store_dwordx4 v[98:101], v102, s[4:7], s19 offen offset:1024 sc1
Lst_25:
    s_mov_b32 s19, 123731968
    s_cmp_eq_u32 s25, 0
    s_cbranch_scc1 Lst_26
    buffer_store_dwordx4 v[98:101], v102, s[4:7], s19 offen
    s_branch Lst_27
Lst_26:
    buffer_store_dwordx4 v[98:101], v102, s[4:7], s19 offen sc1
Lst_27:
    s_cmp_eq_u32 s25, 0
    s_cbranch_scc1 Lst_28
    buffer_store_dwordx4 v[98:101], v102, s[4:7], s19 offen offset:1024
    s_branch Lst_29
Lst_28:
    buffer_store_dwordx4 v[98:101], v102, s[4:7], s19 offen offset:1024 sc1
Lst_29:
Li_13:
    s_waitcnt vmcnt(24)
    s_barrier
    s_mov_b32 s26, 117440512
    s_mov_b32 s63, 0
    s_cmp_lt_u32 s16, 2
    s_cbranch_scc0 Li_30
    s_add_u32 s20, s26, s58
    s_mov_b64 exec, s[100:101]
    s_cmp_eq_u32 s25, 0
    s_cbranch_scc1 Lst_31
    buffer_store_dword a248, v28, s[4:7], s20 offen
    s_branch Lst_32
Lst_31:
    buffer_store_dword a248, v28, s[4:7], s20 offen sc1
Lst_32:
    s_mov_b64 exec, -1
    s_cmp_eq_u32 s25, 0
    s_cbranch_scc1 Lst_33
    buffer_store_dword a248, v13, s[4:7], s26 offen
    s_branch Lst_34
Lst_33:
    buffer_store_dword a248, v13, s[4:7], s26 offen sc1
Lst_34:
    s_cmp_eq_u32 s25, 0
    s_cbranch_scc1 Lst_35
    buffer_store_dword a248, v13, s[4:7], s26 offen offset:32
    s_branch Lst_36
Lst_35:
    buffer_store_dword a248, v13, s[4:7], s26 offen offset:32 sc1
Lst_36:
    s_lshl_b32 s20, s12, 12
    s_add_u32 s20, s20, 131072
    s_add_u32 s20, s20, s26
    s_cmp_eq_u32 s25, 0
    s_cbranch_scc1 Lst_37
    buffer_store_dword a248, v19, s[4:7], s20 offen
    s_branch Lst_38
Lst_37:
    buffer_store_dword a248, v19, s[4:7], s20 offen sc1
Lst_38:
    s_cmp_eq_u32 s25, 0
    s_cbranch_scc1 Lst_39
    buffer_store_dwordx2 a[248:249], v24, s[4:7], s26 offen
    s_branch Lst_40
Lst_39:
    buffer_store_dwordx2 a[248:249], v24, s[4:7], s26 offen sc1
Lst_40:
    s_cmp_eq_u32 s25, 0
    s_cbranch_scc1 Lst_41
    buffer_store_dwordx2 a[248:249], v25, s[4:7], s26 offen
    s_branch Lst_42
Lst_41:
    buffer_store_dwordx2 a[248:249], v25, s[4:7], s26 offen sc1
Lst_42:
    s_cmp_eq_u32 s25, 0
    s_cbranch_scc1 Lst_43
    buffer_store_dwordx2 a[248:249], v26, s[4:7], s26 offen
    s_branch Lst_44
Lst_43:
    buffer_store_dwordx2 a[248:249], v26, s[4:7], s26 offen sc1
Lst_44:
    s_add_u32 s21, s63, s59
    s_mov_b64 exec, s[56:57]
    buffer_store_dwordx4 a[248:251], v29, s[4:7], s21 offen sc1
    s_mov_b64 exec, -1
Li_30:
    s_cmp_eq_u32 s16, 2
    s_cbranch_scc0 Li_45
    s_cmp_eq_u32 s88, 0
    s_cbranch_scc1 Lr_48
    s_add_u32 s20, s26, s58
    s_mov_b64 exec, s[100:101]
    s_cmp_eq_u32 s25, 0
    s_cbranch_scc1 Lst_46
    buffer_store_dword a248, v28, s[4:7], s20 offen
    s_branch Lst_47
Lst_46:
    buffer_store_dword a248, v28, s[4:7], s20 offen sc1
Lst_47:
    s_mov_b64 exec, -1
Lr_48:
    s_mov_b64 exec, s[38:39]
    s_cmp_eq_u32 s25, 0
    s_cbranch_scc1 Lst_50
    buffer_store_dword a248, v13, s[4:7], s26 offen
    s_branch Lst_51
Lst_50:
    buffer_store_dword a248, v13, s[4:7], s26 offen sc1
Lst_51:
    s_cmp_eq_u32 s25, 0
    s_cbranch_scc1 Lst_52
    buffer_store_dword a248, v13, s[4:7], s26 offen offset:32
    s_branch Lst_53
Lst_52:
    buffer_store_dword a248, v13, s[4:7], s26 offen offset:32 sc1
Lst_53:
    s_mov_b64 exec, -1
    s_lshl_b32 s20, s12, 12
    s_add_u32 s20, s20, 131072
    s_add_u32 s20, s20, s26
    s_cmp_eq_u32 s25, 0
    s_cbranch_scc1 Lst_54
    buffer_store_dword a248, v19, s[4:7], s20 offen
    s_branch Lst_55
Lst_54:
    buffer_store_dword a248, v19, s[4:7], s20 offen sc1
Lst_55:
    s_cmp_eq_u32 s25, 0
    s_cbranch_scc1 Lst_56
    buffer_store_dword a248, v19, s[4:7], s20 offen offset:256
    s_branch Lst_57
Lst_56:
    buffer_store_dword a248, v19, s[4:7], s20 offen offset:256 sc1
Lst_57:
    s_cmp_eq_u32 s25, 0
    s_cbranch_scc1 Lst_58
    buffer_store_dwordx2 a[248:249], v25, s[4:7], s26 offen
    s_branch Lst_59
Lst_58:
    buffer_store_dwordx2 a[248:249], v25, s[4:7], s26 offen sc1
Lst_59:
    s_cmp_eq_u32 s25, 0
    s_cbranch_scc1 Lst_60
    buffer_store_dwordx2 a[248:249], v26, s[4:7], s26 offen
    s_branch Lst_61
Lst_60:
    buffer_store_dwordx2 a[248:249], v26, s[4:7], s26 offen sc1
Lst_61:
    s_cmp_eq_u32 s88, 0
    s_cbranch_scc1 Lr_49
    s_add_u32 s21, s63, s59
    s_mov_b64 exec, s[56:57]
    buffer_store_dwordx4 a[248:251], v29, s[4:7], s21 offen sc1
    s_mov_b64 exec, -1
Lr_49:
Li_45:
    s_cmp_eq_u32 s16, 3
    s_cbranch_scc0 Li_62
    s_lshl_b32 s20, s12, 12
    s_add_u32 s20, s20, 131072
    s_add_u32 s20, s20, s26
    s_cmp_eq_u32 s25, 0
    s_cbranch_scc1 Lst_65
    buffer_store_dword a248, v19, s[4:7], s20 offen
    s_branch Lst_66
Lst_65:
    buffer_store_dword a248, v19, s[4:7], s20 offen sc1
Lst_66:
    s_cmp_eq_u32 s25, 0
    s_cbranch_scc1 Lst_67
    buffer_store_dword a248, v19, s[4:7], s20 offen offset:256
    s_branch Lst_68
Lst_67:
    buffer_store_dword a248, v19, s[4:7], s20 offen offset:256 sc1
Lst_68:
    s_cmp_eq_u32 s25, 0
    s_cbranch_scc1 Lst_69
    buffer_store_dwordx2 a[248:249], v25, s[4:7], s26 offen
    s_branch Lst_70
Lst_69:
    buffer_store_dwordx2 a[248:249], v25, s[4:7], s26 offen sc1
Lst_70:
    s_cmp_eq_u32 s25, 0
    s_cbranch_scc1 Lst_71
    buffer_store_dwordx2 a[248:249], v26, s[4:7], s26 offen
    s_branch Lst_72
Lst_71:
    buffer_store_dwordx2 a[248:249], v26, s[4:7], s26 offen sc1
Lst_72:
Li_62:
    s_add_u32 s59, s59, 8192
    s_cmp_eq_u32 s88, 0
    s_cbranch_scc1 Lr_76
    s_add_u32 s21, s63, s59
    s_mov_b64 exec, s[56:57]
    buffer_store_dwordx4 a[248:251], v29, s[4:7], s21 offen sc1
    s_mov_b64 exec, -1
Lr_76:
    s_sub_u32 s59, s59, 8192
    s_mov_b32 s26, 119537664
    s_mov_b32 s63, 131072
    s_cmp_lt_u32 s16, 2
    s_cbranch_scc0 Li_89
    s_add_u32 s20, s26, s58
    s_mov_b64 exec, s[100:101]
    s_cmp_eq_u32 s25, 0
    s_cbranch_scc1 Lst_90
    buffer_store_dword a248, v28, s[4:7], s20 offen
    s_branch Lst_91
Lst_90:
    buffer_store_dword a248, v28, s[4:7], s20 offen sc1
Lst_91:
    s_mov_b64 exec, -1
    s_cmp_eq_u32 s25, 0
    s_cbranch_scc1 Lst_92
    buffer_store_dword a248, v13, s[4:7], s26 offen
    s_branch Lst_93
Lst_92:
    buffer_store_dword a248, v13, s[4:7], s26 offen sc1
Lst_93:
    s_cmp_eq_u32 s25, 0
    s_cbranch_scc1 Lst_94
    buffer_store_dword a248, v13, s[4:7], s26 offen offset:32
    s_branch Lst_95
Lst_94:
    buffer_store_dword a248, v13, s[4:7], s26 offen offset:32 sc1
Lst_95:
    s_lshl_b32 s20, s12, 12
    s_add_u32 s20, s20, 131072
    s_add_u32 s20, s20, s26
    s_cmp_eq_u32 s25, 0
    s_cbranch_scc1 Lst_96
    buffer_store_dword a248, v19, s[4:7], s20 offen
    s_branch Lst_97
Lst_96:
    buffer_store_dword a248, v19, s[4:7], s20 offen sc1
Lst_97:
    s_cmp_eq_u32 s25, 0
    s_cbranch_scc1 Lst_98
    buffer_store_dwordx2 a[248:249], v24, s[4:7], s26 offen
    s_branch Lst_99
Lst_98:
    buffer_store_dwordx2 a[248:249], v24, s[4:7], s26 offen sc1
Lst_99:
    s_cmp_eq_u32 s25, 0
    s_cbranch_scc1 Lst_100
    buffer_store_dwordx2 a[248:249], v25, s[4:7], s26 offen
    s_branch Lst_101
Lst_100:
    buffer_store_dwordx2 a[248:249], v25, s[4:7], s26 offen sc1
Lst_101:
    s_cmp_eq_u32 s25, 0
    s_cbranch_scc1 Lst_102
    buffer_store_dwordx2 a[248:249], v26, s[4:7], s26 offen
    s_branch Lst_103
Lst_102:
    buffer_store_dwordx2 a[248:249], v26, s[4:7], s26 offen sc1
Lst_103:
    s_add_u32 s21, s63, s59
    s_mov_b64 exec, s[56:57]
    buffer_store_dwordx4 a[248:251], v29, s[4:7], s21 offen sc1
    s_mov_b64 exec, -1
Li_89:
    s_cmp_eq_u32 s16, 2
    s_cbranch_scc0 Li_104
    s_cmp_eq_u32 s88, 0
    s_cbranch_scc1 Lr_107
    s_add_u32 s20, s26, s58
    s_mov_b64 exec, s[100:101]
    s_cmp_eq_u32 s25, 0
    s_cbranch_scc1 Lst_105
    buffer_store_dword a248, v28, s[4:7], s20 offen
    s_branch Lst_106
Lst_105:
    buffer_store_dword a248, v28, s[4:7], s20 offen sc1
Lst_106:
    s_mov_b64 exec, -1
Lr_107:
    s_mov_b64 exec, s[38:39]
    s_cmp_eq_u32 s25, 0
    s_cbranch_scc1 Lst_109
    buffer_store_dword a248, v13, s[4:7], s26 offen
    s_branch Lst_110
Lst_109:
    buffer_store_dword a248, v13, s[4:7], s26 offen sc1
Lst_110:
    s_cmp_eq_u32 s25, 0
    s_cbranch_scc1 Lst_111
    buffer_store_dword a248, v13, s[4:7], s26 offen offset:32
    s_branch Lst_112
Lst_111:
    buffer_store_dword a248, v13, s[4:7], s26 offen offset:32 sc1
Lst_112:
    s_mov_b64 exec, -1
    s_lshl_b32 s20, s12, 12
    s_add_u32 s20, s20, 131072
    s_add_u32 s20, s20, s26
    s_cmp_eq_u32 s25, 0
    s_cbranch_scc1 Lst_113
    buffer_store_dword a248, v19, s[4:7], s20 offen
    s_branch Lst_114
Lst_113:
    buffer_store_dword a248, v19, s[4:7], s20 offen sc1
Lst_114:
    s_cmp_eq_u32 s25, 0
    s_cbranch_scc1 Lst_115
    buffer_store_dword a248, v19, s[4:7], s20 offen offset:256
    s_branch Lst_116
Lst_115:
    buffer_store_dword a248, v19, s[4:7], s20 offen offset:256 sc1
Lst_116:
    s_cmp_eq_u32 s25, 0
    s_cbranch_scc1 Lst_117
    buffer_store_dwordx2 a[248:249], v25, s[4:7], s26 offen
    s_branch Lst_118
Lst_117:
    buffer_store_dwordx2 a[248:249], v25, s[4:7], s26 offen sc1
Lst_118:
    s_cmp_eq_u32 s25, 0
    s_cbranch_scc1 Lst_119
    buffer_store_dwordx2 a[248:249], v26, s[4:7], s26 offen
    s_branch Lst_120
Lst_119:
    buffer_store_dwordx2 a[248:249], v26, s[4:7], s26 offen sc1
Lst_120:
    s_cmp_eq_u32 s88, 0
    s_cbranch_scc1 Lr_108
    s_add_u32 s21, s63, s59
    s_mov_b64 exec, s[56:57]
    buffer_store_dwordx4 a[248:251], v29, s[4:7], s21 offen sc1
    s_mov_b64 exec, -1
Lr_108:
Li_104:
    s_cmp_eq_u32 s16, 3
    s_cbranch_scc0 Li_121
    s_lshl_b32 s20, s12, 12
    s_add_u32 s20, s20, 131072
    s_add_u32 s20, s20, s26
    s_cmp_eq_u32 s25, 0
    s_cbranch_scc1 Lst_124
    buffer_store_dword a248, v19, s[4:7], s20 offen
    s_branch Lst_125
Lst_124:
    buffer_store_dword a248, v19, s[4:7], s20 offen sc1
Lst_125:
    s_cmp_eq_u32 s25, 0
    s_cbranch_scc1 Lst_126
    buffer_store_dword a248, v19, s[4:7], s20 offen offset:256
    s_branch Lst_127
Lst_126:
    buffer_store_dword a248, v19, s[4:7], s20 offen offset:256 sc1
Lst_127:
    s_cmp_eq_u32 s25, 0
    s_cbranch_scc1 Lst_128
    buffer_store_dwordx2 a[248:249], v25, s[4:7], s26 offen
    s_branch Lst_129
Lst_128:
    buffer_store_dwordx2 a[248:249], v25, s[4:7], s26 offen sc1
Lst_129:
    s_cmp_eq_u32 s25, 0
    s_cbranch_scc1 Lst_130
    buffer_store_dwordx2 a[248:249], v26, s[4:7], s26 offen
    s_branch Lst_131
Lst_130:
    buffer_store_dwordx2 a[248:249], v26, s[4:7], s26 offen sc1
Lst_131:
Li_121:
    s_add_u32 s59, s59, 8192
    s_cmp_eq_u32 s88, 0
    s_cbranch_scc1 Lr_135
    s_add_u32 s21, s63, s59
    s_mov_b64 exec, s[56:57]
    buffer_store_dwordx4 a[248:251], v29, s[4:7], s21 offen sc1
    s_mov_b64 exec, -1
Lr_135:
    s_sub_u32 s59, s59, 8192
    s_mov_b32 s26, 121634816
    s_mov_b32 s63, 262144
    s_cmp_lt_u32 s16, 2
    s_cbranch_scc0 Li_148
    s_add_u32 s20, s26, s58
    s_mov_b64 exec, s[100:101]
    s_cmp_eq_u32 s25, 0
    s_cbranch_scc1 Lst_149
    buffer_store_dword a248, v28, s[4:7], s20 offen
    s_branch Lst_150
Lst_149:
    buffer_store_dword a248, v28, s[4:7], s20 offen sc1
Lst_150:
    s_mov_b64 exec, -1
    s_cmp_eq_u32 s25, 0
    s_cbranch_scc1 Lst_151
    buffer_store_dword a248, v13, s[4:7], s26 offen
    s_branch Lst_152
Lst_151:
    buffer_store_dword a248, v13, s[4:7], s26 offen sc1
Lst_152:
    s_cmp_eq_u32 s25, 0
    s_cbranch_scc1 Lst_153
    buffer_store_dword a248, v13, s[4:7], s26 offen offset:32
    s_branch Lst_154
Lst_153:
    buffer_store_dword a248, v13, s[4:7], s26 offen offset:32 sc1
Lst_154:
    s_lshl_b32 s20, s12, 12
    s_add_u32 s20, s20, 131072
    s_add_u32 s20, s20, s26
    s_cmp_eq_u32 s25, 0
    s_cbranch_scc1 Lst_155
    buffer_store_dword a248, v19, s[4:7], s20 offen
    s_branch Lst_156
Lst_155:
    buffer_store_dword a248, v19, s[4:7], s20 offen sc1
Lst_156:
    s_cmp_eq_u32 s25, 0
    s_cbranch_scc1 Lst_157
    buffer_store_dwordx2 a[248:249], v24, s[4:7], s26 offen
    s_branch Lst_158
Lst_157:
    buffer_store_dwordx2 a[248:249], v24, s[4:7], s26 offen sc1
Lst_158:
    s_cmp_eq_u32 s25, 0
    s_cbranch_scc1 Lst_159
    buffer_store_dwordx2 a[248:249], v25, s[4:7], s26 offen
    s_branch Lst_160
Lst_159:
    buffer_store_dwordx2 a[248:249], v25, s[4:7], s26 offen sc1
Lst_160:
    s_cmp_eq_u32 s25, 0
    s_cbranch_scc1 Lst_161
    buffer_store_dwordx2 a[248:249], v26, s[4:7], s26 offen
    s_branch Lst_162
Lst_161:
    buffer_store_dwordx2 a[248:249], v26, s[4:7], s26 offen sc1
Lst_162:
    s_add_u32 s21, s63, s59
    s_mov_b64 exec, s[56:57]
    buffer_store_dwordx4 a[248:251], v29, s[4:7], s21 offen sc1
    s_mov_b64 exec, -1
Li_148:
    s_cmp_eq_u32 s16, 2
    s_cbranch_scc0 Li_163
    s_cmp_eq_u32 s88, 0
    s_cbranch_scc1 Lr_166
    s_add_u32 s20, s26, s58
    s_mov_b64 exec, s[100:101]
    s_cmp_eq_u32 s25, 0
    s_cbranch_scc1 Lst_164
    buffer_store_dword a248, v28, s[4:7], s20 offen
    s_branch Lst_165
Lst_164:
    buffer_store_dword a248, v28, s[4:7], s20 offen sc1
Lst_165:
    s_mov_b64 exec, -1
Lr_166:
    s_mov_b64 exec, s[38:39]
    s_cmp_eq_u32 s25, 0
    s_cbranch_scc1 Lst_168
    buffer_store_dword a248, v13, s[4:7], s26 offen
    s_branch Lst_169
Lst_168:
    buffer_store_dword a248, v13, s[4:7], s26 offen sc1
Lst_169:
    s_cmp_eq_u32 s25, 0
    s_cbranch_scc1 Lst_170
    buffer_store_dword a248, v13, s[4:7], s26 offen offset:32
    s_branch Lst_171
Lst_170:
    buffer_store_dword a248, v13, s[4:7], s26 offen offset:32 sc1
Lst_171:
    s_mov_b64 exec, -1
    s_lshl_b32 s20, s12, 12
    s_add_u32 s20, s20, 131072
    s_add_u32 s20, s20, s26
    s_cmp_eq_u32 s25, 0
    s_cbranch_scc1 Lst_172
    buffer_store_dword a248, v19, s[4:7], s20 offen
    s_branch Lst_173
Lst_172:
    buffer_store_dword a248, v19, s[4:7], s20 offen sc1
Lst_173:
    s_cmp_eq_u32 s25, 0
    s_cbranch_scc1 Lst_174
    buffer_store_dword a248, v19, s[4:7], s20 offen offset:256
    s_branch Lst_175
Lst_174:
    buffer_store_dword a248, v19, s[4:7], s20 offen offset:256 sc1
Lst_175:
    s_cmp_eq_u32 s25, 0
    s_cbranch_scc1 Lst_176
    buffer_store_dwordx2 a[248:249], v25, s[4:7], s26 offen
    s_branch Lst_177
Lst_176:
    buffer_store_dwordx2 a[248:249], v25, s[4:7], s26 offen sc1
Lst_177:
    s_cmp_eq_u32 s25, 0
    s_cbranch_scc1 Lst_178
    buffer_store_dwordx2 a[248:249], v26, s[4:7], s26 offen
    s_branch Lst_179
Lst_178:
    buffer_store_dwordx2 a[248:249], v26, s[4:7], s26 offen sc1
Lst_179:
    s_cmp_eq_u32 s88, 0
    s_cbranch_scc1 Lr_167
    s_add_u32 s21, s63, s59
    s_mov_b64 exec, s[56:57]
    buffer_store_dwordx4 a[248:251], v29, s[4:7], s21 offen sc1
    s_mov_b64 exec, -1
Lr_167:
Li_163:
    s_cmp_eq_u32 s16, 3
    s_cbranch_scc0 Li_180
    s_lshl_b32 s20, s12, 12
    s_add_u32 s20, s20, 131072
    s_add_u32 s20, s20, s26
    s_cmp_eq_u32 s25, 0
    s_cbranch_scc1 Lst_183
    buffer_store_dword a248, v19, s[4:7], s20 offen
    s_branch Lst_184
Lst_183:
    buffer_store_dword a248, v19, s[4:7], s20 offen sc1
Lst_184:
    s_cmp_eq_u32 s25, 0
    s_cbranch_scc1 Lst_185
    buffer_store_dword a248, v19, s[4:7], s20 offen offset:256
    s_branch Lst_186
Lst_185:
    buffer_store_dword a248, v19, s[4:7], s20 offen offset:256 sc1
Lst_186:
    s_cmp_eq_u32 s25, 0
    s_cbranch_scc1 Lst_187
    buffer_store_dwordx2 a[248:249], v25, s[4:7], s26 offen
    s_branch Lst_188
Lst_187:
    buffer_store_dwordx2 a[248:249], v25, s[4:7], s26 offen sc1
Lst_188:
    s_cmp_eq_u32 s25, 0
    s_cbranch_scc1 Lst_189
    buffer_store_dwordx2 a[248:249], v26, s[4:7], s26 offen
    s_branch Lst_190
Lst_189:
    buffer_store_dwordx2 a[248:249], v26, s[4:7], s26 offen sc1
Lst_190:
Li_180:
    s_add_u32 s59, s59, 8192
    s_cmp_eq_u32 s88, 0
    s_cbranch_scc1 Lr_194
    s_add_u32 s21, s63, s59
    s_mov_b64 exec, s[56:57]
    buffer_store_dwordx4 a[248:251], v29, s[4:7], s21 offen sc1
    s_mov_b64 exec, -1
Lr_194:
    s_sub_u32 s59, s59, 8192
    s_mov_b32 s26, 123731968
    s_mov_b32 s63, 393216
    s_cmp_lt_u32 s16, 2
    s_cbranch_scc0 Li_207
    s_add_u32 s20, s26, s58
    s_mov_b64 exec, s[100:101]
    s_cmp_eq_u32 s25, 0
    s_cbranch_scc1 Lst_208
    buffer_store_dword a248, v28, s[4:7], s20 offen
    s_branch Lst_209
Lst_208:
    buffer_store_dword a248, v28, s[4:7], s20 offen sc1
Lst_209:
    s_mov_b64 exec, -1
    s_cmp_eq_u32 s25, 0
    s_cbranch_scc1 Lst_210
    buffer_store_dword a248, v13, s[4:7], s26 offen
    s_branch Lst_211
Lst_210:
    buffer_store_dword a248, v13, s[4:7], s26 offen sc1
Lst_211:
    s_cmp_eq_u32 s25, 0
    s_cbranch_scc1 Lst_212
    buffer_store_dword a248, v13, s[4:7], s26 offen offset:32
    s_branch Lst_213
Lst_212:
    buffer_store_dword a248, v13, s[4:7], s26 offen offset:32 sc1
Lst_213:
    s_lshl_b32 s20, s12, 12
    s_add_u32 s20, s20, 131072
    s_add_u32 s20, s20, s26
    s_cmp_eq_u32 s25, 0
    s_cbranch_scc1 Lst_214
    buffer_store_dword a248, v19, s[4:7], s20 offen
    s_branch Lst_215
Lst_214:
    buffer_store_dword a248, v19, s[4:7], s20 offen sc1
Lst_215:
    s_cmp_eq_u32 s25, 0
    s_cbranch_scc1 Lst_216
    buffer_store_dwordx2 a[248:249], v24, s[4:7], s26 offen
    s_branch Lst_217
Lst_216:
    buffer_store_dwordx2 a[248:249], v24, s[4:7], s26 offen sc1
Lst_217:
    s_cmp_eq_u32 s25, 0
    s_cbranch_scc1 Lst_218
    buffer_store_dwordx2 a[248:249], v25, s[4:7], s26 offen
    s_branch Lst_219
Lst_218:
    buffer_store_dwordx2 a[248:249], v25, s[4:7], s26 offen sc1
Lst_219:
    s_cmp_eq_u32 s25, 0
    s_cbranch_scc1 Lst_220
    buffer_store_dwordx2 a[248:249], v26, s[4:7], s26 offen
    s_branch Lst_221
Lst_220:
    buffer_store_dwordx2 a[248:249], v26, s[4:7], s26 offen sc1
Lst_221:
    s_add_u32 s21, s63, s59
    s_mov_b64 exec, s[56:57]
    buffer_store_dwordx4 a[248:251], v29, s[4:7], s21 offen sc1
    s_mov_b64 exec, -1
Li_207:
    s_cmp_eq_u32 s16, 2
    s_cbranch_scc0 Li_222
    s_cmp_eq_u32 s88, 0
    s_cbranch_scc1 Lr_225
    s_add_u32 s20, s26, s58
    s_mov_b64 exec, s[100:101]
    s_cmp_eq_u32 s25, 0
    s_cbranch_scc1 Lst_223
    buffer_store_dword a248, v28, s[4:7], s20 offen
    s_branch Lst_224
Lst_223:
    buffer_store_dword a248, v28, s[4:7], s20 offen sc1
Lst_224:
    s_mov_b64 exec, -1
Lr_225:
    s_mov_b64 exec, s[38:39]
    s_cmp_eq_u32 s25, 0
    s_cbranch_scc1 Lst_227
    buffer_store_dword a248, v13, s[4:7], s26 offen
    s_branch Lst_228
Lst_227:
    buffer_store_dword a248, v13, s[4:7], s26 offen sc1
Lst_228:
    s_cmp_eq_u32 s25, 0
    s_cbranch_scc1 Lst_229
    buffer_store_dword a248, v13, s[4:7], s26 offen offset:32
    s_branch Lst_230
Lst_229:
    buffer_store_dword a248, v13, s[4:7], s26 offen offset:32 sc1
Lst_230:
    s_mov_b64 exec, -1
    s_lshl_b32 s20, s12, 12
    s_add_u32 s20, s20, 131072
    s_add_u32 s20, s20, s26
    s_cmp_eq_u32 s25, 0
    s_cbranch_scc1 Lst_231
    buffer_store_dword a248, v19, s[4:7], s20 offen
    s_branch Lst_232
Lst_231:
    buffer_store_dword a248, v19, s[4:7], s20 offen sc1
Lst_232:
    s_cmp_eq_u32 s25, 0
    s_cbranch_scc1 Lst_233
    buffer_store_dword a248, v19, s[4:7], s20 offen offset:256
    s_branch Lst_234
Lst_233:
    buffer_store_dword a248, v19, s[4:7], s20 offen offset:256 sc1
Lst_234:
    s_cmp_eq_u32 s25, 0
    s_cbranch_scc1 Lst_235
    buffer_store_dwordx2 a[248:249], v25, s[4:7], s26 offen
    s_branch Lst_236
Lst_235:
    buffer_store_dwordx2 a[248:249], v25, s[4:7], s26 offen sc1
Lst_236:
    s_cmp_eq_u32 s25, 0
    s_cbranch_scc1 Lst_237
    buffer_store_dwordx2 a[248:249], v26, s[4:7], s26 offen
    s_branch Lst_238
Lst_237:
    buffer_store_dwordx2 a[248:249], v26, s[4:7], s26 offen sc1
Lst_238:
    s_cmp_eq_u32 s88, 0
    s_cbranch_scc1 Lr_226
    s_add_u32 s21, s63, s59
    s_mov_b64 exec, s[56:57]
    buffer_store_dwordx4 a[248:251], v29, s[4:7], s21 offen sc1
    s_mov_b64 exec, -1
Lr_226:
Li_222:
    s_cmp_eq_u32 s16, 3
    s_cbranch_scc0 Li_239
    s_lshl_b32 s20, s12, 12
    s_add_u32 s20, s20, 131072
    s_add_u32 s20, s20, s26
    s_cmp_eq_u32 s25, 0
    s_cbranch_scc1 Lst_242
    buffer_store_dword a248, v19, s[4:7], s20 offen
    s_branch Lst_243
Lst_242:
    buffer_store_dword a248, v19, s[4:7], s20 offen sc1
Lst_243:
    s_cmp_eq_u32 s25, 0
    s_cbranch_scc1 Lst_244
    buffer_store_dword a248, v19, s[4:7], s20 offen offset:256
    s_branch Lst_245
Lst_244:
    buffer_store_dword a248, v19, s[4:7], s20 offen offset:256 sc1
Lst_245:
    s_cmp_eq_u32 s25, 0
    s_cbranch_scc1 Lst_246
    buffer_store_dwordx2 a[248:249], v25, s[4:7], s26 offen
    s_branch Lst_247
Lst_246:
    buffer_store_dwordx2 a[248:249], v25, s[4:7], s26 offen sc1
Lst_247:
    s_cmp_eq_u32 s25, 0
    s_cbranch_scc1 Lst_248
    buffer_store_dwordx2 a[248:249], v26, s[4:7], s26 offen
    s_branch Lst_249
Lst_248:
    buffer_store_dwordx2 a[248:249], v26, s[4:7], s26 offen sc1
Lst_249:
Li_239:
    s_add_u32 s59, s59, 8192
    s_cmp_eq_u32 s88, 0
    s_cbranch_scc1 Lr_253
    s_add_u32 s21, s63, s59
    s_mov_b64 exec, s[56:57]
    buffer_store_dwordx4 a[248:251], v29, s[4:7], s21 offen sc1
    s_mov_b64 exec, -1
Lr_253:
    s_sub_u32 s59, s59, 8192
    s_lshr_b32 s20, s16, 1
    s_cmp_eq_u32 s20, 0
    s_cbranch_scc0 Lw_266
    v_add_u32 v92, 98304, v70
    ds_read_b64_tr_b16 a[0:1], v92 offset:0
    ds_read_b64_tr_b16 a[2:3], v92 offset:1536
    ds_read_b64_tr_b16 a[4:5], v92 offset:6144
    ds_read_b64_tr_b16 a[6:7], v92 offset:7680
    ds_read_b64_tr_b16 a[8:9], v92 offset:12288
    ds_read_b64_tr_b16 a[10:11], v92 offset:13824
    ds_read_b64_tr_b16 a[12:13], v92 offset:18432
    ds_read_b64_tr_b16 a[14:15], v92 offset:19968
    s_waitcnt lgkmcnt(0)
    v_add_u32 v92, 98304, v71
    ds_read_b64_tr_b16 a[80:81], v92 offset:0
    ds_read_b64_tr_b16 a[82:83], v92 offset:1536
    ds_read_b64_tr_b16 a[84:85], v92 offset:6144
    ds_read_b64_tr_b16 a[86:87], v92 offset:7680
    ds_read_b64_tr_b16 a[88:89], v92 offset:12288
    ds_read_b64_tr_b16 a[90:91], v92 offset:13824
    ds_read_b64_tr_b16 a[92:93], v92 offset:18432
    ds_read_b64_tr_b16 a[94:95], v92 offset:19968
    s_waitcnt lgkmcnt(0)
    v_add_u32 v92, 98304, v72
    ds_read_b64_tr_b16 a[160:161], v92 offset:0
    ds_read_b64_tr_b16 a[162:163], v92 offset:1536
    ds_read_b64_tr_b16 a[164:165], v92 offset:6144
    ds_read_b64_tr_b16 a[166:167], v92 offset:7680
    ds_read_b64_tr_b16 a[168:169], v92 offset:12288
    ds_read_b64_tr_b16 a[170:171], v92 offset:13824
    ds_read_b64_tr_b16 a[172:173], v92 offset:18432
    ds_read_b64_tr_b16 a[174:175], v92 offset:19968
    s_waitcnt lgkmcnt(0)
Lw_266:
    s_barrier
    s_load_dwordx2 s[8:9], s[96:97], 48
    s_mov_b32 s10, 7864320
    s_mov_b32 s11, 0x00020000
    s_waitcnt lgkmcnt(0)
    s_mul_i32 s20, s12, 384
    s_mul_i32 s21, s13, 192
    s_add_u32 s20, s20, s21
    s_add_u32 s20, s20, 0
    s_mul_i32 s21, s16, 6144
    s_add_u32 s21, s21, 98304
    s_mov_b32 m0, s21
    s_add_u32 s21, s21, 1024
    buffer_load_dwordx4 v73, s[8:11], s20 offen lds
    s_mov_b32 m0, s21
    s_add_u32 s21, s21, 1024
    buffer_load_dwordx4 v74, s[8:11], s20 offen lds
    s_mov_b32 m0, s21
    s_add_u32 s21, s21, 1024
    buffer_load_dwordx4 v75, s[8:11], s20 offen lds
    s_mov_b32 m0, s21
    s_add_u32 s21, s21, 1024
    buffer_load_dwordx4 v76, s[8:11], s20 offen lds
    s_mov_b32 m0, s21
    s_add_u32 s21, s21, 1024
    buffer_load_dwordx4 v77, s[8:11], s20 offen lds
    s_mov_b32 m0, s21
    s_add_u32 s21, s21, 1024
    buffer_load_dwordx4 v78, s[8:11], s20 offen lds
    s_waitcnt vmcnt(24)
    s_barrier
    s_lshr_b32 s20, s16, 1
    s_cmp_eq_u32 s20, 0
    s_cbranch_scc0 Lw_267
    v_add_u32 v92, 0, v70
    ds_read_b64_tr_b16 a[16:17], v92 offset:0
    ds_read_b64_tr_b16 a[18:19], v92 offset:1536
    ds_read_b64_tr_b16 a[20:21], v92 offset:6144
    ds_read_b64_tr_b16 a[22:23], v92 offset:7680
    ds_read_b64_tr_b16 a[24:25], v92 offset:12288
    ds_read_b64_tr_b16 a[26:27], v92 offset:13824
    ds_read_b64_tr_b16 a[28:29], v92 offset:18432
    ds_read_b64_tr_b16 a[30:31], v92 offset:19968
    s_waitcnt lgkmcnt(0)
    v_add_u32 v92, 0, v71
    ds_read_b64_tr_b16 a[96:97], v92 offset:0
    ds_read_b64_tr_b16 a[98:99], v92 offset:1536
    ds_read_b64_tr_b16 a[100:101], v92 offset:6144
    ds_read_b64_tr_b16 a[102:103], v92 offset:7680
    ds_read_b64_tr_b16 a[104:105], v92 offset:12288
    ds_read_b64_tr_b16 a[106:107], v92 offset:13824
    ds_read_b64_tr_b16 a[108:109], v92 offset:18432
    ds_read_b64_tr_b16 a[110:111], v92 offset:19968
    s_waitcnt lgkmcnt(0)
    v_add_u32 v92, 0, v72
    ds_read_b64_tr_b16 a[176:177], v92 offset:0
    ds_read_b64_tr_b16 a[178:179], v92 offset:1536
    ds_read_b64_tr_b16 a[180:181], v92 offset:6144
    ds_read_b64_tr_b16 a[182:183], v92 offset:7680
    ds_read_b64_tr_b16 a[184:185], v92 offset:12288
    ds_read_b64_tr_b16 a[186:187], v92 offset:13824
    ds_read_b64_tr_b16 a[188:189], v92 offset:18432
    ds_read_b64_tr_b16 a[190:191], v92 offset:19968
    s_waitcnt lgkmcnt(0)
Lw_267:
    s_barrier
    s_load_dwordx2 s[8:9], s[96:97], 48
    s_mov_b32 s10, 7864320
    s_mov_b32 s11, 0x00020000
    s_waitcnt lgkmcnt(0)
    s_mul_i32 s20, s12, 384
    s_mul_i32 s21, s13, 192
    s_add_u32 s20, s20, s21
    s_add_u32 s20, s20, 1572864
    s_mul_i32 s21, s16, 6144
    s_add_u32 s21, s21, 0
    s_mov_b32 m0, s21
    s_add_u32 s21, s21, 1024
    buffer_load_dwordx4 v73, s[8:11], s20 offen lds
    s_mov_b32 m0, s21
    s_add_u32 s21, s21, 1024
    buffer_load_dwordx4 v74, s[8:11], s20 offen lds
    s_mov_b32 m0, s21
    s_add_u32 s21, s21, 1024
    buffer_load_dwordx4 v75, s[8:11], s20 offen lds
    s_mov_b32 m0, s21
    s_add_u32 s21, s21, 1024
    buffer_load_dwordx4 v76, s[8:11], s20 offen lds
    s_mov_b32 m0, s21
    s_add_u32 s21, s21, 1024
    buffer_load_dwordx4 v77, s[8:11], s20 offen lds
    s_mov_b32 m0, s21
    s_add_u32 s21, s21, 1024
    buffer_load_dwordx4 v78, s[8:11], s20 offen lds
    s_waitcnt vmcnt(24)
    s_barrier
    s_lshr_b32 s20, s16, 1
    s_cmp_eq_u32 s20, 0
    s_cbranch_scc0 Lw_268
    v_add_u32 v92, 24576, v70
    ds_read_b64_tr_b16 a[32:33], v92 offset:0
    ds_read_b64_tr_b16 a[34:35], v92 offset:1536
    ds_read_b64_tr_b16 a[36:37], v92 offset:6144
    ds_read_b64_tr_b16 a[38:39], v92 offset:7680
    ds_read_b64_tr_b16 a[40:41], v92 offset:12288
    ds_read_b64_tr_b16 a[42:43], v92 offset:13824
    ds_read_b64_tr_b16 a[44:45], v92 offset:18432
    ds_read_b64_tr_b16 a[46:47], v92 offset:19968
    s_waitcnt lgkmcnt(0)
    v_add_u32 v92, 24576, v71
    ds_read_b64_tr_b16 a[112:113], v92 offset:0
    ds_read_b64_tr_b16 a[114:115], v92 offset:1536
    ds_read_b64_tr_b16 a[116:117], v92 offset:6144
    ds_read_b64_tr_b16 a[118:119], v92 offset:7680
    ds_read_b64_tr_b16 a[120:121], v92 offset:12288
    ds_read_b64_tr_b16 a[122:123], v92 offset:13824
    ds_read_b64_tr_b16 a[124:125], v92 offset:18432
    ds_read_b64_tr_b16 a[126:127], v92 offset:19968
    s_waitcnt lgkmcnt(0)
    v_add_u32 v92, 24576, v72
    ds_read_b64_tr_b16 a[192:193], v92 offset:0
    ds_read_b64_tr_b16 a[194:195], v92 offset:1536
    ds_read_b64_tr_b16 a[196:197], v92 offset:6144
    ds_read_b64_tr_b16 a[198:199], v92 offset:7680
    ds_read_b64_tr_b16 a[200:201], v92 offset:12288
    ds_read_b64_tr_b16 a[202:203], v92 offset:13824
    ds_read_b64_tr_b16 a[204:205], v92 offset:18432
    ds_read_b64_tr_b16 a[206:207], v92 offset:19968
    s_waitcnt lgkmcnt(0)
Lw_268:
    s_barrier
    s_load_dwordx2 s[8:9], s[96:97], 48
    s_mov_b32 s10, 7864320
    s_mov_b32 s11, 0x00020000
    s_waitcnt lgkmcnt(0)
    s_mul_i32 s20, s12, 384
    s_mul_i32 s21, s13, 192
    s_add_u32 s20, s20, s21
    s_add_u32 s20, s20, 3145728
    s_mul_i32 s21, s16, 6144
    s_add_u32 s21, s21, 24576
    s_mov_b32 m0, s21
    s_add_u32 s21, s21, 1024
    buffer_load_dwordx4 v73, s[8:11], s20 offen lds
    s_mov_b32 m0, s21
    s_add_u32 s21, s21, 1024
    buffer_load_dwordx4 v74, s[8:11], s20 offen lds
    s_mov_b32 m0, s21
    s_add_u32 s21, s21, 1024
    buffer_load_dwordx4 v75, s[8:11], s20 offen lds
    s_mov_b32 m0, s21
    s_add_u32 s21, s21, 1024
    buffer_load_dwordx4 v76, s[8:11], s20 offen lds
    s_mov_b32 m0, s21
    s_add_u32 s21, s21, 1024
    buffer_load_dwordx4 v77, s[8:11], s20 offen lds
    s_mov_b32 m0, s21
    s_add_u32 s21, s21, 1024
    buffer_load_dwordx4 v78, s[8:11], s20 offen lds
    s_waitcnt vmcnt(24)
    s_barrier
    s_lshr_b32 s20, s16, 1
    s_cmp_eq_u32 s20, 0
    s_cbranch_scc0 Lw_269
    v_add_u32 v92, 49152, v70
    ds_read_b64_tr_b16 a[48:49], v92 offset:0
    ds_read_b64_tr_b16 a[50:51], v92 offset:1536
    ds_read_b64_tr_b16 a[52:53], v92 offset:6144
    ds_read_b64_tr_b16 a[54:55], v92 offset:7680
    ds_read_b64_tr_b16 a[56:57], v92 offset:12288
    ds_read_b64_tr_b16 a[58:59], v92 offset:13824
    ds_read_b64_tr_b16 a[60:61], v92 offset:18432
    ds_read_b64_tr_b16 a[62:63], v92 offset:19968
    s_waitcnt lgkmcnt(0)
    v_add_u32 v92, 49152, v71
    ds_read_b64_tr_b16 a[128:129], v92 offset:0
    ds_read_b64_tr_b16 a[130:131], v92 offset:1536
    ds_read_b64_tr_b16 a[132:133], v92 offset:6144
    ds_read_b64_tr_b16 a[134:135], v92 offset:7680
    ds_read_b64_tr_b16 a[136:137], v92 offset:12288
    ds_read_b64_tr_b16 a[138:139], v92 offset:13824
    ds_read_b64_tr_b16 a[140:141], v92 offset:18432
    ds_read_b64_tr_b16 a[142:143], v92 offset:19968
    s_waitcnt lgkmcnt(0)
    v_add_u32 v92, 49152, v72
    ds_read_b64_tr_b16 a[208:209], v92 offset:0
    ds_read_b64_tr_b16 a[210:211], v92 offset:1536
    ds_read_b64_tr_b16 a[212:213], v92 offset:6144
    ds_read_b64_tr_b16 a[214:215], v92 offset:7680
    ds_read_b64_tr_b16 a[216:217], v92 offset:12288
    ds_read_b64_tr_b16 a[218:219], v92 offset:13824
    ds_read_b64_tr_b16 a[220:221], v92 offset:18432
    ds_read_b64_tr_b16 a[222:223], v92 offset:19968
    s_waitcnt lgkmcnt(0)
Lw_269:
    s_barrier
    s_load_dwordx2 s[8:9], s[96:97], 48
    s_mov_b32 s10, 7864320
    s_mov_b32 s11, 0x00020000
    s_waitcnt lgkmcnt(0)
    s_mul_i32 s20, s12, 384
    s_mul_i32 s21, s13, 192
    s_add_u32 s20, s20, s21
    s_add_u32 s20, s20, 4718592
    s_mul_i32 s21, s16, 6144
    s_add_u32 s21, s21, 49152
    s_mov_b32 m0, s21
    s_add_u32 s21, s21, 1024
    buffer_load_dwordx4 v73, s[8:11], s20 offen lds
    s_mov_b32 m0, s21
    s_add_u32 s21, s21, 1024
    buffer_load_dwordx4 v74, s[8:11], s20 offen lds
    s_mov_b32 m0, s21
    s_add_u32 s21, s21, 1024
    buffer_load_dwordx4 v75, s[8:11], s20 offen lds
    s_mov_b32 m0, s21
    s_add_u32 s21, s21, 1024
    buffer_load_dwordx4 v76, s[8:11], s20 offen lds
    s_mov_b32 m0, s21
    s_add_u32 s21, s21, 1024
    buffer_load_dwordx4 v77, s[8:11], s20 offen lds
    s_mov_b32 m0, s21
    s_add_u32 s21, s21, 1024
    buffer_load_dwordx4 v78, s[8:11], s20 offen lds
    s_waitcnt vmcnt(24)
    s_barrier
    s_lshr_b32 s20, s16, 1
    s_cmp_eq_u32 s20, 0
    s_cbranch_scc0 Lw_270
    v_add_u32 v92, 73728, v70
    ds_read_b64_tr_b16 a[64:65], v92 offset:0
    ds_read_b64_tr_b16 a[66:67], v92 offset:1536
    ds_read_b64_tr_b16 a[68:69], v92 offset:6144
    ds_read_b64_tr_b16 a[70:71], v92 offset:7680
    ds_read_b64_tr_b16 a[72:73], v92 offset:12288
    ds_read_b64_tr_b16 a[74:75], v92 offset:13824
    ds_read_b64_tr_b16 a[76:77], v92 offset:18432
    ds_read_b64_tr_b16 a[78:79], v92 offset:19968
    s_waitcnt lgkmcnt(0)
    v_add_u32 v92, 73728, v71
    ds_read_b64_tr_b16 a[144:145], v92 offset:0
    ds_read_b64_tr_b16 a[146:147], v92 offset:1536
    ds_read_b64_tr_b16 a[148:149], v92 offset:6144
    ds_read_b64_tr_b16 a[150:151], v92 offset:7680
    ds_read_b64_tr_b16 a[152:153], v92 offset:12288
    ds_read_b64_tr_b16 a[154:155], v92 offset:13824
    ds_read_b64_tr_b16 a[156:157], v92 offset:18432
    ds_read_b64_tr_b16 a[158:159], v92 offset:19968
    s_waitcnt lgkmcnt(0)
    v_add_u32 v92, 73728, v72
    ds_read_b64_tr_b16 a[224:225], v92 offset:0
    ds_read_b64_tr_b16 a[226:227], v92 offset:1536
    ds_read_b64_tr_b16 a[228:229], v92 offset:6144
    ds_read_b64_tr_b16 a[230:231], v92 offset:7680
    ds_read_b64_tr_b16 a[232:233], v92 offset:12288
    ds_read_b64_tr_b16 a[234:235], v92 offset:13824
    ds_read_b64_tr_b16 a[236:237], v92 offset:18432
    ds_read_b64_tr_b16 a[238:239], v92 offset:19968
    s_waitcnt lgkmcnt(0)
Lw_270:
    s_barrier
    s_load_dwordx2 s[8:9], s[96:97], 48
    s_mov_b32 s10, 7864320
    s_mov_b32 s11, 0x00020000
    s_waitcnt lgkmcnt(0)
    s_mul_i32 s20, s12, 384
    s_mul_i32 s21, s13, 192
    s_add_u32 s20, s20, s21
    s_add_u32 s20, s20, 6291456
    s_mul_i32 s21, s16, 6144
    s_add_u32 s21, s21, 73728
    s_mov_b32 m0, s21
    s_add_u32 s21, s21, 1024
    buffer_load_dwordx4 v73, s[8:11], s20 offen lds
    s_mov_b32 m0, s21
    s_add_u32 s21, s21, 1024
    buffer_load_dwordx4 v74, s[8:11], s20 offen lds
    s_mov_b32 m0, s21
    s_add_u32 s21, s21, 1024
    buffer_load_dwordx4 v75, s[8:11], s20 offen lds
    s_mov_b32 m0, s21
    s_add_u32 s21, s21, 1024
    buffer_load_dwordx4 v76, s[8:11], s20 offen lds
    s_mov_b32 m0, s21
    s_add_u32 s21, s21, 1024
    buffer_load_dwordx4 v77, s[8:11], s20 offen lds
    s_mov_b32 m0, s21
    s_add_u32 s21, s21, 1024
    buffer_load_dwordx4 v78, s[8:11], s20 offen lds
    s_waitcnt vmcnt(24)
    s_barrier
    s_lshr_b32 s20, s16, 1
    s_cmp_eq_u32 s20, 1
    s_cbranch_scc0 Lw_271
    v_add_u32 v92, 98304, v70
    ds_read_b64_tr_b16 a[0:1], v92 offset:0
    ds_read_b64_tr_b16 a[2:3], v92 offset:1536
    ds_read_b64_tr_b16 a[4:5], v92 offset:6144
    ds_read_b64_tr_b16 a[6:7], v92 offset:7680
    ds_read_b64_tr_b16 a[8:9], v92 offset:12288
    ds_read_b64_tr_b16 a[10:11], v92 offset:13824
    ds_read_b64_tr_b16 a[12:13], v92 offset:18432
    ds_read_b64_tr_b16 a[14:15], v92 offset:19968
    s_waitcnt lgkmcnt(0)
    v_add_u32 v92, 98304, v71
    ds_read_b64_tr_b16 a[80:81], v92 offset:0
    ds_read_b64_tr_b16 a[82:83], v92 offset:1536
    ds_read_b64_tr_b16 a[84:85], v92 offset:6144
    ds_read_b64_tr_b16 a[86:87], v92 offset:7680
    ds_read_b64_tr_b16 a[88:89], v92 offset:12288
    ds_read_b64_tr_b16 a[90:91], v92 offset:13824
    ds_read_b64_tr_b16 a[92:93], v92 offset:18432
    ds_read_b64_tr_b16 a[94:95], v92 offset:19968
    s_waitcnt lgkmcnt(0)
    v_add_u32 v92, 98304, v72
    ds_read_b64_tr_b16 a[160:161], v92 offset:0
    ds_read_b64_tr_b16 a[162:163], v92 offset:1536
    ds_read_b64_tr_b16 a[164:165], v92 offset:6144
    ds_read_b64_tr_b16 a[166:167], v92 offset:7680
    ds_read_b64_tr_b16 a[168:169], v92 offset:12288
    ds_read_b64_tr_b16 a[170:171], v92 offset:13824
    ds_read_b64_tr_b16 a[172:173], v92 offset:18432
    ds_read_b64_tr_b16 a[174:175], v92 offset:19968
    s_waitcnt lgkmcnt(0)
Lw_271:
    s_barrier
    s_load_dwordx2 s[8:9], s[96:97], 64
    s_mov_b32 s10, 7864320
    s_mov_b32 s11, 0x00020000
    s_waitcnt lgkmcnt(0)
    s_mul_i32 s20, s12, 245760
    s_mul_i32 s21, s13, 640
    s_add_u32 s20, s20, s21
    s_add_u32 s20, s20, 0
    s_mul_i32 s21, s16, 5120
    s_add_u32 s21, s21, 98304
    s_mov_b32 m0, s21
    s_add_u32 s21, s21, 1024
    buffer_load_dwordx4 v79, s[8:11], s20 offen lds
    s_mov_b32 m0, s21
    s_add_u32 s21, s21, 1024
    buffer_load_dwordx4 v80, s[8:11], s20 offen lds
    s_mov_b32 m0, s21
    s_add_u32 s21, s21, 1024
    buffer_load_dwordx4 v81, s[8:11], s20 offen lds
    s_mov_b32 m0, s21
    s_add_u32 s21, s21, 1024
    buffer_load_dwordx4 v82, s[8:11], s20 offen lds
    s_mov_b32 m0, s21
    s_add_u32 s21, s21, 1024
    buffer_load_dwordx4 v83, s[8:11], s20 offen lds
    s_waitcnt vmcnt(23)
    s_barrier
    s_lshr_b32 s20, s16, 1
    s_cmp_eq_u32 s20, 1
    s_cbranch_scc0 Lw_272
    v_add_u32 v92, 0, v70
    ds_read_b64_tr_b16 a[16:17], v92 offset:0
    ds_read_b64_tr_b16 a[18:19], v92 offset:1536
    ds_read_b64_tr_b16 a[20:21], v92 offset:6144
    ds_read_b64_tr_b16 a[22:23], v92 offset:7680
    ds_read_b64_tr_b16 a[24:25], v92 offset:12288
    ds_read_b64_tr_b16 a[26:27], v92 offset:13824
    ds_read_b64_tr_b16 a[28:29], v92 offset:18432
    ds_read_b64_tr_b16 a[30:31], v92 offset:19968
    s_waitcnt lgkmcnt(0)
    v_add_u32 v92, 0, v71
    ds_read_b64_tr_b16 a[96:97], v92 offset:0
    ds_read_b64_tr_b16 a[98:99], v92 offset:1536
    ds_read_b64_tr_b16 a[100:101], v92 offset:6144
    ds_read_b64_tr_b16 a[102:103], v92 offset:7680
    ds_read_b64_tr_b16 a[104:105], v92 offset:12288
    ds_read_b64_tr_b16 a[106:107], v92 offset:13824
    ds_read_b64_tr_b16 a[108:109], v92 offset:18432
    ds_read_b64_tr_b16 a[110:111], v92 offset:19968
    s_waitcnt lgkmcnt(0)
    v_add_u32 v92, 0, v72
    ds_read_b64_tr_b16 a[176:177], v92 offset:0
    ds_read_b64_tr_b16 a[178:179], v92 offset:1536
    ds_read_b64_tr_b16 a[180:181], v92 offset:6144
    ds_read_b64_tr_b16 a[182:183], v92 offset:7680
    ds_read_b64_tr_b16 a[184:185], v92 offset:12288
    ds_read_b64_tr_b16 a[186:187], v92 offset:13824
    ds_read_b64_tr_b16 a[188:189], v92 offset:18432
    ds_read_b64_tr_b16 a[190:191], v92 offset:19968
    s_waitcnt lgkmcnt(0)
Lw_272:
    s_barrier
    s_load_dwordx2 s[8:9], s[96:97], 64
    s_mov_b32 s10, 7864320
    s_mov_b32 s11, 0x00020000
    s_waitcnt lgkmcnt(0)
    s_mul_i32 s20, s12, 245760
    s_mul_i32 s21, s13, 640
    s_add_u32 s20, s20, s21
    s_add_u32 s20, s20, 320
    s_mul_i32 s21, s16, 5120
    s_add_u32 s21, s21, 0
    s_mov_b32 m0, s21
    s_add_u32 s21, s21, 1024
    buffer_load_dwordx4 v79, s[8:11], s20 offen lds
    s_mov_b32 m0, s21
    s_add_u32 s21, s21, 1024
    buffer_load_dwordx4 v80, s[8:11], s20 offen lds
    s_mov_b32 m0, s21
    s_add_u32 s21, s21, 1024
    buffer_load_dwordx4 v81, s[8:11], s20 offen lds
    s_mov_b32 m0, s21
    s_add_u32 s21, s21, 1024
    buffer_load_dwordx4 v82, s[8:11], s20 offen lds
    s_mov_b32 m0, s21
    s_add_u32 s21, s21, 1024
    buffer_load_dwordx4 v83, s[8:11], s20 offen lds
    s_waitcnt vmcnt(22)
    s_barrier
    s_lshr_b32 s20, s16, 1
    s_cmp_eq_u32 s20, 1
    s_cbranch_scc0 Lw_273
    v_add_u32 v92, 24576, v70
    ds_read_b64_tr_b16 a[32:33], v92 offset:0
    ds_read_b64_tr_b16 a[34:35], v92 offset:1536
    ds_read_b64_tr_b16 a[36:37], v92 offset:6144
    ds_read_b64_tr_b16 a[38:39], v92 offset:7680
    ds_read_b64_tr_b16 a[40:41], v92 offset:12288
    ds_read_b64_tr_b16 a[42:43], v92 offset:13824
    ds_read_b64_tr_b16 a[44:45], v92 offset:18432
    ds_read_b64_tr_b16 a[46:47], v92 offset:19968
    s_waitcnt lgkmcnt(0)
    v_add_u32 v92, 24576, v71
    ds_read_b64_tr_b16 a[112:113], v92 offset:0
    ds_read_b64_tr_b16 a[114:115], v92 offset:1536
    ds_read_b64_tr_b16 a[116:117], v92 offset:6144
    ds_read_b64_tr_b16 a[118:119], v92 offset:7680
    ds_read_b64_tr_b16 a[120:121], v92 offset:12288
    ds_read_b64_tr_b16 a[122:123], v92 offset:13824
    ds_read_b64_tr_b16 a[124:125], v92 offset:18432
    ds_read_b64_tr_b16 a[126:127], v92 offset:19968
    s_waitcnt lgkmcnt(0)
    v_add_u32 v92, 24576, v72
    ds_read_b64_tr_b16 a[192:193], v92 offset:0
    ds_read_b64_tr_b16 a[194:195], v92 offset:1536
    ds_read_b64_tr_b16 a[196:197], v92 offset:6144
    ds_read_b64_tr_b16 a[198:199], v92 offset:7680
    ds_read_b64_tr_b16 a[200:201], v92 offset:12288
    ds_read_b64_tr_b16 a[202:203], v92 offset:13824
    ds_read_b64_tr_b16 a[204:205], v92 offset:18432
    ds_read_b64_tr_b16 a[206:207], v92 offset:19968
    s_waitcnt lgkmcnt(0)
Lw_273:
    s_barrier
    s_load_dwordx2 s[8:9], s[96:97], 64
    s_mov_b32 s10, 7864320
    s_mov_b32 s11, 0x00020000
    s_waitcnt lgkmcnt(0)
    s_mul_i32 s20, s12, 245760
    s_mul_i32 s21, s13, 640
    s_add_u32 s20, s20, s21
    s_add_u32 s20, s20, 81920
    s_mul_i32 s21, s16, 5120
    s_add_u32 s21, s21, 24576
    s_mov_b32 m0, s21
    s_add_u32 s21, s21, 1024
    buffer_load_dwordx4 v79, s[8:11], s20 offen lds
    s_mov_b32 m0, s21
    s_add_u32 s21, s21, 1024
    buffer_load_dwordx4 v80, s[8:11], s20 offen lds
    s_mov_b32 m0, s21
    s_add_u32 s21, s21, 1024
    buffer_load_dwordx4 v81, s[8:11], s20 offen lds
    s_mov_b32 m0, s21
    s_add_u32 s21, s21, 1024
    buffer_load_dwordx4 v82, s[8:11], s20 offen lds
    s_mov_b32 m0, s21
    s_add_u32 s21, s21, 1024
    buffer_load_dwordx4 v83, s[8:11], s20 offen lds
    s_waitcnt vmcnt(21)
    s_barrier
    s_lshr_b32 s20, s16, 1
    s_cmp_eq_u32 s20, 1
    s_cbranch_scc0 Lw_274
    v_add_u32 v92, 49152, v70
    ds_read_b64_tr_b16 a[48:49], v92 offset:0
    ds_read_b64_tr_b16 a[50:51], v92 offset:1536
    ds_read_b64_tr_b16 a[52:53], v92 offset:6144
    ds_read_b64_tr_b16 a[54:55], v92 offset:7680
    ds_read_b64_tr_b16 a[56:57], v92 offset:12288
    ds_read_b64_tr_b16 a[58:59], v92 offset:13824
    ds_read_b64_tr_b16 a[60:61], v92 offset:18432
    ds_read_b64_tr_b16 a[62:63], v92 offset:19968
    s_waitcnt lgkmcnt(0)
    v_add_u32 v92, 49152, v71
    ds_read_b64_tr_b16 a[128:129], v92 offset:0
    ds_read_b64_tr_b16 a[130:131], v92 offset:1536
    ds_read_b64_tr_b16 a[132:133], v92 offset:6144
    ds_read_b64_tr_b16 a[134:135], v92 offset:7680
    ds_read_b64_tr_b16 a[136:137], v92 offset:12288
    ds_read_b64_tr_b16 a[138:139], v92 offset:13824
    ds_read_b64_tr_b16 a[140:141], v92 offset:18432
    ds_read_b64_tr_b16 a[142:143], v92 offset:19968
    s_waitcnt lgkmcnt(0)
    v_add_u32 v92, 49152, v72
    ds_read_b64_tr_b16 a[208:209], v92 offset:0
    ds_read_b64_tr_b16 a[210:211], v92 offset:1536
    ds_read_b64_tr_b16 a[212:213], v92 offset:6144
    ds_read_b64_tr_b16 a[214:215], v92 offset:7680
    ds_read_b64_tr_b16 a[216:217], v92 offset:12288
    ds_read_b64_tr_b16 a[218:219], v92 offset:13824
    ds_read_b64_tr_b16 a[220:221], v92 offset:18432
    ds_read_b64_tr_b16 a[222:223], v92 offset:19968
    s_waitcnt lgkmcnt(0)
Lw_274:
    s_barrier
    s_load_dwordx2 s[8:9], s[96:97], 64
    s_mov_b32 s10, 7864320
    s_mov_b32 s11, 0x00020000
    s_waitcnt lgkmcnt(0)
    s_mul_i32 s20, s12, 245760
    s_mul_i32 s21, s13, 640
    s_add_u32 s20, s20, s21
    s_add_u32 s20, s20, 82240
    s_mul_i32 s21, s16, 5120
    s_add_u32 s21, s21, 49152
    s_mov_b32 m0, s21
    s_add_u32 s21, s21, 1024
    buffer_load_dwordx4 v79, s[8:11], s20 offen lds
    s_mov_b32 m0, s21
    s_add_u32 s21, s21, 1024
    buffer_load_dwordx4 v80, s[8:11], s20 offen lds
    s_mov_b32 m0, s21
    s_add_u32 s21, s21, 1024
    buffer_load_dwordx4 v81, s[8:11], s20 offen lds
    s_mov_b32 m0, s21
    s_add_u32 s21, s21, 1024
    buffer_load_dwordx4 v82, s[8:11], s20 offen lds
    s_mov_b32 m0, s21
    s_add_u32 s21, s21, 1024
    buffer_load_dwordx4 v83, s[8:11], s20 offen lds
    s_waitcnt vmcnt(20)
    s_barrier
    s_lshr_b32 s20, s16, 1
    s_cmp_eq_u32 s20, 1
    s_cbranch_scc0 Lw_275
    v_add_u32 v92, 73728, v70
    ds_read_b64_tr_b16 a[64:65], v92 offset:0
    ds_read_b64_tr_b16 a[66:67], v92 offset:1536
    ds_read_b64_tr_b16 a[68:69], v92 offset:6144
    ds_read_b64_tr_b16 a[70:71], v92 offset:7680
    ds_read_b64_tr_b16 a[72:73], v92 offset:12288
    ds_read_b64_tr_b16 a[74:75], v92 offset:13824
    ds_read_b64_tr_b16 a[76:77], v92 offset:18432
    ds_read_b64_tr_b16 a[78:79], v92 offset:19968
    s_waitcnt lgkmcnt(0)
    v_add_u32 v92, 73728, v71
    ds_read_b64_tr_b16 a[144:145], v92 offset:0
    ds_read_b64_tr_b16 a[146:147], v92 offset:1536
    ds_read_b64_tr_b16 a[148:149], v92 offset:6144
    ds_read_b64_tr_b16 a[150:151], v92 offset:7680
    ds_read_b64_tr_b16 a[152:153], v92 offset:12288
    ds_read_b64_tr_b16 a[154:155], v92 offset:13824
    ds_read_b64_tr_b16 a[156:157], v92 offset:18432
    ds_read_b64_tr_b16 a[158:159], v92 offset:19968
    s_waitcnt lgkmcnt(0)
    v_add_u32 v92, 73728, v72
    ds_read_b64_tr_b16 a[224:225], v92 offset:0
    ds_read_b64_tr_b16 a[226:227], v92 offset:1536
    ds_read_b64_tr_b16 a[228:229], v92 offset:6144
    ds_read_b64_tr_b16 a[230:231], v92 offset:7680
    ds_read_b64_tr_b16 a[232:233], v92 offset:12288
    ds_read_b64_tr_b16 a[234:235], v92 offset:13824
    ds_read_b64_tr_b16 a[236:237], v92 offset:18432
    ds_read_b64_tr_b16 a[238:239], v92 offset:19968
    s_waitcnt lgkmcnt(0)
Lw_275:
    s_barrier
    s_load_dwordx2 s[8:9], s[96:97], 64
    s_mov_b32 s10, 7864320
    s_mov_b32 s11, 0x00020000
    s_waitcnt lgkmcnt(0)
    s_mul_i32 s20, s12, 245760
    s_mul_i32 s21, s13, 640
    s_add_u32 s20, s20, s21
    s_add_u32 s20, s20, 163840
    s_mul_i32 s21, s16, 5120
    s_add_u32 s21, s21, 73728
    s_mov_b32 m0, s21
    s_add_u32 s21, s21, 1024
    buffer_load_dwordx4 v79, s[8:11], s20 offen lds
    s_mov_b32 m0, s21
    s_add_u32 s21, s21, 1024
    buffer_load_dwordx4 v80, s[8:11], s20 offen lds
    s_mov_b32 m0, s21
    s_add_u32 s21, s21, 1024
    buffer_load_dwordx4 v81, s[8:11], s20 offen lds
    s_mov_b32 m0, s21
    s_add_u32 s21, s21, 1024
    buffer_load_dwordx4 v82, s[8:11], s20 offen lds
    s_mov_b32 m0, s21
    s_add_u32 s21, s21, 1024
    buffer_load_dwordx4 v83, s[8:11], s20 offen lds
    s_waitcnt vmcnt(20)
    s_barrier
    v_add_u32 v92, 98304, v84
    s_cmp_eq_u32 s16, 0
    s_cbranch_scc0 Lw_276
    ds_read_b64_tr_b16 v[112:113], v92 offset:0
    ds_read_b64_tr_b16 v[114:115], v92 offset:1280
    ds_read_b64_tr_b16 v[116:117], v92 offset:10240
    ds_read_b64_tr_b16 v[118:119], v92 offset:11520
    ds_read_b64_tr_b16 v[136:137], v92 offset:32
    ds_read_b64_tr_b16 v[138:139], v92 offset:1312
    ds_read_b64_tr_b16 v[140:141], v92 offset:10272
    ds_read_b64_tr_b16 v[142:143], v92 offset:11552
    ds_read_b64_tr_b16 v[160:161], v92 offset:64
    ds_read_b64_tr_b16 v[162:163], v92 offset:1344
    ds_read_b64_tr_b16 v[164:165], v92 offset:10304
    ds_read_b64_tr_b16 v[166:167], v92 offset:11584
    ds_read_b64_tr_b16 v[184:185], v92 offset:96
    ds_read_b64_tr_b16 v[186:187], v92 offset:1376
    ds_read_b64_tr_b16 v[188:189], v92 offset:10336
    ds_read_b64_tr_b16 v[190:191], v92 offset:11616
    ds_read_b64_tr_b16 v[208:209], v92 offset:128
    ds_read_b64_tr_b16 v[210:211], v92 offset:1408
    ds_read_b64_tr_b16 v[212:213], v92 offset:10368
    ds_read_b64_tr_b16 v[214:215], v92 offset:11648
    ds_read_b64_tr_b16 v[232:233], v92 offset:160
    ds_read_b64_tr_b16 v[234:235], v92 offset:1440
    ds_read_b64_tr_b16 v[236:237], v92 offset:10400
    ds_read_b64_tr_b16 v[238:239], v92 offset:11680
    s_waitcnt lgkmcnt(0)
Lw_276:
    s_cmp_eq_u32 s16, 1
    s_cbranch_scc0 Lw_277
    ds_read_b64_tr_b16 v[112:113], v92 offset:192
    ds_read_b64_tr_b16 v[114:115], v92 offset:1472
    ds_read_b64_tr_b16 v[116:117], v92 offset:10432
    ds_read_b64_tr_b16 v[118:119], v92 offset:11712
    ds_read_b64_tr_b16 v[136:137], v92 offset:224
    ds_read_b64_tr_b16 v[138:139], v92 offset:1504
    ds_read_b64_tr_b16 v[140:141], v92 offset:10464
    ds_read_b64_tr_b16 v[142:143], v92 offset:11744
    ds_read_b64_tr_b16 v[160:161], v92 offset:256
    ds_read_b64_tr_b16 v[162:163], v92 offset:1536
    ds_read_b64_tr_b16 v[164:165], v92 offset:10496
    ds_read_b64_tr_b16 v[166:167], v92 offset:11776
    ds_read_b64_tr_b16 v[184:185], v92 offset:288
    ds_read_b64_tr_b16 v[186:187], v92 offset:1568
    ds_read_b64_tr_b16 v[188:189], v92 offset:10528
    ds_read_b64_tr_b16 v[190:191], v92 offset:11808
    s_waitcnt lgkmcnt(0)
Lw_277:
    s_cmp_eq_u32 s16, 2
    s_cbranch_scc0 Lw_278
    s_waitcnt lgkmcnt(0)
Lw_278:
    s_cmp_eq_u32 s16, 3
    s_cbranch_scc0 Lw_279
    s_waitcnt lgkmcnt(0)
Lw_279:
    s_barrier
    s_load_dwordx2 s[8:9], s[96:97], 64
    s_mov_b32 s10, 7864320
    s_mov_b32 s11, 0x00020000
    s_waitcnt lgkmcnt(0)
    s_mul_i32 s20, s12, 245760
    s_mul_i32 s21, s13, 640
    s_add_u32 s20, s20, s21
    s_add_u32 s20, s20, 164160
    s_mul_i32 s21, s16, 5120
    s_add_u32 s21, s21, 98304
    s_mov_b32 m0, s21
    s_add_u32 s21, s21, 1024
    buffer_load_dwordx4 v79, s[8:11], s20 offen lds
    s_mov_b32 m0, s21
    s_add_u32 s21, s21, 1024
    buffer_load_dwordx4 v80, s[8:11], s20 offen lds
    s_mov_b32 m0, s21
    s_add_u32 s21, s21, 1024
    buffer_load_dwordx4 v81, s[8:11], s20 offen lds
    s_mov_b32 m0, s21
    s_add_u32 s21, s21, 1024
    buffer_load_dwordx4 v82, s[8:11], s20 offen lds
    s_mov_b32 m0, s21
    s_add_u32 s21, s21, 1024
    buffer_load_dwordx4 v83, s[8:11], s20 offen lds
    s_waitcnt vmcnt(20)
    s_barrier
    v_add_u32 v92, 0, v84
    s_cmp_eq_u32 s16, 0
    s_cbranch_scc0 Lw_280
    s_waitcnt lgkmcnt(0)
Lw_280:
    s_cmp_eq_u32 s16, 1
    s_cbranch_scc0 Lw_281
    ds_read_b64_tr_b16 v[208:209], v92 offset:0
    ds_read_b64_tr_b16 v[210:211], v92 offset:1280
    ds_read_b64_tr_b16 v[212:213], v92 offset:10240
    ds_read_b64_tr_b16 v[214:215], v92 offset:11520
    ds_read_b64_tr_b16 v[232:233], v92 offset:32
    ds_read_b64_tr_b16 v[234:235], v92 offset:1312
    ds_read_b64_tr_b16 v[236:237], v92 offset:10272
    ds_read_b64_tr_b16 v[238:239], v92 offset:11552
    s_waitcnt lgkmcnt(0)
Lw_281:
    s_cmp_eq_u32 s16, 2
    s_cbranch_scc0 Lw_282
    ds_read_b64_tr_b16 v[160:161], v92 offset:64
    ds_read_b64_tr_b16 v[162:163], v92 offset:1344
    ds_read_b64_tr_b16 v[164:165], v92 offset:10304
    ds_read_b64_tr_b16 v[166:167], v92 offset:11584
    ds_read_b64_tr_b16 v[184:185], v92 offset:96
    ds_read_b64_tr_b16 v[186:187], v92 offset:1376
    ds_read_b64_tr_b16 v[188:189], v92 offset:10336
    ds_read_b64_tr_b16 v[190:191], v92 offset:11616
    ds_read_b64_tr_b16 v[208:209], v92 offset:128
    ds_read_b64_tr_b16 v[210:211], v92 offset:1408
    ds_read_b64_tr_b16 v[212:213], v92 offset:10368
    ds_read_b64_tr_b16 v[214:215], v92 offset:11648
    ds_read_b64_tr_b16 v[232:233], v92 offset:160
    ds_read_b64_tr_b16 v[234:235], v92 offset:1440
    ds_read_b64_tr_b16 v[236:237], v92 offset:10400
    ds_read_b64_tr_b16 v[238:239], v92 offset:11680
    s_waitcnt lgkmcnt(0)
Lw_282:
    s_cmp_eq_u32 s16, 3
    s_cbranch_scc0 Lw_283
    ds_read_b64_tr_b16 v[160:161], v92 offset:192
    ds_read_b64_tr_b16 v[162:163], v92 offset:1472
    ds_read_b64_tr_b16 v[164:165], v92 offset:10432
    ds_read_b64_tr_b16 v[166:167], v92 offset:11712
    ds_read_b64_tr_b16 v[184:185], v92 offset:224
    ds_read_b64_tr_b16 v[186:187], v92 offset:1504
    ds_read_b64_tr_b16 v[188:189], v92 offset:10464
    ds_read_b64_tr_b16 v[190:191], v92 offset:11744
    ds_read_b64_tr_b16 v[208:209], v92 offset:256
    ds_read_b64_tr_b16 v[210:211], v92 offset:1536
    ds_read_b64_tr_b16 v[212:213], v92 offset:10496
    ds_read_b64_tr_b16 v[214:215], v92 offset:11776
    ds_read_b64_tr_b16 v[232:233], v92 offset:288
    ds_read_b64_tr_b16 v[234:235], v92 offset:1568
    ds_read_b64_tr_b16 v[236:237], v92 offset:10528
    ds_read_b64_tr_b16 v[238:239], v92 offset:11808
    s_waitcnt lgkmcnt(0)
Lw_283:
    s_barrier
    s_load_dwordx2 s[8:9], s[96:97], 56
    s_mov_b32 s10, 7864320
    s_mov_b32 s11, 0x00020000
    s_waitcnt lgkmcnt(0)
    s_mul_i32 s20, s12, 384
    s_mul_i32 s21, s13, 192
    s_add_u32 s20, s20, s21
    s_add_u32 s20, s20, 0
    s_mul_i32 s21, s16, 6144
    s_add_u32 s21, s21, 0
    s_mov_b32 m0, s21
    s_add_u32 s21, s21, 1024
    buffer_load_dwordx4 v73, s[8:11], s20 offen lds
    s_mov_b32 m0, s21
    s_add_u32 s21, s21, 1024
    buffer_load_dwordx4 v74, s[8:11], s20 offen lds
    s_mov_b32 m0, s21
    s_add_u32 s21, s21, 1024
    buffer_load_dwordx4 v75, s[8:11], s20 offen lds
    s_mov_b32 m0, s21
    s_add_u32 s21, s21, 1024
    buffer_load_dwordx4 v76, s[8:11], s20 offen lds
    s_mov_b32 m0, s21
    s_add_u32 s21, s21, 1024
    buffer_load_dwordx4 v77, s[8:11], s20 offen lds
    s_mov_b32 m0, s21
    s_add_u32 s21, s21, 1024
    buffer_load_dwordx4 v78, s[8:11], s20 offen lds
    s_waitcnt vmcnt(21)
    s_barrier
    v_add_u32 v92, 24576, v84
    s_cmp_eq_u32 s16, 0
    s_cbranch_scc0 Lw_284
    ds_read_b64_tr_b16 v[120:121], v92 offset:0
    ds_read_b64_tr_b16 v[122:123], v92 offset:1280
    ds_read_b64_tr_b16 v[124:125], v92 offset:10240
    ds_read_b64_tr_b16 v[126:127], v92 offset:11520
    ds_read_b64_tr_b16 v[144:145], v92 offset:32
    ds_read_b64_tr_b16 v[146:147], v92 offset:1312
    ds_read_b64_tr_b16 v[148:149], v92 offset:10272
    ds_read_b64_tr_b16 v[150:151], v92 offset:11552
    ds_read_b64_tr_b16 v[168:169], v92 offset:64
    ds_read_b64_tr_b16 v[170:171], v92 offset:1344
    ds_read_b64_tr_b16 v[172:173], v92 offset:10304
    ds_read_b64_tr_b16 v[174:175], v92 offset:11584
    ds_read_b64_tr_b16 v[192:193], v92 offset:96
    ds_read_b64_tr_b16 v[194:195], v92 offset:1376
    ds_read_b64_tr_b16 v[196:197], v92 offset:10336
    ds_read_b64_tr_b16 v[198:199], v92 offset:11616
    ds_read_b64_tr_b16 v[216:217], v92 offset:128
    ds_read_b64_tr_b16 v[218:219], v92 offset:1408
    ds_read_b64_tr_b16 v[220:221], v92 offset:10368
    ds_read_b64_tr_b16 v[222:223], v92 offset:11648
    ds_read_b64_tr_b16 v[240:241], v92 offset:160
    ds_read_b64_tr_b16 v[242:243], v92 offset:1440
    ds_read_b64_tr_b16 v[244:245], v92 offset:10400
    ds_read_b64_tr_b16 v[246:247], v92 offset:11680
    s_waitcnt lgkmcnt(0)
Lw_284:
    s_cmp_eq_u32 s16, 1
    s_cbranch_scc0 Lw_285
    ds_read_b64_tr_b16 v[120:121], v92 offset:192
    ds_read_b64_tr_b16 v[122:123], v92 offset:1472
    ds_read_b64_tr_b16 v[124:125], v92 offset:10432
    ds_read_b64_tr_b16 v[126:127], v92 offset:11712
    ds_read_b64_tr_b16 v[144:145], v92 offset:224
    ds_read_b64_tr_b16 v[146:147], v92 offset:1504
    ds_read_b64_tr_b16 v[148:149], v92 offset:10464
    ds_read_b64_tr_b16 v[150:151], v92 offset:11744
    ds_read_b64_tr_b16 v[168:169], v92 offset:256
    ds_read_b64_tr_b16 v[170:171], v92 offset:1536
    ds_read_b64_tr_b16 v[172:173], v92 offset:10496
    ds_read_b64_tr_b16 v[174:175], v92 offset:11776
    ds_read_b64_tr_b16 v[192:193], v92 offset:288
    ds_read_b64_tr_b16 v[194:195], v92 offset:1568
    ds_read_b64_tr_b16 v[196:197], v92 offset:10528
    ds_read_b64_tr_b16 v[198:199], v92 offset:11808
    s_waitcnt lgkmcnt(0)
Lw_285:
    s_cmp_eq_u32 s16, 2
    s_cbranch_scc0 Lw_286
    s_waitcnt lgkmcnt(0)
Lw_286:
    s_cmp_eq_u32 s16, 3
    s_cbranch_scc0 Lw_287
    s_waitcnt lgkmcnt(0)
Lw_287:
    s_barrier
    s_load_dwordx2 s[8:9], s[96:97], 56
    s_mov_b32 s10, 7864320
    s_mov_b32 s11, 0x00020000
    s_waitcnt lgkmcnt(0)
    s_mul_i32 s20, s12, 384
    s_mul_i32 s21, s13, 192
    s_add_u32 s20, s20, s21
    s_add_u32 s20, s20, 1572864
    s_mul_i32 s21, s16, 6144
    s_add_u32 s21, s21, 24576
    s_mov_b32 m0, s21
    s_add_u32 s21, s21, 1024
    buffer_load_dwordx4 v73, s[8:11], s20 offen lds
    s_mov_b32 m0, s21
    s_add_u32 s21, s21, 1024
    buffer_load_dwordx4 v74, s[8:11], s20 offen lds
    s_mov_b32 m0, s21
    s_add_u32 s21, s21, 1024
    buffer_load_dwordx4 v75, s[8:11], s20 offen lds
    s_mov_b32 m0, s21
    s_add_u32 s21, s21, 1024
    buffer_load_dwordx4 v76, s[8:11], s20 offen lds
    s_mov_b32 m0, s21
    s_add_u32 s21, s21, 1024
    buffer_load_dwordx4 v77, s[8:11], s20 offen lds
    s_mov_b32 m0, s21
    s_add_u32 s21, s21, 1024
    buffer_load_dwordx4 v78, s[8:11], s20 offen lds
    s_waitcnt vmcnt(22)
    s_barrier
    v_add_u32 v92, 49152, v84
    s_cmp_eq_u32 s16, 0
    s_cbranch_scc0 Lw_288
    s_waitcnt lgkmcnt(0)
Lw_288:
    s_cmp_eq_u32 s16, 1
    s_cbranch_scc0 Lw_289
    ds_read_b64_tr_b16 v[216:217], v92 offset:0
    ds_read_b64_tr_b16 v[218:219], v92 offset:1280
    ds_read_b64_tr_b16 v[220:221], v92 offset:10240
    ds_read_b64_tr_b16 v[222:223], v92 offset:11520
    ds_read_b64_tr_b16 v[240:241], v92 offset:32
    ds_read_b64_tr_b16 v[242:243], v92 offset:1312
    ds_read_b64_tr_b16 v[244:245], v92 offset:10272
    ds_read_b64_tr_b16 v[246:247], v92 offset:11552
    s_waitcnt lgkmcnt(0)
Lw_289:
    s_cmp_eq_u32 s16, 2
    s_cbranch_scc0 Lw_290
    ds_read_b64_tr_b16 v[168:169], v92 offset:64
    ds_read_b64_tr_b16 v[170:171], v92 offset:1344
    ds_read_b64_tr_b16 v[172:173], v92 offset:10304
    ds_read_b64_tr_b16 v[174:175], v92 offset:11584
    ds_read_b64_tr_b16 v[192:193], v92 offset:96
    ds_read_b64_tr_b16 v[194:195], v92 offset:1376
    ds_read_b64_tr_b16 v[196:197], v92 offset:10336
    ds_read_b64_tr_b16 v[198:199], v92 offset:11616
    ds_read_b64_tr_b16 v[216:217], v92 offset:128
    ds_read_b64_tr_b16 v[218:219], v92 offset:1408
    ds_read_b64_tr_b16 v[220:221], v92 offset:10368
    ds_read_b64_tr_b16 v[222:223], v92 offset:11648
    ds_read_b64_tr_b16 v[240:241], v92 offset:160
    ds_read_b64_tr_b16 v[242:243], v92 offset:1440
    ds_read_b64_tr_b16 v[244:245], v92 offset:10400
    ds_read_b64_tr_b16 v[246:247], v92 offset:11680
    s_waitcnt lgkmcnt(0)
Lw_290:
    s_cmp_eq_u32 s16, 3
    s_cbranch_scc0 Lw_291
    ds_read_b64_tr_b16 v[168:169], v92 offset:192
    ds_read_b64_tr_b16 v[170:171], v92 offset:1472
    ds_read_b64_tr_b16 v[172:173], v92 offset:10432
    ds_read_b64_tr_b16 v[174:175], v92 offset:11712
    ds_read_b64_tr_b16 v[192:193], v92 offset:224
    ds_read_b64_tr_b16 v[194:195], v92 offset:1504
    ds_read_b64_tr_b16 v[196:197], v92 offset:10464
    ds_read_b64_tr_b16 v[198:199], v92 offset:11744
    ds_read_b64_tr_b16 v[216:217], v92 offset:256
    ds_read_b64_tr_b16 v[218:219], v92 offset:1536
    ds_read_b64_tr_b16 v[220:221], v92 offset:10496
    ds_read_b64_tr_b16 v[222:223], v92 offset:11776
    ds_read_b64_tr_b16 v[240:241], v92 offset:288
    ds_read_b64_tr_b16 v[242:243], v92 offset:1568
    ds_read_b64_tr_b16 v[244:245], v92 offset:10528
    ds_read_b64_tr_b16 v[246:247], v92 offset:11808
    s_waitcnt lgkmcnt(0)
Lw_291:
    s_barrier
    s_load_dwordx2 s[8:9], s[96:97], 56
    s_mov_b32 s10, 7864320
    s_mov_b32 s11, 0x00020000
    s_waitcnt lgkmcnt(0)
    s_mul_i32 s20, s12, 384
    s_mul_i32 s21, s13, 192
    s_add_u32 s20, s20, s21
    s_add_u32 s20, s20, 3145728
    s_mul_i32 s21, s16, 6144
    s_add_u32 s21, s21, 49152
    s_mov_b32 m0, s21
    s_add_u32 s21, s21, 1024
    buffer_load_dwordx4 v73, s[8:11], s20 offen lds
    s_mov_b32 m0, s21
    s_add_u32 s21, s21, 1024
    buffer_load_dwordx4 v74, s[8:11], s20 offen lds
    s_mov_b32 m0, s21
    s_add_u32 s21, s21, 1024
    buffer_load_dwordx4 v75, s[8:11], s20 offen lds
    s_mov_b32 m0, s21
    s_add_u32 s21, s21, 1024
    buffer_load_dwordx4 v76, s[8:11], s20 offen lds
    s_mov_b32 m0, s21
    s_add_u32 s21, s21, 1024
    buffer_load_dwordx4 v77, s[8:11], s20 offen lds
    s_mov_b32 m0, s21
    s_add_u32 s21, s21, 1024
    buffer_load_dwordx4 v78, s[8:11], s20 offen lds
    s_waitcnt vmcnt(23)
    s_barrier
    v_add_u32 v92, 73728, v84
    s_cmp_eq_u32 s16, 0
    s_cbranch_scc0 Lw_292
    ds_read_b64_tr_b16 v[128:129], v92 offset:0
    ds_read_b64_tr_b16 v[130:131], v92 offset:1280
    ds_read_b64_tr_b16 v[132:133], v92 offset:10240
    ds_read_b64_tr_b16 v[134:135], v92 offset:11520
    ds_read_b64_tr_b16 v[152:153], v92 offset:32
    ds_read_b64_tr_b16 v[154:155], v92 offset:1312
    ds_read_b64_tr_b16 v[156:157], v92 offset:10272
    ds_read_b64_tr_b16 v[158:159], v92 offset:11552
    ds_read_b64_tr_b16 v[176:177], v92 offset:64
    ds_read_b64_tr_b16 v[178:179], v92 offset:1344
    ds_read_b64_tr_b16 v[180:181], v92 offset:10304
    ds_read_b64_tr_b16 v[182:183], v92 offset:11584
    ds_read_b64_tr_b16 v[200:201], v92 offset:96
    ds_read_b64_tr_b16 v[202:203], v92 offset:1376
    ds_read_b64_tr_b16 v[204:205], v92 offset:10336
    ds_read_b64_tr_b16 v[206:207], v92 offset:11616
    ds_read_b64_tr_b16 v[224:225], v92 offset:128
    ds_read_b64_tr_b16 v[226:227], v92 offset:1408
    ds_read_b64_tr_b16 v[228:229], v92 offset:10368
    ds_read_b64_tr_b16 v[230:231], v92 offset:11648
    ds_read_b64_tr_b16 v[248:249], v92 offset:160
    ds_read_b64_tr_b16 v[250:251], v92 offset:1440
    ds_read_b64_tr_b16 v[252:253], v92 offset:10400
    ds_read_b64_tr_b16 v[254:255], v92 offset:11680
    s_waitcnt lgkmcnt(0)
Lw_292:
    s_cmp_eq_u32 s16, 1
    s_cbranch_scc0 Lw_293
    ds_read_b64_tr_b16 v[128:129], v92 offset:192
    ds_read_b64_tr_b16 v[130:131], v92 offset:1472
    ds_read_b64_tr_b16 v[132:133], v92 offset:10432
    ds_read_b64_tr_b16 v[134:135], v92 offset:11712
    ds_read_b64_tr_b16 v[152:153], v92 offset:224
    ds_read_b64_tr_b16 v[154:155], v92 offset:1504
    ds_read_b64_tr_b16 v[156:157], v92 offset:10464
    ds_read_b64_tr_b16 v[158:159], v92 offset:11744
    ds_read_b64_tr_b16 v[176:177], v92 offset:256
    ds_read_b64_tr_b16 v[178:179], v92 offset:1536
    ds_read_b64_tr_b16 v[180:181], v92 offset:10496
    ds_read_b64_tr_b16 v[182:183], v92 offset:11776
    ds_read_b64_tr_b16 v[200:201], v92 offset:288
    ds_read_b64_tr_b16 v[202:203], v92 offset:1568
    ds_read_b64_tr_b16 v[204:205], v92 offset:10528
    ds_read_b64_tr_b16 v[206:207], v92 offset:11808
    s_waitcnt lgkmcnt(0)
Lw_293:
    s_cmp_eq_u32 s16, 2
    s_cbranch_scc0 Lw_294
    s_waitcnt lgkmcnt(0)
Lw_294:
    s_cmp_eq_u32 s16, 3
    s_cbranch_scc0 Lw_295
    s_waitcnt lgkmcnt(0)
Lw_295:
    s_barrier
    s_load_dwordx2 s[8:9], s[96:97], 56
    s_mov_b32 s10, 7864320
    s_mov_b32 s11, 0x00020000
    s_waitcnt lgkmcnt(0)
    s_mul_i32 s20, s12, 384
    s_mul_i32 s21, s13, 192
    s_add_u32 s20, s20, s21
    s_add_u32 s20, s20, 4718592
    s_mul_i32 s21, s16, 6144
    s_add_u32 s21, s21, 73728
    s_mov_b32 m0, s21
    s_add_u32 s21, s21, 1024
    buffer_load_dwordx4 v73, s[8:11], s20 offen lds
    s_mov_b32 m0, s21
    s_add_u32 s21, s21, 1024
    buffer_load_dwordx4 v74, s[8:11], s20 offen lds
    s_mov_b32 m0, s21
    s_add_u32 s21, s21, 1024
    buffer_load_dwordx4 v75, s[8:11], s20 offen lds
    s_mov_b32 m0, s21
    s_add_u32 s21, s21, 1024
    buffer_load_dwordx4 v76, s[8:11], s20 offen lds
    s_mov_b32 m0, s21
    s_add_u32 s21, s21, 1024
    buffer_load_dwordx4 v77, s[8:11], s20 offen lds
    s_mov_b32 m0, s21
    s_add_u32 s21, s21, 1024
    buffer_load_dwordx4 v78, s[8:11], s20 offen lds
    s_waitcnt vmcnt(24)
    s_barrier
    v_add_u32 v92, 98304, v84
    s_cmp_eq_u32 s16, 0
    s_cbranch_scc0 Lw_296
    s_waitcnt lgkmcnt(0)
Lw_296:
    s_cmp_eq_u32 s16, 1
    s_cbranch_scc0 Lw_297
    ds_read_b64_tr_b16 v[224:225], v92 offset:0
    ds_read_b64_tr_b16 v[226:227], v92 offset:1280
    ds_read_b64_tr_b16 v[228:229], v92 offset:10240
    ds_read_b64_tr_b16 v[230:231], v92 offset:11520
    ds_read_b64_tr_b16 v[248:249], v92 offset:32
    ds_read_b64_tr_b16 v[250:251], v92 offset:1312
    ds_read_b64_tr_b16 v[252:253], v92 offset:10272
    ds_read_b64_tr_b16 v[254:255], v92 offset:11552
    s_waitcnt lgkmcnt(0)
Lw_297:
    s_cmp_eq_u32 s16, 2
    s_cbranch_scc0 Lw_298
    ds_read_b64_tr_b16 v[176:177], v92 offset:64
    ds_read_b64_tr_b16 v[178:179], v92 offset:1344
    ds_read_b64_tr_b16 v[180:181], v92 offset:10304
    ds_read_b64_tr_b16 v[182:183], v92 offset:11584
    ds_read_b64_tr_b16 v[200:201], v92 offset:96
    ds_read_b64_tr_b16 v[202:203], v92 offset:1376
    ds_read_b64_tr_b16 v[204:205], v92 offset:10336
    ds_read_b64_tr_b16 v[206:207], v92 offset:11616
    ds_read_b64_tr_b16 v[224:225], v92 offset:128
    ds_read_b64_tr_b16 v[226:227], v92 offset:1408
    ds_read_b64_tr_b16 v[228:229], v92 offset:10368
    ds_read_b64_tr_b16 v[230:231], v92 offset:11648
    ds_read_b64_tr_b16 v[248:249], v92 offset:160
    ds_read_b64_tr_b16 v[250:251], v92 offset:1440
    ds_read_b64_tr_b16 v[252:253], v92 offset:10400
    ds_read_b64_tr_b16 v[254:255], v92 offset:11680
    s_waitcnt lgkmcnt(0)
Lw_298:
    s_cmp_eq_u32 s16, 3
    s_cbranch_scc0 Lw_299
    ds_read_b64_tr_b16 v[176:177], v92 offset:192
    ds_read_b64_tr_b16 v[178:179], v92 offset:1472
    ds_read_b64_tr_b16 v[180:181], v92 offset:10432
    ds_read_b64_tr_b16 v[182:183], v92 offset:11712
    ds_read_b64_tr_b16 v[200:201], v92 offset:224
    ds_read_b64_tr_b16 v[202:203], v92 offset:1504
    ds_read_b64_tr_b16 v[204:205], v92 offset:10464
    ds_read_b64_tr_b16 v[206:207], v92 offset:11744
    ds_read_b64_tr_b16 v[224:225], v92 offset:256
    ds_read_b64_tr_b16 v[226:227], v92 offset:1536
    ds_read_b64_tr_b16 v[228:229], v92 offset:10496
    ds_read_b64_tr_b16 v[230:231], v92 offset:11776
    ds_read_b64_tr_b16 v[248:249], v92 offset:288
    ds_read_b64_tr_b16 v[250:251], v92 offset:1568
    ds_read_b64_tr_b16 v[252:253], v92 offset:10528
    ds_read_b64_tr_b16 v[254:255], v92 offset:11808
    s_waitcnt lgkmcnt(0)
Lw_299:
    s_barrier
    s_load_dwordx2 s[8:9], s[96:97], 56
    s_mov_b32 s10, 7864320
    s_mov_b32 s11, 0x00020000
    s_waitcnt lgkmcnt(0)
    s_mul_i32 s20, s12, 384
    s_mul_i32 s21, s13, 192
    s_add_u32 s20, s20, s21
    s_add_u32 s20, s20, 6291456
    s_mul_i32 s21, s16, 6144
    s_add_u32 s21, s21, 98304
    s_mov_b32 m0, s21
    s_add_u32 s21, s21, 1024
    buffer_load_dwordx4 v73, s[8:11], s20 offen lds
    s_mov_b32 m0, s21
    s_add_u32 s21, s21, 1024
    buffer_load_dwordx4 v74, s[8:11], s20 offen lds
    s_mov_b32 m0, s21
    s_add_u32 s21, s21, 1024
    buffer_load_dwordx4 v75, s[8:11], s20 offen lds
    s_mov_b32 m0, s21
    s_add_u32 s21, s21, 1024
    buffer_load_dwordx4 v76, s[8:11], s20 offen lds
    s_mov_b32 m0, s21
    s_add_u32 s21, s21, 1024
    buffer_load_dwordx4 v77, s[8:11], s20 offen lds
    s_mov_b32 m0, s21
    s_add_u32 s21, s21, 1024
    buffer_load_dwordx4 v78, s[8:11], s20 offen lds
    s_waitcnt vmcnt(24)
    s_barrier
    ds_read_b64_tr_b16 v[32:33], v8 offset:0
    ds_read_b64_tr_b16 v[34:35], v8 offset:1536
    ds_read_b64_tr_b16 v[36:37], v8 offset:6144
    ds_read_b64_tr_b16 v[38:39], v8 offset:7680
    ds_read_b64_tr_b16 v[40:41], v8 offset:12288
    ds_read_b64_tr_b16 v[42:43], v8 offset:13824
    ds_read_b64_tr_b16 v[44:45], v8 offset:18432
    ds_read_b64_tr_b16 v[46:47], v8 offset:19968
    ds_read_b64_tr_b16 v[48:49], v9 offset:0
    ds_read_b64_tr_b16 v[50:51], v9 offset:1536
    ds_read_b64_tr_b16 v[52:53], v9 offset:6144
    ds_read_b64_tr_b16 v[54:55], v9 offset:7680
    ds_read_b64_tr_b16 v[56:57], v9 offset:12288
    ds_read_b64_tr_b16 v[58:59], v9 offset:13824
    ds_read_b64_tr_b16 v[60:61], v9 offset:18432
    ds_read_b64_tr_b16 v[62:63], v9 offset:19968
    s_waitcnt lgkmcnt(0)
    s_barrier
    s_lshl_b32 s20, s16, 1
    s_sub_u32 s20, s20, 2
    s_cmp_lt_u32 s16, 2
    s_cselect_b32 s20, s16, s20
    s_lshl_b32 s20, s20, 11
    s_add_u32 s20, s20, 0
    v_add_u32 v92, s20, v1
    ds_write_b128 v92, v[32:35] offset:0
    ds_write_b128 v92, v[36:39] offset:1024
    ds_write_b128 v92, v[40:43] offset:12288
    ds_write_b128 v92, v[44:47] offset:13312
    s_cmp_lt_u32 s16, 2
    s_cbranch_scc1 Lv_300
    ds_write_b128 v92, v[48:51] offset:2048
    ds_write_b128 v92, v[52:55] offset:3072
    ds_write_b128 v92, v[56:59] offset:14336
    ds_write_b128 v92, v[60:63] offset:15360
Lv_300:
    s_waitcnt lgkmcnt(0)
    s_barrier
    s_waitcnt vmcnt(18)
    s_barrier
    ds_read_b64_tr_b16 v[32:33], v8 offset:24576
    ds_read_b64_tr_b16 v[34:35], v8 offset:26112
    ds_read_b64_tr_b16 v[36:37], v8 offset:30720
    ds_read_b64_tr_b16 v[38:39], v8 offset:32256
    ds_read_b64_tr_b16 v[40:41], v8 offset:36864
    ds_read_b64_tr_b16 v[42:43], v8 offset:38400
    ds_read_b64_tr_b16 v[44:45], v8 offset:43008
    ds_read_b64_tr_b16 v[46:47], v8 offset:44544
    ds_read_b64_tr_b16 v[48:49], v9 offset:24576
    ds_read_b64_tr_b16 v[50:51], v9 offset:26112
    ds_read_b64_tr_b16 v[52:53], v9 offset:30720
    ds_read_b64_tr_b16 v[54:55], v9 offset:32256
    ds_read_b64_tr_b16 v[56:57], v9 offset:36864
    ds_read_b64_tr_b16 v[58:59], v9 offset:38400
    ds_read_b64_tr_b16 v[60:61], v9 offset:43008
    ds_read_b64_tr_b16 v[62:63], v9 offset:44544
    s_waitcnt lgkmcnt(0)
    s_barrier
    s_lshl_b32 s20, s16, 1
    s_sub_u32 s20, s20, 2
    s_cmp_lt_u32 s16, 2
    s_cselect_b32 s20, s16, s20
    s_lshl_b32 s20, s20, 11
    s_add_u32 s20, s20, 24576
    v_add_u32 v92, s20, v1
    ds_write_b128 v92, v[32:35] offset:0
    ds_write_b128 v92, v[36:39] offset:1024
    ds_write_b128 v92, v[40:43] offset:12288
    ds_write_b128 v92, v[44:47] offset:13312
    s_cmp_lt_u32 s16, 2
    s_cbranch_scc1 Lv_301
    ds_write_b128 v92, v[48:51] offset:2048
    ds_write_b128 v92, v[52:55] offset:3072
    ds_write_b128 v92, v[56:59] offset:14336
    ds_write_b128 v92, v[60:63] offset:15360
Lv_301:
    s_waitcnt lgkmcnt(0)
    s_barrier
    s_waitcnt vmcnt(12)
    s_barrier
    ds_read_b64_tr_b16 v[32:33], v8 offset:49152
    ds_read_b64_tr_b16 v[34:35], v8 offset:50688
    ds_read_b64_tr_b16 v[36:37], v8 offset:55296
    ds_read_b64_tr_b16 v[38:39], v8 offset:56832
    ds_read_b64_tr_b16 v[40:41], v10 offset:0
    ds_read_b64_tr_b16 v[42:43], v10 offset:1536
    ds_read_b64_tr_b16 v[44:45], v10 offset:6144
    ds_read_b64_tr_b16 v[46:47], v10 offset:7680
    ds_read_b64_tr_b16 v[48:49], v9 offset:49152
    ds_read_b64_tr_b16 v[50:51], v9 offset:50688
    ds_read_b64_tr_b16 v[52:53], v9 offset:55296
    ds_read_b64_tr_b16 v[54:55], v9 offset:56832
    ds_read_b64_tr_b16 v[56:57], v11 offset:0
    ds_read_b64_tr_b16 v[58:59], v11 offset:1536
    ds_read_b64_tr_b16 v[60:61], v11 offset:6144
    ds_read_b64_tr_b16 v[62:63], v11 offset:7680
    s_waitcnt lgkmcnt(0)
    s_barrier
    s_lshl_b32 s20, s16, 1
    s_sub_u32 s20, s20, 2
    s_cmp_lt_u32 s16, 2
    s_cselect_b32 s20, s16, s20
    s_lshl_b32 s20, s20, 11
    s_add_u32 s20, s20, 49152
    v_add_u32 v92, s20, v1
    ds_write_b128 v92, v[32:35] offset:0
    ds_write_b128 v92, v[36:39] offset:1024
    ds_write_b128 v92, v[40:43] offset:12288
    ds_write_b128 v92, v[44:47] offset:13312
    s_cmp_lt_u32 s16, 2
    s_cbranch_scc1 Lv_302
    ds_write_b128 v92, v[48:51] offset:2048
    ds_write_b128 v92, v[52:55] offset:3072
    ds_write_b128 v92, v[56:59] offset:14336
    ds_write_b128 v92, v[60:63] offset:15360
Lv_302:
    s_waitcnt lgkmcnt(0)
    s_barrier
    s_waitcnt vmcnt(6)
    s_barrier
    ds_read_b64_tr_b16 v[32:33], v10 offset:12288
    ds_read_b64_tr_b16 v[34:35], v10 offset:13824
    ds_read_b64_tr_b16 v[36:37], v10 offset:18432
    ds_read_b64_tr_b16 v[38:39], v10 offset:19968
    ds_read_b64_tr_b16 v[40:41], v10 offset:24576
    ds_read_b64_tr_b16 v[42:43], v10 offset:26112
    ds_read_b64_tr_b16 v[44:45], v10 offset:30720
    ds_read_b64_tr_b16 v[46:47], v10 offset:32256
    ds_read_b64_tr_b16 v[48:49], v11 offset:12288
    ds_read_b64_tr_b16 v[50:51], v11 offset:13824
    ds_read_b64_tr_b16 v[52:53], v11 offset:18432
    ds_read_b64_tr_b16 v[54:55], v11 offset:19968
    ds_read_b64_tr_b16 v[56:57], v11 offset:24576
    ds_read_b64_tr_b16 v[58:59], v11 offset:26112
    ds_read_b64_tr_b16 v[60:61], v11 offset:30720
    ds_read_b64_tr_b16 v[62:63], v11 offset:32256
    s_waitcnt lgkmcnt(0)
    s_barrier
    s_lshl_b32 s20, s16, 1
    s_sub_u32 s20, s20, 2
    s_cmp_lt_u32 s16, 2
    s_cselect_b32 s20, s16, s20
    s_lshl_b32 s20, s20, 11
    s_add_u32 s20, s20, 73728
    v_add_u32 v92, s20, v1
    ds_write_b128 v92, v[32:35] offset:0
    ds_write_b128 v92, v[36:39] offset:1024
    ds_write_b128 v92, v[40:43] offset:12288
    ds_write_b128 v92, v[44:47] offset:13312
    s_cmp_lt_u32 s16, 2
    s_cbranch_scc1 Lv_303
    ds_write_b128 v92, v[48:51] offset:2048
    ds_write_b128 v92, v[52:55] offset:3072
    ds_write_b128 v92, v[56:59] offset:14336
    ds_write_b128 v92, v[60:63] offset:15360
Lv_303:
    s_waitcnt lgkmcnt(0)
    s_barrier
    s_waitcnt vmcnt(0)
    s_barrier
    ds_read_b64_tr_b16 v[32:33], v10 offset:36864
    ds_read_b64_tr_b16 v[34:35], v10 offset:38400
    ds_read_b64_tr_b16 v[36:37], v10 offset:43008
    ds_read_b64_tr_b16 v[38:39], v10 offset:44544
    ds_read_b64_tr_b16 v[40:41], v10 offset:49152
    ds_read_b64_tr_b16 v[42:43], v10 offset:50688
    ds_read_b64_tr_b16 v[44:45], v10 offset:55296
    ds_read_b64_tr_b16 v[46:47], v10 offset:56832
    ds_read_b64_tr_b16 v[48:49], v11 offset:36864
    ds_read_b64_tr_b16 v[50:51], v11 offset:38400
    ds_read_b64_tr_b16 v[52:53], v11 offset:43008
    ds_read_b64_tr_b16 v[54:55], v11 offset:44544
    ds_read_b64_tr_b16 v[56:57], v11 offset:49152
    ds_read_b64_tr_b16 v[58:59], v11 offset:50688
    ds_read_b64_tr_b16 v[60:61], v11 offset:55296
    ds_read_b64_tr_b16 v[62:63], v11 offset:56832
    s_waitcnt lgkmcnt(0)
    s_barrier
    s_lshl_b32 s20, s16, 1
    s_sub_u32 s20, s20, 2
    s_cmp_lt_u32 s16, 2
    s_cselect_b32 s20, s16, s20
    s_lshl_b32 s20, s20, 11
    s_add_u32 s20, s20, 98304
    v_add_u32 v92, s20, v1
    ds_write_b128 v92, v[32:35] offset:0
    ds_write_b128 v92, v[36:39] offset:1024
    ds_write_b128 v92, v[40:43] offset:12288
    ds_write_b128 v92, v[44:47] offset:13312
    s_cmp_lt_u32 s16, 2
    s_cbranch_scc1 Lv_304
    ds_write_b128 v92, v[48:51] offset:2048
    ds_write_b128 v92, v[52:55] offset:3072
    ds_write_b128 v92, v[56:59] offset:14336
    ds_write_b128 v92, v[60:63] offset:15360
Lv_304:
    s_waitcnt lgkmcnt(0)
    s_barrier
    s_waitcnt vmcnt(0)
    s_barrier
    s_lshl_b32 s20, s16, 1
    s_sub_u32 s20, s20, 2
    s_cmp_lt_u32 s16, 2
    s_cselect_b32 s20, s16, s20
    s_lshl_b32 s20, s20, 11
    s_add_u32 s20, s20, 0
    v_add_u32 v8, s20, v1
    v_add_u32 v9, 2048, v8
    v_add_u32 v10, 49152, v8
    v_add_u32 v11, 49152, v9
    s_cmp_lt_u32 s16, 2
    s_cbranch_scc0 Li_305
    s_mul_i32 s20, s16, 3072
    s_add_u32 s20, s20, 151040
    v_add_u32 v11, s20, v1
    s_branch Li_306
Li_305:
    s_mul_i32 s20, s16, 3072
    s_add_u32 s20, s20, 151040
    v_add_u32 v150, s20, v1
Li_306:
    v_mov_b32 v48, 0
    v_mov_b32 v49, 0
    v_mov_b32 v50, 0
    v_mov_b32 v51, 0
    v_mov_b32 v56, 0
    v_mov_b32 v57, 0
    v_mov_b32 v58, 0
    v_mov_b32 v59, 0
    v_mov_b32 v64, 0
    v_mov_b32 v65, 0
    v_mov_b32 v66, 0
    v_mov_b32 v67, 0
    s_cmp_eq_u32 s16, 0
    s_cbranch_scc0 Li_307
    v_mov_b32 v68, 0xf149f2ca
    v_mov_b32 v69, 0xf149f2ca
    v_mov_b32 v70, 0xf149f2ca
    v_mov_b32 v71, 0xf149f2ca
    ds_write_b128 v4, v[68:71] offset:13440
    ds_write_b128 v4, v[68:71] offset:14464
    s_waitcnt lgkmcnt(0)
Li_307:
    s_waitcnt vmcnt(0)
    s_waitcnt vmcnt(0) lgkmcnt(0)
    s_barrier
    s_cmp_eq_u32 s16, 0
    s_cbranch_scc0 Lb_308
    v_mov_b32 v68, 16
    v_mov_b32 v69, 1
    s_mov_b64 exec, 1
    global_atomic_add v68, v69, s[90:91]
    s_mov_b32 s24, 0
Lb_309:
    global_load_dword v70, v68, s[90:91] sc1
    s_waitcnt vmcnt(0)
    v_readfirstlane_b32 s20, v70
    s_nop 3
    s_cmp_ge_u32 s20, 64
    s_cbranch_scc1 Lb_310
    s_sleep 1
    s_add_u32 s24, s24, 1
    s_cmp_lt_u32 s24, 400000
    s_cbranch_scc1 Lb_309
    s_branch L_abort
Lb_310:
    s_mov_b64 exec, -1
Lb_308:
    s_barrier
    s_cmp_eq_u32 s16, 0
    s_cbranch_scc0 Lz_313
    v_mov_b32 v68, 200
    s_mov_b32 s24, 0
Lz_311:
    global_load_dword v69, v68, s[90:91] sc1
    s_waitcnt vmcnt(0)
    v_readfirstlane_b32 s20, v69
    s_nop 3
    s_cmp_ge_u32 s20, 256
    s_cbranch_scc1 Lz_312
    s_sleep 4
    s_add_u32 s24, s24, 1
    s_cmp_lt_u32 s24, 400000
    s_cbranch_scc1 Lz_311
    s_branch L_abort
Lz_312:
Lz_313:
    s_barrier
    v_mov_b32 v68, 20
    s_mov_b32 s24, 0
Lp_314:
    global_load_dword v69, v68, s[90:91] sc1
    s_waitcnt vmcnt(0)
    v_readfirstlane_b32 s20, v69
    s_nop 3
    s_cmp_lg_u32 s20, 0
    s_cbranch_scc1 Lp_315
    s_sleep 2
    s_add_u32 s24, s24, 1
    s_cmp_lt_u32 s24, 400000
    s_cbranch_scc1 Lp_314
    s_branch L_abort
Lp_315:
    s_cmp_eq_u32 s20, 2
    s_cselect_b32 s61, 8192, 0
    s_add_u32 s59, s59, s61
    s_add_u32 s60, s60, s61
    s_cmp_eq_u32 s88, 0
    s_cbranch_scc1 Li_316
    s_load_dwordx2 s[8:9], s[96:97], 32
    s_mov_b32 s10, 10240
    s_mov_b32 s11, 0x00020000
    v_bfe_u32 v68, v0, 3, 1
    v_lshlrev_b32 v68, 1, v68
    v_bfe_u32 v69, v0, 4, 1
    v_add_u32 v68, v68, v69
    s_and_b32 s20, s99, 1
    s_lshl_b32 s20, s20, 2
    v_add_u32 v68, s20, v68
    v_mul_u32_u24 v68, 1280, v68
    v_bfe_u32 v69, v0, 2, 1
    v_bfe_u32 v70, v0, 1, 1
    v_lshlrev_b32 v70, 1, v70
    v_add_u32 v69, v69, v70
    v_and_b32 v70, 1, v0
    v_lshlrev_b32 v70, 3, v70
    v_add_u32 v69, v69, v70
    s_lshr_b32 s20, s99, 1
    s_and_b32 s20, s20, 1
    s_lshl_b32 s20, s20, 2
    s_lshr_b32 s21, s99, 2
    s_lshl_b32 s21, s21, 5
    s_add_u32 s20, s20, s21
    v_add_u32 v69, s20, v69
    v_lshlrev_b32 v69, 1, v69
    v_add_u32 v69, v69, v68
    s_waitcnt lgkmcnt(0)
    s_mov_b64 exec, s[100:101]
    buffer_load_ushort v72, v69, s[8:11], 0 offen
    buffer_load_ushort v73, v69, s[8:11], 0 offen offset:32
    s_waitcnt vmcnt(0)
    v_lshlrev_b32 v73, 16, v73
    v_or_b32 v72, v72, v73
    s_add_u32 s20, s58, 117440512
    s_cmp_eq_u32 s25, 0
    s_cbranch_scc1 Lst_317
    buffer_store_dword v72, v28, s[4:7], s20 offen
    s_branch Lst_318
Lst_317:
    buffer_store_dword v72, v28, s[4:7], s20 offen sc1
Lst_318:
    s_waitcnt vmcnt(0)
    s_mov_b64 exec, -1
Li_316:
    s_lshl_b32 s32, s12, 6
    s_add_u32 s32, s32, 125829120
    s_mul_i32 s46, s16, 3072
    s_add_u32 s46, s46, 151040
    s_mov_b32 s53, -6144
    s_cmp_eq_u32 s16, 3
    s_cbranch_scc0 Lk_319
    v_mov_b32 v14, 0
    v_cmp_gt_u32 vcc, 1, v14
    s_cbranch_vccz Lf_320
    v_and_b32 v108, 7, v0
    v_lshlrev_b32 v108, 2, v108
    s_mov_b32 s24, 0
Lf_321:
    buffer_load_dword v14, v108, s[4:7], s32 offen sc1
    s_waitcnt vmcnt(0)
    v_cmp_gt_u32 vcc, 1, v14
    s_cbranch_vccz Lf_320
    s_add_u32 s24, s24, 1
    s_cmp_lt_u32 s24, 400000
    s_cbranch_scc1 Lf_321
    s_branch L_abort
Lf_320:
    s_mul_i32 s20, s12, 12288
    s_mul_i32 s21, s13, 6144
    s_add_u32 s20, s20, s21
    s_mov_b32 m0, 138752
    s_add_u32 s21, s20, 0
    buffer_load_dwordx4 v1, s[4:7], s21 offen offset:0 sc1 nt lds
    buffer_load_dwordx4 v1, s[4:7], s21 offen offset:1024 sc1 nt lds
    buffer_load_dwordx4 v1, s[4:7], s21 offen offset:2048 sc1 nt lds
    buffer_load_dwordx4 v1, s[4:7], s21 offen offset:3072 sc1 nt lds
    s_mov_b32 m0, 142848
    s_add_u32 s21, s20, 4096
    buffer_load_dwordx4 v1, s[4:7], s21 offen offset:0 sc1 nt lds
    buffer_load_dwordx4 v1, s[4:7], s21 offen offset:1024 sc1 nt lds
    s_waitcnt vmcnt(0)
Lk_319:
    s_cmp_lt_u32 s16, 2
    s_cbranch_scc0 Lk_322
    v_add_u32 v17, 6144, v17
    v_add_u32 v18, 6144, v18
Lk_322:
    s_mov_b32 s17, 0
    s_cmp_eq_u32 s25, 0
    s_cbranch_scc1 Ld_323
    s_cmp_eq_u32 s16, 2
    s_cbranch_scc1 T_2L
    s_cmp_eq_u32 s16, 3
    s_cbranch_scc1 T_3L
    s_branch T_0L
Ld_323:
    s_cmp_eq_u32 s16, 2
    s_cbranch_scc1 T_2G
    s_cmp_eq_u32 s16, 3
    s_cbranch_scc1 T_3G
    s_branch T_0G
    .p2align 6
T_0L:
    s_and_b32 s20, s17, 3
    s_lshl_b32 s18, s20, 21
    s_add_u32 s18, s18, 117440512
    s_lshl_b32 s62, s20, 17
    s_add_u32 s20, s17, 1
    s_and_b32 s20, s20, 3
    s_lshl_b32 s19, s20, 21
    s_add_u32 s19, s19, 117440512
    s_add_u32 s20, s17, 3
    s_and_b32 s20, s20, 3
    s_lshl_b32 s26, s20, 21
    s_add_u32 s26, s26, 117440512
    s_lshl_b32 s63, s20, 17
    s_lshl_b32 s44, s12, 12
    s_add_u32 s44, s44, 131072
    s_add_u32 s44, s44, s18
    s_lshl_b32 s20, s17, 5
    s_add_u32 s20, s20, s12
    s_mul_i32 s21, s20, 3072
    s_add_u32 s30, s21, 106954752
    s_mul_i32 s20, s20, 12288
    s_mul_i32 s21, s16, 6144
    s_add_u32 s28, s20, s21
    s_add_u32 s28, s28, 25165824
    s_mul_i32 s21, s13, 6144
    s_add_u32 s27, s20, s21
    s_mul_i32 s21, s16, 3072
    s_add_u32 s27, s27, s21
    s_add_u32 s27, s27, 393216
    s_add_u32 s20, s17, 1
    s_and_b32 s20, s20, 1
    s_mul_i32 s47, s20, 6144
    s_add_u32 s47, s47, s21
    s_add_u32 s47, s47, 138752
    v_add_u32 v17, s53, v17
    v_add_u32 v18, s53, v18
    s_sub_u32 s53, 0, s53
    s_add_u32 s95, s18, s58
    s_mov_b32 s89, 0xf0000000
    s_mov_b32 s92, 0xf0000000
    s_lshl_b32 s98, s12, 12
    s_add_u32 s98, s98, 131072
    s_mul_i32 s46, s16, 6144
    s_add_u32 s46, s46, 151040
    v_mov_b32 v88, 0
    v_mov_b32 v89, 0
    v_mov_b32 v90, 0
    v_mov_b32 v91, 0
    v_mov_b32 v92, 0
    v_mov_b32 v93, 0
    v_mov_b32 v94, 0
    v_mov_b32 v95, 0
    v_mov_b32 v96, 0
    v_mov_b32 v97, 0
    v_mov_b32 v98, 0
    v_mov_b32 v99, 0
    v_mov_b32 v100, 0
    v_mov_b32 v101, 0
    v_mov_b32 v102, 0
    v_mov_b32 v103, 0
L_loop_0L:
    v_mov_b32 v76, 0
    v_mov_b32 v77, 0
    v_mov_b32 v78, 0
    v_mov_b32 v79, 0
    s_mov_b32 s24, 0
Lg_324:
    buffer_load_dwordx4 v[68:71], v3, s[4:7], s95 offen sc1
    buffer_load_dwordx4 v[72:75], v3, s[4:7], s95 offen offset:1024 sc1
    s_mov_b64 exec, s[34:35]
    buffer_load_dwordx4 v[76:79], v3, s[4:7], s95 offen offset:2048 sc1
    s_mov_b64 exec, -1
    s_waitcnt vmcnt(0)
    v_max3_u32 v84, v68, v69, v70
    v_max3_u32 v85, v71, v72, v73
    v_max3_u32 v84, v84, v74, v75
    v_max3_u32 v85, v85, v76, v77
    v_max3_u32 v84, v84, v78, v79
    v_max_u32 v84, v84, v85
    v_cmp_eq_u32 vcc, -1, v84
    s_cbranch_vccz Lg_325
    s_add_u32 s24, s24, 1
    s_cmp_lt_u32 s24, 400000
    s_cbranch_scc1 Lg_324
    s_branch L_abort
Lg_325:
    ds_write_b128 v2, v[68:71] offset:0
    ds_write_b128 v2, v[72:75] offset:1024
    s_mov_b64 exec, s[34:35]
    ds_write_b128 v2, v[76:79] offset:2048
    s_mov_b64 exec, -1
    s_waitcnt lgkmcnt(0)
    s_barrier
    ds_read_b128 v[68:71], v4 offset:0
    ds_read_b128 v[32:35], v8 offset:0
    ds_read_b128 v[36:39], v8 offset:1024
    ds_read_b128 v[72:75], v4 offset:1024
    ds_read_b128 v[80:83], v8 offset:12288
    ds_read_b128 v[84:87], v8 offset:13312
    s_waitcnt lgkmcnt(3)
    v_smfmac_f32_16x16x64_bf16 v[88:91], v[68:71], a[0:7], v30
    ds_read_b128 v[76:79], v4 offset:2048
    v_smfmac_f32_16x16x64_bf16 v[92:95], v[68:71], a[80:87], v30
    ds_read_b128 v[104:107], v8 offset:24576
    s_mov_b32 m0, s46
    s_nop 0
    buffer_load_dwordx4 v1, s[4:7], s28 offen offset:0 sc1 nt lds
    v_smfmac_f32_16x16x64_bf16 v[96:99], v[68:71], a[160:167], v30
    ds_read_b128 v[108:111], v8 offset:25600
    v_smfmac_f32_16x16x64_bf16 v[100:103], v[68:71], v[32:39], v30
    buffer_load_dwordx4 v1, s[4:7], s28 offen offset:1024 sc1 nt lds
    s_waitcnt lgkmcnt(3)
    v_smfmac_f32_16x16x64_bf16 v[88:91], v[72:75], a[8:15], v30
    ds_read_b128 v[68:71], v4 offset:3072
    v_smfmac_f32_16x16x64_bf16 v[92:95], v[72:75], a[88:95], v30
    ds_read_b128 v[32:35], v8 offset:36864
    buffer_load_dwordx4 v1, s[4:7], s28 offen offset:2048 sc1 nt lds
    v_smfmac_f32_16x16x64_bf16 v[96:99], v[72:75], a[168:175], v30
    ds_read_b128 v[36:39], v8 offset:37888
    v_smfmac_f32_16x16x64_bf16 v[100:103], v[72:75], v[80:87], v30
    buffer_load_dwordx4 v1, s[4:7], s28 offen offset:3072 sc1 nt lds
    s_waitcnt lgkmcnt(3)
    v_smfmac_f32_16x16x64_bf16 v[88:91], v[76:79], a[16:23], v30
    ds_read_b128 v[72:75], v4 offset:4096
    v_smfmac_f32_16x16x64_bf16 v[92:95], v[76:79], a[96:103], v30
    ds_read_b128 v[80:83], v10 offset:0
    s_add_u32 m0, s46, 4096
    s_add_u32 s20, s28, 4096
    buffer_load_dwordx4 v1, s[4:7], s20 offen offset:0 sc1 nt lds
    v_smfmac_f32_16x16x64_bf16 v[96:99], v[76:79], a[176:183], v30
    ds_read_b128 v[84:87], v10 offset:1024
    v_smfmac_f32_16x16x64_bf16 v[100:103], v[76:79], v[104:111], v30
    buffer_load_dwordx4 v1, s[4:7], s20 offen offset:1024 sc1 nt lds
    s_waitcnt lgkmcnt(3)
    v_smfmac_f32_16x16x64_bf16 v[88:91], v[68:71], a[24:31], v30
    ds_read_b128 v[76:79], v4 offset:5120
    v_smfmac_f32_16x16x64_bf16 v[92:95], v[68:71], a[104:111], v30
    ds_read_b128 v[104:107], v10 offset:12288
    s_mov_b32 m0, s47
    s_nop 0
    buffer_load_dwordx4 v1, s[4:7], s27 offen offset:0 sc1 nt lds
    v_smfmac_f32_16x16x64_bf16 v[96:99], v[68:71], a[184:191], v30
    ds_read_b128 v[108:111], v10 offset:13312
    v_smfmac_f32_16x16x64_bf16 v[100:103], v[68:71], v[32:39], v30
    buffer_load_dwordx4 v1, s[4:7], s27 offen offset:1024 sc1 nt lds
    s_waitcnt lgkmcnt(3)
    v_smfmac_f32_16x16x64_bf16 v[88:91], v[72:75], a[32:39], v30
    ds_read_b128 v[68:71], v4 offset:6144
    v_smfmac_f32_16x16x64_bf16 v[92:95], v[72:75], a[112:119], v30
    ds_read_b128 v[32:35], v10 offset:24576
    buffer_load_dwordx4 v1, s[4:7], s27 offen offset:2048 sc1 nt lds
    v_smfmac_f32_16x16x64_bf16 v[96:99], v[72:75], a[192:199], v30
    ds_read_b128 v[36:39], v10 offset:25600
    v_smfmac_f32_16x16x64_bf16 v[100:103], v[72:75], v[80:87], v30
    buffer_store_dword v9, v19, s[4:7], s89 offen sc1
    s_waitcnt lgkmcnt(3)
    v_smfmac_f32_16x16x64_bf16 v[88:91], v[76:79], a[40:47], v30
    ds_read_b128 v[72:75], v4 offset:7168
    v_smfmac_f32_16x16x64_bf16 v[92:95], v[76:79], a[120:127], v30
    ds_read_b128 v[80:83], v10 offset:36864
    s_sub_u32 s22, s63, 131072
    s_and_b32 s22, s22, 0x7ffff
    s_add_u32 s21, s22, s59
    s_mov_b64 exec, s[56:57]
    buffer_store_dwordx4 a[248:251], v29, s[4:7], s21 offen sc1
    s_mov_b64 exec, -1
    v_smfmac_f32_16x16x64_bf16 v[96:99], v[76:79], a[200:207], v30
    ds_read_b128 v[84:87], v10 offset:37888
    v_smfmac_f32_16x16x64_bf16 v[100:103], v[76:79], v[104:111], v30
    s_waitcnt lgkmcnt(3)
    v_smfmac_f32_16x16x64_bf16 v[88:91], v[68:71], a[48:55], v30
    ds_read_b128 v[76:79], v4 offset:8192
    v_smfmac_f32_16x16x64_bf16 v[92:95], v[68:71], a[128:135], v30
    ds_read_b128 v[104:107], v10 offset:49152
    v_smfmac_f32_16x16x64_bf16 v[96:99], v[68:71], a[208:215], v30
    ds_read_b128 v[108:111], v10 offset:50176
    v_smfmac_f32_16x16x64_bf16 v[100:103], v[68:71], v[32:39], v30
    s_waitcnt lgkmcnt(3)
    v_smfmac_f32_16x16x64_bf16 v[88:91], v[72:75], a[56:63], v30
    ds_read_b128 v[68:71], v4 offset:9216
    v_smfmac_f32_16x16x64_bf16 v[92:95], v[72:75], a[136:143], v30
    ds_read_b128 v[32:35], v10 offset:61440
    v_smfmac_f32_16x16x64_bf16 v[96:99], v[72:75], a[216:223], v30
    ds_read_b128 v[36:39], v10 offset:62464
    v_smfmac_f32_16x16x64_bf16 v[100:103], v[72:75], v[80:87], v30
    s_waitcnt lgkmcnt(3)
    v_smfmac_f32_16x16x64_bf16 v[88:91], v[76:79], a[64:71], v30
    v_smfmac_f32_16x16x64_bf16 v[92:95], v[76:79], a[144:151], v30
    v_smfmac_f32_16x16x64_bf16 v[96:99], v[76:79], a[224:231], v30
    v_smfmac_f32_16x16x64_bf16 v[100:103], v[76:79], v[104:111], v30
    s_waitcnt lgkmcnt(0)
    v_smfmac_f32_16x16x64_bf16 v[88:91], v[68:71], a[72:79], v30
    v_smfmac_f32_16x16x64_bf16 v[92:95], v[68:71], a[152:159], v30
    v_smfmac_f32_16x16x64_bf16 v[96:99], v[68:71], a[232:239], v30
    v_smfmac_f32_16x16x64_bf16 v[100:103], v[68:71], v[32:39], v30
    s_nop 5
    v_add_f32 v88, v88, v89
    v_add_f32 v90, v90, v91
    v_add_f32 v92, v92, v93
    v_add_f32 v94, v94, v95
    v_add_f32 v96, v96, v97
    v_add_f32 v98, v98, v99
    v_cvt_pk_bf16_f32 v89, v88, v90
    v_cvt_pk_bf16_f32 v93, v92, v94
    v_cvt_pk_bf16_f32 v97, v96, v98
    v_mov_b32_dpp v91, v89 quad_perm:[1,0,3,2] row_mask:0xf bank_mask:0xf
    v_mov_b32_dpp v95, v93 quad_perm:[1,0,3,2] row_mask:0xf bank_mask:0xf
    v_mov_b32_dpp v99, v97 quad_perm:[1,0,3,2] row_mask:0xf bank_mask:0xf
    v_perm_b32 v91, v91, v89, v31
    ds_write_b32 v5, v91
    v_perm_b32 v95, v95, v93, v31
    ds_write_b32 v6, v95
    v_perm_b32 v99, v99, v97, v31
    ds_write_b32 v7, v99
    v_add_f32 v100, v100, v101
    v_add_f32 v102, v102, v103
    v_cvt_pk_bf16_f32 v100, v100, v102
    s_waitcnt lgkmcnt(0)
    s_barrier
    ds_read_b128 v[84:87], v4 offset:10240
    ds_read_b64 v[96:97], v16
    ds_read_b128 v[32:35], v17
    ds_read_b128 v[36:39], v17 offset:3072
    ds_read_b128 v[40:43], v18
    buffer_store_dword v100, v19, s[4:7], s44 offen
    v_mov_b32 v9, v100
    v_mov_b32 v88, 0
    v_mov_b32 v89, 0
    v_mov_b32 v90, 0
    v_mov_b32 v91, 0
    v_mov_b32 v92, 0
    v_mov_b32 v93, 0
    v_mov_b32 v94, 0
    v_mov_b32 v95, 0
    s_waitcnt lgkmcnt(0)
    v_smfmac_f32_16x16x64_bf16 v[88:91], v[84:87], v[32:39], v30
    v_smfmac_f32_16x16x32_bf16 v[92:95], v[96:97], v[40:43], v30
    s_nop 6
    v_add_f32 v88, v88, v89
    v_add_f32 v90, v90, v91
    v_add_f32 v92, v92, v93
    v_add_f32 v94, v94, v95
    v_add_f32 v88, v88, v92
    v_add_f32 v90, v90, v94
    buffer_store_dword v88, v13, s[4:7], s18 offen
    buffer_store_dword v90, v13, s[4:7], s18 offen offset:32
    ds_write_b32 v12, v88
    ds_write_b32 v12, v90 offset:32
    v_mov_b32 v88, 0
    v_mov_b32 v89, 0
    v_mov_b32 v90, 0
    v_mov_b32 v91, 0
    v_mov_b32 v92, 0
    v_mov_b32 v93, 0
    v_mov_b32 v94, 0
    v_mov_b32 v95, 0
    v_mov_b32 v96, 0
    v_mov_b32 v97, 0
    v_mov_b32 v98, 0
    v_mov_b32 v99, 0
    v_mov_b32 v100, 0
    v_mov_b32 v101, 0
    v_mov_b32 v102, 0
    v_mov_b32 v103, 0
    s_sleep 3
    buffer_load_dwordx4 v[68:71], v15, s[4:7], s18 offen sc1
    buffer_load_dwordx4 v[72:75], v15, s[4:7], s18 offen offset:1024 sc1
    s_waitcnt lgkmcnt(0)
    s_waitcnt vmcnt(5)
    s_barrier
    s_cmp_eq_u32 s17, 63
    s_cbranch_scc1 L_last_0L
    ds_read_b128 v[76:79], v4 offset:13440
    ds_read_b128 v[80:83], v4 offset:14464
    ds_read_b128 v[44:47], v11 offset:0
    ds_read_b128 v[52:55], v11 offset:1024
    ds_read_b128 v[60:63], v11 offset:2048
    s_mov_b32 s24, 0
    s_waitcnt vmcnt(0)
    s_branch Lp_326_chk
Lp_326:
    buffer_load_dwordx4 v[68:71], v15, s[4:7], s18 offen sc1
    buffer_load_dwordx4 v[72:75], v15, s[4:7], s18 offen offset:1024 sc1
    s_waitcnt vmcnt(0)
Lp_326_chk:
    v_max3_u32 v84, v68, v69, v70
    v_max3_u32 v85, v71, v72, v73
    v_max3_u32 v84, v84, v74, v75
    v_max_u32 v84, v84, v85
    v_cmp_eq_u32 vcc, -1, v84
    s_cbranch_vccz Lp_327
    s_add_u32 s24, s24, 1
    s_cmp_lt_u32 s24, 400000
    s_cbranch_scc1 Lp_326
    s_branch L_abort
Lp_327:
    s_mov_b64 exec, s[36:37]
    buffer_load_dwordx2 v[48:49], v20, s[4:7], s44 offen sc1
    buffer_load_dwordx2 v[56:57], v20, s[4:7], s44 offen offset:256 sc1
    buffer_load_dwordx2 v[64:65], v20, s[4:7], s44 offen offset:512 sc1
    s_mov_b64 exec, -1
    s_waitcnt lgkmcnt(3)
    v_pk_add_f32 v[76:77], v[76:77], v[68:69]
    v_pk_add_f32 v[78:79], v[78:79], v[70:71]
    v_pk_add_f32 v[80:81], v[80:81], v[72:73]
    v_pk_add_f32 v[82:83], v[82:83], v[74:75]
    v_max3_f32 v84, v76, v77, v78
    v_max3_f32 v85, v79, v80, v81
    v_max3_f32 v84, v84, v82, v83
    v_max_f32 v84, v84, v85
    s_nop 1
    v_max_f32_dpp v84, v84, v84 quad_perm:[1,0,3,2] row_mask:0xf bank_mask:0xf
    v_mov_b32 v85, v84
    s_nop 1
    v_permlane16_swap_b32 v84, v85
    v_max_f32 v84, v84, v85
    v_mov_b32 v85, v84
    s_nop 1
    v_permlane32_swap_b32 v84, v85
    v_max_f32 v84, v84, v85
    s_mov_b32 s42, 0x3dd53b95
    v_mul_f32 v84, s42, v84
    v_fma_f32 v76, v76, s42, -v84
    v_fma_f32 v77, v77, s42, -v84
    v_fma_f32 v78, v78, s42, -v84
    v_fma_f32 v79, v79, s42, -v84
    v_fma_f32 v80, v80, s42, -v84
    v_fma_f32 v81, v81, s42, -v84
    v_fma_f32 v82, v82, s42, -v84
    v_fma_f32 v83, v83, s42, -v84
    v_exp_f32 v76, v76
    v_exp_f32 v77, v77
    v_exp_f32 v78, v78
    v_exp_f32 v79, v79
    v_exp_f32 v80, v80
    v_exp_f32 v81, v81
    v_exp_f32 v82, v82
    v_exp_f32 v83, v83
    v_cvt_pk_bf16_f32 v68, v76, v77
    v_cvt_pk_bf16_f32 v69, v78, v79
    v_cvt_pk_bf16_f32 v70, v80, v81
    v_cvt_pk_bf16_f32 v71, v82, v83
    s_mov_b32 s24, 0
    s_waitcnt vmcnt(0)
    s_branch Lp_328_chk
Lp_328:
    s_mov_b64 exec, s[36:37]
    buffer_load_dwordx2 v[48:49], v20, s[4:7], s44 offen sc1
    buffer_load_dwordx2 v[56:57], v20, s[4:7], s44 offen offset:256 sc1
    buffer_load_dwordx2 v[64:65], v20, s[4:7], s44 offen offset:512 sc1
    s_mov_b64 exec, -1
    s_waitcnt vmcnt(0)
Lp_328_chk:
    v_max3_u32 v84, v48, v49, v56
    v_max3_u32 v85, v57, v64, v65
    v_max_u32 v84, v84, v85
    v_cmp_eq_u32 vcc, -1, v84
    s_cbranch_vccz Lp_329
    s_add_u32 s24, s24, 1
    s_cmp_lt_u32 s24, 400000
    s_cbranch_scc1 Lp_328
    s_branch L_abort
Lp_329:
    s_waitcnt lgkmcnt(0)
    v_smfmac_f32_16x16x64_bf16 v[88:91], v[68:71], v[44:51], v30
    v_smfmac_f32_16x16x64_bf16 v[92:95], v[68:71], v[52:59], v30
    v_smfmac_f32_16x16x64_bf16 v[96:99], v[68:71], v[60:67], v30
    v_smfmac_f32_16x16x64_bf16 v[100:103], v[68:71], a[240:247], v30
    v_mov_b32 v104, 0
    v_mov_b32 v105, 0
    v_mov_b32 v106, 0
    v_mov_b32 v107, 0
    v_mov_b32 v108, 0
    v_mov_b32 v109, 0
    v_mov_b32 v110, 0
    v_mov_b32 v111, 0
    v_add_f32 v88, v88, v89
    v_add_f32 v90, v90, v91
    v_add_f32 v92, v92, v93
    v_add_f32 v94, v94, v95
    v_add_f32 v96, v96, v97
    v_add_f32 v98, v98, v99
    v_add_f32 v100, v100, v101
    v_add_f32 v102, v102, v103
    v_rcp_f32 v100, v100
    v_rcp_f32 v102, v102
    s_nop 0
    v_mul_f32 v88, v88, v100
    v_mul_f32 v90, v90, v102
    v_mul_f32 v92, v92, v100
    v_mul_f32 v94, v94, v102
    v_mul_f32 v96, v96, v100
    v_mul_f32 v98, v98, v102
    v_cvt_pk_bf16_f32 v89, v88, v90
    v_cvt_pk_bf16_f32 v93, v92, v94
    v_cvt_pk_bf16_f32 v97, v96, v98
    v_mov_b32_dpp v91, v89 quad_perm:[1,0,3,2] row_mask:0xf bank_mask:0xf
    v_mov_b32_dpp v95, v93 quad_perm:[1,0,3,2] row_mask:0xf bank_mask:0xf
    v_mov_b32_dpp v99, v97 quad_perm:[1,0,3,2] row_mask:0xf bank_mask:0xf
    v_perm_b32 v91, v91, v89, v31
    ds_write_b32 v21, v91
    v_perm_b32 v95, v95, v93, v31
    ds_write_b32 v22, v95
    v_perm_b32 v99, v99, v97, v31
    ds_write_b32 v23, v99
    v_mov_b32 v72, 0
    v_mov_b32 v73, 0
    v_mov_b32 v74, 0
    v_mov_b32 v75, 0
    v_mov_b32 v76, 0
    v_mov_b32 v77, 0
    v_mov_b32 v78, 0
    v_mov_b32 v79, 0
    v_mov_b32 v80, 0
    v_mov_b32 v81, 0
    v_mov_b32 v82, 0
    v_mov_b32 v83, 0
    v_mov_b32 v84, 0
    v_mov_b32 v85, 0
    v_mov_b32 v86, 0
    v_mov_b32 v87, 0
    s_waitcnt lgkmcnt(0)
    s_barrier
    ds_read_b128 v[32:35], v4 offset:10240
    ds_read_b128 v[36:39], v4 offset:11264
    ds_read_b128 v[40:43], v4 offset:12288
    s_waitcnt lgkmcnt(2)
    v_smfmac_f32_16x16x64_bf16 v[104:107], v[32:35], v[112:119], v30
    v_smfmac_f32_16x16x64_bf16 v[108:111], v[32:35], v[136:143], v30
    s_waitcnt lgkmcnt(1)
    v_smfmac_f32_16x16x64_bf16 v[104:107], v[36:39], v[120:127], v30
    v_smfmac_f32_16x16x64_bf16 v[108:111], v[36:39], v[144:151], v30
    s_waitcnt lgkmcnt(0)
    v_smfmac_f32_16x16x64_bf16 v[104:107], v[40:43], v[128:135], v30
    v_smfmac_f32_16x16x64_bf16 v[108:111], v[40:43], v[152:159], v30
    v_smfmac_f32_16x16x64_bf16 v[72:75], v[32:35], v[160:167], v30
    s_nop 1
    v_smfmac_f32_16x16x64_bf16 v[76:79], v[32:35], v[184:191], v30
    s_nop 1
    v_smfmac_f32_16x16x64_bf16 v[72:75], v[36:39], v[168:175], v30
    s_nop 1
    v_smfmac_f32_16x16x64_bf16 v[76:79], v[36:39], v[192:199], v30
    v_add_f32 v104, v104, v105
    v_add_f32 v105, v108, v109
    v_smfmac_f32_16x16x64_bf16 v[72:75], v[40:43], v[176:183], v30
    v_add_f32 v108, v106, v107
    v_add_f32 v107, v110, v111
    v_smfmac_f32_16x16x64_bf16 v[76:79], v[40:43], v[200:207], v30
    v_cvt_pk_bf16_f32 v104, v104, v105
    v_cvt_pk_bf16_f32 v105, v108, v107
    buffer_store_dwordx2 v[104:105], v24, s[4:7], s18 offen
    v_smfmac_f32_16x16x64_bf16 v[80:83], v[32:35], v[208:215], v30
    s_nop 1
    v_smfmac_f32_16x16x64_bf16 v[84:87], v[32:35], v[232:239], v30
    s_nop 1
    v_smfmac_f32_16x16x64_bf16 v[80:83], v[36:39], v[216:223], v30
    s_nop 1
    v_smfmac_f32_16x16x64_bf16 v[84:87], v[36:39], v[240:247], v30
    v_add_f32 v72, v72, v73
    v_add_f32 v73, v76, v77
    v_smfmac_f32_16x16x64_bf16 v[80:83], v[40:43], v[224:231], v30
    v_add_f32 v76, v74, v75
    v_add_f32 v75, v78, v79
    v_smfmac_f32_16x16x64_bf16 v[84:87], v[40:43], v[248:255], v30
    v_cvt_pk_bf16_f32 v72, v72, v73
    v_cvt_pk_bf16_f32 v73, v76, v75
    buffer_store_dwordx2 v[72:73], v25, s[4:7], s18 offen
    s_nop 7
    v_add_f32 v80, v80, v81
    v_add_f32 v81, v84, v85
    v_add_f32 v84, v82, v83
    v_add_f32 v83, v86, v87
    v_cvt_pk_bf16_f32 v80, v80, v81
    v_cvt_pk_bf16_f32 v81, v84, v83
    buffer_store_dwordx2 v[80:81], v26, s[4:7], s18 offen
    s_sleep 4
    s_mov_b32 s24, 0
Lp_333:
    buffer_load_dwordx2 v[68:69], v27, s[4:7], s18 offen sc1
    buffer_load_dwordx2 v[70:71], v27, s[4:7], s18 offen offset:512 sc1
    buffer_load_dwordx2 v[72:73], v27, s[4:7], s18 offen offset:1024 sc1
    buffer_load_dwordx2 v[74:75], v27, s[4:7], s18 offen offset:1536 sc1
    s_waitcnt vmcnt(2)
    v_mfma_f32_16x16x32_bf16 v[76:79], a[252:255], v[68:71], 0
    s_waitcnt vmcnt(0)
    v_mfma_f32_16x16x32_bf16 v[76:79], a[252:255], v[72:75], v[76:79]
    s_add_u32 s20, s62, s59
    s_add_u32 s43, s62, s60
    s_add_u32 s45, s19, s58
    s_mov_b64 exec, s[56:57]
    s_nop 4
    v_add_f32 v80, v76, v77
    v_add_f32 v81, v78, v79
    v_add_f32 v80, v80, v81
    v_cmp_u_f32 vcc, v80, v80
    s_mov_b64 exec, -1
    s_cbranch_vccz Lp_334
    s_add_u32 s24, s24, 1
    s_cmp_lt_u32 s24, 400000
    s_cbranch_scc1 Lp_333
    s_branch L_abort
Lp_334:
    s_mov_b64 exec, s[56:57]
    buffer_store_dwordx4 v[76:79], v29, s[4:7], s20 offen sc1
    s_mov_b64 exec, -1
Lk_330:
    buffer_store_dword a248, v13, s[4:7], s26 offen
    buffer_store_dword a248, v13, s[4:7], s26 offen offset:32
    s_lshl_b32 s20, s12, 12
    s_add_u32 s20, s20, 131072
    s_add_u32 s20, s20, s26
    buffer_store_dword a248, v19, s[4:7], s20 offen
    buffer_store_dwordx2 a[248:249], v24, s[4:7], s26 offen
    buffer_store_dwordx2 a[248:249], v25, s[4:7], s26 offen
    buffer_store_dwordx2 a[248:249], v26, s[4:7], s26 offen
    s_add_u32 s20, s26, s58
    s_mov_b64 exec, s[100:101]
    buffer_store_dword a248, v28, s[4:7], s20 offen
    s_mov_b64 exec, -1
    s_sleep 5
    s_mov_b64 exec, s[56:57]
    buffer_load_dwordx4 v[68:71], v29, s[4:7], s43 offen sc1
    s_mov_b64 exec, -1
    s_barrier
Lk_331:
    s_mov_b32 s89, s30
    s_mov_b32 s92, s29
    s_add_u32 s17, s17, 1
    s_mov_b32 s26, s18
    s_mov_b32 s18, s19
    s_add_u32 s19, s19, 2097152
    s_and_b32 s19, s19, 0x77fffff
    s_or_b32 s19, s19, 0x7000000
    s_mov_b32 s63, s62
    s_add_u32 s62, s62, 131072
    s_and_b32 s62, s62, 0x7ffff
    s_add_u32 s44, s18, s98
    s_add_u32 s95, s18, s58
    s_add_u32 s30, s30, 98304
    s_add_u32 s28, s28, 393216
    s_add_u32 s27, s27, 393216
    s_sub_u32 s47, s47, s53
    v_add_u32 v17, s53, v17
    v_add_u32 v18, s53, v18
    s_sub_u32 s53, 0, s53
    v_mov_b32 v88, 0
    v_mov_b32 v89, 0
    v_mov_b32 v90, 0
    v_mov_b32 v91, 0
    v_mov_b32 v92, 0
    v_mov_b32 v93, 0
    v_mov_b32 v94, 0
    v_mov_b32 v95, 0
    v_mov_b32 v96, 0
    v_mov_b32 v97, 0
    v_mov_b32 v98, 0
    v_mov_b32 v99, 0
    v_mov_b32 v100, 0
    v_mov_b32 v101, 0
    v_mov_b32 v102, 0
    v_mov_b32 v103, 0
    s_mov_b32 s24, 0
    s_waitcnt vmcnt(0)
    s_branch Lp_335_chk
Lp_335:
    s_mov_b64 exec, s[56:57]
    buffer_load_dwordx4 v[68:71], v29, s[4:7], s43 offen sc1
    s_mov_b64 exec, -1
    s_waitcnt vmcnt(0)
Lp_335_chk:
    s_mov_b64 exec, s[56:57]
    v_pk_add_f32 v[72:73], v[68:69], v[76:77]
    v_pk_add_f32 v[74:75], v[70:71], v[78:79]
    v_add_f32 v80, v72, v73
    v_add_f32 v81, v74, v75
    v_cvt_pk_bf16_f32 v72, v72, v73
    v_cvt_pk_bf16_f32 v73, v74, v75
    v_add_f32 v80, v80, v81
    v_cmp_u_f32 vcc, v80, v80
    s_mov_b64 exec, -1
    s_cbranch_vccz Lp_336
    s_add_u32 s24, s24, 1
    s_cmp_lt_u32 s24, 400000
    s_cbranch_scc1 Lp_335
    s_branch L_abort
Lp_336:
    v_permlane16_swap_b32 v72, v73
    s_mov_b64 exec, s[100:101]
    buffer_store_dword v72, v28, s[4:7], s45 offen
    s_mov_b64 exec, -1
Lk_332:
    s_barrier
    s_branch L_loop_0L
L_last_0L:
    buffer_store_dword v9, v19, s[4:7], s30 offen sc1
    s_waitcnt vmcnt(0)
    s_barrier
    s_branch L_chain_end
    .p2align 6
T_2L:
    s_and_b32 s20, s17, 3
    s_lshl_b32 s18, s20, 21
    s_add_u32 s18, s18, 117440512
    s_lshl_b32 s62, s20, 17
    s_add_u32 s20, s17, 1
    s_and_b32 s20, s20, 3
    s_lshl_b32 s19, s20, 21
    s_add_u32 s19, s19, 117440512
    s_add_u32 s20, s17, 3
    s_and_b32 s20, s20, 3
    s_lshl_b32 s26, s20, 21
    s_add_u32 s26, s26, 117440512
    s_lshl_b32 s63, s20, 17
    s_lshl_b32 s44, s12, 12
    s_add_u32 s44, s44, 131072
    s_add_u32 s44, s44, s18
    s_lshl_b32 s20, s17, 5
    s_add_u32 s20, s20, s12
    s_mul_i32 s21, s20, 3072
    s_add_u32 s30, s21, 106954752
    s_mul_i32 s20, s20, 12288
    s_mul_i32 s21, s16, 6144
    s_add_u32 s28, s20, s21
    s_add_u32 s28, s28, 25165824
    s_mul_i32 s21, s13, 6144
    s_add_u32 s27, s20, s21
    s_mul_i32 s21, s16, 3072
    s_add_u32 s27, s27, s21
    s_add_u32 s27, s27, 393216
    s_add_u32 s20, s17, 1
    s_and_b32 s20, s20, 1
    s_mul_i32 s47, s20, 6144
    s_add_u32 s47, s47, s21
    s_add_u32 s47, s47, 138752
    s_sub_u32 s53, 0, s53
    s_add_u32 s95, s18, s58
    s_mov_b32 s89, 0xf0000000
    s_mov_b32 s92, 0xf0000000
    s_lshl_b32 s98, s12, 12
    s_add_u32 s98, s98, 131072
    s_mul_i32 s46, s16, 6144
    s_add_u32 s46, s46, 151040
    v_mov_b32 v88, 0
    v_mov_b32 v89, 0
    v_mov_b32 v90, 0
    v_mov_b32 v91, 0
    v_mov_b32 v92, 0
    v_mov_b32 v93, 0
    v_mov_b32 v94, 0
    v_mov_b32 v95, 0
    v_mov_b32 v96, 0
    v_mov_b32 v97, 0
    v_mov_b32 v98, 0
    v_mov_b32 v99, 0
    v_mov_b32 v100, 0
    v_mov_b32 v101, 0
    v_mov_b32 v102, 0
    v_mov_b32 v103, 0
    v_mov_b32 v104, 0
    v_mov_b32 v105, 0
    v_mov_b32 v106, 0
    v_mov_b32 v107, 0
L_loop_2L:
    v_mov_b32 v76, 0
    v_mov_b32 v77, 0
    v_mov_b32 v78, 0
    v_mov_b32 v79, 0
    s_mov_b32 s24, 0
Lg_337:
    buffer_load_dwordx4 v[68:71], v3, s[4:7], s95 offen sc1
    buffer_load_dwordx4 v[72:75], v3, s[4:7], s95 offen offset:1024 sc1
    s_mov_b64 exec, s[34:35]
    buffer_load_dwordx4 v[76:79], v3, s[4:7], s95 offen offset:2048 sc1
    s_mov_b64 exec, -1
    s_waitcnt vmcnt(0)
    v_max3_u32 v84, v68, v69, v70
    v_max3_u32 v85, v71, v72, v73
    v_max3_u32 v84, v84, v74, v75
    v_max3_u32 v85, v85, v76, v77
    v_max3_u32 v84, v84, v78, v79
    v_max_u32 v84, v84, v85
    v_cmp_eq_u32 vcc, -1, v84
    s_cbranch_vccz Lg_338
    s_add_u32 s24, s24, 1
    s_cmp_lt_u32 s24, 400000
    s_cbranch_scc1 Lg_337
    s_branch L_abort
Lg_338:
    ds_write_b128 v2, v[68:71] offset:0
    ds_write_b128 v2, v[72:75] offset:1024
    s_mov_b64 exec, s[34:35]
    ds_write_b128 v2, v[76:79] offset:2048
    s_mov_b64 exec, -1
    s_waitcnt lgkmcnt(0)
    s_barrier
    ds_read_b128 v[68:71], v4 offset:0
    ds_read_b128 v[112:115], v8 offset:0
    ds_read_b128 v[116:119], v8 offset:1024
    ds_read_b128 v[72:75], v4 offset:1024
    ds_read_b128 v[120:123], v8 offset:12288
    ds_read_b128 v[124:127], v8 offset:13312
    s_waitcnt lgkmcnt(3)
    v_smfmac_f32_16x16x64_bf16 v[88:91], v[68:71], a[0:7], v30
    ds_read_b128 v[76:79], v4 offset:2048
    v_smfmac_f32_16x16x64_bf16 v[92:95], v[68:71], a[80:87], v30
    ds_read_b128 v[128:131], v8 offset:24576
    buffer_store_dword v152, v19, s[4:7], s89 offen sc1
    v_smfmac_f32_16x16x64_bf16 v[96:99], v[68:71], a[160:167], v30
    ds_read_b128 v[132:135], v8 offset:25600
    v_smfmac_f32_16x16x64_bf16 v[100:103], v[68:71], v[112:119], v30
    buffer_store_dword v153, v19, s[4:7], s89 offen offset:256 sc1
    s_waitcnt lgkmcnt(3)
    v_smfmac_f32_16x16x64_bf16 v[88:91], v[72:75], a[8:15], v30
    ds_read_b128 v[68:71], v4 offset:3072
    v_smfmac_f32_16x16x64_bf16 v[92:95], v[72:75], a[88:95], v30
    ds_read_b128 v[112:115], v8 offset:36864
    s_sub_u32 s22, s63, 131072
    s_and_b32 s22, s22, 0x7ffff
    s_cmp_eq_u32 s88, 0
    s_cbranch_scc1 Lr_340
    s_add_u32 s21, s22, s59
    s_mov_b64 exec, s[56:57]
    buffer_store_dwordx4 a[248:251], v29, s[4:7], s21 offen sc1
    s_mov_b64 exec, -1
Lr_340:
    v_smfmac_f32_16x16x64_bf16 v[96:99], v[72:75], a[168:175], v30
    ds_read_b128 v[116:119], v8 offset:37888
    v_smfmac_f32_16x16x64_bf16 v[100:103], v[72:75], v[120:127], v30
    s_waitcnt lgkmcnt(3)
    v_smfmac_f32_16x16x64_bf16 v[88:91], v[76:79], a[16:23], v30
    ds_read_b128 v[72:75], v4 offset:4096
    v_smfmac_f32_16x16x64_bf16 v[92:95], v[76:79], a[96:103], v30
    ds_read_b128 v[120:123], v10 offset:0
    v_smfmac_f32_16x16x64_bf16 v[96:99], v[76:79], a[176:183], v30
    ds_read_b128 v[124:127], v10 offset:1024
    v_smfmac_f32_16x16x64_bf16 v[100:103], v[76:79], v[128:135], v30
    s_waitcnt lgkmcnt(3)
    v_smfmac_f32_16x16x64_bf16 v[88:91], v[68:71], a[24:31], v30
    ds_read_b128 v[76:79], v4 offset:5120
    v_smfmac_f32_16x16x64_bf16 v[92:95], v[68:71], a[104:111], v30
    ds_read_b128 v[128:131], v10 offset:12288
    v_smfmac_f32_16x16x64_bf16 v[96:99], v[68:71], a[184:191], v30
    ds_read_b128 v[132:135], v10 offset:13312
    v_smfmac_f32_16x16x64_bf16 v[100:103], v[68:71], v[112:119], v30
    s_waitcnt lgkmcnt(3)
    v_smfmac_f32_16x16x64_bf16 v[88:91], v[72:75], a[32:39], v30
    ds_read_b128 v[68:71], v4 offset:6144
    v_smfmac_f32_16x16x64_bf16 v[92:95], v[72:75], a[112:119], v30
    ds_read_b128 v[112:115], v10 offset:24576
    v_smfmac_f32_16x16x64_bf16 v[96:99], v[72:75], a[192:199], v30
    ds_read_b128 v[116:119], v10 offset:25600
    v_smfmac_f32_16x16x64_bf16 v[100:103], v[72:75], v[120:127], v30
    s_waitcnt lgkmcnt(3)
    v_smfmac_f32_16x16x64_bf16 v[88:91], v[76:79], a[40:47], v30
    ds_read_b128 v[72:75], v4 offset:7168
    v_smfmac_f32_16x16x64_bf16 v[92:95], v[76:79], a[120:127], v30
    ds_read_b128 v[120:123], v10 offset:36864
    v_smfmac_f32_16x16x64_bf16 v[96:99], v[76:79], a[200:207], v30
    ds_read_b128 v[124:127], v10 offset:37888
    v_smfmac_f32_16x16x64_bf16 v[100:103], v[76:79], v[128:135], v30
    s_waitcnt lgkmcnt(3)
    v_smfmac_f32_16x16x64_bf16 v[88:91], v[68:71], a[48:55], v30
    ds_read_b128 v[76:79], v4 offset:8192
    v_smfmac_f32_16x16x64_bf16 v[92:95], v[68:71], a[128:135], v30
    ds_read_b128 v[128:131], v10 offset:49152
    v_smfmac_f32_16x16x64_bf16 v[96:99], v[68:71], a[208:215], v30
    ds_read_b128 v[132:135], v10 offset:50176
    v_smfmac_f32_16x16x64_bf16 v[100:103], v[68:71], v[112:119], v30
    s_waitcnt lgkmcnt(3)
    v_smfmac_f32_16x16x64_bf16 v[88:91], v[72:75], a[56:63], v30
    ds_read_b128 v[68:71], v4 offset:9216
    v_smfmac_f32_16x16x64_bf16 v[92:95], v[72:75], a[136:143], v30
    ds_read_b128 v[112:115], v10 offset:61440
    v_smfmac_f32_16x16x64_bf16 v[96:99], v[72:75], a[216:223], v30
    ds_read_b128 v[116:119], v10 offset:62464
    v_smfmac_f32_16x16x64_bf16 v[100:103], v[72:75], v[120:127], v30
    s_waitcnt lgkmcnt(3)
    v_smfmac_f32_16x16x64_bf16 v[88:91], v[76:79], a[64:71], v30
    v_smfmac_f32_16x16x64_bf16 v[92:95], v[76:79], a[144:151], v30
    v_smfmac_f32_16x16x64_bf16 v[96:99], v[76:79], a[224:231], v30
    v_smfmac_f32_16x16x64_bf16 v[100:103], v[76:79], v[128:135], v30
    s_waitcnt lgkmcnt(0)
    v_smfmac_f32_16x16x64_bf16 v[88:91], v[68:71], a[72:79], v30
    v_smfmac_f32_16x16x64_bf16 v[92:95], v[68:71], a[152:159], v30
    v_smfmac_f32_16x16x64_bf16 v[96:99], v[68:71], a[232:239], v30
    v_smfmac_f32_16x16x64_bf16 v[100:103], v[68:71], v[112:119], v30
    s_nop 5
    v_add_f32 v88, v88, v89
    v_add_f32 v90, v90, v91
    v_add_f32 v92, v92, v93
    v_add_f32 v94, v94, v95
    v_add_f32 v96, v96, v97
    v_add_f32 v98, v98, v99
    v_cvt_pk_bf16_f32 v89, v88, v90
    v_cvt_pk_bf16_f32 v93, v92, v94
    v_cvt_pk_bf16_f32 v97, v96, v98
    v_mov_b32_dpp v91, v89 quad_perm:[1,0,3,2] row_mask:0xf bank_mask:0xf
    v_mov_b32_dpp v95, v93 quad_perm:[1,0,3,2] row_mask:0xf bank_mask:0xf
    v_mov_b32_dpp v99, v97 quad_perm:[1,0,3,2] row_mask:0xf bank_mask:0xf
    v_perm_b32 v91, v91, v89, v31
    ds_write_b32 v5, v91
    v_perm_b32 v95, v95, v93, v31
    ds_write_b32 v6, v95
    v_perm_b32 v99, v99, v97, v31
    ds_write_b32 v7, v99
    v_add_f32 v100, v100, v101
    v_add_f32 v102, v102, v103
    v_cvt_pk_bf16_f32 v100, v100, v102
    s_waitcnt lgkmcnt(0)
    ds_read_b128 v[136:139], v4 offset:0
    ds_read_b128 v[112:115], v9 offset:0
    ds_read_b128 v[116:119], v9 offset:1024
    ds_read_b128 v[140:143], v4 offset:1024
    ds_read_b128 v[120:123], v9 offset:12288
    ds_read_b128 v[124:127], v9 offset:13312
    ds_read_b128 v[80:83], v4 offset:2048
    ds_read_b128 v[128:131], v9 offset:24576
    ds_read_b128 v[132:135], v9 offset:25600
    ds_read_b128 v[84:87], v4 offset:3072
    ds_read_b128 v[32:35], v9 offset:36864
    ds_read_b128 v[36:39], v9 offset:37888
    s_barrier
    ds_read_b128 v[144:147], v4 offset:10240
    ds_read_b64 v[148:149], v16
    ds_read_b128 v[68:71], v17
    ds_read_b128 v[72:75], v17 offset:96
    ds_read_b128 v[76:79], v18
    buffer_store_dword v100, v19, s[4:7], s44 offen
    v_mov_b32 v152, v100
    v_mov_b32 v88, 0
    v_mov_b32 v89, 0
    v_mov_b32 v90, 0
    v_mov_b32 v91, 0
    v_mov_b32 v92, 0
    v_mov_b32 v93, 0
    v_mov_b32 v94, 0
    v_mov_b32 v95, 0
    s_waitcnt lgkmcnt(0)
    v_smfmac_f32_16x16x64_bf16 v[88:91], v[144:147], v[68:75], v30
    v_smfmac_f32_16x16x32_bf16 v[92:95], v[148:149], v[76:79], v30
    v_smfmac_f32_16x16x64_bf16 v[104:107], v[136:139], v[112:119], v30
    ds_read_b128 v[136:139], v4 offset:4096
    ds_read_b128 v[112:115], v11 offset:0
    ds_read_b128 v[116:119], v11 offset:1024
    v_smfmac_f32_16x16x64_bf16 v[104:107], v[140:143], v[120:127], v30
    ds_read_b128 v[140:143], v4 offset:5120
    ds_read_b128 v[120:123], v11 offset:12288
    ds_read_b128 v[124:127], v11 offset:13312
    s_nop 1
    v_add_f32 v88, v88, v89
    v_add_f32 v90, v90, v91
    v_add_f32 v92, v92, v93
    v_add_f32 v94, v94, v95
    v_add_f32 v88, v88, v92
    v_add_f32 v90, v90, v94
    s_mov_b64 exec, s[38:39]
    buffer_store_dword v88, v13, s[4:7], s18 offen
    buffer_store_dword v90, v13, s[4:7], s18 offen offset:32
    ds_write_b32 v12, v88
    ds_write_b32 v12, v90 offset:32
    s_mov_b64 exec, -1
    v_smfmac_f32_16x16x64_bf16 v[104:107], v[80:83], v[128:135], v30
    ds_read_b128 v[80:83], v4 offset:6144
    ds_read_b128 v[128:131], v11 offset:24576
    ds_read_b128 v[132:135], v11 offset:25600
    v_smfmac_f32_16x16x64_bf16 v[104:107], v[84:87], v[32:39], v30
    ds_read_b128 v[84:87], v4 offset:7168
    ds_read_b128 v[32:35], v11 offset:36864
    ds_read_b128 v[36:39], v11 offset:37888
    s_waitcnt lgkmcnt(11)
    v_smfmac_f32_16x16x64_bf16 v[104:107], v[136:139], v[112:119], v30
    ds_read_b128 v[136:139], v4 offset:8192
    ds_read_b128 v[112:115], v11 offset:49152
    ds_read_b128 v[116:119], v11 offset:50176
    s_waitcnt lgkmcnt(11)
    v_smfmac_f32_16x16x64_bf16 v[104:107], v[140:143], v[120:127], v30
    ds_read_b128 v[140:143], v4 offset:9216
    ds_read_b128 v[120:123], v11 offset:61440
    ds_read_b128 v[124:127], v11 offset:62464
    s_waitcnt lgkmcnt(9)
    v_smfmac_f32_16x16x64_bf16 v[104:107], v[80:83], v[128:135], v30
    s_waitcnt lgkmcnt(6)
    v_smfmac_f32_16x16x64_bf16 v[104:107], v[84:87], v[32:39], v30
    s_waitcnt lgkmcnt(3)
    v_smfmac_f32_16x16x64_bf16 v[104:107], v[136:139], v[112:119], v30
    s_waitcnt lgkmcnt(0)
    v_smfmac_f32_16x16x64_bf16 v[104:107], v[140:143], v[120:127], v30
    s_nop 7
    v_add_f32 v104, v104, v105
    v_add_f32 v106, v106, v107
    v_cvt_pk_bf16_f32 v104, v104, v106
    buffer_store_dword v104, v19, s[4:7], s44 offen offset:256
    v_mov_b32 v153, v104
    v_mov_b32 v88, 0
    v_mov_b32 v89, 0
    v_mov_b32 v90, 0
    v_mov_b32 v91, 0
    v_mov_b32 v92, 0
    v_mov_b32 v93, 0
    v_mov_b32 v94, 0
    v_mov_b32 v95, 0
    v_mov_b32 v96, 0
    v_mov_b32 v97, 0
    v_mov_b32 v98, 0
    v_mov_b32 v99, 0
    v_mov_b32 v100, 0
    v_mov_b32 v101, 0
    v_mov_b32 v102, 0
    v_mov_b32 v103, 0
    buffer_load_dwordx4 v[68:71], v15, s[4:7], s18 offen sc1
    buffer_load_dwordx4 v[72:75], v15, s[4:7], s18 offen offset:1024 sc1
    s_waitcnt vmcnt(6)
    s_barrier
    s_cmp_eq_u32 s17, 63
    s_cbranch_scc1 L_last_2L
    ds_read_b128 v[76:79], v4 offset:13440
    ds_read_b128 v[80:83], v4 offset:14464
    ds_read_b128 v[44:47], v150 offset:0
    ds_read_b128 v[52:55], v150 offset:1024
    ds_read_b128 v[60:63], v150 offset:2048
    s_mov_b32 s24, 0
    s_waitcnt vmcnt(0)
    s_branch Lp_341_chk
Lp_341:
    buffer_load_dwordx4 v[68:71], v15, s[4:7], s18 offen sc1
    buffer_load_dwordx4 v[72:75], v15, s[4:7], s18 offen offset:1024 sc1
    s_waitcnt vmcnt(0)
Lp_341_chk:
    v_max3_u32 v84, v68, v69, v70
    v_max3_u32 v85, v71, v72, v73
    v_max3_u32 v84, v84, v74, v75
    v_max_u32 v84, v84, v85
    v_cmp_eq_u32 vcc, -1, v84
    s_cbranch_vccz Lp_342
    s_add_u32 s24, s24, 1
    s_cmp_lt_u32 s24, 400000
    s_cbranch_scc1 Lp_341
    s_branch L_abort
Lp_342:
    s_mov_b64 exec, s[36:37]
    buffer_load_dwordx2 v[48:49], v20, s[4:7], s44 offen sc1
    buffer_load_dwordx2 v[56:57], v20, s[4:7], s44 offen offset:256 sc1
    buffer_load_dwordx2 v[64:65], v20, s[4:7], s44 offen offset:512 sc1
    s_mov_b64 exec, -1
    s_waitcnt lgkmcnt(3)
    v_pk_add_f32 v[76:77], v[76:77], v[68:69]
    v_pk_add_f32 v[78:79], v[78:79], v[70:71]
    v_pk_add_f32 v[80:81], v[80:81], v[72:73]
    v_pk_add_f32 v[82:83], v[82:83], v[74:75]
    v_max3_f32 v84, v76, v77, v78
    v_max3_f32 v85, v79, v80, v81
    v_max3_f32 v84, v84, v82, v83
    v_max_f32 v84, v84, v85
    s_nop 1
    v_max_f32_dpp v84, v84, v84 quad_perm:[1,0,3,2] row_mask:0xf bank_mask:0xf
    v_mov_b32 v85, v84
    s_nop 1
    v_permlane16_swap_b32 v84, v85
    v_max_f32 v84, v84, v85
    v_mov_b32 v85, v84
    s_nop 1
    v_permlane32_swap_b32 v84, v85
    v_max_f32 v84, v84, v85
    s_mov_b32 s42, 0x3dd53b95
    v_mul_f32 v84, s42, v84
    v_fma_f32 v76, v76, s42, -v84
    v_fma_f32 v77, v77, s42, -v84
    v_fma_f32 v78, v78, s42, -v84
    v_fma_f32 v79, v79, s42, -v84
    v_fma_f32 v80, v80, s42, -v84
    v_fma_f32 v81, v81, s42, -v84
    v_fma_f32 v82, v82, s42, -v84
    v_fma_f32 v83, v83, s42, -v84
    v_exp_f32 v76, v76
    v_exp_f32 v77, v77
    v_exp_f32 v78, v78
    v_exp_f32 v79, v79
    v_exp_f32 v80, v80
    v_exp_f32 v81, v81
    v_exp_f32 v82, v82
    v_exp_f32 v83, v83
    v_cvt_pk_bf16_f32 v68, v76, v77
    v_cvt_pk_bf16_f32 v69, v78, v79
    v_cvt_pk_bf16_f32 v70, v80, v81
    v_cvt_pk_bf16_f32 v71, v82, v83
    s_mov_b32 s24, 0
    s_waitcnt vmcnt(0)
    s_branch Lp_343_chk
Lp_343:
    s_mov_b64 exec, s[36:37]
    buffer_load_dwordx2 v[48:49], v20, s[4:7], s44 offen sc1
    buffer_load_dwordx2 v[56:57], v20, s[4:7], s44 offen offset:256 sc1
    buffer_load_dwordx2 v[64:65], v20, s[4:7], s44 offen offset:512 sc1
    s_mov_b64 exec, -1
    s_waitcnt vmcnt(0)
Lp_343_chk:
    v_max3_u32 v84, v48, v49, v56
    v_max3_u32 v85, v57, v64, v65
    v_max_u32 v84, v84, v85
    v_cmp_eq_u32 vcc, -1, v84
    s_cbranch_vccz Lp_344
    s_add_u32 s24, s24, 1
    s_cmp_lt_u32 s24, 400000
    s_cbranch_scc1 Lp_343
    s_branch L_abort
Lp_344:
    s_waitcnt lgkmcnt(0)
    v_smfmac_f32_16x16x64_bf16 v[88:91], v[68:71], v[44:51], v30
    v_smfmac_f32_16x16x64_bf16 v[92:95], v[68:71], v[52:59], v30
    v_smfmac_f32_16x16x64_bf16 v[96:99], v[68:71], v[60:67], v30
    v_smfmac_f32_16x16x64_bf16 v[100:103], v[68:71], a[240:247], v30
    v_mov_b32 v72, 0
    v_mov_b32 v73, 0
    v_mov_b32 v74, 0
    v_mov_b32 v75, 0
    v_mov_b32 v76, 0
    v_mov_b32 v77, 0
    v_mov_b32 v78, 0
    v_mov_b32 v79, 0
    v_add_f32 v88, v88, v89
    v_add_f32 v90, v90, v91
    v_add_f32 v92, v92, v93
    v_add_f32 v94, v94, v95
    v_add_f32 v96, v96, v97
    v_add_f32 v98, v98, v99
    v_add_f32 v100, v100, v101
    v_add_f32 v102, v102, v103
    v_rcp_f32 v100, v100
    v_rcp_f32 v102, v102
    s_nop 0
    v_mul_f32 v88, v88, v100
    v_mul_f32 v90, v90, v102
    v_mul_f32 v92, v92, v100
    v_mul_f32 v94, v94, v102
    v_mul_f32 v96, v96, v100
    v_mul_f32 v98, v98, v102
    v_cvt_pk_bf16_f32 v89, v88, v90
    v_cvt_pk_bf16_f32 v93, v92, v94
    v_cvt_pk_bf16_f32 v97, v96, v98
    v_mov_b32_dpp v91, v89 quad_perm:[1,0,3,2] row_mask:0xf bank_mask:0xf
    v_mov_b32_dpp v95, v93 quad_perm:[1,0,3,2] row_mask:0xf bank_mask:0xf
    v_mov_b32_dpp v99, v97 quad_perm:[1,0,3,2] row_mask:0xf bank_mask:0xf
    v_perm_b32 v91, v91, v89, v31
    ds_write_b32 v21, v91
    v_perm_b32 v95, v95, v93, v31
    ds_write_b32 v22, v95
    v_perm_b32 v99, v99, v97, v31
    ds_write_b32 v23, v99
    v_mov_b32 v80, 0
    v_mov_b32 v81, 0
    v_mov_b32 v82, 0
    v_mov_b32 v83, 0
    v_mov_b32 v84, 0
    v_mov_b32 v85, 0
    v_mov_b32 v86, 0
    v_mov_b32 v87, 0
    s_waitcnt lgkmcnt(0)
    s_barrier
    ds_read_b128 v[32:35], v4 offset:10240
    ds_read_b128 v[36:39], v4 offset:11264
    ds_read_b128 v[40:43], v4 offset:12288
    s_waitcnt lgkmcnt(2)
    v_smfmac_f32_16x16x64_bf16 v[72:75], v[32:35], v[160:167], v30
    v_smfmac_f32_16x16x64_bf16 v[76:79], v[32:35], v[184:191], v30
    s_waitcnt lgkmcnt(1)
    v_smfmac_f32_16x16x64_bf16 v[72:75], v[36:39], v[168:175], v30
    v_smfmac_f32_16x16x64_bf16 v[76:79], v[36:39], v[192:199], v30
    s_waitcnt lgkmcnt(0)
    v_smfmac_f32_16x16x64_bf16 v[72:75], v[40:43], v[176:183], v30
    v_smfmac_f32_16x16x64_bf16 v[76:79], v[40:43], v[200:207], v30
    v_smfmac_f32_16x16x64_bf16 v[80:83], v[32:35], v[208:215], v30
    s_nop 1
    v_smfmac_f32_16x16x64_bf16 v[84:87], v[32:35], v[232:239], v30
    s_nop 1
    v_smfmac_f32_16x16x64_bf16 v[80:83], v[36:39], v[216:223], v30
    s_nop 1
    v_smfmac_f32_16x16x64_bf16 v[84:87], v[36:39], v[240:247], v30
    v_add_f32 v72, v72, v73
    v_add_f32 v73, v76, v77
    v_smfmac_f32_16x16x64_bf16 v[80:83], v[40:43], v[224:231], v30
    v_add_f32 v76, v74, v75
    v_add_f32 v75, v78, v79
    v_smfmac_f32_16x16x64_bf16 v[84:87], v[40:43], v[248:255], v30
    v_cvt_pk_bf16_f32 v72, v72, v73
    v_cvt_pk_bf16_f32 v73, v76, v75
    buffer_store_dwordx2 v[72:73], v25, s[4:7], s18 offen
    s_nop 7
    v_add_f32 v80, v80, v81
    v_add_f32 v81, v84, v85
    v_add_f32 v84, v82, v83
    v_add_f32 v83, v86, v87
    v_cvt_pk_bf16_f32 v80, v80, v81
    v_cvt_pk_bf16_f32 v81, v84, v83
    buffer_store_dwordx2 v[80:81], v26, s[4:7], s18 offen
    s_cmp_eq_u32 s88, 0
    s_cbranch_scc1 Lk_347
    s_sleep 6
    s_mov_b32 s24, 0
Lp_350:
    buffer_load_dwordx2 v[68:69], v27, s[4:7], s18 offen sc1
    buffer_load_dwordx2 v[70:71], v27, s[4:7], s18 offen offset:512 sc1
    buffer_load_dwordx2 v[72:73], v27, s[4:7], s18 offen offset:1024 sc1
    buffer_load_dwordx2 v[74:75], v27, s[4:7], s18 offen offset:1536 sc1
    s_waitcnt vmcnt(2)
    v_mfma_f32_16x16x32_bf16 v[76:79], a[252:255], v[68:71], 0
    s_waitcnt vmcnt(0)
    v_mfma_f32_16x16x32_bf16 v[76:79], a[252:255], v[72:75], v[76:79]
    s_add_u32 s20, s62, s59
    s_add_u32 s43, s62, s60
    s_add_u32 s45, s19, s58
    s_mov_b64 exec, s[56:57]
    s_nop 4
    v_add_f32 v80, v76, v77
    v_add_f32 v81, v78, v79
    v_add_f32 v80, v80, v81
    v_cmp_u_f32 vcc, v80, v80
    s_mov_b64 exec, -1
    s_cbranch_vccz Lp_351
    s_add_u32 s24, s24, 1
    s_cmp_lt_u32 s24, 400000
    s_cbranch_scc1 Lp_350
    s_branch L_abort
Lp_351:
    s_mov_b64 exec, s[56:57]
    buffer_store_dwordx4 v[76:79], v29, s[4:7], s20 offen sc1
    s_mov_b64 exec, -1
Lk_347:
    s_cmp_eq_u32 s88, 0
    s_cbranch_scc0 Lk_352
    s_barrier
Lk_352:
    s_mov_b64 exec, s[38:39]
    buffer_store_dword a248, v13, s[4:7], s26 offen
    buffer_store_dword a248, v13, s[4:7], s26 offen offset:32
    s_mov_b64 exec, -1
    s_lshl_b32 s20, s12, 12
    s_add_u32 s20, s20, 131072
    s_add_u32 s20, s20, s26
    buffer_store_dword a248, v19, s[4:7], s20 offen
    buffer_store_dword a248, v19, s[4:7], s20 offen offset:256
    buffer_store_dwordx2 a[248:249], v25, s[4:7], s26 offen
    buffer_store_dwordx2 a[248:249], v26, s[4:7], s26 offen
    s_cmp_eq_u32 s88, 0
    s_cbranch_scc1 Lr_345
    s_add_u32 s20, s26, s58
    s_mov_b64 exec, s[100:101]
    buffer_store_dword a248, v28, s[4:7], s20 offen
    s_mov_b64 exec, -1
Lr_345:
    s_cmp_eq_u32 s88, 0
    s_cbranch_scc1 Lk_348
    s_sleep 5
    s_mov_b64 exec, s[56:57]
    buffer_load_dwordx4 v[68:71], v29, s[4:7], s43 offen sc1
    s_mov_b64 exec, -1
    s_barrier
Lk_348:
    s_mov_b32 s89, s30
    s_mov_b32 s92, s29
    s_add_u32 s17, s17, 1
    s_mov_b32 s26, s18
    s_mov_b32 s18, s19
    s_add_u32 s19, s19, 2097152
    s_and_b32 s19, s19, 0x77fffff
    s_or_b32 s19, s19, 0x7000000
    s_mov_b32 s63, s62
    s_add_u32 s62, s62, 131072
    s_and_b32 s62, s62, 0x7ffff
    s_add_u32 s44, s18, s98
    s_add_u32 s95, s18, s58
    s_add_u32 s30, s30, 98304
    s_add_u32 s28, s28, 393216
    s_add_u32 s27, s27, 393216
    v_mov_b32 v88, 0
    v_mov_b32 v89, 0
    v_mov_b32 v90, 0
    v_mov_b32 v91, 0
    v_mov_b32 v92, 0
    v_mov_b32 v93, 0
    v_mov_b32 v94, 0
    v_mov_b32 v95, 0
    v_mov_b32 v96, 0
    v_mov_b32 v97, 0
    v_mov_b32 v98, 0
    v_mov_b32 v99, 0
    v_mov_b32 v100, 0
    v_mov_b32 v101, 0
    v_mov_b32 v102, 0
    v_mov_b32 v103, 0
    v_mov_b32 v104, 0
    v_mov_b32 v105, 0
    v_mov_b32 v106, 0
    v_mov_b32 v107, 0
    s_cmp_eq_u32 s88, 0
    s_cbranch_scc1 Lk_349
    s_mov_b32 s24, 0
    s_waitcnt vmcnt(0)
    s_branch Lp_354_chk
Lp_354:
    s_mov_b64 exec, s[56:57]
    buffer_load_dwordx4 v[68:71], v29, s[4:7], s43 offen sc1
    s_mov_b64 exec, -1
    s_waitcnt vmcnt(0)
Lp_354_chk:
    s_mov_b64 exec, s[56:57]
    v_pk_add_f32 v[72:73], v[68:69], v[76:77]
    v_pk_add_f32 v[74:75], v[70:71], v[78:79]
    v_add_f32 v80, v72, v73
    v_add_f32 v81, v74, v75
    v_cvt_pk_bf16_f32 v72, v72, v73
    v_cvt_pk_bf16_f32 v73, v74, v75
    v_add_f32 v80, v80, v81
    v_cmp_u_f32 vcc, v80, v80
    s_mov_b64 exec, -1
    s_cbranch_vccz Lp_355
    s_add_u32 s24, s24, 1
    s_cmp_lt_u32 s24, 400000
    s_cbranch_scc1 Lp_354
    s_branch L_abort
Lp_355:
    v_permlane16_swap_b32 v72, v73
    s_mov_b64 exec, s[100:101]
    buffer_store_dword v72, v28, s[4:7], s45 offen
    s_mov_b64 exec, -1
Lk_349:
    s_barrier
    s_branch L_loop_2L
L_last_2L:
    buffer_store_dword v152, v19, s[4:7], s30 offen sc1
    buffer_store_dword v153, v19, s[4:7], s30 offen offset:256 sc1
    s_waitcnt vmcnt(0)
    s_barrier
    s_branch L_chain_end
    .p2align 6
T_3L:
    s_and_b32 s20, s17, 3
    s_lshl_b32 s18, s20, 21
    s_add_u32 s18, s18, 117440512
    s_lshl_b32 s62, s20, 17
    s_add_u32 s20, s17, 1
    s_and_b32 s20, s20, 3
    s_lshl_b32 s19, s20, 21
    s_add_u32 s19, s19, 117440512
    s_add_u32 s20, s17, 3
    s_and_b32 s20, s20, 3
    s_lshl_b32 s26, s20, 21
    s_add_u32 s26, s26, 117440512
    s_lshl_b32 s63, s20, 17
    s_lshl_b32 s44, s12, 12
    s_add_u32 s44, s44, 131072
    s_add_u32 s44, s44, s18
    s_lshl_b32 s20, s17, 5
    s_add_u32 s20, s20, s12
    s_mul_i32 s21, s20, 3072
    s_add_u32 s30, s21, 106954752
    s_mul_i32 s20, s20, 12288
    s_mul_i32 s21, s16, 6144
    s_add_u32 s28, s20, s21
    s_add_u32 s28, s28, 25165824
    s_mul_i32 s21, s13, 6144
    s_add_u32 s27, s20, s21
    s_mul_i32 s21, s16, 3072
    s_add_u32 s27, s27, s21
    s_add_u32 s27, s27, 393216
    s_add_u32 s20, s17, 1
    s_and_b32 s20, s20, 1
    s_mul_i32 s47, s20, 6144
    s_add_u32 s47, s47, s21
    s_add_u32 s47, s47, 138752
    s_sub_u32 s53, 0, s53
    s_add_u32 s95, s18, s58
    s_add_u32 s33, s17, 2
    s_min_u32 s33, s33, 64
    s_mov_b32 s89, 0xf0000000
    s_mov_b32 s92, 0xf0000000
    s_lshl_b32 s98, s12, 12
    s_add_u32 s98, s98, 131072
    s_mul_i32 s46, s16, 6144
    s_add_u32 s46, s46, 151040
    v_mov_b32 v88, 0
    v_mov_b32 v89, 0
    v_mov_b32 v90, 0
    v_mov_b32 v91, 0
    v_mov_b32 v92, 0
    v_mov_b32 v93, 0
    v_mov_b32 v94, 0
    v_mov_b32 v95, 0
    v_mov_b32 v96, 0
    v_mov_b32 v97, 0
    v_mov_b32 v98, 0
    v_mov_b32 v99, 0
    v_mov_b32 v100, 0
    v_mov_b32 v101, 0
    v_mov_b32 v102, 0
    v_mov_b32 v103, 0
    v_mov_b32 v104, 0
    v_mov_b32 v105, 0
    v_mov_b32 v106, 0
    v_mov_b32 v107, 0
L_loop_3L:
    v_cmp_gt_u32 vcc, s33, v14
    s_cbranch_vccz Lf_356
    v_and_b32 v108, 7, v0
    v_lshlrev_b32 v108, 2, v108
    s_mov_b32 s24, 0
Lf_357:
    buffer_load_dword v14, v108, s[4:7], s32 offen sc1
    s_waitcnt vmcnt(0)
    v_cmp_gt_u32 vcc, s33, v14
    s_cbranch_vccz Lf_356
    s_add_u32 s24, s24, 1
    s_cmp_lt_u32 s24, 400000
    s_cbranch_scc1 Lf_357
    s_branch L_abort
Lf_356:
    v_mov_b32 v76, 0
    v_mov_b32 v77, 0
    v_mov_b32 v78, 0
    v_mov_b32 v79, 0
    s_mov_b32 s24, 0
Lg_358:
    buffer_load_dwordx4 v[68:71], v3, s[4:7], s95 offen sc1
    buffer_load_dwordx4 v[72:75], v3, s[4:7], s95 offen offset:1024 sc1
    s_mov_b64 exec, s[34:35]
    buffer_load_dwordx4 v[76:79], v3, s[4:7], s95 offen offset:2048 sc1
    s_mov_b64 exec, -1
    s_waitcnt vmcnt(0)
    v_max3_u32 v84, v68, v69, v70
    v_max3_u32 v85, v71, v72, v73
    v_max3_u32 v84, v84, v74, v75
    v_max3_u32 v85, v85, v76, v77
    v_max3_u32 v84, v84, v78, v79
    v_max_u32 v84, v84, v85
    v_cmp_eq_u32 vcc, -1, v84
    s_cbranch_vccz Lg_359
    s_add_u32 s24, s24, 1
    s_cmp_lt_u32 s24, 400000
    s_cbranch_scc1 Lg_358
    s_branch L_abort
Lg_359:
    ds_write_b128 v2, v[68:71] offset:0
    ds_write_b128 v2, v[72:75] offset:1024
    s_mov_b64 exec, s[34:35]
    ds_write_b128 v2, v[76:79] offset:2048
    s_mov_b64 exec, -1
    s_waitcnt lgkmcnt(0)
    s_barrier
    ds_read_b128 v[68:71], v4 offset:0
    ds_read_b128 v[112:115], v8 offset:0
    ds_read_b128 v[116:119], v8 offset:1024
    ds_read_b128 v[72:75], v4 offset:1024
    ds_read_b128 v[120:123], v8 offset:12288
    ds_read_b128 v[124:127], v8 offset:13312
    s_waitcnt lgkmcnt(3)
    v_smfmac_f32_16x16x64_bf16 v[88:91], v[68:71], a[0:7], v30
    ds_read_b128 v[76:79], v4 offset:2048
    v_smfmac_f32_16x16x64_bf16 v[92:95], v[68:71], a[80:87], v30
    ds_read_b128 v[128:131], v8 offset:24576
    buffer_store_dword v152, v19, s[4:7], s89 offen sc1
    v_smfmac_f32_16x16x64_bf16 v[96:99], v[68:71], a[160:167], v30
    ds_read_b128 v[132:135], v8 offset:25600
    v_smfmac_f32_16x16x64_bf16 v[100:103], v[68:71], v[112:119], v30
    buffer_store_dword v153, v19, s[4:7], s89 offen offset:256 sc1
    s_waitcnt lgkmcnt(3)
    v_smfmac_f32_16x16x64_bf16 v[88:91], v[72:75], a[8:15], v30
    ds_read_b128 v[68:71], v4 offset:3072
    v_smfmac_f32_16x16x64_bf16 v[92:95], v[72:75], a[88:95], v30
    ds_read_b128 v[112:115], v8 offset:36864
    buffer_store_dwordx4 v[144:147], v148, s[4:7], s92 offen sc1
    v_smfmac_f32_16x16x64_bf16 v[96:99], v[72:75], a[168:175], v30
    ds_read_b128 v[116:119], v8 offset:37888
    v_smfmac_f32_16x16x64_bf16 v[100:103], v[72:75], v[120:127], v30
    s_mov_b64 exec, s[34:35]
    buffer_store_dwordx4 v[156:159], v149, s[4:7], s92 offen sc1
    s_mov_b64 exec, -1
    s_waitcnt lgkmcnt(3)
    v_smfmac_f32_16x16x64_bf16 v[88:91], v[76:79], a[16:23], v30
    ds_read_b128 v[72:75], v4 offset:4096
    v_smfmac_f32_16x16x64_bf16 v[92:95], v[76:79], a[96:103], v30
    ds_read_b128 v[120:123], v10 offset:0
    s_lshl_b32 s20, s12, 8
    s_lshl_b32 s21, s13, 7
    s_add_u32 s20, s20, s21
    s_add_u32 s20, s20, 125845504
    s_add_u32 s21, s17, -1
    s_max_i32 s21, s21, 0
    v_mov_b32 v16, s21
    v_mov_b32 v17, 0
    s_mov_b64 exec, 1
    buffer_store_dword v16, v17, s[4:7], s20 offen sc1
    s_mov_b64 exec, -1
    v_smfmac_f32_16x16x64_bf16 v[96:99], v[76:79], a[176:183], v30
    ds_read_b128 v[124:127], v10 offset:1024
    v_smfmac_f32_16x16x64_bf16 v[100:103], v[76:79], v[128:135], v30
    s_waitcnt lgkmcnt(3)
    v_smfmac_f32_16x16x64_bf16 v[88:91], v[68:71], a[24:31], v30
    ds_read_b128 v[76:79], v4 offset:5120
    v_smfmac_f32_16x16x64_bf16 v[92:95], v[68:71], a[104:111], v30
    ds_read_b128 v[128:131], v10 offset:12288
    v_smfmac_f32_16x16x64_bf16 v[96:99], v[68:71], a[184:191], v30
    ds_read_b128 v[132:135], v10 offset:13312
    v_smfmac_f32_16x16x64_bf16 v[100:103], v[68:71], v[112:119], v30
    s_waitcnt lgkmcnt(3)
    v_smfmac_f32_16x16x64_bf16 v[88:91], v[72:75], a[32:39], v30
    ds_read_b128 v[68:71], v4 offset:6144
    v_smfmac_f32_16x16x64_bf16 v[92:95], v[72:75], a[112:119], v30
    ds_read_b128 v[112:115], v10 offset:24576
    v_smfmac_f32_16x16x64_bf16 v[96:99], v[72:75], a[192:199], v30
    ds_read_b128 v[116:119], v10 offset:25600
    v_smfmac_f32_16x16x64_bf16 v[100:103], v[72:75], v[120:127], v30
    s_waitcnt lgkmcnt(3)
    v_smfmac_f32_16x16x64_bf16 v[88:91], v[76:79], a[40:47], v30
    ds_read_b128 v[72:75], v4 offset:7168
    v_smfmac_f32_16x16x64_bf16 v[92:95], v[76:79], a[120:127], v30
    ds_read_b128 v[120:123], v10 offset:36864
    v_smfmac_f32_16x16x64_bf16 v[96:99], v[76:79], a[200:207], v30
    ds_read_b128 v[124:127], v10 offset:37888
    v_smfmac_f32_16x16x64_bf16 v[100:103], v[76:79], v[128:135], v30
    s_waitcnt lgkmcnt(3)
    v_smfmac_f32_16x16x64_bf16 v[88:91], v[68:71], a[48:55], v30
    ds_read_b128 v[76:79], v4 offset:8192
    v_smfmac_f32_16x16x64_bf16 v[92:95], v[68:71], a[128:135], v30
    ds_read_b128 v[128:131], v10 offset:49152
    v_smfmac_f32_16x16x64_bf16 v[96:99], v[68:71], a[208:215], v30
    ds_read_b128 v[132:135], v10 offset:50176
    v_smfmac_f32_16x16x64_bf16 v[100:103], v[68:71], v[112:119], v30
    s_waitcnt lgkmcnt(3)
    v_smfmac_f32_16x16x64_bf16 v[88:91], v[72:75], a[56:63], v30
    ds_read_b128 v[68:71], v4 offset:9216
    v_smfmac_f32_16x16x64_bf16 v[92:95], v[72:75], a[136:143], v30
    ds_read_b128 v[112:115], v10 offset:61440
    v_smfmac_f32_16x16x64_bf16 v[96:99], v[72:75], a[216:223], v30
    ds_read_b128 v[116:119], v10 offset:62464
    v_smfmac_f32_16x16x64_bf16 v[100:103], v[72:75], v[120:127], v30
    s_waitcnt lgkmcnt(3)
    v_smfmac_f32_16x16x64_bf16 v[88:91], v[76:79], a[64:71], v30
    v_smfmac_f32_16x16x64_bf16 v[92:95], v[76:79], a[144:151], v30
    v_smfmac_f32_16x16x64_bf16 v[96:99], v[76:79], a[224:231], v30
    v_smfmac_f32_16x16x64_bf16 v[100:103], v[76:79], v[128:135], v30
    s_waitcnt lgkmcnt(0)
    v_smfmac_f32_16x16x64_bf16 v[88:91], v[68:71], a[72:79], v30
    v_smfmac_f32_16x16x64_bf16 v[92:95], v[68:71], a[152:159], v30
    v_smfmac_f32_16x16x64_bf16 v[96:99], v[68:71], a[232:239], v30
    v_smfmac_f32_16x16x64_bf16 v[100:103], v[68:71], v[112:119], v30
    s_nop 5
    v_add_f32 v88, v88, v89
    v_add_f32 v90, v90, v91
    v_add_f32 v92, v92, v93
    v_add_f32 v94, v94, v95
    v_add_f32 v96, v96, v97
    v_add_f32 v98, v98, v99
    v_cvt_pk_bf16_f32 v89, v88, v90
    v_cvt_pk_bf16_f32 v93, v92, v94
    v_cvt_pk_bf16_f32 v97, v96, v98
    v_mov_b32_dpp v91, v89 quad_perm:[1,0,3,2] row_mask:0xf bank_mask:0xf
    v_mov_b32_dpp v95, v93 quad_perm:[1,0,3,2] row_mask:0xf bank_mask:0xf
    v_mov_b32_dpp v99, v97 quad_perm:[1,0,3,2] row_mask:0xf bank_mask:0xf
    v_perm_b32 v91, v91, v89, v31
    ds_write_b32 v5, v91
    v_perm_b32 v95, v95, v93, v31
    ds_write_b32 v6, v95
    v_perm_b32 v99, v99, v97, v31
    ds_write_b32 v7, v99
    v_add_f32 v100, v100, v101
    v_add_f32 v102, v102, v103
    v_cvt_pk_bf16_f32 v100, v100, v102
    s_waitcnt lgkmcnt(0)
    ds_read_b128 v[136:139], v4 offset:0
    ds_read_b128 v[112:115], v9 offset:0
    ds_read_b128 v[116:119], v9 offset:1024
    ds_read_b128 v[140:143], v4 offset:1024
    ds_read_b128 v[120:123], v9 offset:12288
    ds_read_b128 v[124:127], v9 offset:13312
    ds_read_b128 v[80:83], v4 offset:2048
    ds_read_b128 v[128:131], v9 offset:24576
    ds_read_b128 v[132:135], v9 offset:25600
    ds_read_b128 v[84:87], v4 offset:3072
    ds_read_b128 v[32:35], v9 offset:36864
    ds_read_b128 v[36:39], v9 offset:37888
    s_barrier
    buffer_store_dword v100, v19, s[4:7], s44 offen
    v_mov_b32 v152, v100
    s_waitcnt lgkmcnt(9)
    v_smfmac_f32_16x16x64_bf16 v[104:107], v[136:139], v[112:119], v30
    ds_read_b128 v[136:139], v4 offset:4096
    ds_read_b128 v[112:115], v11 offset:0
    ds_read_b128 v[116:119], v11 offset:1024
    s_waitcnt lgkmcnt(9)
    v_smfmac_f32_16x16x64_bf16 v[104:107], v[140:143], v[120:127], v30
    ds_read_b128 v[140:143], v4 offset:5120
    ds_read_b128 v[120:123], v11 offset:12288
    ds_read_b128 v[124:127], v11 offset:13312
    s_waitcnt lgkmcnt(9)
    v_smfmac_f32_16x16x64_bf16 v[104:107], v[80:83], v[128:135], v30
    ds_read_b128 v[80:83], v4 offset:6144
    ds_read_b128 v[128:131], v11 offset:24576
    ds_read_b128 v[132:135], v11 offset:25600
    s_waitcnt lgkmcnt(9)
    v_smfmac_f32_16x16x64_bf16 v[104:107], v[84:87], v[32:39], v30
    ds_read_b128 v[84:87], v4 offset:7168
    ds_read_b128 v[32:35], v11 offset:36864
    ds_read_b128 v[36:39], v11 offset:37888
    s_waitcnt lgkmcnt(9)
    v_smfmac_f32_16x16x64_bf16 v[104:107], v[136:139], v[112:119], v30
    ds_read_b128 v[136:139], v4 offset:8192
    ds_read_b128 v[112:115], v11 offset:49152
    ds_read_b128 v[116:119], v11 offset:50176
    s_waitcnt lgkmcnt(9)
    v_smfmac_f32_16x16x64_bf16 v[104:107], v[140:143], v[120:127], v30
    ds_read_b128 v[140:143], v4 offset:9216
    ds_read_b128 v[120:123], v11 offset:61440
    ds_read_b128 v[124:127], v11 offset:62464
    s_waitcnt lgkmcnt(9)
    v_smfmac_f32_16x16x64_bf16 v[104:107], v[80:83], v[128:135], v30
    s_waitcnt lgkmcnt(6)
    v_smfmac_f32_16x16x64_bf16 v[104:107], v[84:87], v[32:39], v30
    s_waitcnt lgkmcnt(3)
    v_smfmac_f32_16x16x64_bf16 v[104:107], v[136:139], v[112:119], v30
    s_waitcnt lgkmcnt(0)
    v_smfmac_f32_16x16x64_bf16 v[104:107], v[140:143], v[120:127], v30
    s_mul_i32 s21, s13, 192
    s_add_u32 s29, s30, s21
    s_add_u32 s29, s29, -6291456
    v_add_u32 v154, 0, v0
    v_mul_u32_u24 v155, 0x1556, v154
    v_lshrrev_b32 v155, 16, v155
    v_mul_u32_u24 v24, 12, v155
    v_sub_u32 v24, v154, v24
    v_lshlrev_b32 v24, 4, v24
    v_mul_u32_u24 v18, 208, v155
    v_add_u32 v18, v18, v24
    v_add_u32 v18, 134656, v18
    v_mul_u32_u24 v148, 384, v155
    v_add_u32 v148, v148, v24
    ds_read_b128 v[144:147], v18
    v_add_u32 v154, 64, v0
    v_mul_u32_u24 v155, 0x1556, v154
    v_lshrrev_b32 v155, 16, v155
    v_mul_u32_u24 v24, 12, v155
    v_sub_u32 v24, v154, v24
    v_lshlrev_b32 v24, 4, v24
    v_mul_u32_u24 v18, 208, v155
    v_add_u32 v18, v18, v24
    v_add_u32 v18, 134656, v18
    v_mul_u32_u24 v149, 384, v155
    v_add_u32 v149, v149, v24
    ds_read_b128 v[156:159], v18
    s_nop 7
    v_add_f32 v104, v104, v105
    v_add_f32 v106, v106, v107
    v_cvt_pk_bf16_f32 v104, v104, v106
    buffer_store_dword v104, v19, s[4:7], s44 offen offset:256
    v_mov_b32 v153, v104
    v_mov_b32 v88, 0
    v_mov_b32 v89, 0
    v_mov_b32 v90, 0
    v_mov_b32 v91, 0
    v_mov_b32 v92, 0
    v_mov_b32 v93, 0
    v_mov_b32 v94, 0
    v_mov_b32 v95, 0
    v_mov_b32 v96, 0
    v_mov_b32 v97, 0
    v_mov_b32 v98, 0
    v_mov_b32 v99, 0
    v_mov_b32 v100, 0
    v_mov_b32 v101, 0
    v_mov_b32 v102, 0
    v_mov_b32 v103, 0
    s_sleep 2
    buffer_load_dwordx4 v[68:71], v15, s[4:7], s18 offen sc1
    buffer_load_dwordx4 v[72:75], v15, s[4:7], s18 offen offset:1024 sc1
    s_waitcnt lgkmcnt(0)
    s_waitcnt vmcnt(4)
    s_barrier
    s_cmp_eq_u32 s17, 63
    s_cbranch_scc1 L_last_3L
    ds_read_b128 v[76:79], v4 offset:13440
    ds_read_b128 v[80:83], v4 offset:14464
    ds_read_b128 v[44:47], v150 offset:0
    ds_read_b128 v[52:55], v150 offset:1024
    ds_read_b128 v[60:63], v150 offset:2048
    s_mov_b32 s24, 0
    s_waitcnt vmcnt(0)
    s_branch Lp_360_chk
Lp_360:
    buffer_load_dwordx4 v[68:71], v15, s[4:7], s18 offen sc1
    buffer_load_dwordx4 v[72:75], v15, s[4:7], s18 offen offset:1024 sc1
    s_waitcnt vmcnt(0)
Lp_360_chk:
    v_max3_u32 v84, v68, v69, v70
    v_max3_u32 v85, v71, v72, v73
    v_max3_u32 v84, v84, v74, v75
    v_max_u32 v84, v84, v85
    v_cmp_eq_u32 vcc, -1, v84
    s_cbranch_vccz Lp_361
    s_add_u32 s24, s24, 1
    s_cmp_lt_u32 s24, 400000
    s_cbranch_scc1 Lp_360
    s_branch L_abort
Lp_361:
    s_mov_b64 exec, s[36:37]
    buffer_load_dwordx2 v[48:49], v20, s[4:7], s44 offen sc1
    buffer_load_dwordx2 v[56:57], v20, s[4:7], s44 offen offset:256 sc1
    buffer_load_dwordx2 v[64:65], v20, s[4:7], s44 offen offset:512 sc1
    s_mov_b64 exec, -1
    s_waitcnt lgkmcnt(3)
    v_pk_add_f32 v[76:77], v[76:77], v[68:69]
    v_pk_add_f32 v[78:79], v[78:79], v[70:71]
    v_pk_add_f32 v[80:81], v[80:81], v[72:73]
    v_pk_add_f32 v[82:83], v[82:83], v[74:75]
    v_max3_f32 v84, v76, v77, v78
    v_max3_f32 v85, v79, v80, v81
    v_max3_f32 v84, v84, v82, v83
    v_max_f32 v84, v84, v85
    s_nop 1
    v_max_f32_dpp v84, v84, v84 quad_perm:[1,0,3,2] row_mask:0xf bank_mask:0xf
    v_mov_b32 v85, v84
    s_nop 1
    v_permlane16_swap_b32 v84, v85
    v_max_f32 v84, v84, v85
    v_mov_b32 v85, v84
    s_nop 1
    v_permlane32_swap_b32 v84, v85
    v_max_f32 v84, v84, v85
    s_mov_b32 s42, 0x3dd53b95
    v_mul_f32 v84, s42, v84
    v_fma_f32 v76, v76, s42, -v84
    v_fma_f32 v77, v77, s42, -v84
    v_fma_f32 v78, v78, s42, -v84
    v_fma_f32 v79, v79, s42, -v84
    v_fma_f32 v80, v80, s42, -v84
    v_fma_f32 v81, v81, s42, -v84
    v_fma_f32 v82, v82, s42, -v84
    v_fma_f32 v83, v83, s42, -v84
    v_exp_f32 v76, v76
    v_exp_f32 v77, v77
    v_exp_f32 v78, v78
    v_exp_f32 v79, v79
    v_exp_f32 v80, v80
    v_exp_f32 v81, v81
    v_exp_f32 v82, v82
    v_exp_f32 v83, v83
    v_cvt_pk_bf16_f32 v68, v76, v77
    v_cvt_pk_bf16_f32 v69, v78, v79
    v_cvt_pk_bf16_f32 v70, v80, v81
    v_cvt_pk_bf16_f32 v71, v82, v83
    s_mov_b32 s24, 0
    s_waitcnt vmcnt(0)
    s_branch Lp_362_chk
Lp_362:
    s_mov_b64 exec, s[36:37]
    buffer_load_dwordx2 v[48:49], v20, s[4:7], s44 offen sc1
    buffer_load_dwordx2 v[56:57], v20, s[4:7], s44 offen offset:256 sc1
    buffer_load_dwordx2 v[64:65], v20, s[4:7], s44 offen offset:512 sc1
    s_mov_b64 exec, -1
    s_waitcnt vmcnt(0)
Lp_362_chk:
    v_max3_u32 v84, v48, v49, v56
    v_max3_u32 v85, v57, v64, v65
    v_max_u32 v84, v84, v85
    v_cmp_eq_u32 vcc, -1, v84
    s_cbranch_vccz Lp_363
    s_add_u32 s24, s24, 1
    s_cmp_lt_u32 s24, 400000
    s_cbranch_scc1 Lp_362
    s_branch L_abort
Lp_363:
    s_waitcnt lgkmcnt(0)
    v_smfmac_f32_16x16x64_bf16 v[88:91], v[68:71], v[44:51], v30
    v_smfmac_f32_16x16x64_bf16 v[92:95], v[68:71], v[52:59], v30
    v_smfmac_f32_16x16x64_bf16 v[96:99], v[68:71], v[60:67], v30
    v_smfmac_f32_16x16x64_bf16 v[100:103], v[68:71], a[240:247], v30
    v_mov_b32 v72, 0
    v_mov_b32 v73, 0
    v_mov_b32 v74, 0
    v_mov_b32 v75, 0
    v_mov_b32 v76, 0
    v_mov_b32 v77, 0
    v_mov_b32 v78, 0
    v_mov_b32 v79, 0
    v_add_f32 v88, v88, v89
    v_add_f32 v90, v90, v91
    v_add_f32 v92, v92, v93
    v_add_f32 v94, v94, v95
    v_add_f32 v96, v96, v97
    v_add_f32 v98, v98, v99
    v_add_f32 v100, v100, v101
    v_add_f32 v102, v102, v103
    v_rcp_f32 v100, v100
    v_rcp_f32 v102, v102
    s_nop 0
    v_mul_f32 v88, v88, v100
    v_mul_f32 v90, v90, v102
    v_mul_f32 v92, v92, v100
    v_mul_f32 v94, v94, v102
    v_mul_f32 v96, v96, v100
    v_mul_f32 v98, v98, v102
    v_cvt_pk_bf16_f32 v89, v88, v90
    v_cvt_pk_bf16_f32 v93, v92, v94
    v_cvt_pk_bf16_f32 v97, v96, v98
    v_mov_b32_dpp v91, v89 quad_perm:[1,0,3,2] row_mask:0xf bank_mask:0xf
    v_mov_b32_dpp v95, v93 quad_perm:[1,0,3,2] row_mask:0xf bank_mask:0xf
    v_mov_b32_dpp v99, v97 quad_perm:[1,0,3,2] row_mask:0xf bank_mask:0xf
    v_perm_b32 v91, v91, v89, v31
    ds_write_b32 v21, v91
    v_perm_b32 v95, v95, v93, v31
    ds_write_b32 v22, v95
    v_perm_b32 v99, v99, v97, v31
    ds_write_b32 v23, v99
    v_mov_b32 v80, 0
    v_mov_b32 v81, 0
    v_mov_b32 v82, 0
    v_mov_b32 v83, 0
    v_mov_b32 v84, 0
    v_mov_b32 v85, 0
    v_mov_b32 v86, 0
    v_mov_b32 v87, 0
    s_waitcnt lgkmcnt(0)
    s_barrier
    ds_read_b128 v[32:35], v4 offset:10240
    ds_read_b128 v[36:39], v4 offset:11264
    ds_read_b128 v[40:43], v4 offset:12288
    s_waitcnt lgkmcnt(2)
    v_smfmac_f32_16x16x64_bf16 v[72:75], v[32:35], v[160:167], v30
    v_smfmac_f32_16x16x64_bf16 v[76:79], v[32:35], v[184:191], v30
    s_waitcnt lgkmcnt(1)
    v_smfmac_f32_16x16x64_bf16 v[72:75], v[36:39], v[168:175], v30
    v_smfmac_f32_16x16x64_bf16 v[76:79], v[36:39], v[192:199], v30
    s_waitcnt lgkmcnt(0)
    v_smfmac_f32_16x16x64_bf16 v[72:75], v[40:43], v[176:183], v30
    v_smfmac_f32_16x16x64_bf16 v[76:79], v[40:43], v[200:207], v30
    v_smfmac_f32_16x16x64_bf16 v[80:83], v[32:35], v[208:215], v30
    s_nop 1
    v_smfmac_f32_16x16x64_bf16 v[84:87], v[32:35], v[232:239], v30
    s_nop 1
    v_smfmac_f32_16x16x64_bf16 v[80:83], v[36:39], v[216:223], v30
    s_nop 1
    v_smfmac_f32_16x16x64_bf16 v[84:87], v[36:39], v[240:247], v30
    v_add_f32 v72, v72, v73
    v_add_f32 v73, v76, v77
    v_smfmac_f32_16x16x64_bf16 v[80:83], v[40:43], v[224:231], v30
    v_add_f32 v76, v74, v75
    v_add_f32 v75, v78, v79
    v_smfmac_f32_16x16x64_bf16 v[84:87], v[40:43], v[248:255], v30
    v_cvt_pk_bf16_f32 v72, v72, v73
    v_cvt_pk_bf16_f32 v73, v76, v75
    buffer_store_dwordx2 v[72:73], v25, s[4:7], s18 offen
    s_nop 7
    v_add_f32 v80, v80, v81
    v_add_f32 v81, v84, v85
    v_add_f32 v84, v82, v83
    v_add_f32 v83, v86, v87
    v_cvt_pk_bf16_f32 v80, v80, v81
    v_cvt_pk_bf16_f32 v81, v84, v83
    buffer_store_dwordx2 v[80:81], v26, s[4:7], s18 offen
    s_barrier
    s_lshl_b32 s20, s12, 12
    s_add_u32 s20, s20, 131072
    s_add_u32 s20, s20, s26
    buffer_store_dword a248, v19, s[4:7], s20 offen
    buffer_store_dword a248, v19, s[4:7], s20 offen offset:256
    buffer_store_dwordx2 a[248:249], v25, s[4:7], s26 offen
    buffer_store_dwordx2 a[248:249], v26, s[4:7], s26 offen
    s_mov_b32 s89, s30
    s_mov_b32 s92, s29
    v_and_b32 v12, 7, v0
    v_lshlrev_b32 v12, 2, v12
    buffer_load_dword v14, v12, s[4:7], s32 offen sc1
    s_add_u32 s17, s17, 1
    s_mov_b32 s26, s18
    s_mov_b32 s18, s19
    s_add_u32 s19, s19, 2097152
    s_and_b32 s19, s19, 0x77fffff
    s_or_b32 s19, s19, 0x7000000
    s_mov_b32 s63, s62
    s_add_u32 s62, s62, 131072
    s_and_b32 s62, s62, 0x7ffff
    s_add_u32 s44, s18, s98
    s_add_u32 s95, s18, s58
    s_add_u32 s30, s30, 98304
    s_add_u32 s28, s28, 393216
    s_add_u32 s27, s27, 393216
    s_add_u32 s33, s17, 2
    s_min_u32 s33, s33, 64
    v_mov_b32 v88, 0
    v_mov_b32 v89, 0
    v_mov_b32 v90, 0
    v_mov_b32 v91, 0
    v_mov_b32 v92, 0
    v_mov_b32 v93, 0
    v_mov_b32 v94, 0
    v_mov_b32 v95, 0
    v_mov_b32 v96, 0
    v_mov_b32 v97, 0
    v_mov_b32 v98, 0
    v_mov_b32 v99, 0
    v_mov_b32 v100, 0
    v_mov_b32 v101, 0
    v_mov_b32 v102, 0
    v_mov_b32 v103, 0
    v_mov_b32 v104, 0
    v_mov_b32 v105, 0
    v_mov_b32 v106, 0
    v_mov_b32 v107, 0
    s_barrier
    s_branch L_loop_3L
L_last_3L:
    buffer_store_dword v152, v19, s[4:7], s30 offen sc1
    buffer_store_dword v153, v19, s[4:7], s30 offen offset:256 sc1
    buffer_store_dwordx4 v[144:147], v148, s[4:7], s29 offen sc1
    s_mov_b64 exec, s[34:35]
    buffer_store_dwordx4 v[156:159], v149, s[4:7], s29 offen sc1
    s_mov_b64 exec, -1
    s_waitcnt vmcnt(0)
    s_barrier
    s_lshl_b32 s20, s12, 8
    s_lshl_b32 s21, s13, 7
    s_add_u32 s20, s20, s21
    s_add_u32 s20, s20, 125845504
    s_add_u32 s21, s17, 1
    v_mov_b32 v16, s21
    v_mov_b32 v17, 0
    s_mov_b64 exec, 1
    buffer_store_dword v16, v17, s[4:7], s20 offen sc1
    s_mov_b64 exec, -1
    s_branch L_chain_end
    .p2align 6
T_0G:
    s_and_b32 s20, s17, 3
    s_lshl_b32 s18, s20, 21
    s_add_u32 s18, s18, 117440512
    s_lshl_b32 s62, s20, 17
    s_add_u32 s20, s17, 1
    s_and_b32 s20, s20, 3
    s_lshl_b32 s19, s20, 21
    s_add_u32 s19, s19, 117440512
    s_add_u32 s20, s17, 3
    s_and_b32 s20, s20, 3
    s_lshl_b32 s26, s20, 21
    s_add_u32 s26, s26, 117440512
    s_lshl_b32 s63, s20, 17
    s_lshl_b32 s44, s12, 12
    s_add_u32 s44, s44, 131072
    s_add_u32 s44, s44, s18
    s_lshl_b32 s20, s17, 5
    s_add_u32 s20, s20, s12
    s_mul_i32 s21, s20, 3072
    s_add_u32 s30, s21, 106954752
    s_mul_i32 s20, s20, 12288
    s_mul_i32 s21, s16, 6144
    s_add_u32 s28, s20, s21
    s_add_u32 s28, s28, 25165824
    s_mul_i32 s21, s13, 6144
    s_add_u32 s27, s20, s21
    s_mul_i32 s21, s16, 3072
    s_add_u32 s27, s27, s21
    s_add_u32 s27, s27, 393216
    s_add_u32 s20, s17, 1
    s_and_b32 s20, s20, 1
    s_mul_i32 s47, s20, 6144
    s_add_u32 s47, s47, s21
    s_add_u32 s47, s47, 138752
    v_add_u32 v17, s53, v17
    v_add_u32 v18, s53, v18
    s_sub_u32 s53, 0, s53
    s_add_u32 s95, s18, s58
    s_mov_b32 s89, 0xf0000000
    s_mov_b32 s92, 0xf0000000
    s_lshl_b32 s98, s12, 12
    s_add_u32 s98, s98, 131072
    s_mul_i32 s46, s16, 6144
    s_add_u32 s46, s46, 151040
    v_mov_b32 v88, 0
    v_mov_b32 v89, 0
    v_mov_b32 v90, 0
    v_mov_b32 v91, 0
    v_mov_b32 v92, 0
    v_mov_b32 v93, 0
    v_mov_b32 v94, 0
    v_mov_b32 v95, 0
    v_mov_b32 v96, 0
    v_mov_b32 v97, 0
    v_mov_b32 v98, 0
    v_mov_b32 v99, 0
    v_mov_b32 v100, 0
    v_mov_b32 v101, 0
    v_mov_b32 v102, 0
    v_mov_b32 v103, 0
L_loop_0G:
    v_mov_b32 v76, 0
    v_mov_b32 v77, 0
    v_mov_b32 v78, 0
    v_mov_b32 v79, 0
    s_mov_b32 s24, 0
Lg_367:
    buffer_load_dwordx4 v[68:71], v3, s[4:7], s95 offen sc1
    buffer_load_dwordx4 v[72:75], v3, s[4:7], s95 offen offset:1024 sc1
    s_mov_b64 exec, s[34:35]
    buffer_load_dwordx4 v[76:79], v3, s[4:7], s95 offen offset:2048 sc1
    s_mov_b64 exec, -1
    s_waitcnt vmcnt(0)
    v_max3_u32 v84, v68, v69, v70
    v_max3_u32 v85, v71, v72, v73
    v_max3_u32 v84, v84, v74, v75
    v_max3_u32 v85, v85, v76, v77
    v_max3_u32 v84, v84, v78, v79
    v_max_u32 v84, v84, v85
    v_cmp_eq_u32 vcc, -1, v84
    s_cbranch_vccz Lg_368
    s_add_u32 s24, s24, 1
    s_cmp_lt_u32 s24, 400000
    s_cbranch_scc1 Lg_367
    s_branch L_abort
Lg_368:
    ds_write_b128 v2, v[68:71] offset:0
    ds_write_b128 v2, v[72:75] offset:1024
    s_mov_b64 exec, s[34:35]
    ds_write_b128 v2, v[76:79] offset:2048
    s_mov_b64 exec, -1
    s_waitcnt lgkmcnt(0)
    s_barrier
    ds_read_b128 v[68:71], v4 offset:0
    ds_read_b128 v[32:35], v8 offset:0
    ds_read_b128 v[36:39], v8 offset:1024
    ds_read_b128 v[72:75], v4 offset:1024
    ds_read_b128 v[80:83], v8 offset:12288
    ds_read_b128 v[84:87], v8 offset:13312
    s_waitcnt lgkmcnt(3)
    v_smfmac_f32_16x16x64_bf16 v[88:91], v[68:71], a[0:7], v30
    ds_read_b128 v[76:79], v4 offset:2048
    v_smfmac_f32_16x16x64_bf16 v[92:95], v[68:71], a[80:87], v30
    ds_read_b128 v[104:107], v8 offset:24576
    s_mov_b32 m0, s46
    s_nop 0
    buffer_load_dwordx4 v1, s[4:7], s28 offen offset:0 sc1 nt lds
    v_smfmac_f32_16x16x64_bf16 v[96:99], v[68:71], a[160:167], v30
    ds_read_b128 v[108:111], v8 offset:25600
    v_smfmac_f32_16x16x64_bf16 v[100:103], v[68:71], v[32:39], v30
    buffer_load_dwordx4 v1, s[4:7], s28 offen offset:1024 sc1 nt lds
    s_waitcnt lgkmcnt(3)
    v_smfmac_f32_16x16x64_bf16 v[88:91], v[72:75], a[8:15], v30
    ds_read_b128 v[68:71], v4 offset:3072
    v_smfmac_f32_16x16x64_bf16 v[92:95], v[72:75], a[88:95], v30
    ds_read_b128 v[32:35], v8 offset:36864
    buffer_load_dwordx4 v1, s[4:7], s28 offen offset:2048 sc1 nt lds
    v_smfmac_f32_16x16x64_bf16 v[96:99], v[72:75], a[168:175], v30
    ds_read_b128 v[36:39], v8 offset:37888
    v_smfmac_f32_16x16x64_bf16 v[100:103], v[72:75], v[80:87], v30
    buffer_load_dwordx4 v1, s[4:7], s28 offen offset:3072 sc1 nt lds
    s_waitcnt lgkmcnt(3)
    v_smfmac_f32_16x16x64_bf16 v[88:91], v[76:79], a[16:23], v30
    ds_read_b128 v[72:75], v4 offset:4096
    v_smfmac_f32_16x16x64_bf16 v[92:95], v[76:79], a[96:103], v30
    ds_read_b128 v[80:83], v10 offset:0
    s_add_u32 m0, s46, 4096
    s_add_u32 s20, s28, 4096
    buffer_load_dwordx4 v1, s[4:7], s20 offen offset:0 sc1 nt lds
    v_smfmac_f32_16x16x64_bf16 v[96:99], v[76:79], a[176:183], v30
    ds_read_b128 v[84:87], v10 offset:1024
    v_smfmac_f32_16x16x64_bf16 v[100:103], v[76:79], v[104:111], v30
    buffer_load_dwordx4 v1, s[4:7], s20 offen offset:1024 sc1 nt lds
    s_waitcnt lgkmcnt(3)
    v_smfmac_f32_16x16x64_bf16 v[88:91], v[68:71], a[24:31], v30
    ds_read_b128 v[76:79], v4 offset:5120
    v_smfmac_f32_16x16x64_bf16 v[92:95], v[68:71], a[104:111], v30
    ds_read_b128 v[104:107], v10 offset:12288
    s_mov_b32 m0, s47
    s_nop 0
    buffer_load_dwordx4 v1, s[4:7], s27 offen offset:0 sc1 nt lds
    v_smfmac_f32_16x16x64_bf16 v[96:99], v[68:71], a[184:191], v30
    ds_read_b128 v[108:111], v10 offset:13312
    v_smfmac_f32_16x16x64_bf16 v[100:103], v[68:71], v[32:39], v30
    buffer_load_dwordx4 v1, s[4:7], s27 offen offset:1024 sc1 nt lds
    s_waitcnt lgkmcnt(3)
    v_smfmac_f32_16x16x64_bf16 v[88:91], v[72:75], a[32:39], v30
    ds_read_b128 v[68:71], v4 offset:6144
    v_smfmac_f32_16x16x64_bf16 v[92:95], v[72:75], a[112:119], v30
    ds_read_b128 v[32:35], v10 offset:24576
    buffer_load_dwordx4 v1, s[4:7], s27 offen offset:2048 sc1 nt lds
    v_smfmac_f32_16x16x64_bf16 v[96:99], v[72:75], a[192:199], v30
    ds_read_b128 v[36:39], v10 offset:25600
    v_smfmac_f32_16x16x64_bf16 v[100:103], v[72:75], v[80:87], v30
    buffer_store_dword v9, v19, s[4:7], s89 offen sc1
    s_waitcnt lgkmcnt(3)
    v_smfmac_f32_16x16x64_bf16 v[88:91], v[76:79], a[40:47], v30
    ds_read_b128 v[72:75], v4 offset:7168
    v_smfmac_f32_16x16x64_bf16 v[92:95], v[76:79], a[120:127], v30
    ds_read_b128 v[80:83], v10 offset:36864
    s_sub_u32 s22, s63, 131072
    s_and_b32 s22, s22, 0x7ffff
    s_add_u32 s21, s22, s59
    s_mov_b64 exec, s[56:57]
    buffer_store_dwordx4 a[248:251], v29, s[4:7], s21 offen sc1
    s_mov_b64 exec, -1
    v_smfmac_f32_16x16x64_bf16 v[96:99], v[76:79], a[200:207], v30
    ds_read_b128 v[84:87], v10 offset:37888
    v_smfmac_f32_16x16x64_bf16 v[100:103], v[76:79], v[104:111], v30
    s_waitcnt lgkmcnt(3)
    v_smfmac_f32_16x16x64_bf16 v[88:91], v[68:71], a[48:55], v30
    ds_read_b128 v[76:79], v4 offset:8192
    v_smfmac_f32_16x16x64_bf16 v[92:95], v[68:71], a[128:135], v30
    ds_read_b128 v[104:107], v10 offset:49152
    v_smfmac_f32_16x16x64_bf16 v[96:99], v[68:71], a[208:215], v30
    ds_read_b128 v[108:111], v10 offset:50176
    v_smfmac_f32_16x16x64_bf16 v[100:103], v[68:71], v[32:39], v30
    s_waitcnt lgkmcnt(3)
    v_smfmac_f32_16x16x64_bf16 v[88:91], v[72:75], a[56:63], v30
    ds_read_b128 v[68:71], v4 offset:9216
    v_smfmac_f32_16x16x64_bf16 v[92:95], v[72:75], a[136:143], v30
    ds_read_b128 v[32:35], v10 offset:61440
    v_smfmac_f32_16x16x64_bf16 v[96:99], v[72:75], a[216:223], v30
    ds_read_b128 v[36:39], v10 offset:62464
    v_smfmac_f32_16x16x64_bf16 v[100:103], v[72:75], v[80:87], v30
    s_waitcnt lgkmcnt(3)
    v_smfmac_f32_16x16x64_bf16 v[88:91], v[76:79], a[64:71], v30
    v_smfmac_f32_16x16x64_bf16 v[92:95], v[76:79], a[144:151], v30
    v_smfmac_f32_16x16x64_bf16 v[96:99], v[76:79], a[224:231], v30
    v_smfmac_f32_16x16x64_bf16 v[100:103], v[76:79], v[104:111], v30
    s_waitcnt lgkmcnt(0)
    v_smfmac_f32_16x16x64_bf16 v[88:91], v[68:71], a[72:79], v30
    v_smfmac_f32_16x16x64_bf16 v[92:95], v[68:71], a[152:159], v30
    v_smfmac_f32_16x16x64_bf16 v[96:99], v[68:71], a[232:239], v30
    v_smfmac_f32_16x16x64_bf16 v[100:103], v[68:71], v[32:39], v30
    s_nop 5
    v_add_f32 v88, v88, v89
    v_add_f32 v90, v90, v91
    v_add_f32 v92, v92, v93
    v_add_f32 v94, v94, v95
    v_add_f32 v96, v96, v97
    v_add_f32 v98, v98, v99
    v_cvt_pk_bf16_f32 v89, v88, v90
    v_cvt_pk_bf16_f32 v93, v92, v94
    v_cvt_pk_bf16_f32 v97, v96, v98
    v_mov_b32_dpp v91, v89 quad_perm:[1,0,3,2] row_mask:0xf bank_mask:0xf
    v_mov_b32_dpp v95, v93 quad_perm:[1,0,3,2] row_mask:0xf bank_mask:0xf
    v_mov_b32_dpp v99, v97 quad_perm:[1,0,3,2] row_mask:0xf bank_mask:0xf
    v_perm_b32 v91, v91, v89, v31
    ds_write_b32 v5, v91
    v_perm_b32 v95, v95, v93, v31
    ds_write_b32 v6, v95
    v_perm_b32 v99, v99, v97, v31
    ds_write_b32 v7, v99
    v_add_f32 v100, v100, v101
    v_add_f32 v102, v102, v103
    v_cvt_pk_bf16_f32 v100, v100, v102
    s_waitcnt lgkmcnt(0)
    s_barrier
    ds_read_b128 v[84:87], v4 offset:10240
    ds_read_b64 v[96:97], v16
    ds_read_b128 v[32:35], v17
    ds_read_b128 v[36:39], v17 offset:3072
    ds_read_b128 v[40:43], v18
    buffer_store_dword v100, v19, s[4:7], s44 offen sc1
    v_mov_b32 v9, v100
    v_mov_b32 v88, 0
    v_mov_b32 v89, 0
    v_mov_b32 v90, 0
    v_mov_b32 v91, 0
    v_mov_b32 v92, 0
    v_mov_b32 v93, 0
    v_mov_b32 v94, 0
    v_mov_b32 v95, 0
    s_waitcnt lgkmcnt(0)
    v_smfmac_f32_16x16x64_bf16 v[88:91], v[84:87], v[32:39], v30
    v_smfmac_f32_16x16x32_bf16 v[92:95], v[96:97], v[40:43], v30
    s_nop 6
    v_add_f32 v88, v88, v89
    v_add_f32 v90, v90, v91
    v_add_f32 v92, v92, v93
    v_add_f32 v94, v94, v95
    v_add_f32 v88, v88, v92
    v_add_f32 v90, v90, v94
    buffer_store_dword v88, v13, s[4:7], s18 offen sc1
    buffer_store_dword v90, v13, s[4:7], s18 offen offset:32 sc1
    ds_write_b32 v12, v88
    ds_write_b32 v12, v90 offset:32
    v_mov_b32 v88, 0
    v_mov_b32 v89, 0
    v_mov_b32 v90, 0
    v_mov_b32 v91, 0
    v_mov_b32 v92, 0
    v_mov_b32 v93, 0
    v_mov_b32 v94, 0
    v_mov_b32 v95, 0
    v_mov_b32 v96, 0
    v_mov_b32 v97, 0
    v_mov_b32 v98, 0
    v_mov_b32 v99, 0
    v_mov_b32 v100, 0
    v_mov_b32 v101, 0
    v_mov_b32 v102, 0
    v_mov_b32 v103, 0
    s_sleep 3
    buffer_load_dwordx4 v[68:71], v15, s[4:7], s18 offen sc1
    buffer_load_dwordx4 v[72:75], v15, s[4:7], s18 offen offset:1024 sc1
    s_waitcnt lgkmcnt(0)
    s_waitcnt vmcnt(5)
    s_barrier
    s_cmp_eq_u32 s17, 63
    s_cbranch_scc1 L_last_0G
    ds_read_b128 v[76:79], v4 offset:13440
    ds_read_b128 v[80:83], v4 offset:14464
    ds_read_b128 v[44:47], v11 offset:0
    ds_read_b128 v[52:55], v11 offset:1024
    ds_read_b128 v[60:63], v11 offset:2048
    s_mov_b32 s24, 0
    s_waitcnt vmcnt(0)
    s_branch Lp_369_chk
Lp_369:
    buffer_load_dwordx4 v[68:71], v15, s[4:7], s18 offen sc1
    buffer_load_dwordx4 v[72:75], v15, s[4:7], s18 offen offset:1024 sc1
    s_waitcnt vmcnt(0)
Lp_369_chk:
    v_max3_u32 v84, v68, v69, v70
    v_max3_u32 v85, v71, v72, v73
    v_max3_u32 v84, v84, v74, v75
    v_max_u32 v84, v84, v85
    v_cmp_eq_u32 vcc, -1, v84
    s_cbranch_vccz Lp_370
    s_add_u32 s24, s24, 1
    s_cmp_lt_u32 s24, 400000
    s_cbranch_scc1 Lp_369
    s_branch L_abort
Lp_370:
    s_mov_b64 exec, s[36:37]
    buffer_load_dwordx2 v[48:49], v20, s[4:7], s44 offen sc1
    buffer_load_dwordx2 v[56:57], v20, s[4:7], s44 offen offset:256 sc1
    buffer_load_dwordx2 v[64:65], v20, s[4:7], s44 offen offset:512 sc1
    s_mov_b64 exec, -1
    s_waitcnt lgkmcnt(3)
    v_pk_add_f32 v[76:77], v[76:77], v[68:69]
    v_pk_add_f32 v[78:79], v[78:79], v[70:71]
    v_pk_add_f32 v[80:81], v[80:81], v[72:73]
    v_pk_add_f32 v[82:83], v[82:83], v[74:75]
    v_max3_f32 v84, v76, v77, v78
    v_max3_f32 v85, v79, v80, v81
    v_max3_f32 v84, v84, v82, v83
    v_max_f32 v84, v84, v85
    s_nop 1
    v_max_f32_dpp v84, v84, v84 quad_perm:[1,0,3,2] row_mask:0xf bank_mask:0xf
    v_mov_b32 v85, v84
    s_nop 1
    v_permlane16_swap_b32 v84, v85
    v_max_f32 v84, v84, v85
    v_mov_b32 v85, v84
    s_nop 1
    v_permlane32_swap_b32 v84, v85
    v_max_f32 v84, v84, v85
    s_mov_b32 s42, 0x3dd53b95
    v_mul_f32 v84, s42, v84
    v_fma_f32 v76, v76, s42, -v84
    v_fma_f32 v77, v77, s42, -v84
    v_fma_f32 v78, v78, s42, -v84
    v_fma_f32 v79, v79, s42, -v84
    v_fma_f32 v80, v80, s42, -v84
    v_fma_f32 v81, v81, s42, -v84
    v_fma_f32 v82, v82, s42, -v84
    v_fma_f32 v83, v83, s42, -v84
    v_exp_f32 v76, v76
    v_exp_f32 v77, v77
    v_exp_f32 v78, v78
    v_exp_f32 v79, v79
    v_exp_f32 v80, v80
    v_exp_f32 v81, v81
    v_exp_f32 v82, v82
    v_exp_f32 v83, v83
    v_cvt_pk_bf16_f32 v68, v76, v77
    v_cvt_pk_bf16_f32 v69, v78, v79
    v_cvt_pk_bf16_f32 v70, v80, v81
    v_cvt_pk_bf16_f32 v71, v82, v83
    s_mov_b32 s24, 0
    s_waitcnt vmcnt(0)
    s_branch Lp_371_chk
Lp_371:
    s_mov_b64 exec, s[36:37]
    buffer_load_dwordx2 v[48:49], v20, s[4:7], s44 offen sc1
    buffer_load_dwordx2 v[56:57], v20, s[4:7], s44 offen offset:256 sc1
    buffer_load_dwordx2 v[64:65], v20, s[4:7], s44 offen offset:512 sc1
    s_mov_b64 exec, -1
    s_waitcnt vmcnt(0)
Lp_371_chk:
    v_max3_u32 v84, v48, v49, v56
    v_max3_u32 v85, v57, v64, v65
    v_max_u32 v84, v84, v85
    v_cmp_eq_u32 vcc, -1, v84
    s_cbranch_vccz Lp_372
    s_add_u32 s24, s24, 1
    s_cmp_lt_u32 s24, 400000
    s_cbranch_scc1 Lp_371
    s_branch L_abort
Lp_372:
    s_waitcnt lgkmcnt(0)
    v_smfmac_f32_16x16x64_bf16 v[88:91], v[68:71], v[44:51], v30
    v_smfmac_f32_16x16x64_bf16 v[92:95], v[68:71], v[52:59], v30
    v_smfmac_f32_16x16x64_bf16 v[96:99], v[68:71], v[60:67], v30
    v_smfmac_f32_16x16x64_bf16 v[100:103], v[68:71], a[240:247], v30
    v_mov_b32 v104, 0
    v_mov_b32 v105, 0
    v_mov_b32 v106, 0
    v_mov_b32 v107, 0
    v_mov_b32 v108, 0
    v_mov_b32 v109, 0
    v_mov_b32 v110, 0
    v_mov_b32 v111, 0
    v_add_f32 v88, v88, v89
    v_add_f32 v90, v90, v91
    v_add_f32 v92, v92, v93
    v_add_f32 v94, v94, v95
    v_add_f32 v96, v96, v97
    v_add_f32 v98, v98, v99
    v_add_f32 v100, v100, v101
    v_add_f32 v102, v102, v103
    v_rcp_f32 v100, v100
    v_rcp_f32 v102, v102
    s_nop 0
    v_mul_f32 v88, v88, v100
    v_mul_f32 v90, v90, v102
    v_mul_f32 v92, v92, v100
    v_mul_f32 v94, v94, v102
    v_mul_f32 v96, v96, v100
    v_mul_f32 v98, v98, v102
    v_cvt_pk_bf16_f32 v89, v88, v90
    v_cvt_pk_bf16_f32 v93, v92, v94
    v_cvt_pk_bf16_f32 v97, v96, v98
    v_mov_b32_dpp v91, v89 quad_perm:[1,0,3,2] row_mask:0xf bank_mask:0xf
    v_mov_b32_dpp v95, v93 quad_perm:[1,0,3,2] row_mask:0xf bank_mask:0xf
    v_mov_b32_dpp v99, v97 quad_perm:[1,0,3,2] row_mask:0xf bank_mask:0xf
    v_perm_b32 v91, v91, v89, v31
    ds_write_b32 v21, v91
    v_perm_b32 v95, v95, v93, v31
    ds_write_b32 v22, v95
    v_perm_b32 v99, v99, v97, v31
    ds_write_b32 v23, v99
    v_mov_b32 v72, 0
    v_mov_b32 v73, 0
    v_mov_b32 v74, 0
    v_mov_b32 v75, 0
    v_mov_b32 v76, 0
    v_mov_b32 v77, 0
    v_mov_b32 v78, 0
    v_mov_b32 v79, 0
    v_mov_b32 v80, 0
    v_mov_b32 v81, 0
    v_mov_b32 v82, 0
    v_mov_b32 v83, 0
    v_mov_b32 v84, 0
    v_mov_b32 v85, 0
    v_mov_b32 v86, 0
    v_mov_b32 v87, 0
    s_waitcnt lgkmcnt(0)
    s_barrier
    ds_read_b128 v[32:35], v4 offset:10240
    ds_read_b128 v[36:39], v4 offset:11264
    ds_read_b128 v[40:43], v4 offset:12288
    s_waitcnt lgkmcnt(2)
    v_smfmac_f32_16x16x64_bf16 v[104:107], v[32:35], v[112:119], v30
    v_smfmac_f32_16x16x64_bf16 v[108:111], v[32:35], v[136:143], v30
    s_waitcnt lgkmcnt(1)
    v_smfmac_f32_16x16x64_bf16 v[104:107], v[36:39], v[120:127], v30
    v_smfmac_f32_16x16x64_bf16 v[108:111], v[36:39], v[144:151], v30
    s_waitcnt lgkmcnt(0)
    v_smfmac_f32_16x16x64_bf16 v[104:107], v[40:43], v[128:135], v30
    v_smfmac_f32_16x16x64_bf16 v[108:111], v[40:43], v[152:159], v30
    v_smfmac_f32_16x16x64_bf16 v[72:75], v[32:35], v[160:167], v30
    s_nop 1
    v_smfmac_f32_16x16x64_bf16 v[76:79], v[32:35], v[184:191], v30
    s_nop 1
    v_smfmac_f32_16x16x64_bf16 v[72:75], v[36:39], v[168:175], v30
    s_nop 1
    v_smfmac_f32_16x16x64_bf16 v[76:79], v[36:39], v[192:199], v30
    v_add_f32 v104, v104, v105
    v_add_f32 v105, v108, v109
    v_smfmac_f32_16x16x64_bf16 v[72:75], v[40:43], v[176:183], v30
    v_add_f32 v108, v106, v107
    v_add_f32 v107, v110, v111
    v_smfmac_f32_16x16x64_bf16 v[76:79], v[40:43], v[200:207], v30
    v_cvt_pk_bf16_f32 v104, v104, v105
    v_cvt_pk_bf16_f32 v105, v108, v107
    buffer_store_dwordx2 v[104:105], v24, s[4:7], s18 offen sc1
    v_smfmac_f32_16x16x64_bf16 v[80:83], v[32:35], v[208:215], v30
    s_nop 1
    v_smfmac_f32_16x16x64_bf16 v[84:87], v[32:35], v[232:239], v30
    s_nop 1
    v_smfmac_f32_16x16x64_bf16 v[80:83], v[36:39], v[216:223], v30
    s_nop 1
    v_smfmac_f32_16x16x64_bf16 v[84:87], v[36:39], v[240:247], v30
    v_add_f32 v72, v72, v73
    v_add_f32 v73, v76, v77
    v_smfmac_f32_16x16x64_bf16 v[80:83], v[40:43], v[224:231], v30
    v_add_f32 v76, v74, v75
    v_add_f32 v75, v78, v79
    v_smfmac_f32_16x16x64_bf16 v[84:87], v[40:43], v[248:255], v30
    v_cvt_pk_bf16_f32 v72, v72, v73
    v_cvt_pk_bf16_f32 v73, v76, v75
    buffer_store_dwordx2 v[72:73], v25, s[4:7], s18 offen sc1
    s_nop 7
    v_add_f32 v80, v80, v81
    v_add_f32 v81, v84, v85
    v_add_f32 v84, v82, v83
    v_add_f32 v83, v86, v87
    v_cvt_pk_bf16_f32 v80, v80, v81
    v_cvt_pk_bf16_f32 v81, v84, v83
    buffer_store_dwordx2 v[80:81], v26, s[4:7], s18 offen sc1
    s_sleep 4
    s_mov_b32 s24, 0
Lp_376:
    buffer_load_dwordx2 v[68:69], v27, s[4:7], s18 offen sc1
    buffer_load_dwordx2 v[70:71], v27, s[4:7], s18 offen offset:512 sc1
    buffer_load_dwordx2 v[72:73], v27, s[4:7], s18 offen offset:1024 sc1
    buffer_load_dwordx2 v[74:75], v27, s[4:7], s18 offen offset:1536 sc1
    s_waitcnt vmcnt(2)
    v_mfma_f32_16x16x32_bf16 v[76:79], a[252:255], v[68:71], 0
    s_waitcnt vmcnt(0)
    v_mfma_f32_16x16x32_bf16 v[76:79], a[252:255], v[72:75], v[76:79]
    s_add_u32 s20, s62, s59
    s_add_u32 s43, s62, s60
    s_add_u32 s45, s19, s58
    s_mov_b64 exec, s[56:57]
    s_nop 4
    v_add_f32 v80, v76, v77
    v_add_f32 v81, v78, v79
    v_add_f32 v80, v80, v81
    v_cmp_u_f32 vcc, v80, v80
    s_mov_b64 exec, -1
    s_cbranch_vccz Lp_377
    s_add_u32 s24, s24, 1
    s_cmp_lt_u32 s24, 400000
    s_cbranch_scc1 Lp_376
    s_branch L_abort
Lp_377:
    s_mov_b64 exec, s[56:57]
    buffer_store_dwordx4 v[76:79], v29, s[4:7], s20 offen sc1
    s_mov_b64 exec, -1
Lk_373:
    buffer_store_dword a248, v13, s[4:7], s26 offen sc1
    buffer_store_dword a248, v13, s[4:7], s26 offen offset:32 sc1
    s_lshl_b32 s20, s12, 12
    s_add_u32 s20, s20, 131072
    s_add_u32 s20, s20, s26
    buffer_store_dword a248, v19, s[4:7], s20 offen sc1
    buffer_store_dwordx2 a[248:249], v24, s[4:7], s26 offen sc1
    buffer_store_dwordx2 a[248:249], v25, s[4:7], s26 offen sc1
    buffer_store_dwordx2 a[248:249], v26, s[4:7], s26 offen sc1
    s_add_u32 s20, s26, s58
    s_mov_b64 exec, s[100:101]
    buffer_store_dword a248, v28, s[4:7], s20 offen sc1
    s_mov_b64 exec, -1
    s_sleep 5
    s_mov_b64 exec, s[56:57]
    buffer_load_dwordx4 v[68:71], v29, s[4:7], s43 offen sc1
    s_mov_b64 exec, -1
    s_barrier
Lk_374:
    s_mov_b32 s89, s30
    s_mov_b32 s92, s29
    s_add_u32 s17, s17, 1
    s_mov_b32 s26, s18
    s_mov_b32 s18, s19
    s_add_u32 s19, s19, 2097152
    s_and_b32 s19, s19, 0x77fffff
    s_or_b32 s19, s19, 0x7000000
    s_mov_b32 s63, s62
    s_add_u32 s62, s62, 131072
    s_and_b32 s62, s62, 0x7ffff
    s_add_u32 s44, s18, s98
    s_add_u32 s95, s18, s58
    s_add_u32 s30, s30, 98304
    s_add_u32 s28, s28, 393216
    s_add_u32 s27, s27, 393216
    s_sub_u32 s47, s47, s53
    v_add_u32 v17, s53, v17
    v_add_u32 v18, s53, v18
    s_sub_u32 s53, 0, s53
    v_mov_b32 v88, 0
    v_mov_b32 v89, 0
    v_mov_b32 v90, 0
    v_mov_b32 v91, 0
    v_mov_b32 v92, 0
    v_mov_b32 v93, 0
    v_mov_b32 v94, 0
    v_mov_b32 v95, 0
    v_mov_b32 v96, 0
    v_mov_b32 v97, 0
    v_mov_b32 v98, 0
    v_mov_b32 v99, 0
    v_mov_b32 v100, 0
    v_mov_b32 v101, 0
    v_mov_b32 v102, 0
    v_mov_b32 v103, 0
    s_mov_b32 s24, 0
    s_waitcnt vmcnt(0)
    s_branch Lp_378_chk
Lp_378:
    s_mov_b64 exec, s[56:57]
    buffer_load_dwordx4 v[68:71], v29, s[4:7], s43 offen sc1
    s_mov_b64 exec, -1
    s_waitcnt vmcnt(0)
Lp_378_chk:
    s_mov_b64 exec, s[56:57]
    v_pk_add_f32 v[72:73], v[68:69], v[76:77]
    v_pk_add_f32 v[74:75], v[70:71], v[78:79]
    v_add_f32 v80, v72, v73
    v_add_f32 v81, v74, v75
    v_cvt_pk_bf16_f32 v72, v72, v73
    v_cvt_pk_bf16_f32 v73, v74, v75
    v_add_f32 v80, v80, v81
    v_cmp_u_f32 vcc, v80, v80
    s_mov_b64 exec, -1
    s_cbranch_vccz Lp_379
    s_add_u32 s24, s24, 1
    s_cmp_lt_u32 s24, 400000
    s_cbranch_scc1 Lp_378
    s_branch L_abort
Lp_379:
    v_permlane16_swap_b32 v72, v73
    s_mov_b64 exec, s[100:101]
    buffer_store_dword v72, v28, s[4:7], s45 offen sc1
    s_mov_b64 exec, -1
Lk_375:
    s_barrier
    s_branch L_loop_0G
L_last_0G:
    buffer_store_dword v9, v19, s[4:7], s30 offen sc1
    s_waitcnt vmcnt(0)
    s_barrier
    s_branch L_chain_end
    .p2align 6
T_2G:
    s_and_b32 s20, s17, 3
    s_lshl_b32 s18, s20, 21
    s_add_u32 s18, s18, 117440512
    s_lshl_b32 s62, s20, 17
    s_add_u32 s20, s17, 1
    s_and_b32 s20, s20, 3
    s_lshl_b32 s19, s20, 21
    s_add_u32 s19, s19, 117440512
    s_add_u32 s20, s17, 3
    s_and_b32 s20, s20, 3
    s_lshl_b32 s26, s20, 21
    s_add_u32 s26, s26, 117440512
    s_lshl_b32 s63, s20, 17
    s_lshl_b32 s44, s12, 12
    s_add_u32 s44, s44, 131072
    s_add_u32 s44, s44, s18
    s_lshl_b32 s20, s17, 5
    s_add_u32 s20, s20, s12
    s_mul_i32 s21, s20, 3072
    s_add_u32 s30, s21, 106954752
    s_mul_i32 s20, s20, 12288
    s_mul_i32 s21, s16, 6144
    s_add_u32 s28, s20, s21
    s_add_u32 s28, s28, 25165824
    s_mul_i32 s21, s13, 6144
    s_add_u32 s27, s20, s21
    s_mul_i32 s21, s16, 3072
    s_add_u32 s27, s27, s21
    s_add_u32 s27, s27, 393216
    s_add_u32 s20, s17, 1
    s_and_b32 s20, s20, 1
    s_mul_i32 s47, s20, 6144
    s_add_u32 s47, s47, s21
    s_add_u32 s47, s47, 138752
    s_sub_u32 s53, 0, s53
    s_add_u32 s95, s18, s58
    s_mov_b32 s89, 0xf0000000
    s_mov_b32 s92, 0xf0000000
    s_lshl_b32 s98, s12, 12
    s_add_u32 s98, s98, 131072
    s_mul_i32 s46, s16, 6144
    s_add_u32 s46, s46, 151040
    v_mov_b32 v88, 0
    v_mov_b32 v89, 0
    v_mov_b32 v90, 0
    v_mov_b32 v91, 0
    v_mov_b32 v92, 0
    v_mov_b32 v93, 0
    v_mov_b32 v94, 0
    v_mov_b32 v95, 0
    v_mov_b32 v96, 0
    v_mov_b32 v97, 0
    v_mov_b32 v98, 0
    v_mov_b32 v99, 0
    v_mov_b32 v100, 0
    v_mov_b32 v101, 0
    v_mov_b32 v102, 0
    v_mov_b32 v103, 0
    v_mov_b32 v104, 0
    v_mov_b32 v105, 0
    v_mov_b32 v106, 0
    v_mov_b32 v107, 0
L_loop_2G:
    v_mov_b32 v76, 0
    v_mov_b32 v77, 0
    v_mov_b32 v78, 0
    v_mov_b32 v79, 0
    s_mov_b32 s24, 0
Lg_380:
    buffer_load_dwordx4 v[68:71], v3, s[4:7], s95 offen sc1
    buffer_load_dwordx4 v[72:75], v3, s[4:7], s95 offen offset:1024 sc1
    s_mov_b64 exec, s[34:35]
    buffer_load_dwordx4 v[76:79], v3, s[4:7], s95 offen offset:2048 sc1
    s_mov_b64 exec, -1
    s_waitcnt vmcnt(0)
    v_max3_u32 v84, v68, v69, v70
    v_max3_u32 v85, v71, v72, v73
    v_max3_u32 v84, v84, v74, v75
    v_max3_u32 v85, v85, v76, v77
    v_max3_u32 v84, v84, v78, v79
    v_max_u32 v84, v84, v85
    v_cmp_eq_u32 vcc, -1, v84
    s_cbranch_vccz Lg_381
    s_add_u32 s24, s24, 1
    s_cmp_lt_u32 s24, 400000
    s_cbranch_scc1 Lg_380
    s_branch L_abort
Lg_381:
    ds_write_b128 v2, v[68:71] offset:0
    ds_write_b128 v2, v[72:75] offset:1024
    s_mov_b64 exec, s[34:35]
    ds_write_b128 v2, v[76:79] offset:2048
    s_mov_b64 exec, -1
    s_waitcnt lgkmcnt(0)
    s_barrier
    ds_read_b128 v[68:71], v4 offset:0
    ds_read_b128 v[112:115], v8 offset:0
    ds_read_b128 v[116:119], v8 offset:1024
    ds_read_b128 v[72:75], v4 offset:1024
    ds_read_b128 v[120:123], v8 offset:12288
    ds_read_b128 v[124:127], v8 offset:13312
    s_waitcnt lgkmcnt(3)
    v_smfmac_f32_16x16x64_bf16 v[88:91], v[68:71], a[0:7], v30
    ds_read_b128 v[76:79], v4 offset:2048
    v_smfmac_f32_16x16x64_bf16 v[92:95], v[68:71], a[80:87], v30
    ds_read_b128 v[128:131], v8 offset:24576
    buffer_store_dword v152, v19, s[4:7], s89 offen sc1
    v_smfmac_f32_16x16x64_bf16 v[96:99], v[68:71], a[160:167], v30
    ds_read_b128 v[132:135], v8 offset:25600
    v_smfmac_f32_16x16x64_bf16 v[100:103], v[68:71], v[112:119], v30
    buffer_store_dword v153, v19, s[4:7], s89 offen offset:256 sc1
    s_waitcnt lgkmcnt(3)
    v_smfmac_f32_16x16x64_bf16 v[88:91], v[72:75], a[8:15], v30
    ds_read_b128 v[68:71], v4 offset:3072
    v_smfmac_f32_16x16x64_bf16 v[92:95], v[72:75], a[88:95], v30
    ds_read_b128 v[112:115], v8 offset:36864
    s_sub_u32 s22, s63, 131072
    s_and_b32 s22, s22, 0x7ffff
    s_cmp_eq_u32 s88, 0
    s_cbranch_scc1 Lr_383
    s_add_u32 s21, s22, s59
    s_mov_b64 exec, s[56:57]
    buffer_store_dwordx4 a[248:251], v29, s[4:7], s21 offen sc1
    s_mov_b64 exec, -1
Lr_383:
    v_smfmac_f32_16x16x64_bf16 v[96:99], v[72:75], a[168:175], v30
    ds_read_b128 v[116:119], v8 offset:37888
    v_smfmac_f32_16x16x64_bf16 v[100:103], v[72:75], v[120:127], v30
    s_waitcnt lgkmcnt(3)
    v_smfmac_f32_16x16x64_bf16 v[88:91], v[76:79], a[16:23], v30
    ds_read_b128 v[72:75], v4 offset:4096
    v_smfmac_f32_16x16x64_bf16 v[92:95], v[76:79], a[96:103], v30
    ds_read_b128 v[120:123], v10 offset:0
    v_smfmac_f32_16x16x64_bf16 v[96:99], v[76:79], a[176:183], v30
    ds_read_b128 v[124:127], v10 offset:1024
    v_smfmac_f32_16x16x64_bf16 v[100:103], v[76:79], v[128:135], v30
    s_waitcnt lgkmcnt(3)
    v_smfmac_f32_16x16x64_bf16 v[88:91], v[68:71], a[24:31], v30
    ds_read_b128 v[76:79], v4 offset:5120
    v_smfmac_f32_16x16x64_bf16 v[92:95], v[68:71], a[104:111], v30
    ds_read_b128 v[128:131], v10 offset:12288
    v_smfmac_f32_16x16x64_bf16 v[96:99], v[68:71], a[184:191], v30
    ds_read_b128 v[132:135], v10 offset:13312
    v_smfmac_f32_16x16x64_bf16 v[100:103], v[68:71], v[112:119], v30
    s_waitcnt lgkmcnt(3)
    v_smfmac_f32_16x16x64_bf16 v[88:91], v[72:75], a[32:39], v30
    ds_read_b128 v[68:71], v4 offset:6144
    v_smfmac_f32_16x16x64_bf16 v[92:95], v[72:75], a[112:119], v30
    ds_read_b128 v[112:115], v10 offset:24576
    v_smfmac_f32_16x16x64_bf16 v[96:99], v[72:75], a[192:199], v30
    ds_read_b128 v[116:119], v10 offset:25600
    v_smfmac_f32_16x16x64_bf16 v[100:103], v[72:75], v[120:127], v30
    s_waitcnt lgkmcnt(3)
    v_smfmac_f32_16x16x64_bf16 v[88:91], v[76:79], a[40:47], v30
    ds_read_b128 v[72:75], v4 offset:7168
    v_smfmac_f32_16x16x64_bf16 v[92:95], v[76:79], a[120:127], v30
    ds_read_b128 v[120:123], v10 offset:36864
    v_smfmac_f32_16x16x64_bf16 v[96:99], v[76:79], a[200:207], v30
    ds_read_b128 v[124:127], v10 offset:37888
    v_smfmac_f32_16x16x64_bf16 v[100:103], v[76:79], v[128:135], v30
    s_waitcnt lgkmcnt(3)
    v_smfmac_f32_16x16x64_bf16 v[88:91], v[68:71], a[48:55], v30
    ds_read_b128 v[76:79], v4 offset:8192
    v_smfmac_f32_16x16x64_bf16 v[92:95], v[68:71], a[128:135], v30
    ds_read_b128 v[128:131], v10 offset:49152
    v_smfmac_f32_16x16x64_bf16 v[96:99], v[68:71], a[208:215], v30
    ds_read_b128 v[132:135], v10 offset:50176
    v_smfmac_f32_16x16x64_bf16 v[100:103], v[68:71], v[112:119], v30
    s_waitcnt lgkmcnt(3)
    v_smfmac_f32_16x16x64_bf16 v[88:91], v[72:75], a[56:63], v30
    ds_read_b128 v[68:71], v4 offset:9216
    v_smfmac_f32_16x16x64_bf16 v[92:95], v[72:75], a[136:143], v30
    ds_read_b128 v[112:115], v10 offset:61440
    v_smfmac_f32_16x16x64_bf16 v[96:99], v[72:75], a[216:223], v30
    ds_read_b128 v[116:119], v10 offset:62464
    v_smfmac_f32_16x16x64_bf16 v[100:103], v[72:75], v[120:127], v30
    s_waitcnt lgkmcnt(3)
    v_smfmac_f32_16x16x64_bf16 v[88:91], v[76:79], a[64:71], v30
    v_smfmac_f32_16x16x64_bf16 v[92:95], v[76:79], a[144:151], v30
    v_smfmac_f32_16x16x64_bf16 v[96:99], v[76:79], a[224:231], v30
    v_smfmac_f32_16x16x64_bf16 v[100:103], v[76:79], v[128:135], v30
    s_waitcnt lgkmcnt(0)
    v_smfmac_f32_16x16x64_bf16 v[88:91], v[68:71], a[72:79], v30
    v_smfmac_f32_16x16x64_bf16 v[92:95], v[68:71], a[152:159], v30
    v_smfmac_f32_16x16x64_bf16 v[96:99], v[68:71], a[232:239], v30
    v_smfmac_f32_16x16x64_bf16 v[100:103], v[68:71], v[112:119], v30
    s_nop 5
    v_add_f32 v88, v88, v89
    v_add_f32 v90, v90, v91
    v_add_f32 v92, v92, v93
    v_add_f32 v94, v94, v95
    v_add_f32 v96, v96, v97
    v_add_f32 v98, v98, v99
    v_cvt_pk_bf16_f32 v89, v88, v90
    v_cvt_pk_bf16_f32 v93, v92, v94
    v_cvt_pk_bf16_f32 v97, v96, v98
    v_mov_b32_dpp v91, v89 quad_perm:[1,0,3,2] row_mask:0xf bank_mask:0xf
    v_mov_b32_dpp v95, v93 quad_perm:[1,0,3,2] row_mask:0xf bank_mask:0xf
    v_mov_b32_dpp v99, v97 quad_perm:[1,0,3,2] row_mask:0xf bank_mask:0xf
    v_perm_b32 v91, v91, v89, v31
    ds_write_b32 v5, v91
    v_perm_b32 v95, v95, v93, v31
    ds_write_b32 v6, v95
    v_perm_b32 v99, v99, v97, v31
    ds_write_b32 v7, v99
    v_add_f32 v100, v100, v101
    v_add_f32 v102, v102, v103
    v_cvt_pk_bf16_f32 v100, v100, v102
    s_waitcnt lgkmcnt(0)
    ds_read_b128 v[136:139], v4 offset:0
    ds_read_b128 v[112:115], v9 offset:0
    ds_read_b128 v[116:119], v9 offset:1024
    ds_read_b128 v[140:143], v4 offset:1024
    ds_read_b128 v[120:123], v9 offset:12288
    ds_read_b128 v[124:127], v9 offset:13312
    ds_read_b128 v[80:83], v4 offset:2048
    ds_read_b128 v[128:131], v9 offset:24576
    ds_read_b128 v[132:135], v9 offset:25600
    ds_read_b128 v[84:87], v4 offset:3072
    ds_read_b128 v[32:35], v9 offset:36864
    ds_read_b128 v[36:39], v9 offset:37888
    s_barrier
    ds_read_b128 v[144:147], v4 offset:10240
    ds_read_b64 v[148:149], v16
    ds_read_b128 v[68:71], v17
    ds_read_b128 v[72:75], v17 offset:96
    ds_read_b128 v[76:79], v18
    buffer_store_dword v100, v19, s[4:7], s44 offen sc1
    v_mov_b32 v152, v100
    v_mov_b32 v88, 0
    v_mov_b32 v89, 0
    v_mov_b32 v90, 0
    v_mov_b32 v91, 0
    v_mov_b32 v92, 0
    v_mov_b32 v93, 0
    v_mov_b32 v94, 0
    v_mov_b32 v95, 0
    s_waitcnt lgkmcnt(0)
    v_smfmac_f32_16x16x64_bf16 v[88:91], v[144:147], v[68:75], v30
    v_smfmac_f32_16x16x32_bf16 v[92:95], v[148:149], v[76:79], v30
    v_smfmac_f32_16x16x64_bf16 v[104:107], v[136:139], v[112:119], v30
    ds_read_b128 v[136:139], v4 offset:4096
    ds_read_b128 v[112:115], v11 offset:0
    ds_read_b128 v[116:119], v11 offset:1024
    v_smfmac_f32_16x16x64_bf16 v[104:107], v[140:143], v[120:127], v30
    ds_read_b128 v[140:143], v4 offset:5120
    ds_read_b128 v[120:123], v11 offset:12288
    ds_read_b128 v[124:127], v11 offset:13312
    s_nop 1
    v_add_f32 v88, v88, v89
    v_add_f32 v90, v90, v91
    v_add_f32 v92, v92, v93
    v_add_f32 v94, v94, v95
    v_add_f32 v88, v88, v92
    v_add_f32 v90, v90, v94
    s_mov_b64 exec, s[38:39]
    buffer_store_dword v88, v13, s[4:7], s18 offen sc1
    buffer_store_dword v90, v13, s[4:7], s18 offen offset:32 sc1
    ds_write_b32 v12, v88
    ds_write_b32 v12, v90 offset:32
    s_mov_b64 exec, -1
    v_smfmac_f32_16x16x64_bf16 v[104:107], v[80:83], v[128:135], v30
    ds_read_b128 v[80:83], v4 offset:6144
    ds_read_b128 v[128:131], v11 offset:24576
    ds_read_b128 v[132:135], v11 offset:25600
    v_smfmac_f32_16x16x64_bf16 v[104:107], v[84:87], v[32:39], v30
    ds_read_b128 v[84:87], v4 offset:7168
    ds_read_b128 v[32:35], v11 offset:36864
    ds_read_b128 v[36:39], v11 offset:37888
    s_waitcnt lgkmcnt(11)
    v_smfmac_f32_16x16x64_bf16 v[104:107], v[136:139], v[112:119], v30
    ds_read_b128 v[136:139], v4 offset:8192
    ds_read_b128 v[112:115], v11 offset:49152
    ds_read_b128 v[116:119], v11 offset:50176
    s_waitcnt lgkmcnt(11)
    v_smfmac_f32_16x16x64_bf16 v[104:107], v[140:143], v[120:127], v30
    ds_read_b128 v[140:143], v4 offset:9216
    ds_read_b128 v[120:123], v11 offset:61440
    ds_read_b128 v[124:127], v11 offset:62464
    s_waitcnt lgkmcnt(9)
    v_smfmac_f32_16x16x64_bf16 v[104:107], v[80:83], v[128:135], v30
    s_waitcnt lgkmcnt(6)
    v_smfmac_f32_16x16x64_bf16 v[104:107], v[84:87], v[32:39], v30
    s_waitcnt lgkmcnt(3)
    v_smfmac_f32_16x16x64_bf16 v[104:107], v[136:139], v[112:119], v30
    s_waitcnt lgkmcnt(0)
    v_smfmac_f32_16x16x64_bf16 v[104:107], v[140:143], v[120:127], v30
    s_nop 7
    v_add_f32 v104, v104, v105
    v_add_f32 v106, v106, v107
    v_cvt_pk_bf16_f32 v104, v104, v106
    buffer_store_dword v104, v19, s[4:7], s44 offen offset:256 sc1
    v_mov_b32 v153, v104
    v_mov_b32 v88, 0
    v_mov_b32 v89, 0
    v_mov_b32 v90, 0
    v_mov_b32 v91, 0
    v_mov_b32 v92, 0
    v_mov_b32 v93, 0
    v_mov_b32 v94, 0
    v_mov_b32 v95, 0
    v_mov_b32 v96, 0
    v_mov_b32 v97, 0
    v_mov_b32 v98, 0
    v_mov_b32 v99, 0
    v_mov_b32 v100, 0
    v_mov_b32 v101, 0
    v_mov_b32 v102, 0
    v_mov_b32 v103, 0
    buffer_load_dwordx4 v[68:71], v15, s[4:7], s18 offen sc1
    buffer_load_dwordx4 v[72:75], v15, s[4:7], s18 offen offset:1024 sc1
    s_waitcnt vmcnt(6)
    s_barrier
    s_cmp_eq_u32 s17, 63
    s_cbranch_scc1 L_last_2G
    ds_read_b128 v[76:79], v4 offset:13440
    ds_read_b128 v[80:83], v4 offset:14464
    ds_read_b128 v[44:47], v150 offset:0
    ds_read_b128 v[52:55], v150 offset:1024
    ds_read_b128 v[60:63], v150 offset:2048
    s_mov_b32 s24, 0
    s_waitcnt vmcnt(0)
    s_branch Lp_384_chk
Lp_384:
    buffer_load_dwordx4 v[68:71], v15, s[4:7], s18 offen sc1
    buffer_load_dwordx4 v[72:75], v15, s[4:7], s18 offen offset:1024 sc1
    s_waitcnt vmcnt(0)
Lp_384_chk:
    v_max3_u32 v84, v68, v69, v70
    v_max3_u32 v85, v71, v72, v73
    v_max3_u32 v84, v84, v74, v75
    v_max_u32 v84, v84, v85
    v_cmp_eq_u32 vcc, -1, v84
    s_cbranch_vccz Lp_385
    s_add_u32 s24, s24, 1
    s_cmp_lt_u32 s24, 400000
    s_cbranch_scc1 Lp_384
    s_branch L_abort
Lp_385:
    s_mov_b64 exec, s[36:37]
    buffer_load_dwordx2 v[48:49], v20, s[4:7], s44 offen sc1
    buffer_load_dwordx2 v[56:57], v20, s[4:7], s44 offen offset:256 sc1
    buffer_load_dwordx2 v[64:65], v20, s[4:7], s44 offen offset:512 sc1
    s_mov_b64 exec, -1
    s_waitcnt lgkmcnt(3)
    v_pk_add_f32 v[76:77], v[76:77], v[68:69]
    v_pk_add_f32 v[78:79], v[78:79], v[70:71]
    v_pk_add_f32 v[80:81], v[80:81], v[72:73]
    v_pk_add_f32 v[82:83], v[82:83], v[74:75]
    v_max3_f32 v84, v76, v77, v78
    v_max3_f32 v85, v79, v80, v81
    v_max3_f32 v84, v84, v82, v83
    v_max_f32 v84, v84, v85
    s_nop 1
    v_max_f32_dpp v84, v84, v84 quad_perm:[1,0,3,2] row_mask:0xf bank_mask:0xf
    v_mov_b32 v85, v84
    s_nop 1
    v_permlane16_swap_b32 v84, v85
    v_max_f32 v84, v84, v85
    v_mov_b32 v85, v84
    s_nop 1
    v_permlane32_swap_b32 v84, v85
    v_max_f32 v84, v84, v85
    s_mov_b32 s42, 0x3dd53b95
    v_mul_f32 v84, s42, v84
    v_fma_f32 v76, v76, s42, -v84
    v_fma_f32 v77, v77, s42, -v84
    v_fma_f32 v78, v78, s42, -v84
    v_fma_f32 v79, v79, s42, -v84
    v_fma_f32 v80, v80, s42, -v84
    v_fma_f32 v81, v81, s42, -v84
    v_fma_f32 v82, v82, s42, -v84
    v_fma_f32 v83, v83, s42, -v84
    v_exp_f32 v76, v76
    v_exp_f32 v77, v77
    v_exp_f32 v78, v78
    v_exp_f32 v79, v79
    v_exp_f32 v80, v80
    v_exp_f32 v81, v81
    v_exp_f32 v82, v82
    v_exp_f32 v83, v83
    v_cvt_pk_bf16_f32 v68, v76, v77
    v_cvt_pk_bf16_f32 v69, v78, v79
    v_cvt_pk_bf16_f32 v70, v80, v81
    v_cvt_pk_bf16_f32 v71, v82, v83
    s_mov_b32 s24, 0
    s_waitcnt vmcnt(0)
    s_branch Lp_386_chk
Lp_386:
    s_mov_b64 exec, s[36:37]
    buffer_load_dwordx2 v[48:49], v20, s[4:7], s44 offen sc1
    buffer_load_dwordx2 v[56:57], v20, s[4:7], s44 offen offset:256 sc1
    buffer_load_dwordx2 v[64:65], v20, s[4:7], s44 offen offset:512 sc1
    s_mov_b64 exec, -1
    s_waitcnt vmcnt(0)
Lp_386_chk:
    v_max3_u32 v84, v48, v49, v56
    v_max3_u32 v85, v57, v64, v65
    v_max_u32 v84, v84, v85
    v_cmp_eq_u32 vcc, -1, v84
    s_cbranch_vccz Lp_387
    s_add_u32 s24, s24, 1
    s_cmp_lt_u32 s24, 400000
    s_cbranch_scc1 Lp_386
    s_branch L_abort
Lp_387:
    s_waitcnt lgkmcnt(0)
    v_smfmac_f32_16x16x64_bf16 v[88:91], v[68:71], v[44:51], v30
    v_smfmac_f32_16x16x64_bf16 v[92:95], v[68:71], v[52:59], v30
    v_smfmac_f32_16x16x64_bf16 v[96:99], v[68:71], v[60:67], v30
    v_smfmac_f32_16x16x64_bf16 v[100:103], v[68:71], a[240:247], v30
    v_mov_b32 v72, 0
    v_mov_b32 v73, 0
    v_mov_b32 v74, 0
    v_mov_b32 v75, 0
    v_mov_b32 v76, 0
    v_mov_b32 v77, 0
    v_mov_b32 v78, 0
    v_mov_b32 v79, 0
    v_add_f32 v88, v88, v89
    v_add_f32 v90, v90, v91
    v_add_f32 v92, v92, v93
    v_add_f32 v94, v94, v95
    v_add_f32 v96, v96, v97
    v_add_f32 v98, v98, v99
    v_add_f32 v100, v100, v101
    v_add_f32 v102, v102, v103
    v_rcp_f32 v100, v100
    v_rcp_f32 v102, v102
    s_nop 0
    v_mul_f32 v88, v88, v100
    v_mul_f32 v90, v90, v102
    v_mul_f32 v92, v92, v100
    v_mul_f32 v94, v94, v102
    v_mul_f32 v96, v96, v100
    v_mul_f32 v98, v98, v102
    v_cvt_pk_bf16_f32 v89, v88, v90
    v_cvt_pk_bf16_f32 v93, v92, v94
    v_cvt_pk_bf16_f32 v97, v96, v98
    v_mov_b32_dpp v91, v89 quad_perm:[1,0,3,2] row_mask:0xf bank_mask:0xf
    v_mov_b32_dpp v95, v93 quad_perm:[1,0,3,2] row_mask:0xf bank_mask:0xf
    v_mov_b32_dpp v99, v97 quad_perm:[1,0,3,2] row_mask:0xf bank_mask:0xf
    v_perm_b32 v91, v91, v89, v31
    ds_write_b32 v21, v91
    v_perm_b32 v95, v95, v93, v31
    ds_write_b32 v22, v95
    v_perm_b32 v99, v99, v97, v31
    ds_write_b32 v23, v99
    v_mov_b32 v80, 0
    v_mov_b32 v81, 0
    v_mov_b32 v82, 0
    v_mov_b32 v83, 0
    v_mov_b32 v84, 0
    v_mov_b32 v85, 0
    v_mov_b32 v86, 0
    v_mov_b32 v87, 0
    s_waitcnt lgkmcnt(0)
    s_barrier
    ds_read_b128 v[32:35], v4 offset:10240
    ds_read_b128 v[36:39], v4 offset:11264
    ds_read_b128 v[40:43], v4 offset:12288
    s_waitcnt lgkmcnt(2)
    v_smfmac_f32_16x16x64_bf16 v[72:75], v[32:35], v[160:167], v30
    v_smfmac_f32_16x16x64_bf16 v[76:79], v[32:35], v[184:191], v30
    s_waitcnt lgkmcnt(1)
    v_smfmac_f32_16x16x64_bf16 v[72:75], v[36:39], v[168:175], v30
    v_smfmac_f32_16x16x64_bf16 v[76:79], v[36:39], v[192:199], v30
    s_waitcnt lgkmcnt(0)
    v_smfmac_f32_16x16x64_bf16 v[72:75], v[40:43], v[176:183], v30
    v_smfmac_f32_16x16x64_bf16 v[76:79], v[40:43], v[200:207], v30
    v_smfmac_f32_16x16x64_bf16 v[80:83], v[32:35], v[208:215], v30
    s_nop 1
    v_smfmac_f32_16x16x64_bf16 v[84:87], v[32:35], v[232:239], v30
    s_nop 1
    v_smfmac_f32_16x16x64_bf16 v[80:83], v[36:39], v[216:223], v30
    s_nop 1
    v_smfmac_f32_16x16x64_bf16 v[84:87], v[36:39], v[240:247], v30
    v_add_f32 v72, v72, v73
    v_add_f32 v73, v76, v77
    v_smfmac_f32_16x16x64_bf16 v[80:83], v[40:43], v[224:231], v30
    v_add_f32 v76, v74, v75
    v_add_f32 v75, v78, v79
    v_smfmac_f32_16x16x64_bf16 v[84:87], v[40:43], v[248:255], v30
    v_cvt_pk_bf16_f32 v72, v72, v73
    v_cvt_pk_bf16_f32 v73, v76, v75
    buffer_store_dwordx2 v[72:73], v25, s[4:7], s18 offen sc1
    s_nop 7
    v_add_f32 v80, v80, v81
    v_add_f32 v81, v84, v85
    v_add_f32 v84, v82, v83
    v_add_f32 v83, v86, v87
    v_cvt_pk_bf16_f32 v80, v80, v81
    v_cvt_pk_bf16_f32 v81, v84, v83
    buffer_store_dwordx2 v[80:81], v26, s[4:7], s18 offen sc1
    s_cmp_eq_u32 s88, 0
    s_cbranch_scc1 Lk_390
    s_sleep 6
    s_mov_b32 s24, 0
Lp_393:
    buffer_load_dwordx2 v[68:69], v27, s[4:7], s18 offen sc1
    buffer_load_dwordx2 v[70:71], v27, s[4:7], s18 offen offset:512 sc1
    buffer_load_dwordx2 v[72:73], v27, s[4:7], s18 offen offset:1024 sc1
    buffer_load_dwordx2 v[74:75], v27, s[4:7], s18 offen offset:1536 sc1
    s_waitcnt vmcnt(2)
    v_mfma_f32_16x16x32_bf16 v[76:79], a[252:255], v[68:71], 0
    s_waitcnt vmcnt(0)
    v_mfma_f32_16x16x32_bf16 v[76:79], a[252:255], v[72:75], v[76:79]
    s_add_u32 s20, s62, s59
    s_add_u32 s43, s62, s60
    s_add_u32 s45, s19, s58
    s_mov_b64 exec, s[56:57]
    s_nop 4
    v_add_f32 v80, v76, v77
    v_add_f32 v81, v78, v79
    v_add_f32 v80, v80, v81
    v_cmp_u_f32 vcc, v80, v80
    s_mov_b64 exec, -1
    s_cbranch_vccz Lp_394
    s_add_u32 s24, s24, 1
    s_cmp_lt_u32 s24, 400000
    s_cbranch_scc1 Lp_393
    s_branch L_abort
Lp_394:
    s_mov_b64 exec, s[56:57]
    buffer_store_dwordx4 v[76:79], v29, s[4:7], s20 offen sc1
    s_mov_b64 exec, -1
Lk_390:
    s_cmp_eq_u32 s88, 0
    s_cbranch_scc0 Lk_395
    s_barrier
Lk_395:
    s_mov_b64 exec, s[38:39]
    buffer_store_dword a248, v13, s[4:7], s26 offen sc1
    buffer_store_dword a248, v13, s[4:7], s26 offen offset:32 sc1
    s_mov_b64 exec, -1
    s_lshl_b32 s20, s12, 12
    s_add_u32 s20, s20, 131072
    s_add_u32 s20, s20, s26
    buffer_store_dword a248, v19, s[4:7], s20 offen sc1
    buffer_store_dword a248, v19, s[4:7], s20 offen offset:256 sc1
    buffer_store_dwordx2 a[248:249], v25, s[4:7], s26 offen sc1
    buffer_store_dwordx2 a[248:249], v26, s[4:7], s26 offen sc1
    s_cmp_eq_u32 s88, 0
    s_cbranch_scc1 Lr_388
    s_add_u32 s20, s26, s58
    s_mov_b64 exec, s[100:101]
    buffer_store_dword a248, v28, s[4:7], s20 offen sc1
    s_mov_b64 exec, -1
Lr_388:
    s_cmp_eq_u32 s88, 0
    s_cbranch_scc1 Lk_391
    s_sleep 5
    s_mov_b64 exec, s[56:57]
    buffer_load_dwordx4 v[68:71], v29, s[4:7], s43 offen sc1
    s_mov_b64 exec, -1
    s_barrier
Lk_391:
    s_mov_b32 s89, s30
    s_mov_b32 s92, s29
    s_add_u32 s17, s17, 1
    s_mov_b32 s26, s18
    s_mov_b32 s18, s19
    s_add_u32 s19, s19, 2097152
    s_and_b32 s19, s19, 0x77fffff
    s_or_b32 s19, s19, 0x7000000
    s_mov_b32 s63, s62
    s_add_u32 s62, s62, 131072
    s_and_b32 s62, s62, 0x7ffff
    s_add_u32 s44, s18, s98
    s_add_u32 s95, s18, s58
    s_add_u32 s30, s30, 98304
    s_add_u32 s28, s28, 393216
    s_add_u32 s27, s27, 393216
    v_mov_b32 v88, 0
    v_mov_b32 v89, 0
    v_mov_b32 v90, 0
    v_mov_b32 v91, 0
    v_mov_b32 v92, 0
    v_mov_b32 v93, 0
    v_mov_b32 v94, 0
    v_mov_b32 v95, 0
    v_mov_b32 v96, 0
    v_mov_b32 v97, 0
    v_mov_b32 v98, 0
    v_mov_b32 v99, 0
    v_mov_b32 v100, 0
    v_mov_b32 v101, 0
    v_mov_b32 v102, 0
    v_mov_b32 v103, 0
    v_mov_b32 v104, 0
    v_mov_b32 v105, 0
    v_mov_b32 v106, 0
    v_mov_b32 v107, 0
    s_cmp_eq_u32 s88, 0
    s_cbranch_scc1 Lk_392
    s_mov_b32 s24, 0
    s_waitcnt vmcnt(0)
    s_branch Lp_397_chk
Lp_397:
    s_mov_b64 exec, s[56:57]
    buffer_load_dwordx4 v[68:71], v29, s[4:7], s43 offen sc1
    s_mov_b64 exec, -1
    s_waitcnt vmcnt(0)
Lp_397_chk:
    s_mov_b64 exec, s[56:57]
    v_pk_add_f32 v[72:73], v[68:69], v[76:77]
    v_pk_add_f32 v[74:75], v[70:71], v[78:79]
    v_add_f32 v80, v72, v73
    v_add_f32 v81, v74, v75
    v_cvt_pk_bf16_f32 v72, v72, v73
    v_cvt_pk_bf16_f32 v73, v74, v75
    v_add_f32 v80, v80, v81
    v_cmp_u_f32 vcc, v80, v80
    s_mov_b64 exec, -1
    s_cbranch_vccz Lp_398
    s_add_u32 s24, s24, 1
    s_cmp_lt_u32 s24, 400000
    s_cbranch_scc1 Lp_397
    s_branch L_abort
Lp_398:
    v_permlane16_swap_b32 v72, v73
    s_mov_b64 exec, s[100:101]
    buffer_store_dword v72, v28, s[4:7], s45 offen sc1
    s_mov_b64 exec, -1
Lk_392:
    s_barrier
    s_branch L_loop_2G
L_last_2G:
    buffer_store_dword v152, v19, s[4:7], s30 offen sc1
    buffer_store_dword v153, v19, s[4:7], s30 offen offset:256 sc1
    s_waitcnt vmcnt(0)
    s_barrier
    s_branch L_chain_end
    .p2align 6
T_3G:
    s_and_b32 s20, s17, 3
    s_lshl_b32 s18, s20, 21
    s_add_u32 s18, s18, 117440512
    s_lshl_b32 s62, s20, 17
    s_add_u32 s20, s17, 1
    s_and_b32 s20, s20, 3
    s_lshl_b32 s19, s20, 21
    s_add_u32 s19, s19, 117440512
    s_add_u32 s20, s17, 3
    s_and_b32 s20, s20, 3
    s_lshl_b32 s26, s20, 21
    s_add_u32 s26, s26, 117440512
    s_lshl_b32 s63, s20, 17
    s_lshl_b32 s44, s12, 12
    s_add_u32 s44, s44, 131072
    s_add_u32 s44, s44, s18
    s_lshl_b32 s20, s17, 5
    s_add_u32 s20, s20, s12
    s_mul_i32 s21, s20, 3072
    s_add_u32 s30, s21, 106954752
    s_mul_i32 s20, s20, 12288
    s_mul_i32 s21, s16, 6144
    s_add_u32 s28, s20, s21
    s_add_u32 s28, s28, 25165824
    s_mul_i32 s21, s13, 6144
    s_add_u32 s27, s20, s21
    s_mul_i32 s21, s16, 3072
    s_add_u32 s27, s27, s21
    s_add_u32 s27, s27, 393216
    s_add_u32 s20, s17, 1
    s_and_b32 s20, s20, 1
    s_mul_i32 s47, s20, 6144
    s_add_u32 s47, s47, s21
    s_add_u32 s47, s47, 138752
    s_sub_u32 s53, 0, s53
    s_add_u32 s95, s18, s58
    s_add_u32 s33, s17, 2
    s_min_u32 s33, s33, 64
    s_mov_b32 s89, 0xf0000000
    s_mov_b32 s92, 0xf0000000
    s_lshl_b32 s98, s12, 12
    s_add_u32 s98, s98, 131072
    s_mul_i32 s46, s16, 6144
    s_add_u32 s46, s46, 151040
    v_mov_b32 v88, 0
    v_mov_b32 v89, 0
    v_mov_b32 v90, 0
    v_mov_b32 v91, 0
    v_mov_b32 v92, 0
    v_mov_b32 v93, 0
    v_mov_b32 v94, 0
    v_mov_b32 v95, 0
    v_mov_b32 v96, 0
    v_mov_b32 v97, 0
    v_mov_b32 v98, 0
    v_mov_b32 v99, 0
    v_mov_b32 v100, 0
    v_mov_b32 v101, 0
    v_mov_b32 v102, 0
    v_mov_b32 v103, 0
    v_mov_b32 v104, 0
    v_mov_b32 v105, 0
    v_mov_b32 v106, 0
    v_mov_b32 v107, 0
L_loop_3G:
    v_cmp_gt_u32 vcc, s33, v14
    s_cbranch_vccz Lf_399
    v_and_b32 v108, 7, v0
    v_lshlrev_b32 v108, 2, v108
    s_mov_b32 s24, 0
Lf_400:
    buffer_load_dword v14, v108, s[4:7], s32 offen sc1
    s_waitcnt vmcnt(0)
    v_cmp_gt_u32 vcc, s33, v14
    s_cbranch_vccz Lf_399
    s_add_u32 s24, s24, 1
    s_cmp_lt_u32 s24, 400000
    s_cbranch_scc1 Lf_400
    s_branch L_abort
Lf_399:
    v_mov_b32 v76, 0
    v_mov_b32 v77, 0
    v_mov_b32 v78, 0
    v_mov_b32 v79, 0
    s_mov_b32 s24, 0
Lg_401:
    buffer_load_dwordx4 v[68:71], v3, s[4:7], s95 offen sc1
    buffer_load_dwordx4 v[72:75], v3, s[4:7], s95 offen offset:1024 sc1
    s_mov_b64 exec, s[34:35]
    buffer_load_dwordx4 v[76:79], v3, s[4:7], s95 offen offset:2048 sc1
    s_mov_b64 exec, -1
    s_waitcnt vmcnt(0)
    v_max3_u32 v84, v68, v69, v70
    v_max3_u32 v85, v71, v72, v73
    v_max3_u32 v84, v84, v74, v75
    v_max3_u32 v85, v85, v76, v77
    v_max3_u32 v84, v84, v78, v79
    v_max_u32 v84, v84, v85
    v_cmp_eq_u32 vcc, -1, v84
    s_cbranch_vccz Lg_402
    s_add_u32 s24, s24, 1
    s_cmp_lt_u32 s24, 400000
    s_cbranch_scc1 Lg_401
    s_branch L_abort
Lg_402:
    ds_write_b128 v2, v[68:71] offset:0
    ds_write_b128 v2, v[72:75] offset:1024
    s_mov_b64 exec, s[34:35]
    ds_write_b128 v2, v[76:79] offset:2048
    s_mov_b64 exec, -1
    s_waitcnt lgkmcnt(0)
    s_barrier
    ds_read_b128 v[68:71], v4 offset:0
    ds_read_b128 v[112:115], v8 offset:0
    ds_read_b128 v[116:119], v8 offset:1024
    ds_read_b128 v[72:75], v4 offset:1024
    ds_read_b128 v[120:123], v8 offset:12288
    ds_read_b128 v[124:127], v8 offset:13312
    s_waitcnt lgkmcnt(3)
    v_smfmac_f32_16x16x64_bf16 v[88:91], v[68:71], a[0:7], v30
    ds_read_b128 v[76:79], v4 offset:2048
    v_smfmac_f32_16x16x64_bf16 v[92:95], v[68:71], a[80:87], v30
    ds_read_b128 v[128:131], v8 offset:24576
    buffer_store_dword v152, v19, s[4:7], s89 offen sc1
    v_smfmac_f32_16x16x64_bf16 v[96:99], v[68:71], a[160:167], v30
    ds_read_b128 v[132:135], v8 offset:25600
    v_smfmac_f32_16x16x64_bf16 v[100:103], v[68:71], v[112:119], v30
    buffer_store_dword v153, v19, s[4:7], s89 offen offset:256 sc1
    s_waitcnt lgkmcnt(3)
    v_smfmac_f32_16x16x64_bf16 v[88:91], v[72:75], a[8:15], v30
    ds_read_b128 v[68:71], v4 offset:3072
    v_smfmac_f32_16x16x64_bf16 v[92:95], v[72:75], a[88:95], v30
    ds_read_b128 v[112:115], v8 offset:36864
    buffer_store_dwordx4 v[144:147], v148, s[4:7], s92 offen sc1
    v_smfmac_f32_16x16x64_bf16 v[96:99], v[72:75], a[168:175], v30
    ds_read_b128 v[116:119], v8 offset:37888
    v_smfmac_f32_16x16x64_bf16 v[100:103], v[72:75], v[120:127], v30
    s_mov_b64 exec, s[34:35]
    buffer_store_dwordx4 v[156:159], v149, s[4:7], s92 offen sc1
    s_mov_b64 exec, -1
    s_waitcnt lgkmcnt(3)
    v_smfmac_f32_16x16x64_bf16 v[88:91], v[76:79], a[16:23], v30
    ds_read_b128 v[72:75], v4 offset:4096
    v_smfmac_f32_16x16x64_bf16 v[92:95], v[76:79], a[96:103], v30
    ds_read_b128 v[120:123], v10 offset:0
    s_lshl_b32 s20, s12, 8
    s_lshl_b32 s21, s13, 7
    s_add_u32 s20, s20, s21
    s_add_u32 s20, s20, 125845504
    s_add_u32 s21, s17, -1
    s_max_i32 s21, s21, 0
    v_mov_b32 v16, s21
    v_mov_b32 v17, 0
    s_mov_b64 exec, 1
    buffer_store_dword v16, v17, s[4:7], s20 offen sc1
    s_mov_b64 exec, -1
    v_smfmac_f32_16x16x64_bf16 v[96:99], v[76:79], a[176:183], v30
    ds_read_b128 v[124:127], v10 offset:1024
    v_smfmac_f32_16x16x64_bf16 v[100:103], v[76:79], v[128:135], v30
    s_waitcnt lgkmcnt(3)
    v_smfmac_f32_16x16x64_bf16 v[88:91], v[68:71], a[24:31], v30
    ds_read_b128 v[76:79], v4 offset:5120
    v_smfmac_f32_16x16x64_bf16 v[92:95], v[68:71], a[104:111], v30
    ds_read_b128 v[128:131], v10 offset:12288
    v_smfmac_f32_16x16x64_bf16 v[96:99], v[68:71], a[184:191], v30
    ds_read_b128 v[132:135], v10 offset:13312
    v_smfmac_f32_16x16x64_bf16 v[100:103], v[68:71], v[112:119], v30
    s_waitcnt lgkmcnt(3)
    v_smfmac_f32_16x16x64_bf16 v[88:91], v[72:75], a[32:39], v30
    ds_read_b128 v[68:71], v4 offset:6144
    v_smfmac_f32_16x16x64_bf16 v[92:95], v[72:75], a[112:119], v30
    ds_read_b128 v[112:115], v10 offset:24576
    v_smfmac_f32_16x16x64_bf16 v[96:99], v[72:75], a[192:199], v30
    ds_read_b128 v[116:119], v10 offset:25600
    v_smfmac_f32_16x16x64_bf16 v[100:103], v[72:75], v[120:127], v30
    s_waitcnt lgkmcnt(3)
    v_smfmac_f32_16x16x64_bf16 v[88:91], v[76:79], a[40:47], v30
    ds_read_b128 v[72:75], v4 offset:7168
    v_smfmac_f32_16x16x64_bf16 v[92:95], v[76:79], a[120:127], v30
    ds_read_b128 v[120:123], v10 offset:36864
    v_smfmac_f32_16x16x64_bf16 v[96:99], v[76:79], a[200:207], v30
    ds_read_b128 v[124:127], v10 offset:37888
    v_smfmac_f32_16x16x64_bf16 v[100:103], v[76:79], v[128:135], v30
    s_waitcnt lgkmcnt(3)
    v_smfmac_f32_16x16x64_bf16 v[88:91], v[68:71], a[48:55], v30
    ds_read_b128 v[76:79], v4 offset:8192
    v_smfmac_f32_16x16x64_bf16 v[92:95], v[68:71], a[128:135], v30
    ds_read_b128 v[128:131], v10 offset:49152
    v_smfmac_f32_16x16x64_bf16 v[96:99], v[68:71], a[208:215], v30
    ds_read_b128 v[132:135], v10 offset:50176
    v_smfmac_f32_16x16x64_bf16 v[100:103], v[68:71], v[112:119], v30
    s_waitcnt lgkmcnt(3)
    v_smfmac_f32_16x16x64_bf16 v[88:91], v[72:75], a[56:63], v30
    ds_read_b128 v[68:71], v4 offset:9216
    v_smfmac_f32_16x16x64_bf16 v[92:95], v[72:75], a[136:143], v30
    ds_read_b128 v[112:115], v10 offset:61440
    v_smfmac_f32_16x16x64_bf16 v[96:99], v[72:75], a[216:223], v30
    ds_read_b128 v[116:119], v10 offset:62464
    v_smfmac_f32_16x16x64_bf16 v[100:103], v[72:75], v[120:127], v30
    s_waitcnt lgkmcnt(3)
    v_smfmac_f32_16x16x64_bf16 v[88:91], v[76:79], a[64:71], v30
    v_smfmac_f32_16x16x64_bf16 v[92:95], v[76:79], a[144:151], v30
    v_smfmac_f32_16x16x64_bf16 v[96:99], v[76:79], a[224:231], v30
    v_smfmac_f32_16x16x64_bf16 v[100:103], v[76:79], v[128:135], v30
    s_waitcnt lgkmcnt(0)
    v_smfmac_f32_16x16x64_bf16 v[88:91], v[68:71], a[72:79], v30
    v_smfmac_f32_16x16x64_bf16 v[92:95], v[68:71], a[152:159], v30
    v_smfmac_f32_16x16x64_bf16 v[96:99], v[68:71], a[232:239], v30
    v_smfmac_f32_16x16x64_bf16 v[100:103], v[68:71], v[112:119], v30
    s_nop 5
    v_add_f32 v88, v88, v89
    v_add_f32 v90, v90, v91
    v_add_f32 v92, v92, v93
    v_add_f32 v94, v94, v95
    v_add_f32 v96, v96, v97
    v_add_f32 v98, v98, v99
    v_cvt_pk_bf16_f32 v89, v88, v90
    v_cvt_pk_bf16_f32 v93, v92, v94
    v_cvt_pk_bf16_f32 v97, v96, v98
    v_mov_b32_dpp v91, v89 quad_perm:[1,0,3,2] row_mask:0xf bank_mask:0xf
    v_mov_b32_dpp v95, v93 quad_perm:[1,0,3,2] row_mask:0xf bank_mask:0xf
    v_mov_b32_dpp v99, v97 quad_perm:[1,0,3,2] row_mask:0xf bank_mask:0xf
    v_perm_b32 v91, v91, v89, v31
    ds_write_b32 v5, v91
    v_perm_b32 v95, v95, v93, v31
    ds_write_b32 v6, v95
    v_perm_b32 v99, v99, v97, v31
    ds_write_b32 v7, v99
    v_add_f32 v100, v100, v101
    v_add_f32 v102, v102, v103
    v_cvt_pk_bf16_f32 v100, v100, v102
    s_waitcnt lgkmcnt(0)
    ds_read_b128 v[136:139], v4 offset:0
    ds_read_b128 v[112:115], v9 offset:0
    ds_read_b128 v[116:119], v9 offset:1024
    ds_read_b128 v[140:143], v4 offset:1024
    ds_read_b128 v[120:123], v9 offset:12288
    ds_read_b128 v[124:127], v9 offset:13312
    ds_read_b128 v[80:83], v4 offset:2048
    ds_read_b128 v[128:131], v9 offset:24576
    ds_read_b128 v[132:135], v9 offset:25600
    ds_read_b128 v[84:87], v4 offset:3072
    ds_read_b128 v[32:35], v9 offset:36864
    ds_read_b128 v[36:39], v9 offset:37888
    s_barrier
    buffer_store_dword v100, v19, s[4:7], s44 offen sc1
    v_mov_b32 v152, v100
    s_waitcnt lgkmcnt(9)
    v_smfmac_f32_16x16x64_bf16 v[104:107], v[136:139], v[112:119], v30
    ds_read_b128 v[136:139], v4 offset:4096
    ds_read_b128 v[112:115], v11 offset:0
    ds_read_b128 v[116:119], v11 offset:1024
    s_waitcnt lgkmcnt(9)
    v_smfmac_f32_16x16x64_bf16 v[104:107], v[140:143], v[120:127], v30
    ds_read_b128 v[140:143], v4 offset:5120
    ds_read_b128 v[120:123], v11 offset:12288
    ds_read_b128 v[124:127], v11 offset:13312
    s_waitcnt lgkmcnt(9)
    v_smfmac_f32_16x16x64_bf16 v[104:107], v[80:83], v[128:135], v30
    ds_read_b128 v[80:83], v4 offset:6144
    ds_read_b128 v[128:131], v11 offset:24576
    ds_read_b128 v[132:135], v11 offset:25600
    s_waitcnt lgkmcnt(9)
    v_smfmac_f32_16x16x64_bf16 v[104:107], v[84:87], v[32:39], v30
    ds_read_b128 v[84:87], v4 offset:7168
    ds_read_b128 v[32:35], v11 offset:36864
    ds_read_b128 v[36:39], v11 offset:37888
    s_waitcnt lgkmcnt(9)
    v_smfmac_f32_16x16x64_bf16 v[104:107], v[136:139], v[112:119], v30
    ds_read_b128 v[136:139], v4 offset:8192
    ds_read_b128 v[112:115], v11 offset:49152
    ds_read_b128 v[116:119], v11 offset:50176
    s_waitcnt lgkmcnt(9)
    v_smfmac_f32_16x16x64_bf16 v[104:107], v[140:143], v[120:127], v30
    ds_read_b128 v[140:143], v4 offset:9216
    ds_read_b128 v[120:123], v11 offset:61440
    ds_read_b128 v[124:127], v11 offset:62464
    s_waitcnt lgkmcnt(9)
    v_smfmac_f32_16x16x64_bf16 v[104:107], v[80:83], v[128:135], v30
    s_waitcnt lgkmcnt(6)
    v_smfmac_f32_16x16x64_bf16 v[104:107], v[84:87], v[32:39], v30
    s_waitcnt lgkmcnt(3)
    v_smfmac_f32_16x16x64_bf16 v[104:107], v[136:139], v[112:119], v30
    s_waitcnt lgkmcnt(0)
    v_smfmac_f32_16x16x64_bf16 v[104:107], v[140:143], v[120:127], v30
    s_mul_i32 s21, s13, 192
    s_add_u32 s29, s30, s21
    s_add_u32 s29, s29, -6291456
    v_add_u32 v154, 0, v0
    v_mul_u32_u24 v155, 0x1556, v154
    v_lshrrev_b32 v155, 16, v155
    v_mul_u32_u24 v24, 12, v155
    v_sub_u32 v24, v154, v24
    v_lshlrev_b32 v24, 4, v24
    v_mul_u32_u24 v18, 208, v155
    v_add_u32 v18, v18, v24
    v_add_u32 v18, 134656, v18
    v_mul_u32_u24 v148, 384, v155
    v_add_u32 v148, v148, v24
    ds_read_b128 v[144:147], v18
    v_add_u32 v154, 64, v0
    v_mul_u32_u24 v155, 0x1556, v154
    v_lshrrev_b32 v155, 16, v155
    v_mul_u32_u24 v24, 12, v155
    v_sub_u32 v24, v154, v24
    v_lshlrev_b32 v24, 4, v24
    v_mul_u32_u24 v18, 208, v155
    v_add_u32 v18, v18, v24
    v_add_u32 v18, 134656, v18
    v_mul_u32_u24 v149, 384, v155
    v_add_u32 v149, v149, v24
    ds_read_b128 v[156:159], v18
    s_nop 7
    v_add_f32 v104, v104, v105
    v_add_f32 v106, v106, v107
    v_cvt_pk_bf16_f32 v104, v104, v106
    buffer_store_dword v104, v19, s[4:7], s44 offen offset:256 sc1
    v_mov_b32 v153, v104
    v_mov_b32 v88, 0
    v_mov_b32 v89, 0
    v_mov_b32 v90, 0
    v_mov_b32 v91, 0
    v_mov_b32 v92, 0
    v_mov_b32 v93, 0
    v_mov_b32 v94, 0
    v_mov_b32 v95, 0
    v_mov_b32 v96, 0
    v_mov_b32 v97, 0
    v_mov_b32 v98, 0
    v_mov_b32 v99, 0
    v_mov_b32 v100, 0
    v_mov_b32 v101, 0
    v_mov_b32 v102, 0
    v_mov_b32 v103, 0
    s_sleep 2
    buffer_load_dwordx4 v[68:71], v15, s[4:7], s18 offen sc1
    buffer_load_dwordx4 v[72:75], v15, s[4:7], s18 offen offset:1024 sc1
    s_waitcnt lgkmcnt(0)
    s_waitcnt vmcnt(4)
    s_barrier
    s_cmp_eq_u32 s17, 63
    s_cbranch_scc1 L_last_3G
    ds_read_b128 v[76:79], v4 offset:13440
    ds_read_b128 v[80:83], v4 offset:14464
    ds_read_b128 v[44:47], v150 offset:0
    ds_read_b128 v[52:55], v150 offset:1024
    ds_read_b128 v[60:63], v150 offset:2048
    s_mov_b32 s24, 0
    s_waitcnt vmcnt(0)
    s_branch Lp_403_chk
Lp_403:
    buffer_load_dwordx4 v[68:71], v15, s[4:7], s18 offen sc1
    buffer_load_dwordx4 v[72:75], v15, s[4:7], s18 offen offset:1024 sc1
    s_waitcnt vmcnt(0)
Lp_403_chk:
    v_max3_u32 v84, v68, v69, v70
    v_max3_u32 v85, v71, v72, v73
    v_max3_u32 v84, v84, v74, v75
    v_max_u32 v84, v84, v85
    v_cmp_eq_u32 vcc, -1, v84
    s_cbranch_vccz Lp_404
    s_add_u32 s24, s24, 1
    s_cmp_lt_u32 s24, 400000
    s_cbranch_scc1 Lp_403
    s_branch L_abort
Lp_404:
    s_mov_b64 exec, s[36:37]
    buffer_load_dwordx2 v[48:49], v20, s[4:7], s44 offen sc1
    buffer_load_dwordx2 v[56:57], v20, s[4:7], s44 offen offset:256 sc1
    buffer_load_dwordx2 v[64:65], v20, s[4:7], s44 offen offset:512 sc1
    s_mov_b64 exec, -1
    s_waitcnt lgkmcnt(3)
    v_pk_add_f32 v[76:77], v[76:77], v[68:69]
    v_pk_add_f32 v[78:79], v[78:79], v[70:71]
    v_pk_add_f32 v[80:81], v[80:81], v[72:73]
    v_pk_add_f32 v[82:83], v[82:83], v[74:75]
    v_max3_f32 v84, v76, v77, v78
    v_max3_f32 v85, v79, v80, v81
    v_max3_f32 v84, v84, v82, v83
    v_max_f32 v84, v84, v85
    s_nop 1
    v_max_f32_dpp v84, v84, v84 quad_perm:[1,0,3,2] row_mask:0xf bank_mask:0xf
    v_mov_b32 v85, v84
    s_nop 1
    v_permlane16_swap_b32 v84, v85
    v_max_f32 v84, v84, v85
    v_mov_b32 v85, v84
    s_nop 1
    v_permlane32_swap_b32 v84, v85
    v_max_f32 v84, v84, v85
    s_mov_b32 s42, 0x3dd53b95
    v_mul_f32 v84, s42, v84
    v_fma_f32 v76, v76, s42, -v84
    v_fma_f32 v77, v77, s42, -v84
    v_fma_f32 v78, v78, s42, -v84
    v_fma_f32 v79, v79, s42, -v84
    v_fma_f32 v80, v80, s42, -v84
    v_fma_f32 v81, v81, s42, -v84
    v_fma_f32 v82, v82, s42, -v84
    v_fma_f32 v83, v83, s42, -v84
    v_exp_f32 v76, v76
    v_exp_f32 v77, v77
    v_exp_f32 v78, v78
    v_exp_f32 v79, v79
    v_exp_f32 v80, v80
    v_exp_f32 v81, v81
    v_exp_f32 v82, v82
    v_exp_f32 v83, v83
    v_cvt_pk_bf16_f32 v68, v76, v77
    v_cvt_pk_bf16_f32 v69, v78, v79
    v_cvt_pk_bf16_f32 v70, v80, v81
    v_cvt_pk_bf16_f32 v71, v82, v83
    s_mov_b32 s24, 0
    s_waitcnt vmcnt(0)
    s_branch Lp_405_chk
Lp_405:
    s_mov_b64 exec, s[36:37]
    buffer_load_dwordx2 v[48:49], v20, s[4:7], s44 offen sc1
    buffer_load_dwordx2 v[56:57], v20, s[4:7], s44 offen offset:256 sc1
    buffer_load_dwordx2 v[64:65], v20, s[4:7], s44 offen offset:512 sc1
    s_mov_b64 exec, -1
    s_waitcnt vmcnt(0)
Lp_405_chk:
    v_max3_u32 v84, v48, v49, v56
    v_max3_u32 v85, v57, v64, v65
    v_max_u32 v84, v84, v85
    v_cmp_eq_u32 vcc, -1, v84
    s_cbranch_vccz Lp_406
    s_add_u32 s24, s24, 1
    s_cmp_lt_u32 s24, 400000
    s_cbranch_scc1 Lp_405
    s_branch L_abort
Lp_406:
    s_waitcnt lgkmcnt(0)
    v_smfmac_f32_16x16x64_bf16 v[88:91], v[68:71], v[44:51], v30
    v_smfmac_f32_16x16x64_bf16 v[92:95], v[68:71], v[52:59], v30
    v_smfmac_f32_16x16x64_bf16 v[96:99], v[68:71], v[60:67], v30
    v_smfmac_f32_16x16x64_bf16 v[100:103], v[68:71], a[240:247], v30
    v_mov_b32 v72, 0
    v_mov_b32 v73, 0
    v_mov_b32 v74, 0
    v_mov_b32 v75, 0
    v_mov_b32 v76, 0
    v_mov_b32 v77, 0
    v_mov_b32 v78, 0
    v_mov_b32 v79, 0
    v_add_f32 v88, v88, v89
    v_add_f32 v90, v90, v91
    v_add_f32 v92, v92, v93
    v_add_f32 v94, v94, v95
    v_add_f32 v96, v96, v97
    v_add_f32 v98, v98, v99
    v_add_f32 v100, v100, v101
    v_add_f32 v102, v102, v103
    v_rcp_f32 v100, v100
    v_rcp_f32 v102, v102
    s_nop 0
    v_mul_f32 v88, v88, v100
    v_mul_f32 v90, v90, v102
    v_mul_f32 v92, v92, v100
    v_mul_f32 v94, v94, v102
    v_mul_f32 v96, v96, v100
    v_mul_f32 v98, v98, v102
    v_cvt_pk_bf16_f32 v89, v88, v90
    v_cvt_pk_bf16_f32 v93, v92, v94
    v_cvt_pk_bf16_f32 v97, v96, v98
    v_mov_b32_dpp v91, v89 quad_perm:[1,0,3,2] row_mask:0xf bank_mask:0xf
    v_mov_b32_dpp v95, v93 quad_perm:[1,0,3,2] row_mask:0xf bank_mask:0xf
    v_mov_b32_dpp v99, v97 quad_perm:[1,0,3,2] row_mask:0xf bank_mask:0xf
    v_perm_b32 v91, v91, v89, v31
    ds_write_b32 v21, v91
    v_perm_b32 v95, v95, v93, v31
    ds_write_b32 v22, v95
    v_perm_b32 v99, v99, v97, v31
    ds_write_b32 v23, v99
    v_mov_b32 v80, 0
    v_mov_b32 v81, 0
    v_mov_b32 v82, 0
    v_mov_b32 v83, 0
    v_mov_b32 v84, 0
    v_mov_b32 v85, 0
    v_mov_b32 v86, 0
    v_mov_b32 v87, 0
    s_waitcnt lgkmcnt(0)
    s_barrier
    ds_read_b128 v[32:35], v4 offset:10240
    ds_read_b128 v[36:39], v4 offset:11264
    ds_read_b128 v[40:43], v4 offset:12288
    s_waitcnt lgkmcnt(2)
    v_smfmac_f32_16x16x64_bf16 v[72:75], v[32:35], v[160:167], v30
    v_smfmac_f32_16x16x64_bf16 v[76:79], v[32:35], v[184:191], v30
    s_waitcnt lgkmcnt(1)
    v_smfmac_f32_16x16x64_bf16 v[72:75], v[36:39], v[168:175], v30
    v_smfmac_f32_16x16x64_bf16 v[76:79], v[36:39], v[192:199], v30
    s_waitcnt lgkmcnt(0)
    v_smfmac_f32_16x16x64_bf16 v[72:75], v[40:43], v[176:183], v30
    v_smfmac_f32_16x16x64_bf16 v[76:79], v[40:43], v[200:207], v30
    v_smfmac_f32_16x16x64_bf16 v[80:83], v[32:35], v[208:215], v30
    s_nop 1
    v_smfmac_f32_16x16x64_bf16 v[84:87], v[32:35], v[232:239], v30
    s_nop 1
    v_smfmac_f32_16x16x64_bf16 v[80:83], v[36:39], v[216:223], v30
    s_nop 1
    v_smfmac_f32_16x16x64_bf16 v[84:87], v[36:39], v[240:247], v30
    v_add_f32 v72, v72, v73
    v_add_f32 v73, v76, v77
    v_smfmac_f32_16x16x64_bf16 v[80:83], v[40:43], v[224:231], v30
    v_add_f32 v76, v74, v75
    v_add_f32 v75, v78, v79
    v_smfmac_f32_16x16x64_bf16 v[84:87], v[40:43], v[248:255], v30
    v_cvt_pk_bf16_f32 v72, v72, v73
    v_cvt_pk_bf16_f32 v73, v76, v75
    buffer_store_dwordx2 v[72:73], v25, s[4:7], s18 offen sc1
    s_nop 7
    v_add_f32 v80, v80, v81
    v_add_f32 v81, v84, v85
    v_add_f32 v84, v82, v83
    v_add_f32 v83, v86, v87
    v_cvt_pk_bf16_f32 v80, v80, v81
    v_cvt_pk_bf16_f32 v81, v84, v83
    buffer_store_dwordx2 v[80:81], v26, s[4:7], s18 offen sc1
    s_barrier
    s_lshl_b32 s20, s12, 12
    s_add_u32 s20, s20, 131072
    s_add_u32 s20, s20, s26
    buffer_store_dword a248, v19, s[4:7], s20 offen sc1
    buffer_store_dword a248, v19, s[4:7], s20 offen offset:256 sc1
    buffer_store_dwordx2 a[248:249], v25, s[4:7], s26 offen sc1
    buffer_store_dwordx2 a[248:249], v26, s[4:7], s26 offen sc1
    s_mov_b32 s89, s30
    s_mov_b32 s92, s29
    v_and_b32 v12, 7, v0
    v_lshlrev_b32 v12, 2, v12
    buffer_load_dword v14, v12, s[4:7], s32 offen sc1
    s_add_u32 s17, s17, 1
    s_mov_b32 s26, s18
    s_mov_b32 s18, s19
    s_add_u32 s19, s19, 2097152
    s_and_b32 s19, s19, 0x77fffff
    s_or_b32 s19, s19, 0x7000000
    s_mov_b32 s63, s62
    s_add_u32 s62, s62, 131072
    s_and_b32 s62, s62, 0x7ffff
    s_add_u32 s44, s18, s98
    s_add_u32 s95, s18, s58
    s_add_u32 s30, s30, 98304
    s_add_u32 s28, s28, 393216
    s_add_u32 s27, s27, 393216
    s_add_u32 s33, s17, 2
    s_min_u32 s33, s33, 64
    v_mov_b32 v88, 0
    v_mov_b32 v89, 0
    v_mov_b32 v90, 0
    v_mov_b32 v91, 0
    v_mov_b32 v92, 0
    v_mov_b32 v93, 0
    v_mov_b32 v94, 0
    v_mov_b32 v95, 0
    v_mov_b32 v96, 0
    v_mov_b32 v97, 0
    v_mov_b32 v98, 0
    v_mov_b32 v99, 0
    v_mov_b32 v100, 0
    v_mov_b32 v101, 0
    v_mov_b32 v102, 0
    v_mov_b32 v103, 0
    v_mov_b32 v104, 0
    v_mov_b32 v105, 0
    v_mov_b32 v106, 0
    v_mov_b32 v107, 0
    s_barrier
    s_branch L_loop_3G
L_last_3G:
    buffer_store_dword v152, v19, s[4:7], s30 offen sc1
    buffer_store_dword v153, v19, s[4:7], s30 offen offset:256 sc1
    buffer_store_dwordx4 v[144:147], v148, s[4:7], s29 offen sc1
    s_mov_b64 exec, s[34:35]
    buffer_store_dwordx4 v[156:159], v149, s[4:7], s29 offen sc1
    s_mov_b64 exec, -1
    s_waitcnt vmcnt(0)
    s_barrier
    s_lshl_b32 s20, s12, 8
    s_lshl_b32 s21, s13, 7
    s_add_u32 s20, s20, s21
    s_add_u32 s20, s20, 125845504
    s_add_u32 s21, s17, 1
    v_mov_b32 v16, s21
    v_mov_b32 v17, 0
    s_mov_b64 exec, 1
    buffer_store_dword v16, v17, s[4:7], s20 offen sc1
    s_mov_b64 exec, -1
    s_branch L_chain_end
L_chain_end:
    s_waitcnt vmcnt(0)
    s_branch L_exit
L_role_worker:
    s_cmp_lt_u32 s94, 96
    s_cbranch_scc0 L_w_notqkv
    s_getpc_b64 s[40:41]
L_pc1:
    s_add_u32 s40, s40, L_table_qkv-L_pc1
    s_addc_u32 s41, s41, 0
    s_lshr_b32 s12, s94, 5
    s_and_b32 s13, s94, 31
    s_lshl_b32 s20, s16, 8
    v_lshlrev_b32 v92, 2, v0
    v_add_u32 v92, s20, v92
    s_mov_b32 s42, s40
    s_mov_b32 s43, s41
    global_load_dword v108, v92, s[42:43]
    s_add_u32 s42, s42, 1024
    s_addc_u32 s43, s43, 0
    global_load_dword v109, v92, s[42:43]
    s_add_u32 s42, s42, 1024
    s_addc_u32 s43, s43, 0
    global_load_dword v110, v92, s[42:43]
    s_add_u32 s42, s42, 1024
    s_addc_u32 s43, s43, 0
    global_load_dword v111, v92, s[42:43]
    s_add_u32 s42, s42, 1024
    s_addc_u32 s43, s43, 0
    global_load_dword v112, v92, s[42:43]
    s_add_u32 s42, s42, 1024
    s_addc_u32 s43, s43, 0
    global_load_dword v113, v92, s[42:43]
    s_add_u32 s42, s42, 1024
    s_addc_u32 s43, s43, 0
    global_load_dword v104, v92, s[42:43]
    s_add_u32 s42, s42, 1024
    s_addc_u32 s43, s43, 0
    global_load_dword v105, v92, s[42:43]
    s_add_u32 s42, s42, 1024
    s_addc_u32 s43, s43, 0
    global_load_dword v106, v92, s[42:43]
    s_add_u32 s42, s42, 1024
    s_addc_u32 s43, s43, 0
    global_load_dword v95, v92, s[42:43]
    s_add_u32 s42, s42, 1024
    s_addc_u32 s43, s43, 0
    global_load_dword v96, v92, s[42:43]
    s_add_u32 s42, s42, 1024
    s_addc_u32 s43, s43, 0
    global_load_dword v97, v92, s[42:43]
    s_add_u32 s42, s42, 1024
    s_addc_u32 s43, s43, 0
    global_load_dword v2, v92, s[42:43]
    s_add_u32 s42, s42, 1024
    s_addc_u32 s43, s43, 0
    global_load_dword v3, v92, s[42:43]
    s_add_u32 s42, s42, 1024
    s_addc_u32 s43, s43, 0
    global_load_dword v4, v92, s[42:43]
    s_add_u32 s42, s42, 1024
    s_addc_u32 s43, s43, 0
    global_load_dword v5, v92, s[42:43]
    s_add_u32 s42, s42, 1024
    s_addc_u32 s43, s43, 0
    global_load_dword v6, v92, s[42:43]
    s_add_u32 s42, s42, 1024
    s_addc_u32 s43, s43, 0
    global_load_dword v7, v92, s[42:43]
    s_add_u32 s42, s42, 1024
    s_addc_u32 s43, s43, 0
    global_load_dword v8, v92, s[42:43]
    s_add_u32 s42, s42, 1024
    s_addc_u32 s43, s43, 0
    global_load_dword v9, v92, s[42:43]
    s_add_u32 s42, s42, 1024
    s_addc_u32 s43, s43, 0
    global_load_dword v10, v92, s[42:43]
    s_add_u32 s42, s42, 1024
    s_addc_u32 s43, s43, 0
    global_load_dword v11, v92, s[42:43]
    s_add_u32 s42, s42, 1024
    s_addc_u32 s43, s43, 0
    global_load_dword v16, v92, s[42:43]
    s_add_u32 s42, s42, 1024
    s_addc_u32 s43, s43, 0
    global_load_dword v17, v92, s[42:43]
    s_add_u32 s42, s42, 1024
    s_addc_u32 s43, s43, 0
    global_load_dword v18, v92, s[42:43]
    s_add_u32 s42, s42, 1024
    s_addc_u32 s43, s43, 0
    global_load_dword v19, v92, s[42:43]
    s_waitcnt vmcnt(0)
    v_lshlrev_b32 v1, 4, v0
    s_cmp_eq_u32 s12, 1
    s_cbranch_scc0 Lq_410
    v_mov_b32 v104, v95
    v_mov_b32 v105, v96
    v_mov_b32 v106, v97
Lq_410:
    s_cmp_eq_u32 s12, 0
    s_cselect_b32 s20, 48, 56
    s_cmp_eq_u32 s12, 2
    s_cselect_b32 s20, 40, s20
    s_load_dwordx2 s[8:9], s[96:97], s20
    s_mov_b32 s10, 7864320
    s_mov_b32 s11, 0x00020000
    s_waitcnt lgkmcnt(0)
    s_mul_i32 s20, s13, 384
    s_add_u32 s20, s20, 0
    s_mul_i32 s21, s16, 6144
    s_add_u32 s21, s21, 0
    s_mov_b32 m0, s21
    s_add_u32 s21, s21, 1024
    buffer_load_dwordx4 v108, s[8:11], s20 offen lds
    s_mov_b32 m0, s21
    s_add_u32 s21, s21, 1024
    buffer_load_dwordx4 v109, s[8:11], s20 offen lds
    s_mov_b32 m0, s21
    s_add_u32 s21, s21, 1024
    buffer_load_dwordx4 v110, s[8:11], s20 offen lds
    s_mov_b32 m0, s21
    s_add_u32 s21, s21, 1024
    buffer_load_dwordx4 v111, s[8:11], s20 offen lds
    s_mov_b32 m0, s21
    s_add_u32 s21, s21, 1024
    buffer_load_dwordx4 v112, s[8:11], s20 offen lds
    s_mov_b32 m0, s21
    s_add_u32 s21, s21, 1024
    buffer_load_dwordx4 v113, s[8:11], s20 offen lds
    s_mul_i32 s20, s13, 384
    s_add_u32 s20, s20, 786432
    s_mul_i32 s21, s16, 6144
    s_add_u32 s21, s21, 24576
    s_mov_b32 m0, s21
    s_add_u32 s21, s21, 1024
    buffer_load_dwordx4 v108, s[8:11], s20 offen lds
    s_mov_b32 m0, s21
    s_add_u32 s21, s21, 1024
    buffer_load_dwordx4 v109, s[8:11], s20 offen lds
    s_mov_b32 m0, s21
    s_add_u32 s21, s21, 1024
    buffer_load_dwordx4 v110, s[8:11], s20 offen lds
    s_mov_b32 m0, s21
    s_add_u32 s21, s21, 1024
    buffer_load_dwordx4 v111, s[8:11], s20 offen lds
    s_mov_b32 m0, s21
    s_add_u32 s21, s21, 1024
    buffer_load_dwordx4 v112, s[8:11], s20 offen lds
    s_mov_b32 m0, s21
    s_add_u32 s21, s21, 1024
    buffer_load_dwordx4 v113, s[8:11], s20 offen lds
    s_mul_i32 s20, s13, 384
    s_add_u32 s20, s20, 1572864
    s_mul_i32 s21, s16, 6144
    s_add_u32 s21, s21, 49152
    s_mov_b32 m0, s21
    s_add_u32 s21, s21, 1024
    buffer_load_dwordx4 v108, s[8:11], s20 offen lds
    s_mov_b32 m0, s21
    s_add_u32 s21, s21, 1024
    buffer_load_dwordx4 v109, s[8:11], s20 offen lds
    s_mov_b32 m0, s21
    s_add_u32 s21, s21, 1024
    buffer_load_dwordx4 v110, s[8:11], s20 offen lds
    s_mov_b32 m0, s21
    s_add_u32 s21, s21, 1024
    buffer_load_dwordx4 v111, s[8:11], s20 offen lds
    s_mov_b32 m0, s21
    s_add_u32 s21, s21, 1024
    buffer_load_dwordx4 v112, s[8:11], s20 offen lds
    s_mov_b32 m0, s21
    s_add_u32 s21, s21, 1024
    buffer_load_dwordx4 v113, s[8:11], s20 offen lds
    s_mul_i32 s20, s13, 384
    s_add_u32 s20, s20, 2359296
    s_mul_i32 s21, s16, 6144
    s_add_u32 s21, s21, 73728
    s_mov_b32 m0, s21
    s_add_u32 s21, s21, 1024
    buffer_load_dwordx4 v108, s[8:11], s20 offen lds
    s_mov_b32 m0, s21
    s_add_u32 s21, s21, 1024
    buffer_load_dwordx4 v109, s[8:11], s20 offen lds
    s_mov_b32 m0, s21
    s_add_u32 s21, s21, 1024
    buffer_load_dwordx4 v110, s[8:11], s20 offen lds
    s_mov_b32 m0, s21
    s_add_u32 s21, s21, 1024
    buffer_load_dwordx4 v111, s[8:11], s20 offen lds
    s_mov_b32 m0, s21
    s_add_u32 s21, s21, 1024
    buffer_load_dwordx4 v112, s[8:11], s20 offen lds
    s_mov_b32 m0, s21
    s_add_u32 s21, s21, 1024
    buffer_load_dwordx4 v113, s[8:11], s20 offen lds
    s_mul_i32 s20, s13, 384
    s_add_u32 s20, s20, 3145728
    s_mul_i32 s21, s16, 6144
    s_add_u32 s21, s21, 98304
    s_mov_b32 m0, s21
    s_add_u32 s21, s21, 1024
    buffer_load_dwordx4 v108, s[8:11], s20 offen lds
    s_mov_b32 m0, s21
    s_add_u32 s21, s21, 1024
    buffer_load_dwordx4 v109, s[8:11], s20 offen lds
    s_mov_b32 m0, s21
    s_add_u32 s21, s21, 1024
    buffer_load_dwordx4 v110, s[8:11], s20 offen lds
    s_mov_b32 m0, s21
    s_add_u32 s21, s21, 1024
    buffer_load_dwordx4 v111, s[8:11], s20 offen lds
    s_mov_b32 m0, s21
    s_add_u32 s21, s21, 1024
    buffer_load_dwordx4 v112, s[8:11], s20 offen lds
    s_mov_b32 m0, s21
    s_add_u32 s21, s21, 1024
    buffer_load_dwordx4 v113, s[8:11], s20 offen lds
    s_waitcnt vmcnt(24)
    s_barrier
    v_add_u32 v92, 0, v104
    ds_read_b64_tr_b16 a[0:1], v92 offset:0
    ds_read_b64_tr_b16 a[2:3], v92 offset:1536
    ds_read_b64_tr_b16 a[4:5], v92 offset:12288
    ds_read_b64_tr_b16 a[6:7], v92 offset:13824
    v_add_u32 v92, 0, v105
    ds_read_b64_tr_b16 a[80:81], v92 offset:0
    ds_read_b64_tr_b16 a[82:83], v92 offset:1536
    ds_read_b64_tr_b16 a[84:85], v92 offset:12288
    ds_read_b64_tr_b16 a[86:87], v92 offset:13824
    v_add_u32 v92, 0, v106
    ds_read_b64_tr_b16 a[160:161], v92 offset:0
    ds_read_b64_tr_b16 a[162:163], v92 offset:1536
    ds_read_b64_tr_b16 a[164:165], v92 offset:12288
    ds_read_b64_tr_b16 a[166:167], v92 offset:13824
    s_waitcnt lgkmcnt(0)
    s_barrier
    s_mul_i32 s20, s13, 384
    s_add_u32 s20, s20, 3932160
    s_mul_i32 s21, s16, 6144
    s_add_u32 s21, s21, 0
    s_mov_b32 m0, s21
    s_add_u32 s21, s21, 1024
    buffer_load_dwordx4 v108, s[8:11], s20 offen lds
    s_mov_b32 m0, s21
    s_add_u32 s21, s21, 1024
    buffer_load_dwordx4 v109, s[8:11], s20 offen lds
    s_mov_b32 m0, s21
    s_add_u32 s21, s21, 1024
    buffer_load_dwordx4 v110, s[8:11], s20 offen lds
    s_mov_b32 m0, s21
    s_add_u32 s21, s21, 1024
    buffer_load_dwordx4 v111, s[8:11], s20 offen lds
    s_mov_b32 m0, s21
    s_add_u32 s21, s21, 1024
    buffer_load_dwordx4 v112, s[8:11], s20 offen lds
    s_mov_b32 m0, s21
    s_add_u32 s21, s21, 1024
    buffer_load_dwordx4 v113, s[8:11], s20 offen lds
    s_waitcnt vmcnt(24)
    s_barrier
    v_add_u32 v92, 24576, v104
    ds_read_b64_tr_b16 a[8:9], v92 offset:0
    ds_read_b64_tr_b16 a[10:11], v92 offset:1536
    ds_read_b64_tr_b16 a[12:13], v92 offset:12288
    ds_read_b64_tr_b16 a[14:15], v92 offset:13824
    v_add_u32 v92, 24576, v105
    ds_read_b64_tr_b16 a[88:89], v92 offset:0
    ds_read_b64_tr_b16 a[90:91], v92 offset:1536
    ds_read_b64_tr_b16 a[92:93], v92 offset:12288
    ds_read_b64_tr_b16 a[94:95], v92 offset:13824
    v_add_u32 v92, 24576, v106
    ds_read_b64_tr_b16 a[168:169], v92 offset:0
    ds_read_b64_tr_b16 a[170:171], v92 offset:1536
    ds_read_b64_tr_b16 a[172:173], v92 offset:12288
    ds_read_b64_tr_b16 a[174:175], v92 offset:13824
    s_waitcnt lgkmcnt(0)
    s_barrier
    s_mul_i32 s20, s13, 384
    s_add_u32 s20, s20, 4718592
    s_mul_i32 s21, s16, 6144
    s_add_u32 s21, s21, 24576
    s_mov_b32 m0, s21
    s_add_u32 s21, s21, 1024
    buffer_load_dwordx4 v108, s[8:11], s20 offen lds
    s_mov_b32 m0, s21
    s_add_u32 s21, s21, 1024
    buffer_load_dwordx4 v109, s[8:11], s20 offen lds
    s_mov_b32 m0, s21
    s_add_u32 s21, s21, 1024
    buffer_load_dwordx4 v110, s[8:11], s20 offen lds
    s_mov_b32 m0, s21
    s_add_u32 s21, s21, 1024
    buffer_load_dwordx4 v111, s[8:11], s20 offen lds
    s_mov_b32 m0, s21
    s_add_u32 s21, s21, 1024
    buffer_load_dwordx4 v112, s[8:11], s20 offen lds
    s_mov_b32 m0, s21
    s_add_u32 s21, s21, 1024
    buffer_load_dwordx4 v113, s[8:11], s20 offen lds
    s_waitcnt vmcnt(24)
    s_barrier
    v_add_u32 v92, 49152, v104
    ds_read_b64_tr_b16 a[16:17], v92 offset:0
    ds_read_b64_tr_b16 a[18:19], v92 offset:1536
    ds_read_b64_tr_b16 a[20:21], v92 offset:12288
    ds_read_b64_tr_b16 a[22:23], v92 offset:13824
    v_add_u32 v92, 49152, v105
    ds_read_b64_tr_b16 a[96:97], v92 offset:0
    ds_read_b64_tr_b16 a[98:99], v92 offset:1536
    ds_read_b64_tr_b16 a[100:101], v92 offset:12288
    ds_read_b64_tr_b16 a[102:103], v92 offset:13824
    v_add_u32 v92, 49152, v106
    ds_read_b64_tr_b16 a[176:177], v92 offset:0
    ds_read_b64_tr_b16 a[178:179], v92 offset:1536
    ds_read_b64_tr_b16 a[180:181], v92 offset:12288
    ds_read_b64_tr_b16 a[182:183], v92 offset:13824
    s_waitcnt lgkmcnt(0)
    s_barrier
    s_mul_i32 s20, s13, 384
    s_add_u32 s20, s20, 5505024
    s_mul_i32 s21, s16, 6144
    s_add_u32 s21, s21, 49152
    s_mov_b32 m0, s21
    s_add_u32 s21, s21, 1024
    buffer_load_dwordx4 v108, s[8:11], s20 offen lds
    s_mov_b32 m0, s21
    s_add_u32 s21, s21, 1024
    buffer_load_dwordx4 v109, s[8:11], s20 offen lds
    s_mov_b32 m0, s21
    s_add_u32 s21, s21, 1024
    buffer_load_dwordx4 v110, s[8:11], s20 offen lds
    s_mov_b32 m0, s21
    s_add_u32 s21, s21, 1024
    buffer_load_dwordx4 v111, s[8:11], s20 offen lds
    s_mov_b32 m0, s21
    s_add_u32 s21, s21, 1024
    buffer_load_dwordx4 v112, s[8:11], s20 offen lds
    s_mov_b32 m0, s21
    s_add_u32 s21, s21, 1024
    buffer_load_dwordx4 v113, s[8:11], s20 offen lds
    s_waitcnt vmcnt(24)
    s_barrier
    v_add_u32 v92, 73728, v104
    ds_read_b64_tr_b16 a[24:25], v92 offset:0
    ds_read_b64_tr_b16 a[26:27], v92 offset:1536
    ds_read_b64_tr_b16 a[28:29], v92 offset:12288
    ds_read_b64_tr_b16 a[30:31], v92 offset:13824
    v_add_u32 v92, 73728, v105
    ds_read_b64_tr_b16 a[104:105], v92 offset:0
    ds_read_b64_tr_b16 a[106:107], v92 offset:1536
    ds_read_b64_tr_b16 a[108:109], v92 offset:12288
    ds_read_b64_tr_b16 a[110:111], v92 offset:13824
    v_add_u32 v92, 73728, v106
    ds_read_b64_tr_b16 a[184:185], v92 offset:0
    ds_read_b64_tr_b16 a[186:187], v92 offset:1536
    ds_read_b64_tr_b16 a[188:189], v92 offset:12288
    ds_read_b64_tr_b16 a[190:191], v92 offset:13824
    s_waitcnt lgkmcnt(0)
    s_barrier
    s_mul_i32 s20, s13, 384
    s_add_u32 s20, s20, 6291456
    s_mul_i32 s21, s16, 6144
    s_add_u32 s21, s21, 73728
    s_mov_b32 m0, s21
    s_add_u32 s21, s21, 1024
    buffer_load_dwordx4 v108, s[8:11], s20 offen lds
    s_mov_b32 m0, s21
    s_add_u32 s21, s21, 1024
    buffer_load_dwordx4 v109, s[8:11], s20 offen lds
    s_mov_b32 m0, s21
    s_add_u32 s21, s21, 1024
    buffer_load_dwordx4 v110, s[8:11], s20 offen lds
    s_mov_b32 m0, s21
    s_add_u32 s21, s21, 1024
    buffer_load_dwordx4 v111, s[8:11], s20 offen lds
    s_mov_b32 m0, s21
    s_add_u32 s21, s21, 1024
    buffer_load_dwordx4 v112, s[8:11], s20 offen lds
    s_mov_b32 m0, s21
    s_add_u32 s21, s21, 1024
    buffer_load_dwordx4 v113, s[8:11], s20 offen lds
    s_waitcnt vmcnt(24)
    s_barrier
    v_add_u32 v92, 98304, v104
    ds_read_b64_tr_b16 a[32:33], v92 offset:0
    ds_read_b64_tr_b16 a[34:35], v92 offset:1536
    ds_read_b64_tr_b16 a[36:37], v92 offset:12288
    ds_read_b64_tr_b16 a[38:39], v92 offset:13824
    v_add_u32 v92, 98304, v105
    ds_read_b64_tr_b16 a[112:113], v92 offset:0
    ds_read_b64_tr_b16 a[114:115], v92 offset:1536
    ds_read_b64_tr_b16 a[116:117], v92 offset:12288
    ds_read_b64_tr_b16 a[118:119], v92 offset:13824
    v_add_u32 v92, 98304, v106
    ds_read_b64_tr_b16 a[192:193], v92 offset:0
    ds_read_b64_tr_b16 a[194:195], v92 offset:1536
    ds_read_b64_tr_b16 a[196:197], v92 offset:12288
    ds_read_b64_tr_b16 a[198:199], v92 offset:13824
    s_waitcnt lgkmcnt(0)
    s_barrier
    s_mul_i32 s20, s13, 384
    s_add_u32 s20, s20, 7077888
    s_mul_i32 s21, s16, 6144
    s_add_u32 s21, s21, 98304
    s_mov_b32 m0, s21
    s_add_u32 s21, s21, 1024
    buffer_load_dwordx4 v108, s[8:11], s20 offen lds
    s_mov_b32 m0, s21
    s_add_u32 s21, s21, 1024
    buffer_load_dwordx4 v109, s[8:11], s20 offen lds
    s_mov_b32 m0, s21
    s_add_u32 s21, s21, 1024
    buffer_load_dwordx4 v110, s[8:11], s20 offen lds
    s_mov_b32 m0, s21
    s_add_u32 s21, s21, 1024
    buffer_load_dwordx4 v111, s[8:11], s20 offen lds
    s_mov_b32 m0, s21
    s_add_u32 s21, s21, 1024
    buffer_load_dwordx4 v112, s[8:11], s20 offen lds
    s_mov_b32 m0, s21
    s_add_u32 s21, s21, 1024
    buffer_load_dwordx4 v113, s[8:11], s20 offen lds
    s_waitcnt vmcnt(24)
    s_barrier
    v_add_u32 v92, 0, v104
    ds_read_b64_tr_b16 a[40:41], v92 offset:0
    ds_read_b64_tr_b16 a[42:43], v92 offset:1536
    ds_read_b64_tr_b16 a[44:45], v92 offset:12288
    ds_read_b64_tr_b16 a[46:47], v92 offset:13824
    v_add_u32 v92, 0, v105
    ds_read_b64_tr_b16 a[120:121], v92 offset:0
    ds_read_b64_tr_b16 a[122:123], v92 offset:1536
    ds_read_b64_tr_b16 a[124:125], v92 offset:12288
    ds_read_b64_tr_b16 a[126:127], v92 offset:13824
    v_add_u32 v92, 0, v106
    ds_read_b64_tr_b16 a[200:201], v92 offset:0
    ds_read_b64_tr_b16 a[202:203], v92 offset:1536
    ds_read_b64_tr_b16 a[204:205], v92 offset:12288
    ds_read_b64_tr_b16 a[206:207], v92 offset:13824
    s_waitcnt lgkmcnt(0)
    s_waitcnt vmcnt(18)
    s_barrier
    v_add_u32 v92, 24576, v104
    ds_read_b64_tr_b16 a[48:49], v92 offset:0
    ds_read_b64_tr_b16 a[50:51], v92 offset:1536
    ds_read_b64_tr_b16 a[52:53], v92 offset:12288
    ds_read_b64_tr_b16 a[54:55], v92 offset:13824
    v_add_u32 v92, 24576, v105
    ds_read_b64_tr_b16 a[128:129], v92 offset:0
    ds_read_b64_tr_b16 a[130:131], v92 offset:1536
    ds_read_b64_tr_b16 a[132:133], v92 offset:12288
    ds_read_b64_tr_b16 a[134:135], v92 offset:13824
    v_add_u32 v92, 24576, v106
    ds_read_b64_tr_b16 a[208:209], v92 offset:0
    ds_read_b64_tr_b16 a[210:211], v92 offset:1536
    ds_read_b64_tr_b16 a[212:213], v92 offset:12288
    ds_read_b64_tr_b16 a[214:215], v92 offset:13824
    s_waitcnt lgkmcnt(0)
    s_waitcnt vmcnt(12)
    s_barrier
    v_add_u32 v92, 49152, v104
    ds_read_b64_tr_b16 a[56:57], v92 offset:0
    ds_read_b64_tr_b16 a[58:59], v92 offset:1536
    ds_read_b64_tr_b16 a[60:61], v92 offset:12288
    ds_read_b64_tr_b16 a[62:63], v92 offset:13824
    v_add_u32 v92, 49152, v105
    ds_read_b64_tr_b16 a[136:137], v92 offset:0
    ds_read_b64_tr_b16 a[138:139], v92 offset:1536
    ds_read_b64_tr_b16 a[140:141], v92 offset:12288
    ds_read_b64_tr_b16 a[142:143], v92 offset:13824
    v_add_u32 v92, 49152, v106
    ds_read_b64_tr_b16 a[216:217], v92 offset:0
    ds_read_b64_tr_b16 a[218:219], v92 offset:1536
    ds_read_b64_tr_b16 a[220:221], v92 offset:12288
    ds_read_b64_tr_b16 a[222:223], v92 offset:13824
    s_waitcnt lgkmcnt(0)
    s_waitcnt vmcnt(6)
    s_barrier
    v_add_u32 v92, 73728, v104
    ds_read_b64_tr_b16 a[64:65], v92 offset:0
    ds_read_b64_tr_b16 a[66:67], v92 offset:1536
    ds_read_b64_tr_b16 a[68:69], v92 offset:12288
    ds_read_b64_tr_b16 a[70:71], v92 offset:13824
    v_add_u32 v92, 73728, v105
    ds_read_b64_tr_b16 a[144:145], v92 offset:0
    ds_read_b64_tr_b16 a[146:147], v92 offset:1536
    ds_read_b64_tr_b16 a[148:149], v92 offset:12288
    ds_read_b64_tr_b16 a[150:151], v92 offset:13824
    v_add_u32 v92, 73728, v106
    ds_read_b64_tr_b16 a[224:225], v92 offset:0
    ds_read_b64_tr_b16 a[226:227], v92 offset:1536
    ds_read_b64_tr_b16 a[228:229], v92 offset:12288
    ds_read_b64_tr_b16 a[230:231], v92 offset:13824
    s_waitcnt lgkmcnt(0)
    s_waitcnt vmcnt(0)
    s_barrier
    v_add_u32 v92, 98304, v104
    ds_read_b64_tr_b16 a[72:73], v92 offset:0
    ds_read_b64_tr_b16 a[74:75], v92 offset:1536
    ds_read_b64_tr_b16 a[76:77], v92 offset:12288
    ds_read_b64_tr_b16 a[78:79], v92 offset:13824
    v_add_u32 v92, 98304, v105
    ds_read_b64_tr_b16 a[152:153], v92 offset:0
    ds_read_b64_tr_b16 a[154:155], v92 offset:1536
    ds_read_b64_tr_b16 a[156:157], v92 offset:12288
    ds_read_b64_tr_b16 a[158:159], v92 offset:13824
    v_add_u32 v92, 98304, v106
    ds_read_b64_tr_b16 a[232:233], v92 offset:0
    ds_read_b64_tr_b16 a[234:235], v92 offset:1536
    ds_read_b64_tr_b16 a[236:237], v92 offset:12288
    ds_read_b64_tr_b16 a[238:239], v92 offset:13824
    s_waitcnt lgkmcnt(0)
    s_barrier
    s_cmp_eq_u32 s16, 0
    s_cbranch_scc0 Lz_413
    v_mov_b32 v250, 200
    s_mov_b32 s24, 0
Lz_411:
    global_load_dword v251, v250, s[90:91] sc1
    s_waitcnt vmcnt(0)
    v_readfirstlane_b32 s20, v251
    s_nop 3
    s_cmp_ge_u32 s20, 256
    s_cbranch_scc1 Lz_412
    s_sleep 4
    s_add_u32 s24, s24, 1
    s_cmp_lt_u32 s24, 400000
    s_cbranch_scc1 Lz_411
    s_branch L_abort
Lz_412:
Lz_413:
    s_barrier
    s_load_dwordx2 s[8:9], s[96:97], 24
    s_mov_b32 s10, 2621440
    s_mov_b32 s11, 0x00020000
    s_waitcnt lgkmcnt(0)
    s_cmp_eq_u32 s12, 0
    s_mov_b32 s21, 25165824
    s_cselect_b32 s20, 0, s21
    s_cmp_eq_u32 s12, 2
    s_mov_b32 s21, 50331648
    s_cselect_b32 s20, s21, s20
    s_mul_i32 s21, s13, 12288
    s_add_u32 s20, s20, s21
    s_mul_i32 s21, s16, 3072
    s_add_u32 s18, s20, s21
    s_lshl_b32 s20, s13, 6
    s_lshl_b32 s21, s12, 4
    s_add_u32 s20, s20, s21
    s_lshl_b32 s21, s16, 2
    s_add_u32 s20, s20, s21
    s_add_u32 s19, s20, 125829120
    s_cmp_eq_u32 s12, 1
    s_cbranch_scc1 Lq_414
    s_mul_i32 s23, s16, 10240
    s_add_u32 s26, s23, 0
    s_mov_b32 s44, 0
    s_add_u32 m0, s26, 0
    s_nop 0
    buffer_load_dwordx4 v2, s[8:11], s44 offen lds
    s_add_u32 m0, s26, 1024
    s_nop 0
    buffer_load_dwordx4 v3, s[8:11], s44 offen lds
    s_add_u32 m0, s26, 2048
    s_nop 0
    buffer_load_dwordx4 v4, s[8:11], s44 offen lds
    s_add_u32 m0, s26, 3072
    s_nop 0
    buffer_load_dwordx4 v5, s[8:11], s44 offen lds
    s_add_u32 m0, s26, 4096
    s_nop 0
    buffer_load_dwordx4 v6, s[8:11], s44 offen lds
    s_add_u32 m0, s26, 5120
    s_nop 0
    buffer_load_dwordx4 v7, s[8:11], s44 offen lds
    s_add_u32 m0, s26, 6144
    s_nop 0
    buffer_load_dwordx4 v8, s[8:11], s44 offen lds
    s_add_u32 m0, s26, 7168
    s_nop 0
    buffer_load_dwordx4 v9, s[8:11], s44 offen lds
    s_add_u32 m0, s26, 8192
    s_nop 0
    buffer_load_dwordx4 v10, s[8:11], s44 offen lds
    s_add_u32 m0, s26, 9216
    s_nop 0
    buffer_load_dwordx4 v11, s[8:11], s44 offen lds
    s_add_u32 s26, s23, 40960
    s_mov_b32 s44, 40960
    s_add_u32 m0, s26, 0
    s_nop 0
    buffer_load_dwordx4 v2, s[8:11], s44 offen lds
    s_add_u32 m0, s26, 1024
    s_nop 0
    buffer_load_dwordx4 v3, s[8:11], s44 offen lds
    s_add_u32 m0, s26, 2048
    s_nop 0
    buffer_load_dwordx4 v4, s[8:11], s44 offen lds
    s_add_u32 m0, s26, 3072
    s_nop 0
    buffer_load_dwordx4 v5, s[8:11], s44 offen lds
    s_add_u32 m0, s26, 4096
    s_nop 0
    buffer_load_dwordx4 v6, s[8:11], s44 offen lds
    s_add_u32 m0, s26, 5120
    s_nop 0
    buffer_load_dwordx4 v7, s[8:11], s44 offen lds
    s_add_u32 m0, s26, 6144
    s_nop 0
    buffer_load_dwordx4 v8, s[8:11], s44 offen lds
    s_add_u32 m0, s26, 7168
    s_nop 0
    buffer_load_dwordx4 v9, s[8:11], s44 offen lds
    s_add_u32 m0, s26, 8192
    s_nop 0
    buffer_load_dwordx4 v10, s[8:11], s44 offen lds
    s_add_u32 m0, s26, 9216
    s_nop 0
    buffer_load_dwordx4 v11, s[8:11], s44 offen lds
    s_mov_b32 s17, 0
    s_mov_b32 s27, 0
    s_waitcnt vmcnt(10)
L_qkv_loop_K:
    s_barrier
    s_mul_i32 s28, s27, 40960
    v_add_u32 v12, s28, v16
    v_add_u32 v13, s28, v17
    v_add_u32 v14, s28, v18
    v_add_u32 v15, s28, v19
    s_add_u32 s20, s27, 2
    s_cmp_ge_u32 s20, 3
    s_cbranch_scc0 LqK0a
    s_sub_u32 s20, s20, 3
LqK0a:
    s_mul_i32 s26, s20, 40960
    s_add_u32 s26, s26, s23
    s_add_u32 s20, s17, 2
    s_min_u32 s20, s20, 63
    s_mul_i32 s44, s20, 40960
    s_sub_u32 s20, s17, 1
    s_mul_i32 s45, s20, 393216
    s_add_u32 s45, s45, s18
    s_cmp_eq_u32 s17, 0
    s_cselect_b32 s45, 0xf0000000, s45
    s_add_u32 s27, s27, 1
    s_cmp_eq_u32 s27, 3
    s_cselect_b32 s27, 0, s27
    s_cmp_lt_u32 s17, 2
    s_cbranch_scc1 Lq_416
    s_sub_u32 s20, s17, 1
    v_mov_b32 v104, s20
    v_mov_b32 v105, 0
    s_mov_b64 exec, 1
    buffer_store_dword v104, v105, s[4:7], s19 offen sc1
    s_mov_b64 exec, -1
Lq_416:
    ds_read_b128 v[20:23], v12 offset:0
    ds_read_b128 v[24:27], v12 offset:20480
    ds_read_b128 v[28:31], v13 offset:0
    ds_read_b128 v[32:35], v13 offset:20480
    s_waitcnt lgkmcnt(2)
    v_mfma_f32_16x16x32_bf16 v[44:47], a[0:3], v[20:23], 0
    ds_read_b128 v[36:39], v14 offset:0
    v_mfma_f32_16x16x32_bf16 v[48:51], a[80:83], v[20:23], 0
    v_mfma_f32_16x16x32_bf16 v[52:55], a[160:163], v[20:23], 0
    v_mfma_f32_16x16x32_bf16 v[56:59], a[0:3], v[24:27], 0
    ds_read_b128 v[40:43], v14 offset:20480
    v_mfma_f32_16x16x32_bf16 v[60:63], a[80:83], v[24:27], 0
    v_mfma_f32_16x16x32_bf16 v[64:67], a[160:163], v[24:27], 0
    s_waitcnt lgkmcnt(2)
    v_mfma_f32_16x16x32_bf16 v[44:47], a[4:7], v[28:31], v[44:47]
    ds_read_b128 v[20:23], v15 offset:0
    v_mfma_f32_16x16x32_bf16 v[48:51], a[84:87], v[28:31], v[48:51]
    v_mfma_f32_16x16x32_bf16 v[52:55], a[164:167], v[28:31], v[52:55]
    v_mfma_f32_16x16x32_bf16 v[56:59], a[4:7], v[32:35], v[56:59]
    ds_read_b128 v[24:27], v15 offset:20480
    v_mfma_f32_16x16x32_bf16 v[60:63], a[84:87], v[32:35], v[60:63]
    v_mfma_f32_16x16x32_bf16 v[64:67], a[164:167], v[32:35], v[64:67]
    s_waitcnt lgkmcnt(2)
    v_mfma_f32_16x16x32_bf16 v[44:47], a[8:11], v[36:39], v[44:47]
    ds_read_b128 v[28:31], v12 offset:256
    v_mfma_f32_16x16x32_bf16 v[48:51], a[88:91], v[36:39], v[48:51]
    v_cvt_pk_bf16_f32 v92, v68, v69
    v_mfma_f32_16x16x32_bf16 v[52:55], a[168:171], v[36:39], v[52:55]
    v_cvt_pk_bf16_f32 v93, v70, v71
    v_mfma_f32_16x16x32_bf16 v[56:59], a[8:11], v[40:43], v[56:59]
    ds_read_b128 v[32:35], v12 offset:20736
    v_mfma_f32_16x16x32_bf16 v[60:63], a[88:91], v[40:43], v[60:63]
    v_cvt_pk_bf16_f32 v94, v72, v73
    v_mfma_f32_16x16x32_bf16 v[64:67], a[168:171], v[40:43], v[64:67]
    v_cvt_pk_bf16_f32 v95, v74, v75
    s_waitcnt lgkmcnt(2)
    v_mfma_f32_16x16x32_bf16 v[44:47], a[12:15], v[20:23], v[44:47]
    ds_read_b128 v[36:39], v13 offset:256
    v_mfma_f32_16x16x32_bf16 v[48:51], a[92:95], v[20:23], v[48:51]
    buffer_store_dwordx4 v[92:95], v1, s[4:7], s45 offen offset:0 sc1
    v_mfma_f32_16x16x32_bf16 v[52:55], a[172:175], v[20:23], v[52:55]
    v_cvt_pk_bf16_f32 v96, v80, v81
    v_mfma_f32_16x16x32_bf16 v[56:59], a[12:15], v[24:27], v[56:59]
    ds_read_b128 v[40:43], v13 offset:20736
    v_mfma_f32_16x16x32_bf16 v[60:63], a[92:95], v[24:27], v[60:63]
    v_cvt_pk_bf16_f32 v97, v82, v83
    v_mfma_f32_16x16x32_bf16 v[64:67], a[172:175], v[24:27], v[64:67]
    v_cvt_pk_bf16_f32 v98, v84, v85
    s_waitcnt lgkmcnt(2)
    v_mfma_f32_16x16x32_bf16 v[44:47], a[16:19], v[28:31], v[44:47]
    ds_read_b128 v[20:23], v14 offset:256
    v_mfma_f32_16x16x32_bf16 v[48:51], a[96:99], v[28:31], v[48:51]
    v_cvt_pk_bf16_f32 v99, v86, v87
    v_mfma_f32_16x16x32_bf16 v[52:55], a[176:179], v[28:31], v[52:55]
    buffer_store_dwordx4 v[96:99], v1, s[4:7], s45 offen offset:1024 sc1
    v_mfma_f32_16x16x32_bf16 v[56:59], a[16:19], v[32:35], v[56:59]
    ds_read_b128 v[24:27], v14 offset:20736
    v_mfma_f32_16x16x32_bf16 v[60:63], a[96:99], v[32:35], v[60:63]
    v_cvt_pk_bf16_f32 v100, v76, v77
    v_mfma_f32_16x16x32_bf16 v[64:67], a[176:179], v[32:35], v[64:67]
    v_cvt_pk_bf16_f32 v101, v78, v79
    s_waitcnt lgkmcnt(2)
    v_mfma_f32_16x16x32_bf16 v[44:47], a[20:23], v[36:39], v[44:47]
    ds_read_b128 v[28:31], v15 offset:256
    v_mfma_f32_16x16x32_bf16 v[48:51], a[100:103], v[36:39], v[48:51]
    v_cvt_pk_bf16_f32 v102, v88, v89
    v_mfma_f32_16x16x32_bf16 v[52:55], a[180:183], v[36:39], v[52:55]
    v_cvt_pk_bf16_f32 v103, v90, v91
    v_mfma_f32_16x16x32_bf16 v[56:59], a[20:23], v[40:43], v[56:59]
    ds_read_b128 v[32:35], v15 offset:20736
    v_mfma_f32_16x16x32_bf16 v[60:63], a[100:103], v[40:43], v[60:63]
    s_nop 1
    v_mfma_f32_16x16x32_bf16 v[64:67], a[180:183], v[40:43], v[64:67]
    v_permlane16_swap_b32 v100, v102
    s_waitcnt lgkmcnt(2)
    v_mfma_f32_16x16x32_bf16 v[44:47], a[24:27], v[20:23], v[44:47]
    ds_read_b128 v[36:39], v12 offset:512
    v_mfma_f32_16x16x32_bf16 v[48:51], a[104:107], v[20:23], v[48:51]
    v_permlane16_swap_b32 v101, v103
    v_mfma_f32_16x16x32_bf16 v[52:55], a[184:187], v[20:23], v[52:55]
    buffer_store_dwordx4 v[100:103], v1, s[4:7], s45 offen offset:2048 sc1
    v_mfma_f32_16x16x32_bf16 v[56:59], a[24:27], v[24:27], v[56:59]
    ds_read_b128 v[40:43], v12 offset:20992
    v_mfma_f32_16x16x32_bf16 v[60:63], a[104:107], v[24:27], v[60:63]
    v_mfma_f32_16x16x32_bf16 v[64:67], a[184:187], v[24:27], v[64:67]
    s_waitcnt lgkmcnt(2)
    v_mfma_f32_16x16x32_bf16 v[44:47], a[28:31], v[28:31], v[44:47]
    ds_read_b128 v[20:23], v13 offset:512
    v_mfma_f32_16x16x32_bf16 v[48:51], a[108:111], v[28:31], v[48:51]
    v_mfma_f32_16x16x32_bf16 v[52:55], a[188:191], v[28:31], v[52:55]
    v_mfma_f32_16x16x32_bf16 v[56:59], a[28:31], v[32:35], v[56:59]
    ds_read_b128 v[24:27], v13 offset:20992
    v_mfma_f32_16x16x32_bf16 v[60:63], a[108:111], v[32:35], v[60:63]
    v_mfma_f32_16x16x32_bf16 v[64:67], a[188:191], v[32:35], v[64:67]
    s_waitcnt lgkmcnt(2)
    v_mfma_f32_16x16x32_bf16 v[44:47], a[32:35], v[36:39], v[44:47]
    ds_read_b128 v[28:31], v14 offset:512
    v_mfma_f32_16x16x32_bf16 v[48:51], a[112:115], v[36:39], v[48:51]
    v_mfma_f32_16x16x32_bf16 v[52:55], a[192:195], v[36:39], v[52:55]
    s_add_u32 m0, s26, 0
    s_nop 0
    buffer_load_dwordx4 v2, s[8:11], s44 offen lds
    v_mfma_f32_16x16x32_bf16 v[56:59], a[32:35], v[40:43], v[56:59]
    ds_read_b128 v[32:35], v14 offset:20992
    v_mfma_f32_16x16x32_bf16 v[60:63], a[112:115], v[40:43], v[60:63]
    v_mfma_f32_16x16x32_bf16 v[64:67], a[192:195], v[40:43], v[64:67]
    s_waitcnt lgkmcnt(2)
    v_mfma_f32_16x16x32_bf16 v[44:47], a[36:39], v[20:23], v[44:47]
    ds_read_b128 v[36:39], v15 offset:512
    v_mfma_f32_16x16x32_bf16 v[48:51], a[116:119], v[20:23], v[48:51]
    v_mfma_f32_16x16x32_bf16 v[52:55], a[196:199], v[20:23], v[52:55]
    s_add_u32 m0, s26, 1024
    s_nop 0
    buffer_load_dwordx4 v3, s[8:11], s44 offen lds
    v_mfma_f32_16x16x32_bf16 v[56:59], a[36:39], v[24:27], v[56:59]
    ds_read_b128 v[40:43], v15 offset:20992
    v_mfma_f32_16x16x32_bf16 v[60:63], a[116:119], v[24:27], v[60:63]
    v_mfma_f32_16x16x32_bf16 v[64:67], a[196:199], v[24:27], v[64:67]
    s_waitcnt lgkmcnt(2)
    v_mfma_f32_16x16x32_bf16 v[44:47], a[40:43], v[28:31], v[44:47]
    ds_read_b128 v[20:23], v12 offset:768
    v_mfma_f32_16x16x32_bf16 v[48:51], a[120:123], v[28:31], v[48:51]
    v_mfma_f32_16x16x32_bf16 v[52:55], a[200:203], v[28:31], v[52:55]
    s_add_u32 m0, s26, 2048
    s_nop 0
    buffer_load_dwordx4 v4, s[8:11], s44 offen lds
    v_mfma_f32_16x16x32_bf16 v[56:59], a[40:43], v[32:35], v[56:59]
    ds_read_b128 v[24:27], v12 offset:21248
    v_mfma_f32_16x16x32_bf16 v[60:63], a[120:123], v[32:35], v[60:63]
    v_mfma_f32_16x16x32_bf16 v[64:67], a[200:203], v[32:35], v[64:67]
    s_waitcnt lgkmcnt(2)
    v_mfma_f32_16x16x32_bf16 v[44:47], a[44:47], v[36:39], v[44:47]
    ds_read_b128 v[28:31], v13 offset:768
    v_mfma_f32_16x16x32_bf16 v[48:51], a[124:127], v[36:39], v[48:51]
    v_mfma_f32_16x16x32_bf16 v[52:55], a[204:207], v[36:39], v[52:55]
    s_add_u32 m0, s26, 3072
    s_nop 0
    buffer_load_dwordx4 v5, s[8:11], s44 offen lds
    v_mfma_f32_16x16x32_bf16 v[56:59], a[44:47], v[40:43], v[56:59]
    ds_read_b128 v[32:35], v13 offset:21248
    v_mfma_f32_16x16x32_bf16 v[60:63], a[124:127], v[40:43], v[60:63]
    v_mfma_f32_16x16x32_bf16 v[64:67], a[204:207], v[40:43], v[64:67]
    s_waitcnt lgkmcnt(2)
    v_mfma_f32_16x16x32_bf16 v[44:47], a[48:51], v[20:23], v[44:47]
    ds_read_b128 v[36:39], v14 offset:768
    v_mfma_f32_16x16x32_bf16 v[48:51], a[128:131], v[20:23], v[48:51]
    v_mfma_f32_16x16x32_bf16 v[52:55], a[208:211], v[20:23], v[52:55]
    s_add_u32 m0, s26, 4096
    s_nop 0
    buffer_load_dwordx4 v6, s[8:11], s44 offen lds
    v_mfma_f32_16x16x32_bf16 v[56:59], a[48:51], v[24:27], v[56:59]
    ds_read_b128 v[40:43], v14 offset:21248
    v_mfma_f32_16x16x32_bf16 v[60:63], a[128:131], v[24:27], v[60:63]
    v_mfma_f32_16x16x32_bf16 v[64:67], a[208:211], v[24:27], v[64:67]
    s_waitcnt lgkmcnt(2)
    v_mfma_f32_16x16x32_bf16 v[44:47], a[52:55], v[28:31], v[44:47]
    ds_read_b128 v[20:23], v15 offset:768
    v_mfma_f32_16x16x32_bf16 v[48:51], a[132:135], v[28:31], v[48:51]
    v_mfma_f32_16x16x32_bf16 v[52:55], a[212:215], v[28:31], v[52:55]
    s_add_u32 m0, s26, 5120
    s_nop 0
    buffer_load_dwordx4 v7, s[8:11], s44 offen lds
    v_mfma_f32_16x16x32_bf16 v[56:59], a[52:55], v[32:35], v[56:59]
    ds_read_b128 v[24:27], v15 offset:21248
    v_mfma_f32_16x16x32_bf16 v[60:63], a[132:135], v[32:35], v[60:63]
    v_mfma_f32_16x16x32_bf16 v[64:67], a[212:215], v[32:35], v[64:67]
    s_waitcnt lgkmcnt(2)
    v_mfma_f32_16x16x32_bf16 v[44:47], a[56:59], v[36:39], v[44:47]
    ds_read_b128 v[28:31], v12 offset:1024
    v_mfma_f32_16x16x32_bf16 v[48:51], a[136:139], v[36:39], v[48:51]
    v_mfma_f32_16x16x32_bf16 v[52:55], a[216:219], v[36:39], v[52:55]
    s_add_u32 m0, s26, 6144
    s_nop 0
    buffer_load_dwordx4 v8, s[8:11], s44 offen lds
    v_mfma_f32_16x16x32_bf16 v[56:59], a[56:59], v[40:43], v[56:59]
    ds_read_b128 v[32:35], v12 offset:21504
    v_mfma_f32_16x16x32_bf16 v[60:63], a[136:139], v[40:43], v[60:63]
    v_mfma_f32_16x16x32_bf16 v[64:67], a[216:219], v[40:43], v[64:67]
    s_waitcnt lgkmcnt(2)
    v_mfma_f32_16x16x32_bf16 v[44:47], a[60:63], v[20:23], v[44:47]
    ds_read_b128 v[36:39], v13 offset:1024
    v_mfma_f32_16x16x32_bf16 v[48:51], a[140:143], v[20:23], v[48:51]
    v_mfma_f32_16x16x32_bf16 v[52:55], a[220:223], v[20:23], v[52:55]
    s_add_u32 m0, s26, 7168
    s_nop 0
    buffer_load_dwordx4 v9, s[8:11], s44 offen lds
    v_mfma_f32_16x16x32_bf16 v[56:59], a[60:63], v[24:27], v[56:59]
    ds_read_b128 v[40:43], v13 offset:21504
    v_mfma_f32_16x16x32_bf16 v[60:63], a[140:143], v[24:27], v[60:63]
    v_mfma_f32_16x16x32_bf16 v[64:67], a[220:223], v[24:27], v[64:67]
    s_waitcnt lgkmcnt(2)
    v_mfma_f32_16x16x32_bf16 v[44:47], a[64:67], v[28:31], v[44:47]
    ds_read_b128 v[20:23], v14 offset:1024
    v_mfma_f32_16x16x32_bf16 v[48:51], a[144:147], v[28:31], v[48:51]
    v_mfma_f32_16x16x32_bf16 v[52:55], a[224:227], v[28:31], v[52:55]
    s_add_u32 m0, s26, 8192
    s_nop 0
    buffer_load_dwordx4 v10, s[8:11], s44 offen lds
    v_mfma_f32_16x16x32_bf16 v[56:59], a[64:67], v[32:35], v[56:59]
    ds_read_b128 v[24:27], v14 offset:21504
    v_mfma_f32_16x16x32_bf16 v[60:63], a[144:147], v[32:35], v[60:63]
    v_mfma_f32_16x16x32_bf16 v[64:67], a[224:227], v[32:35], v[64:67]
    s_waitcnt lgkmcnt(2)
    v_mfma_f32_16x16x32_bf16 v[44:47], a[68:71], v[36:39], v[44:47]
    ds_read_b128 v[28:31], v15 offset:1024
    v_mfma_f32_16x16x32_bf16 v[48:51], a[148:151], v[36:39], v[48:51]
    v_mfma_f32_16x16x32_bf16 v[52:55], a[228:231], v[36:39], v[52:55]
    s_add_u32 m0, s26, 9216
    s_nop 0
    buffer_load_dwordx4 v11, s[8:11], s44 offen lds
    v_mfma_f32_16x16x32_bf16 v[56:59], a[68:71], v[40:43], v[56:59]
    ds_read_b128 v[32:35], v15 offset:21504
    v_mfma_f32_16x16x32_bf16 v[60:63], a[148:151], v[40:43], v[60:63]
    v_mfma_f32_16x16x32_bf16 v[64:67], a[228:231], v[40:43], v[64:67]
    s_waitcnt lgkmcnt(2)
    v_mfma_f32_16x16x32_bf16 v[44:47], a[72:75], v[20:23], v[44:47]
    v_mfma_f32_16x16x32_bf16 v[48:51], a[152:155], v[20:23], v[48:51]
    v_mfma_f32_16x16x32_bf16 v[52:55], a[232:235], v[20:23], v[52:55]
    v_mfma_f32_16x16x32_bf16 v[56:59], a[72:75], v[24:27], v[56:59]
    v_mfma_f32_16x16x32_bf16 v[60:63], a[152:155], v[24:27], v[60:63]
    v_mfma_f32_16x16x32_bf16 v[64:67], a[232:235], v[24:27], v[64:67]
    s_waitcnt lgkmcnt(0)
    v_mfma_f32_16x16x32_bf16 v[44:47], a[76:79], v[28:31], v[44:47]
    v_mfma_f32_16x16x32_bf16 v[48:51], a[156:159], v[28:31], v[48:51]
    v_mfma_f32_16x16x32_bf16 v[52:55], a[236:239], v[28:31], v[52:55]
    v_mfma_f32_16x16x32_bf16 v[56:59], a[76:79], v[32:35], v[56:59]
    v_mfma_f32_16x16x32_bf16 v[60:63], a[156:159], v[32:35], v[60:63]
    v_mfma_f32_16x16x32_bf16 v[64:67], a[236:239], v[32:35], v[64:67]
    s_add_u32 s17, s17, 1
    s_waitcnt vmcnt(10)
    s_barrier
    s_mul_i32 s28, s27, 40960
    v_add_u32 v12, s28, v16
    v_add_u32 v13, s28, v17
    v_add_u32 v14, s28, v18
    v_add_u32 v15, s28, v19
    s_add_u32 s20, s27, 2
    s_cmp_ge_u32 s20, 3
    s_cbranch_scc0 LqK1a
    s_sub_u32 s20, s20, 3
LqK1a:
    s_mul_i32 s26, s20, 40960
    s_add_u32 s26, s26, s23
    s_add_u32 s20, s17, 2
    s_min_u32 s20, s20, 63
    s_mul_i32 s44, s20, 40960
    s_sub_u32 s20, s17, 1
    s_mul_i32 s45, s20, 393216
    s_add_u32 s45, s45, s18
    s_cmp_eq_u32 s17, 0
    s_cselect_b32 s45, 0xf0000000, s45
    s_add_u32 s27, s27, 1
    s_cmp_eq_u32 s27, 3
    s_cselect_b32 s27, 0, s27
    s_cmp_lt_u32 s17, 2
    s_cbranch_scc1 Lq_417
    s_sub_u32 s20, s17, 1
    v_mov_b32 v104, s20
    v_mov_b32 v105, 0
    s_mov_b64 exec, 1
    buffer_store_dword v104, v105, s[4:7], s19 offen sc1
    s_mov_b64 exec, -1
Lq_417:
    ds_read_b128 v[20:23], v12 offset:0
    ds_read_b128 v[24:27], v12 offset:20480
    ds_read_b128 v[28:31], v13 offset:0
    ds_read_b128 v[32:35], v13 offset:20480
    s_waitcnt lgkmcnt(2)
    v_mfma_f32_16x16x32_bf16 v[68:71], a[0:3], v[20:23], 0
    ds_read_b128 v[36:39], v14 offset:0
    v_mfma_f32_16x16x32_bf16 v[72:75], a[80:83], v[20:23], 0
    v_mfma_f32_16x16x32_bf16 v[76:79], a[160:163], v[20:23], 0
    v_mfma_f32_16x16x32_bf16 v[80:83], a[0:3], v[24:27], 0
    ds_read_b128 v[40:43], v14 offset:20480
    v_mfma_f32_16x16x32_bf16 v[84:87], a[80:83], v[24:27], 0
    v_mfma_f32_16x16x32_bf16 v[88:91], a[160:163], v[24:27], 0
    s_waitcnt lgkmcnt(2)
    v_mfma_f32_16x16x32_bf16 v[68:71], a[4:7], v[28:31], v[68:71]
    ds_read_b128 v[20:23], v15 offset:0
    v_mfma_f32_16x16x32_bf16 v[72:75], a[84:87], v[28:31], v[72:75]
    v_mfma_f32_16x16x32_bf16 v[76:79], a[164:167], v[28:31], v[76:79]
    v_mfma_f32_16x16x32_bf16 v[80:83], a[4:7], v[32:35], v[80:83]
    ds_read_b128 v[24:27], v15 offset:20480
    v_mfma_f32_16x16x32_bf16 v[84:87], a[84:87], v[32:35], v[84:87]
    v_mfma_f32_16x16x32_bf16 v[88:91], a[164:167], v[32:35], v[88:91]
    s_waitcnt lgkmcnt(2)
    v_mfma_f32_16x16x32_bf16 v[68:71], a[8:11], v[36:39], v[68:71]
    ds_read_b128 v[28:31], v12 offset:256
    v_mfma_f32_16x16x32_bf16 v[72:75], a[88:91], v[36:39], v[72:75]
    v_cvt_pk_bf16_f32 v92, v44, v45
    v_mfma_f32_16x16x32_bf16 v[76:79], a[168:171], v[36:39], v[76:79]
    v_cvt_pk_bf16_f32 v93, v46, v47
    v_mfma_f32_16x16x32_bf16 v[80:83], a[8:11], v[40:43], v[80:83]
    ds_read_b128 v[32:35], v12 offset:20736
    v_mfma_f32_16x16x32_bf16 v[84:87], a[88:91], v[40:43], v[84:87]
    v_cvt_pk_bf16_f32 v94, v48, v49
    v_mfma_f32_16x16x32_bf16 v[88:91], a[168:171], v[40:43], v[88:91]
    v_cvt_pk_bf16_f32 v95, v50, v51
    s_waitcnt lgkmcnt(2)
    v_mfma_f32_16x16x32_bf16 v[68:71], a[12:15], v[20:23], v[68:71]
    ds_read_b128 v[36:39], v13 offset:256
    v_mfma_f32_16x16x32_bf16 v[72:75], a[92:95], v[20:23], v[72:75]
    buffer_store_dwordx4 v[92:95], v1, s[4:7], s45 offen offset:0 sc1
    v_mfma_f32_16x16x32_bf16 v[76:79], a[172:175], v[20:23], v[76:79]
    v_cvt_pk_bf16_f32 v96, v56, v57
    v_mfma_f32_16x16x32_bf16 v[80:83], a[12:15], v[24:27], v[80:83]
    ds_read_b128 v[40:43], v13 offset:20736
    v_mfma_f32_16x16x32_bf16 v[84:87], a[92:95], v[24:27], v[84:87]
    v_cvt_pk_bf16_f32 v97, v58, v59
    v_mfma_f32_16x16x32_bf16 v[88:91], a[172:175], v[24:27], v[88:91]
    v_cvt_pk_bf16_f32 v98, v60, v61
    s_waitcnt lgkmcnt(2)
    v_mfma_f32_16x16x32_bf16 v[68:71], a[16:19], v[28:31], v[68:71]
    ds_read_b128 v[20:23], v14 offset:256
    v_mfma_f32_16x16x32_bf16 v[72:75], a[96:99], v[28:31], v[72:75]
    v_cvt_pk_bf16_f32 v99, v62, v63
    v_mfma_f32_16x16x32_bf16 v[76:79], a[176:179], v[28:31], v[76:79]
    buffer_store_dwordx4 v[96:99], v1, s[4:7], s45 offen offset:1024 sc1
    v_mfma_f32_16x16x32_bf16 v[80:83], a[16:19], v[32:35], v[80:83]
    ds_read_b128 v[24:27], v14 offset:20736
    v_mfma_f32_16x16x32_bf16 v[84:87], a[96:99], v[32:35], v[84:87]
    v_cvt_pk_bf16_f32 v100, v52, v53
    v_mfma_f32_16x16x32_bf16 v[88:91], a[176:179], v[32:35], v[88:91]
    v_cvt_pk_bf16_f32 v101, v54, v55
    s_waitcnt lgkmcnt(2)
    v_mfma_f32_16x16x32_bf16 v[68:71], a[20:23], v[36:39], v[68:71]
    ds_read_b128 v[28:31], v15 offset:256
    v_mfma_f32_16x16x32_bf16 v[72:75], a[100:103], v[36:39], v[72:75]
    v_cvt_pk_bf16_f32 v102, v64, v65
    v_mfma_f32_16x16x32_bf16 v[76:79], a[180:183], v[36:39], v[76:79]
    v_cvt_pk_bf16_f32 v103, v66, v67
    v_mfma_f32_16x16x32_bf16 v[80:83], a[20:23], v[40:43], v[80:83]
    ds_read_b128 v[32:35], v15 offset:20736
    v_mfma_f32_16x16x32_bf16 v[84:87], a[100:103], v[40:43], v[84:87]
    s_nop 1
    v_mfma_f32_16x16x32_bf16 v[88:91], a[180:183], v[40:43], v[88:91]
    v_permlane16_swap_b32 v100, v102
    s_waitcnt lgkmcnt(2)
    v_mfma_f32_16x16x32_bf16 v[68:71], a[24:27], v[20:23], v[68:71]
    ds_read_b128 v[36:39], v12 offset:512
    v_mfma_f32_16x16x32_bf16 v[72:75], a[104:107], v[20:23], v[72:75]
    v_permlane16_swap_b32 v101, v103
    v_mfma_f32_16x16x32_bf16 v[76:79], a[184:187], v[20:23], v[76:79]
    buffer_store_dwordx4 v[100:103], v1, s[4:7], s45 offen offset:2048 sc1
    v_mfma_f32_16x16x32_bf16 v[80:83], a[24:27], v[24:27], v[80:83]
    ds_read_b128 v[40:43], v12 offset:20992
    v_mfma_f32_16x16x32_bf16 v[84:87], a[104:107], v[24:27], v[84:87]
    v_mfma_f32_16x16x32_bf16 v[88:91], a[184:187], v[24:27], v[88:91]
    s_waitcnt lgkmcnt(2)
    v_mfma_f32_16x16x32_bf16 v[68:71], a[28:31], v[28:31], v[68:71]
    ds_read_b128 v[20:23], v13 offset:512
    v_mfma_f32_16x16x32_bf16 v[72:75], a[108:111], v[28:31], v[72:75]
    v_mfma_f32_16x16x32_bf16 v[76:79], a[188:191], v[28:31], v[76:79]
    v_mfma_f32_16x16x32_bf16 v[80:83], a[28:31], v[32:35], v[80:83]
    ds_read_b128 v[24:27], v13 offset:20992
    v_mfma_f32_16x16x32_bf16 v[84:87], a[108:111], v[32:35], v[84:87]
    v_mfma_f32_16x16x32_bf16 v[88:91], a[188:191], v[32:35], v[88:91]
    s_waitcnt lgkmcnt(2)
    v_mfma_f32_16x16x32_bf16 v[68:71], a[32:35], v[36:39], v[68:71]
    ds_read_b128 v[28:31], v14 offset:512
    v_mfma_f32_16x16x32_bf16 v[72:75], a[112:115], v[36:39], v[72:75]
    v_mfma_f32_16x16x32_bf16 v[76:79], a[192:195], v[36:39], v[76:79]
    s_add_u32 m0, s26, 0
    s_nop 0
    buffer_load_dwordx4 v2, s[8:11], s44 offen lds
    v_mfma_f32_16x16x32_bf16 v[80:83], a[32:35], v[40:43], v[80:83]
    ds_read_b128 v[32:35], v14 offset:20992
    v_mfma_f32_16x16x32_bf16 v[84:87], a[112:115], v[40:43], v[84:87]
    v_mfma_f32_16x16x32_bf16 v[88:91], a[192:195], v[40:43], v[88:91]
    s_waitcnt lgkmcnt(2)
    v_mfma_f32_16x16x32_bf16 v[68:71], a[36:39], v[20:23], v[68:71]
    ds_read_b128 v[36:39], v15 offset:512
    v_mfma_f32_16x16x32_bf16 v[72:75], a[116:119], v[20:23], v[72:75]
    v_mfma_f32_16x16x32_bf16 v[76:79], a[196:199], v[20:23], v[76:79]
    s_add_u32 m0, s26, 1024
    s_nop 0
    buffer_load_dwordx4 v3, s[8:11], s44 offen lds
    v_mfma_f32_16x16x32_bf16 v[80:83], a[36:39], v[24:27], v[80:83]
    ds_read_b128 v[40:43], v15 offset:20992
    v_mfma_f32_16x16x32_bf16 v[84:87], a[116:119], v[24:27], v[84:87]
    v_mfma_f32_16x16x32_bf16 v[88:91], a[196:199], v[24:27], v[88:91]
    s_waitcnt lgkmcnt(2)
    v_mfma_f32_16x16x32_bf16 v[68:71], a[40:43], v[28:31], v[68:71]
    ds_read_b128 v[20:23], v12 offset:768
    v_mfma_f32_16x16x32_bf16 v[72:75], a[120:123], v[28:31], v[72:75]
    v_mfma_f32_16x16x32_bf16 v[76:79], a[200:203], v[28:31], v[76:79]
    s_add_u32 m0, s26, 2048
    s_nop 0
    buffer_load_dwordx4 v4, s[8:11], s44 offen lds
    v_mfma_f32_16x16x32_bf16 v[80:83], a[40:43], v[32:35], v[80:83]
    ds_read_b128 v[24:27], v12 offset:21248
    v_mfma_f32_16x16x32_bf16 v[84:87], a[120:123], v[32:35], v[84:87]
    v_mfma_f32_16x16x32_bf16 v[88:91], a[200:203], v[32:35], v[88:91]
    s_waitcnt lgkmcnt(2)
    v_mfma_f32_16x16x32_bf16 v[68:71], a[44:47], v[36:39], v[68:71]
    ds_read_b128 v[28:31], v13 offset:768
    v_mfma_f32_16x16x32_bf16 v[72:75], a[124:127], v[36:39], v[72:75]
    v_mfma_f32_16x16x32_bf16 v[76:79], a[204:207], v[36:39], v[76:79]
    s_add_u32 m0, s26, 3072
    s_nop 0
    buffer_load_dwordx4 v5, s[8:11], s44 offen lds
    v_mfma_f32_16x16x32_bf16 v[80:83], a[44:47], v[40:43], v[80:83]
    ds_read_b128 v[32:35], v13 offset:21248
    v_mfma_f32_16x16x32_bf16 v[84:87], a[124:127], v[40:43], v[84:87]
    v_mfma_f32_16x16x32_bf16 v[88:91], a[204:207], v[40:43], v[88:91]
    s_waitcnt lgkmcnt(2)
    v_mfma_f32_16x16x32_bf16 v[68:71], a[48:51], v[20:23], v[68:71]
    ds_read_b128 v[36:39], v14 offset:768
    v_mfma_f32_16x16x32_bf16 v[72:75], a[128:131], v[20:23], v[72:75]
    v_mfma_f32_16x16x32_bf16 v[76:79], a[208:211], v[20:23], v[76:79]
    s_add_u32 m0, s26, 4096
    s_nop 0
    buffer_load_dwordx4 v6, s[8:11], s44 offen lds
    v_mfma_f32_16x16x32_bf16 v[80:83], a[48:51], v[24:27], v[80:83]
    ds_read_b128 v[40:43], v14 offset:21248
    v_mfma_f32_16x16x32_bf16 v[84:87], a[128:131], v[24:27], v[84:87]
    v_mfma_f32_16x16x32_bf16 v[88:91], a[208:211], v[24:27], v[88:91]
    s_waitcnt lgkmcnt(2)
    v_mfma_f32_16x16x32_bf16 v[68:71], a[52:55], v[28:31], v[68:71]
    ds_read_b128 v[20:23], v15 offset:768
    v_mfma_f32_16x16x32_bf16 v[72:75], a[132:135], v[28:31], v[72:75]
    v_mfma_f32_16x16x32_bf16 v[76:79], a[212:215], v[28:31], v[76:79]
    s_add_u32 m0, s26, 5120
    s_nop 0
    buffer_load_dwordx4 v7, s[8:11], s44 offen lds
    v_mfma_f32_16x16x32_bf16 v[80:83], a[52:55], v[32:35], v[80:83]
    ds_read_b128 v[24:27], v15 offset:21248
    v_mfma_f32_16x16x32_bf16 v[84:87], a[132:135], v[32:35], v[84:87]
    v_mfma_f32_16x16x32_bf16 v[88:91], a[212:215], v[32:35], v[88:91]
    s_waitcnt lgkmcnt(2)
    v_mfma_f32_16x16x32_bf16 v[68:71], a[56:59], v[36:39], v[68:71]
    ds_read_b128 v[28:31], v12 offset:1024
    v_mfma_f32_16x16x32_bf16 v[72:75], a[136:139], v[36:39], v[72:75]
    v_mfma_f32_16x16x32_bf16 v[76:79], a[216:219], v[36:39], v[76:79]
    s_add_u32 m0, s26, 6144
    s_nop 0
    buffer_load_dwordx4 v8, s[8:11], s44 offen lds
    v_mfma_f32_16x16x32_bf16 v[80:83], a[56:59], v[40:43], v[80:83]
    ds_read_b128 v[32:35], v12 offset:21504
    v_mfma_f32_16x16x32_bf16 v[84:87], a[136:139], v[40:43], v[84:87]
    v_mfma_f32_16x16x32_bf16 v[88:91], a[216:219], v[40:43], v[88:91]
    s_waitcnt lgkmcnt(2)
    v_mfma_f32_16x16x32_bf16 v[68:71], a[60:63], v[20:23], v[68:71]
    ds_read_b128 v[36:39], v13 offset:1024
    v_mfma_f32_16x16x32_bf16 v[72:75], a[140:143], v[20:23], v[72:75]
    v_mfma_f32_16x16x32_bf16 v[76:79], a[220:223], v[20:23], v[76:79]
    s_add_u32 m0, s26, 7168
    s_nop 0
    buffer_load_dwordx4 v9, s[8:11], s44 offen lds
    v_mfma_f32_16x16x32_bf16 v[80:83], a[60:63], v[24:27], v[80:83]
    ds_read_b128 v[40:43], v13 offset:21504
    v_mfma_f32_16x16x32_bf16 v[84:87], a[140:143], v[24:27], v[84:87]
    v_mfma_f32_16x16x32_bf16 v[88:91], a[220:223], v[24:27], v[88:91]
    s_waitcnt lgkmcnt(2)
    v_mfma_f32_16x16x32_bf16 v[68:71], a[64:67], v[28:31], v[68:71]
    ds_read_b128 v[20:23], v14 offset:1024
    v_mfma_f32_16x16x32_bf16 v[72:75], a[144:147], v[28:31], v[72:75]
    v_mfma_f32_16x16x32_bf16 v[76:79], a[224:227], v[28:31], v[76:79]
    s_add_u32 m0, s26, 8192
    s_nop 0
    buffer_load_dwordx4 v10, s[8:11], s44 offen lds
    v_mfma_f32_16x16x32_bf16 v[80:83], a[64:67], v[32:35], v[80:83]
    ds_read_b128 v[24:27], v14 offset:21504
    v_mfma_f32_16x16x32_bf16 v[84:87], a[144:147], v[32:35], v[84:87]
    v_mfma_f32_16x16x32_bf16 v[88:91], a[224:227], v[32:35], v[88:91]
    s_waitcnt lgkmcnt(2)
    v_mfma_f32_16x16x32_bf16 v[68:71], a[68:71], v[36:39], v[68:71]
    ds_read_b128 v[28:31], v15 offset:1024
    v_mfma_f32_16x16x32_bf16 v[72:75], a[148:151], v[36:39], v[72:75]
    v_mfma_f32_16x16x32_bf16 v[76:79], a[228:231], v[36:39], v[76:79]
    s_add_u32 m0, s26, 9216
    s_nop 0
    buffer_load_dwordx4 v11, s[8:11], s44 offen lds
    v_mfma_f32_16x16x32_bf16 v[80:83], a[68:71], v[40:43], v[80:83]
    ds_read_b128 v[32:35], v15 offset:21504
    v_mfma_f32_16x16x32_bf16 v[84:87], a[148:151], v[40:43], v[84:87]
    v_mfma_f32_16x16x32_bf16 v[88:91], a[228:231], v[40:43], v[88:91]
    s_waitcnt lgkmcnt(2)
    v_mfma_f32_16x16x32_bf16 v[68:71], a[72:75], v[20:23], v[68:71]
    v_mfma_f32_16x16x32_bf16 v[72:75], a[152:155], v[20:23], v[72:75]
    v_mfma_f32_16x16x32_bf16 v[76:79], a[232:235], v[20:23], v[76:79]
    v_mfma_f32_16x16x32_bf16 v[80:83], a[72:75], v[24:27], v[80:83]
    v_mfma_f32_16x16x32_bf16 v[84:87], a[152:155], v[24:27], v[84:87]
    v_mfma_f32_16x16x32_bf16 v[88:91], a[232:235], v[24:27], v[88:91]
    s_waitcnt lgkmcnt(0)
    v_mfma_f32_16x16x32_bf16 v[68:71], a[76:79], v[28:31], v[68:71]
    v_mfma_f32_16x16x32_bf16 v[72:75], a[156:159], v[28:31], v[72:75]
    v_mfma_f32_16x16x32_bf16 v[76:79], a[236:239], v[28:31], v[76:79]
    v_mfma_f32_16x16x32_bf16 v[80:83], a[76:79], v[32:35], v[80:83]
    v_mfma_f32_16x16x32_bf16 v[84:87], a[156:159], v[32:35], v[84:87]
    v_mfma_f32_16x16x32_bf16 v[88:91], a[236:239], v[32:35], v[88:91]
    s_add_u32 s17, s17, 1
    s_waitcnt vmcnt(10)
    s_cmp_lt_u32 s17, 64
    s_cbranch_scc1 L_qkv_loop_K
    s_mov_b32 s45, s18
    s_add_u32 s45, s45, 24772608
    s_nop 7
    v_cvt_pk_bf16_f32 v92, v68, v69
    v_cvt_pk_bf16_f32 v93, v70, v71
    v_cvt_pk_bf16_f32 v94, v72, v73
    v_cvt_pk_bf16_f32 v95, v74, v75
    buffer_store_dwordx4 v[92:95], v1, s[4:7], s45 offen offset:0 sc1
    v_cvt_pk_bf16_f32 v96, v80, v81
    v_cvt_pk_bf16_f32 v97, v82, v83
    v_cvt_pk_bf16_f32 v98, v84, v85
    v_cvt_pk_bf16_f32 v99, v86, v87
    buffer_store_dwordx4 v[96:99], v1, s[4:7], s45 offen offset:1024 sc1
    v_cvt_pk_bf16_f32 v100, v76, v77
    v_cvt_pk_bf16_f32 v101, v78, v79
    v_cvt_pk_bf16_f32 v102, v88, v89
    v_cvt_pk_bf16_f32 v103, v90, v91
    s_nop 1
    v_permlane16_swap_b32 v100, v102
    v_permlane16_swap_b32 v101, v103
    buffer_store_dwordx4 v[100:103], v1, s[4:7], s45 offen offset:2048 sc1
    s_waitcnt vmcnt(0)
    v_mov_b32 v104, 64
    v_mov_b32 v105, 0
    s_mov_b64 exec, 1
    buffer_store_dword v104, v105, s[4:7], s19 offen sc1
    s_mov_b64 exec, -1
    s_waitcnt vmcnt(0)
    s_branch Lq_415
Lq_414:
    s_mul_i32 s23, s16, 10240
    s_add_u32 s26, s23, 0
    s_mov_b32 s44, 0
    s_add_u32 m0, s26, 0
    s_nop 0
    buffer_load_dwordx4 v2, s[8:11], s44 offen lds
    s_add_u32 m0, s26, 1024
    s_nop 0
    buffer_load_dwordx4 v3, s[8:11], s44 offen lds
    s_add_u32 m0, s26, 2048
    s_nop 0
    buffer_load_dwordx4 v4, s[8:11], s44 offen lds
    s_add_u32 m0, s26, 3072
    s_nop 0
    buffer_load_dwordx4 v5, s[8:11], s44 offen lds
    s_add_u32 m0, s26, 4096
    s_nop 0
    buffer_load_dwordx4 v6, s[8:11], s44 offen lds
    s_add_u32 m0, s26, 5120
    s_nop 0
    buffer_load_dwordx4 v7, s[8:11], s44 offen lds
    s_add_u32 m0, s26, 6144
    s_nop 0
    buffer_load_dwordx4 v8, s[8:11], s44 offen lds
    s_add_u32 m0, s26, 7168
    s_nop 0
    buffer_load_dwordx4 v9, s[8:11], s44 offen lds
    s_add_u32 m0, s26, 8192
    s_nop 0
    buffer_load_dwordx4 v10, s[8:11], s44 offen lds
    s_add_u32 m0, s26, 9216
    s_nop 0
    buffer_load_dwordx4 v11, s[8:11], s44 offen lds
    s_add_u32 s26, s23, 40960
    s_mov_b32 s44, 40960
    s_add_u32 m0, s26, 0
    s_nop 0
    buffer_load_dwordx4 v2, s[8:11], s44 offen lds
    s_add_u32 m0, s26, 1024
    s_nop 0
    buffer_load_dwordx4 v3, s[8:11], s44 offen lds
    s_add_u32 m0, s26, 2048
    s_nop 0
    buffer_load_dwordx4 v4, s[8:11], s44 offen lds
    s_add_u32 m0, s26, 3072
    s_nop 0
    buffer_load_dwordx4 v5, s[8:11], s44 offen lds
    s_add_u32 m0, s26, 4096
    s_nop 0
    buffer_load_dwordx4 v6, s[8:11], s44 offen lds
    s_add_u32 m0, s26, 5120
    s_nop 0
    buffer_load_dwordx4 v7, s[8:11], s44 offen lds
    s_add_u32 m0, s26, 6144
    s_nop 0
    buffer_load_dwordx4 v8, s[8:11], s44 offen lds
    s_add_u32 m0, s26, 7168
    s_nop 0
    buffer_load_dwordx4 v9, s[8:11], s44 offen lds
    s_add_u32 m0, s26, 8192
    s_nop 0
    buffer_load_dwordx4 v10, s[8:11], s44 offen lds
    s_add_u32 m0, s26, 9216
    s_nop 0
    buffer_load_dwordx4 v11, s[8:11], s44 offen lds
    s_mov_b32 s17, 0
    s_mov_b32 s27, 0
    s_waitcnt vmcnt(10)
L_qkv_loop_V:
    s_barrier
    s_mul_i32 s28, s27, 40960
    v_add_u32 v12, s28, v16
    v_add_u32 v13, s28, v17
    v_add_u32 v14, s28, v18
    v_add_u32 v15, s28, v19
    s_add_u32 s20, s27, 2
    s_cmp_ge_u32 s20, 3
    s_cbranch_scc0 LqV0a
    s_sub_u32 s20, s20, 3
LqV0a:
    s_mul_i32 s26, s20, 40960
    s_add_u32 s26, s26, s23
    s_add_u32 s20, s17, 2
    s_min_u32 s20, s20, 63
    s_mul_i32 s44, s20, 40960
    s_sub_u32 s20, s17, 1
    s_mul_i32 s45, s20, 393216
    s_add_u32 s45, s45, s18
    s_cmp_eq_u32 s17, 0
    s_cselect_b32 s45, 0xf0000000, s45
    s_add_u32 s27, s27, 1
    s_cmp_eq_u32 s27, 3
    s_cselect_b32 s27, 0, s27
    s_cmp_lt_u32 s17, 2
    s_cbranch_scc1 Lq_418
    s_sub_u32 s20, s17, 1
    v_mov_b32 v104, s20
    v_mov_b32 v105, 0
    s_mov_b64 exec, 1
    buffer_store_dword v104, v105, s[4:7], s19 offen sc1
    s_mov_b64 exec, -1
Lq_418:
    ds_read_b128 v[20:23], v12 offset:0
    ds_read_b128 v[24:27], v12 offset:20480
    ds_read_b128 v[28:31], v13 offset:0
    ds_read_b128 v[32:35], v13 offset:20480
    s_waitcnt lgkmcnt(2)
    v_mfma_f32_16x16x32_bf16 v[44:47], v[20:23], a[0:3], 0
    ds_read_b128 v[36:39], v14 offset:0
    v_mfma_f32_16x16x32_bf16 v[48:51], v[20:23], a[80:83], 0
    v_mfma_f32_16x16x32_bf16 v[52:55], v[20:23], a[160:163], 0
    v_mfma_f32_16x16x32_bf16 v[56:59], v[24:27], a[0:3], 0
    ds_read_b128 v[40:43], v14 offset:20480
    v_mfma_f32_16x16x32_bf16 v[60:63], v[24:27], a[80:83], 0
    v_mfma_f32_16x16x32_bf16 v[64:67], v[24:27], a[160:163], 0
    s_waitcnt lgkmcnt(2)
    v_mfma_f32_16x16x32_bf16 v[44:47], v[28:31], a[4:7], v[44:47]
    ds_read_b128 v[20:23], v15 offset:0
    v_mfma_f32_16x16x32_bf16 v[48:51], v[28:31], a[84:87], v[48:51]
    v_mfma_f32_16x16x32_bf16 v[52:55], v[28:31], a[164:167], v[52:55]
    v_mfma_f32_16x16x32_bf16 v[56:59], v[32:35], a[4:7], v[56:59]
    ds_read_b128 v[24:27], v15 offset:20480
    v_mfma_f32_16x16x32_bf16 v[60:63], v[32:35], a[84:87], v[60:63]
    v_mfma_f32_16x16x32_bf16 v[64:67], v[32:35], a[164:167], v[64:67]
    s_waitcnt lgkmcnt(2)
    v_mfma_f32_16x16x32_bf16 v[44:47], v[36:39], a[8:11], v[44:47]
    ds_read_b128 v[28:31], v12 offset:256
    v_mfma_f32_16x16x32_bf16 v[48:51], v[36:39], a[88:91], v[48:51]
    v_cvt_pk_bf16_f32 v92, v68, v69
    v_mfma_f32_16x16x32_bf16 v[52:55], v[36:39], a[168:171], v[52:55]
    v_cvt_pk_bf16_f32 v93, v70, v71
    v_mfma_f32_16x16x32_bf16 v[56:59], v[40:43], a[8:11], v[56:59]
    ds_read_b128 v[32:35], v12 offset:20736
    v_mfma_f32_16x16x32_bf16 v[60:63], v[40:43], a[88:91], v[60:63]
    v_cvt_pk_bf16_f32 v94, v80, v81
    v_mfma_f32_16x16x32_bf16 v[64:67], v[40:43], a[168:171], v[64:67]
    v_cvt_pk_bf16_f32 v95, v82, v83
    s_waitcnt lgkmcnt(2)
    v_mfma_f32_16x16x32_bf16 v[44:47], v[20:23], a[12:15], v[44:47]
    ds_read_b128 v[36:39], v13 offset:256
    v_mfma_f32_16x16x32_bf16 v[48:51], v[20:23], a[92:95], v[48:51]
    buffer_store_dwordx4 v[92:95], v1, s[4:7], s45 offen offset:0 sc1
    v_mfma_f32_16x16x32_bf16 v[52:55], v[20:23], a[172:175], v[52:55]
    v_cvt_pk_bf16_f32 v96, v72, v73
    v_mfma_f32_16x16x32_bf16 v[56:59], v[24:27], a[12:15], v[56:59]
    ds_read_b128 v[40:43], v13 offset:20736
    v_mfma_f32_16x16x32_bf16 v[60:63], v[24:27], a[92:95], v[60:63]
    v_cvt_pk_bf16_f32 v97, v74, v75
    v_mfma_f32_16x16x32_bf16 v[64:67], v[24:27], a[172:175], v[64:67]
    v_cvt_pk_bf16_f32 v98, v84, v85
    s_waitcnt lgkmcnt(2)
    v_mfma_f32_16x16x32_bf16 v[44:47], v[28:31], a[16:19], v[44:47]
    ds_read_b128 v[20:23], v14 offset:256
    v_mfma_f32_16x16x32_bf16 v[48:51], v[28:31], a[96:99], v[48:51]
    v_cvt_pk_bf16_f32 v99, v86, v87
    v_mfma_f32_16x16x32_bf16 v[52:55], v[28:31], a[176:179], v[52:55]
    buffer_store_dwordx4 v[96:99], v1, s[4:7], s45 offen offset:1024 sc1
    v_mfma_f32_16x16x32_bf16 v[56:59], v[32:35], a[16:19], v[56:59]
    ds_read_b128 v[24:27], v14 offset:20736
    v_mfma_f32_16x16x32_bf16 v[60:63], v[32:35], a[96:99], v[60:63]
    v_cvt_pk_bf16_f32 v100, v76, v77
    v_mfma_f32_16x16x32_bf16 v[64:67], v[32:35], a[176:179], v[64:67]
    v_cvt_pk_bf16_f32 v101, v78, v79
    s_waitcnt lgkmcnt(2)
    v_mfma_f32_16x16x32_bf16 v[44:47], v[36:39], a[20:23], v[44:47]
    ds_read_b128 v[28:31], v15 offset:256
    v_mfma_f32_16x16x32_bf16 v[48:51], v[36:39], a[100:103], v[48:51]
    v_cvt_pk_bf16_f32 v102, v88, v89
    v_mfma_f32_16x16x32_bf16 v[52:55], v[36:39], a[180:183], v[52:55]
    v_cvt_pk_bf16_f32 v103, v90, v91
    v_mfma_f32_16x16x32_bf16 v[56:59], v[40:43], a[20:23], v[56:59]
    ds_read_b128 v[32:35], v15 offset:20736
    v_mfma_f32_16x16x32_bf16 v[60:63], v[40:43], a[100:103], v[60:63]
    buffer_store_dwordx4 v[100:103], v1, s[4:7], s45 offen offset:2048 sc1
    v_mfma_f32_16x16x32_bf16 v[64:67], v[40:43], a[180:183], v[64:67]
    s_waitcnt lgkmcnt(2)
    v_mfma_f32_16x16x32_bf16 v[44:47], v[20:23], a[24:27], v[44:47]
    ds_read_b128 v[36:39], v12 offset:512
    v_mfma_f32_16x16x32_bf16 v[48:51], v[20:23], a[104:107], v[48:51]
    v_mfma_f32_16x16x32_bf16 v[52:55], v[20:23], a[184:187], v[52:55]
    v_mfma_f32_16x16x32_bf16 v[56:59], v[24:27], a[24:27], v[56:59]
    ds_read_b128 v[40:43], v12 offset:20992
    v_mfma_f32_16x16x32_bf16 v[60:63], v[24:27], a[104:107], v[60:63]
    v_mfma_f32_16x16x32_bf16 v[64:67], v[24:27], a[184:187], v[64:67]
    s_waitcnt lgkmcnt(2)
    v_mfma_f32_16x16x32_bf16 v[44:47], v[28:31], a[28:31], v[44:47]
    ds_read_b128 v[20:23], v13 offset:512
    v_mfma_f32_16x16x32_bf16 v[48:51], v[28:31], a[108:111], v[48:51]
    v_mfma_f32_16x16x32_bf16 v[52:55], v[28:31], a[188:191], v[52:55]
    v_mfma_f32_16x16x32_bf16 v[56:59], v[32:35], a[28:31], v[56:59]
    ds_read_b128 v[24:27], v13 offset:20992
    v_mfma_f32_16x16x32_bf16 v[60:63], v[32:35], a[108:111], v[60:63]
    v_mfma_f32_16x16x32_bf16 v[64:67], v[32:35], a[188:191], v[64:67]
    s_waitcnt lgkmcnt(2)
    v_mfma_f32_16x16x32_bf16 v[44:47], v[36:39], a[32:35], v[44:47]
    ds_read_b128 v[28:31], v14 offset:512
    v_mfma_f32_16x16x32_bf16 v[48:51], v[36:39], a[112:115], v[48:51]
    v_mfma_f32_16x16x32_bf16 v[52:55], v[36:39], a[192:195], v[52:55]
    s_add_u32 m0, s26, 0
    s_nop 0
    buffer_load_dwordx4 v2, s[8:11], s44 offen lds
    v_mfma_f32_16x16x32_bf16 v[56:59], v[40:43], a[32:35], v[56:59]
    ds_read_b128 v[32:35], v14 offset:20992
    v_mfma_f32_16x16x32_bf16 v[60:63], v[40:43], a[112:115], v[60:63]
    v_mfma_f32_16x16x32_bf16 v[64:67], v[40:43], a[192:195], v[64:67]
    s_waitcnt lgkmcnt(2)
    v_mfma_f32_16x16x32_bf16 v[44:47], v[20:23], a[36:39], v[44:47]
    ds_read_b128 v[36:39], v15 offset:512
    v_mfma_f32_16x16x32_bf16 v[48:51], v[20:23], a[116:119], v[48:51]
    v_mfma_f32_16x16x32_bf16 v[52:55], v[20:23], a[196:199], v[52:55]
    s_add_u32 m0, s26, 1024
    s_nop 0
    buffer_load_dwordx4 v3, s[8:11], s44 offen lds
    v_mfma_f32_16x16x32_bf16 v[56:59], v[24:27], a[36:39], v[56:59]
    ds_read_b128 v[40:43], v15 offset:20992
    v_mfma_f32_16x16x32_bf16 v[60:63], v[24:27], a[116:119], v[60:63]
    v_mfma_f32_16x16x32_bf16 v[64:67], v[24:27], a[196:199], v[64:67]
    s_waitcnt lgkmcnt(2)
    v_mfma_f32_16x16x32_bf16 v[44:47], v[28:31], a[40:43], v[44:47]
    ds_read_b128 v[20:23], v12 offset:768
    v_mfma_f32_16x16x32_bf16 v[48:51], v[28:31], a[120:123], v[48:51]
    v_mfma_f32_16x16x32_bf16 v[52:55], v[28:31], a[200:203], v[52:55]
    s_add_u32 m0, s26, 2048
    s_nop 0
    buffer_load_dwordx4 v4, s[8:11], s44 offen lds
    v_mfma_f32_16x16x32_bf16 v[56:59], v[32:35], a[40:43], v[56:59]
    ds_read_b128 v[24:27], v12 offset:21248
    v_mfma_f32_16x16x32_bf16 v[60:63], v[32:35], a[120:123], v[60:63]
    v_mfma_f32_16x16x32_bf16 v[64:67], v[32:35], a[200:203], v[64:67]
    s_waitcnt lgkmcnt(2)
    v_mfma_f32_16x16x32_bf16 v[44:47], v[36:39], a[44:47], v[44:47]
    ds_read_b128 v[28:31], v13 offset:768
    v_mfma_f32_16x16x32_bf16 v[48:51], v[36:39], a[124:127], v[48:51]
    v_mfma_f32_16x16x32_bf16 v[52:55], v[36:39], a[204:207], v[52:55]
    s_add_u32 m0, s26, 3072
    s_nop 0
    buffer_load_dwordx4 v5, s[8:11], s44 offen lds
    v_mfma_f32_16x16x32_bf16 v[56:59], v[40:43], a[44:47], v[56:59]
    ds_read_b128 v[32:35], v13 offset:21248
    v_mfma_f32_16x16x32_bf16 v[60:63], v[40:43], a[124:127], v[60:63]
    v_mfma_f32_16x16x32_bf16 v[64:67], v[40:43], a[204:207], v[64:67]
    s_waitcnt lgkmcnt(2)
    v_mfma_f32_16x16x32_bf16 v[44:47], v[20:23], a[48:51], v[44:47]
    ds_read_b128 v[36:39], v14 offset:768
    v_mfma_f32_16x16x32_bf16 v[48:51], v[20:23], a[128:131], v[48:51]
    v_mfma_f32_16x16x32_bf16 v[52:55], v[20:23], a[208:211], v[52:55]
    s_add_u32 m0, s26, 4096
    s_nop 0
    buffer_load_dwordx4 v6, s[8:11], s44 offen lds
    v_mfma_f32_16x16x32_bf16 v[56:59], v[24:27], a[48:51], v[56:59]
    ds_read_b128 v[40:43], v14 offset:21248
    v_mfma_f32_16x16x32_bf16 v[60:63], v[24:27], a[128:131], v[60:63]
    v_mfma_f32_16x16x32_bf16 v[64:67], v[24:27], a[208:211], v[64:67]
    s_waitcnt lgkmcnt(2)
    v_mfma_f32_16x16x32_bf16 v[44:47], v[28:31], a[52:55], v[44:47]
    ds_read_b128 v[20:23], v15 offset:768
    v_mfma_f32_16x16x32_bf16 v[48:51], v[28:31], a[132:135], v[48:51]
    v_mfma_f32_16x16x32_bf16 v[52:55], v[28:31], a[212:215], v[52:55]
    s_add_u32 m0, s26, 5120
    s_nop 0
    buffer_load_dwordx4 v7, s[8:11], s44 offen lds
    v_mfma_f32_16x16x32_bf16 v[56:59], v[32:35], a[52:55], v[56:59]
    ds_read_b128 v[24:27], v15 offset:21248
    v_mfma_f32_16x16x32_bf16 v[60:63], v[32:35], a[132:135], v[60:63]
    v_mfma_f32_16x16x32_bf16 v[64:67], v[32:35], a[212:215], v[64:67]
    s_waitcnt lgkmcnt(2)
    v_mfma_f32_16x16x32_bf16 v[44:47], v[36:39], a[56:59], v[44:47]
    ds_read_b128 v[28:31], v12 offset:1024
    v_mfma_f32_16x16x32_bf16 v[48:51], v[36:39], a[136:139], v[48:51]
    v_mfma_f32_16x16x32_bf16 v[52:55], v[36:39], a[216:219], v[52:55]
    s_add_u32 m0, s26, 6144
    s_nop 0
    buffer_load_dwordx4 v8, s[8:11], s44 offen lds
    v_mfma_f32_16x16x32_bf16 v[56:59], v[40:43], a[56:59], v[56:59]
    ds_read_b128 v[32:35], v12 offset:21504
    v_mfma_f32_16x16x32_bf16 v[60:63], v[40:43], a[136:139], v[60:63]
    v_mfma_f32_16x16x32_bf16 v[64:67], v[40:43], a[216:219], v[64:67]
    s_waitcnt lgkmcnt(2)
    v_mfma_f32_16x16x32_bf16 v[44:47], v[20:23], a[60:63], v[44:47]
    ds_read_b128 v[36:39], v13 offset:1024
    v_mfma_f32_16x16x32_bf16 v[48:51], v[20:23], a[140:143], v[48:51]
    v_mfma_f32_16x16x32_bf16 v[52:55], v[20:23], a[220:223], v[52:55]
    s_add_u32 m0, s26, 7168
    s_nop 0
    buffer_load_dwordx4 v9, s[8:11], s44 offen lds
    v_mfma_f32_16x16x32_bf16 v[56:59], v[24:27], a[60:63], v[56:59]
    ds_read_b128 v[40:43], v13 offset:21504
    v_mfma_f32_16x16x32_bf16 v[60:63], v[24:27], a[140:143], v[60:63]
    v_mfma_f32_16x16x32_bf16 v[64:67], v[24:27], a[220:223], v[64:67]
    s_waitcnt lgkmcnt(2)
    v_mfma_f32_16x16x32_bf16 v[44:47], v[28:31], a[64:67], v[44:47]
    ds_read_b128 v[20:23], v14 offset:1024
    v_mfma_f32_16x16x32_bf16 v[48:51], v[28:31], a[144:147], v[48:51]
    v_mfma_f32_16x16x32_bf16 v[52:55], v[28:31], a[224:227], v[52:55]
    s_add_u32 m0, s26, 8192
    s_nop 0
    buffer_load_dwordx4 v10, s[8:11], s44 offen lds
    v_mfma_f32_16x16x32_bf16 v[56:59], v[32:35], a[64:67], v[56:59]
    ds_read_b128 v[24:27], v14 offset:21504
    v_mfma_f32_16x16x32_bf16 v[60:63], v[32:35], a[144:147], v[60:63]
    v_mfma_f32_16x16x32_bf16 v[64:67], v[32:35], a[224:227], v[64:67]
    s_waitcnt lgkmcnt(2)
    v_mfma_f32_16x16x32_bf16 v[44:47], v[36:39], a[68:71], v[44:47]
    ds_read_b128 v[28:31], v15 offset:1024
    v_mfma_f32_16x16x32_bf16 v[48:51], v[36:39], a[148:151], v[48:51]
    v_mfma_f32_16x16x32_bf16 v[52:55], v[36:39], a[228:231], v[52:55]
    s_add_u32 m0, s26, 9216
    s_nop 0
    buffer_load_dwordx4 v11, s[8:11], s44 offen lds
    v_mfma_f32_16x16x32_bf16 v[56:59], v[40:43], a[68:71], v[56:59]
    ds_read_b128 v[32:35], v15 offset:21504
    v_mfma_f32_16x16x32_bf16 v[60:63], v[40:43], a[148:151], v[60:63]
    v_mfma_f32_16x16x32_bf16 v[64:67], v[40:43], a[228:231], v[64:67]
    s_waitcnt lgkmcnt(2)
    v_mfma_f32_16x16x32_bf16 v[44:47], v[20:23], a[72:75], v[44:47]
    v_mfma_f32_16x16x32_bf16 v[48:51], v[20:23], a[152:155], v[48:51]
    v_mfma_f32_16x16x32_bf16 v[52:55], v[20:23], a[232:235], v[52:55]
    v_mfma_f32_16x16x32_bf16 v[56:59], v[24:27], a[72:75], v[56:59]
    v_mfma_f32_16x16x32_bf16 v[60:63], v[24:27], a[152:155], v[60:63]
    v_mfma_f32_16x16x32_bf16 v[64:67], v[24:27], a[232:235], v[64:67]
    s_waitcnt lgkmcnt(0)
    v_mfma_f32_16x16x32_bf16 v[44:47], v[28:31], a[76:79], v[44:47]
    v_mfma_f32_16x16x32_bf16 v[48:51], v[28:31], a[156:159], v[48:51]
    v_mfma_f32_16x16x32_bf16 v[52:55], v[28:31], a[236:239], v[52:55]
    v_mfma_f32_16x16x32_bf16 v[56:59], v[32:35], a[76:79], v[56:59]
    v_mfma_f32_16x16x32_bf16 v[60:63], v[32:35], a[156:159], v[60:63]
    v_mfma_f32_16x16x32_bf16 v[64:67], v[32:35], a[236:239], v[64:67]
    s_add_u32 s17, s17, 1
    s_waitcnt vmcnt(10)
    s_barrier
    s_mul_i32 s28, s27, 40960
    v_add_u32 v12, s28, v16
    v_add_u32 v13, s28, v17
    v_add_u32 v14, s28, v18
    v_add_u32 v15, s28, v19
    s_add_u32 s20, s27, 2
    s_cmp_ge_u32 s20, 3
    s_cbranch_scc0 LqV1a
    s_sub_u32 s20, s20, 3
LqV1a:
    s_mul_i32 s26, s20, 40960
    s_add_u32 s26, s26, s23
    s_add_u32 s20, s17, 2
    s_min_u32 s20, s20, 63
    s_mul_i32 s44, s20, 40960
    s_sub_u32 s20, s17, 1
    s_mul_i32 s45, s20, 393216
    s_add_u32 s45, s45, s18
    s_cmp_eq_u32 s17, 0
    s_cselect_b32 s45, 0xf0000000, s45
    s_add_u32 s27, s27, 1
    s_cmp_eq_u32 s27, 3
    s_cselect_b32 s27, 0, s27
    s_cmp_lt_u32 s17, 2
    s_cbranch_scc1 Lq_419
    s_sub_u32 s20, s17, 1
    v_mov_b32 v104, s20
    v_mov_b32 v105, 0
    s_mov_b64 exec, 1
    buffer_store_dword v104, v105, s[4:7], s19 offen sc1
    s_mov_b64 exec, -1
Lq_419:
    ds_read_b128 v[20:23], v12 offset:0
    ds_read_b128 v[24:27], v12 offset:20480
    ds_read_b128 v[28:31], v13 offset:0
    ds_read_b128 v[32:35], v13 offset:20480
    s_waitcnt lgkmcnt(2)
    v_mfma_f32_16x16x32_bf16 v[68:71], v[20:23], a[0:3], 0
    ds_read_b128 v[36:39], v14 offset:0
    v_mfma_f32_16x16x32_bf16 v[72:75], v[20:23], a[80:83], 0
    v_mfma_f32_16x16x32_bf16 v[76:79], v[20:23], a[160:163], 0
    v_mfma_f32_16x16x32_bf16 v[80:83], v[24:27], a[0:3], 0
    ds_read_b128 v[40:43], v14 offset:20480
    v_mfma_f32_16x16x32_bf16 v[84:87], v[24:27], a[80:83], 0
    v_mfma_f32_16x16x32_bf16 v[88:91], v[24:27], a[160:163], 0
    s_waitcnt lgkmcnt(2)
    v_mfma_f32_16x16x32_bf16 v[68:71], v[28:31], a[4:7], v[68:71]
    ds_read_b128 v[20:23], v15 offset:0
    v_mfma_f32_16x16x32_bf16 v[72:75], v[28:31], a[84:87], v[72:75]
    v_mfma_f32_16x16x32_bf16 v[76:79], v[28:31], a[164:167], v[76:79]
    v_mfma_f32_16x16x32_bf16 v[80:83], v[32:35], a[4:7], v[80:83]
    ds_read_b128 v[24:27], v15 offset:20480
    v_mfma_f32_16x16x32_bf16 v[84:87], v[32:35], a[84:87], v[84:87]
    v_mfma_f32_16x16x32_bf16 v[88:91], v[32:35], a[164:167], v[88:91]
    s_waitcnt lgkmcnt(2)
    v_mfma_f32_16x16x32_bf16 v[68:71], v[36:39], a[8:11], v[68:71]
    ds_read_b128 v[28:31], v12 offset:256
    v_mfma_f32_16x16x32_bf16 v[72:75], v[36:39], a[88:91], v[72:75]
    v_cvt_pk_bf16_f32 v92, v44, v45
    v_mfma_f32_16x16x32_bf16 v[76:79], v[36:39], a[168:171], v[76:79]
    v_cvt_pk_bf16_f32 v93, v46, v47
    v_mfma_f32_16x16x32_bf16 v[80:83], v[40:43], a[8:11], v[80:83]
    ds_read_b128 v[32:35], v12 offset:20736
    v_mfma_f32_16x16x32_bf16 v[84:87], v[40:43], a[88:91], v[84:87]
    v_cvt_pk_bf16_f32 v94, v56, v57
    v_mfma_f32_16x16x32_bf16 v[88:91], v[40:43], a[168:171], v[88:91]
    v_cvt_pk_bf16_f32 v95, v58, v59
    s_waitcnt lgkmcnt(2)
    v_mfma_f32_16x16x32_bf16 v[68:71], v[20:23], a[12:15], v[68:71]
    ds_read_b128 v[36:39], v13 offset:256
    v_mfma_f32_16x16x32_bf16 v[72:75], v[20:23], a[92:95], v[72:75]
    buffer_store_dwordx4 v[92:95], v1, s[4:7], s45 offen offset:0 sc1
    v_mfma_f32_16x16x32_bf16 v[76:79], v[20:23], a[172:175], v[76:79]
    v_cvt_pk_bf16_f32 v96, v48, v49
    v_mfma_f32_16x16x32_bf16 v[80:83], v[24:27], a[12:15], v[80:83]
    ds_read_b128 v[40:43], v13 offset:20736
    v_mfma_f32_16x16x32_bf16 v[84:87], v[24:27], a[92:95], v[84:87]
    v_cvt_pk_bf16_f32 v97, v50, v51
    v_mfma_f32_16x16x32_bf16 v[88:91], v[24:27], a[172:175], v[88:91]
    v_cvt_pk_bf16_f32 v98, v60, v61
    s_waitcnt lgkmcnt(2)
    v_mfma_f32_16x16x32_bf16 v[68:71], v[28:31], a[16:19], v[68:71]
    ds_read_b128 v[20:23], v14 offset:256
    v_mfma_f32_16x16x32_bf16 v[72:75], v[28:31], a[96:99], v[72:75]
    v_cvt_pk_bf16_f32 v99, v62, v63
    v_mfma_f32_16x16x32_bf16 v[76:79], v[28:31], a[176:179], v[76:79]
    buffer_store_dwordx4 v[96:99], v1, s[4:7], s45 offen offset:1024 sc1
    v_mfma_f32_16x16x32_bf16 v[80:83], v[32:35], a[16:19], v[80:83]
    ds_read_b128 v[24:27], v14 offset:20736
    v_mfma_f32_16x16x32_bf16 v[84:87], v[32:35], a[96:99], v[84:87]
    v_cvt_pk_bf16_f32 v100, v52, v53
    v_mfma_f32_16x16x32_bf16 v[88:91], v[32:35], a[176:179], v[88:91]
    v_cvt_pk_bf16_f32 v101, v54, v55
    s_waitcnt lgkmcnt(2)
    v_mfma_f32_16x16x32_bf16 v[68:71], v[36:39], a[20:23], v[68:71]
    ds_read_b128 v[28:31], v15 offset:256
    v_mfma_f32_16x16x32_bf16 v[72:75], v[36:39], a[100:103], v[72:75]
    v_cvt_pk_bf16_f32 v102, v64, v65
    v_mfma_f32_16x16x32_bf16 v[76:79], v[36:39], a[180:183], v[76:79]
    v_cvt_pk_bf16_f32 v103, v66, v67
    v_mfma_f32_16x16x32_bf16 v[80:83], v[40:43], a[20:23], v[80:83]
    ds_read_b128 v[32:35], v15 offset:20736
    v_mfma_f32_16x16x32_bf16 v[84:87], v[40:43], a[100:103], v[84:87]
    buffer_store_dwordx4 v[100:103], v1, s[4:7], s45 offen offset:2048 sc1
    v_mfma_f32_16x16x32_bf16 v[88:91], v[40:43], a[180:183], v[88:91]
    s_waitcnt lgkmcnt(2)
    v_mfma_f32_16x16x32_bf16 v[68:71], v[20:23], a[24:27], v[68:71]
    ds_read_b128 v[36:39], v12 offset:512
    v_mfma_f32_16x16x32_bf16 v[72:75], v[20:23], a[104:107], v[72:75]
    v_mfma_f32_16x16x32_bf16 v[76:79], v[20:23], a[184:187], v[76:79]
    v_mfma_f32_16x16x32_bf16 v[80:83], v[24:27], a[24:27], v[80:83]
    ds_read_b128 v[40:43], v12 offset:20992
    v_mfma_f32_16x16x32_bf16 v[84:87], v[24:27], a[104:107], v[84:87]
    v_mfma_f32_16x16x32_bf16 v[88:91], v[24:27], a[184:187], v[88:91]
    s_waitcnt lgkmcnt(2)
    v_mfma_f32_16x16x32_bf16 v[68:71], v[28:31], a[28:31], v[68:71]
    ds_read_b128 v[20:23], v13 offset:512
    v_mfma_f32_16x16x32_bf16 v[72:75], v[28:31], a[108:111], v[72:75]
    v_mfma_f32_16x16x32_bf16 v[76:79], v[28:31], a[188:191], v[76:79]
    v_mfma_f32_16x16x32_bf16 v[80:83], v[32:35], a[28:31], v[80:83]
    ds_read_b128 v[24:27], v13 offset:20992
    v_mfma_f32_16x16x32_bf16 v[84:87], v[32:35], a[108:111], v[84:87]
    v_mfma_f32_16x16x32_bf16 v[88:91], v[32:35], a[188:191], v[88:91]
    s_waitcnt lgkmcnt(2)
    v_mfma_f32_16x16x32_bf16 v[68:71], v[36:39], a[32:35], v[68:71]
    ds_read_b128 v[28:31], v14 offset:512
    v_mfma_f32_16x16x32_bf16 v[72:75], v[36:39], a[112:115], v[72:75]
    v_mfma_f32_16x16x32_bf16 v[76:79], v[36:39], a[192:195], v[76:79]
    s_add_u32 m0, s26, 0
    s_nop 0
    buffer_load_dwordx4 v2, s[8:11], s44 offen lds
    v_mfma_f32_16x16x32_bf16 v[80:83], v[40:43], a[32:35], v[80:83]
    ds_read_b128 v[32:35], v14 offset:20992
    v_mfma_f32_16x16x32_bf16 v[84:87], v[40:43], a[112:115], v[84:87]
    v_mfma_f32_16x16x32_bf16 v[88:91], v[40:43], a[192:195], v[88:91]
    s_waitcnt lgkmcnt(2)
    v_mfma_f32_16x16x32_bf16 v[68:71], v[20:23], a[36:39], v[68:71]
    ds_read_b128 v[36:39], v15 offset:512
    v_mfma_f32_16x16x32_bf16 v[72:75], v[20:23], a[116:119], v[72:75]
    v_mfma_f32_16x16x32_bf16 v[76:79], v[20:23], a[196:199], v[76:79]
    s_add_u32 m0, s26, 1024
    s_nop 0
    buffer_load_dwordx4 v3, s[8:11], s44 offen lds
    v_mfma_f32_16x16x32_bf16 v[80:83], v[24:27], a[36:39], v[80:83]
    ds_read_b128 v[40:43], v15 offset:20992
    v_mfma_f32_16x16x32_bf16 v[84:87], v[24:27], a[116:119], v[84:87]
    v_mfma_f32_16x16x32_bf16 v[88:91], v[24:27], a[196:199], v[88:91]
    s_waitcnt lgkmcnt(2)
    v_mfma_f32_16x16x32_bf16 v[68:71], v[28:31], a[40:43], v[68:71]
    ds_read_b128 v[20:23], v12 offset:768
    v_mfma_f32_16x16x32_bf16 v[72:75], v[28:31], a[120:123], v[72:75]
    v_mfma_f32_16x16x32_bf16 v[76:79], v[28:31], a[200:203], v[76:79]
    s_add_u32 m0, s26, 2048
    s_nop 0
    buffer_load_dwordx4 v4, s[8:11], s44 offen lds
    v_mfma_f32_16x16x32_bf16 v[80:83], v[32:35], a[40:43], v[80:83]
    ds_read_b128 v[24:27], v12 offset:21248
    v_mfma_f32_16x16x32_bf16 v[84:87], v[32:35], a[120:123], v[84:87]
    v_mfma_f32_16x16x32_bf16 v[88:91], v[32:35], a[200:203], v[88:91]
    s_waitcnt lgkmcnt(2)
    v_mfma_f32_16x16x32_bf16 v[68:71], v[36:39], a[44:47], v[68:71]
    ds_read_b128 v[28:31], v13 offset:768
    v_mfma_f32_16x16x32_bf16 v[72:75], v[36:39], a[124:127], v[72:75]
    v_mfma_f32_16x16x32_bf16 v[76:79], v[36:39], a[204:207], v[76:79]
    s_add_u32 m0, s26, 3072
    s_nop 0
    buffer_load_dwordx4 v5, s[8:11], s44 offen lds
    v_mfma_f32_16x16x32_bf16 v[80:83], v[40:43], a[44:47], v[80:83]
    ds_read_b128 v[32:35], v13 offset:21248
    v_mfma_f32_16x16x32_bf16 v[84:87], v[40:43], a[124:127], v[84:87]
    v_mfma_f32_16x16x32_bf16 v[88:91], v[40:43], a[204:207], v[88:91]
    s_waitcnt lgkmcnt(2)
    v_mfma_f32_16x16x32_bf16 v[68:71], v[20:23], a[48:51], v[68:71]
    ds_read_b128 v[36:39], v14 offset:768
    v_mfma_f32_16x16x32_bf16 v[72:75], v[20:23], a[128:131], v[72:75]
    v_mfma_f32_16x16x32_bf16 v[76:79], v[20:23], a[208:211], v[76:79]
    s_add_u32 m0, s26, 4096
    s_nop 0
    buffer_load_dwordx4 v6, s[8:11], s44 offen lds
    v_mfma_f32_16x16x32_bf16 v[80:83], v[24:27], a[48:51], v[80:83]
    ds_read_b128 v[40:43], v14 offset:21248
    v_mfma_f32_16x16x32_bf16 v[84:87], v[24:27], a[128:131], v[84:87]
    v_mfma_f32_16x16x32_bf16 v[88:91], v[24:27], a[208:211], v[88:91]
    s_waitcnt lgkmcnt(2)
    v_mfma_f32_16x16x32_bf16 v[68:71], v[28:31], a[52:55], v[68:71]
    ds_read_b128 v[20:23], v15 offset:768
    v_mfma_f32_16x16x32_bf16 v[72:75], v[28:31], a[132:135], v[72:75]
    v_mfma_f32_16x16x32_bf16 v[76:79], v[28:31], a[212:215], v[76:79]
    s_add_u32 m0, s26, 5120
    s_nop 0
    buffer_load_dwordx4 v7, s[8:11], s44 offen lds
    v_mfma_f32_16x16x32_bf16 v[80:83], v[32:35], a[52:55], v[80:83]
    ds_read_b128 v[24:27], v15 offset:21248
    v_mfma_f32_16x16x32_bf16 v[84:87], v[32:35], a[132:135], v[84:87]
    v_mfma_f32_16x16x32_bf16 v[88:91], v[32:35], a[212:215], v[88:91]
    s_waitcnt lgkmcnt(2)
    v_mfma_f32_16x16x32_bf16 v[68:71], v[36:39], a[56:59], v[68:71]
    ds_read_b128 v[28:31], v12 offset:1024
    v_mfma_f32_16x16x32_bf16 v[72:75], v[36:39], a[136:139], v[72:75]
    v_mfma_f32_16x16x32_bf16 v[76:79], v[36:39], a[216:219], v[76:79]
    s_add_u32 m0, s26, 6144
    s_nop 0
    buffer_load_dwordx4 v8, s[8:11], s44 offen lds
    v_mfma_f32_16x16x32_bf16 v[80:83], v[40:43], a[56:59], v[80:83]
    ds_read_b128 v[32:35], v12 offset:21504
    v_mfma_f32_16x16x32_bf16 v[84:87], v[40:43], a[136:139], v[84:87]
    v_mfma_f32_16x16x32_bf16 v[88:91], v[40:43], a[216:219], v[88:91]
    s_waitcnt lgkmcnt(2)
    v_mfma_f32_16x16x32_bf16 v[68:71], v[20:23], a[60:63], v[68:71]
    ds_read_b128 v[36:39], v13 offset:1024
    v_mfma_f32_16x16x32_bf16 v[72:75], v[20:23], a[140:143], v[72:75]
    v_mfma_f32_16x16x32_bf16 v[76:79], v[20:23], a[220:223], v[76:79]
    s_add_u32 m0, s26, 7168
    s_nop 0
    buffer_load_dwordx4 v9, s[8:11], s44 offen lds
    v_mfma_f32_16x16x32_bf16 v[80:83], v[24:27], a[60:63], v[80:83]
    ds_read_b128 v[40:43], v13 offset:21504
    v_mfma_f32_16x16x32_bf16 v[84:87], v[24:27], a[140:143], v[84:87]
    v_mfma_f32_16x16x32_bf16 v[88:91], v[24:27], a[220:223], v[88:91]
    s_waitcnt lgkmcnt(2)
    v_mfma_f32_16x16x32_bf16 v[68:71], v[28:31], a[64:67], v[68:71]
    ds_read_b128 v[20:23], v14 offset:1024
    v_mfma_f32_16x16x32_bf16 v[72:75], v[28:31], a[144:147], v[72:75]
    v_mfma_f32_16x16x32_bf16 v[76:79], v[28:31], a[224:227], v[76:79]
    s_add_u32 m0, s26, 8192
    s_nop 0
    buffer_load_dwordx4 v10, s[8:11], s44 offen lds
    v_mfma_f32_16x16x32_bf16 v[80:83], v[32:35], a[64:67], v[80:83]
    ds_read_b128 v[24:27], v14 offset:21504
    v_mfma_f32_16x16x32_bf16 v[84:87], v[32:35], a[144:147], v[84:87]
    v_mfma_f32_16x16x32_bf16 v[88:91], v[32:35], a[224:227], v[88:91]
    s_waitcnt lgkmcnt(2)
    v_mfma_f32_16x16x32_bf16 v[68:71], v[36:39], a[68:71], v[68:71]
    ds_read_b128 v[28:31], v15 offset:1024
    v_mfma_f32_16x16x32_bf16 v[72:75], v[36:39], a[148:151], v[72:75]
    v_mfma_f32_16x16x32_bf16 v[76:79], v[36:39], a[228:231], v[76:79]
    s_add_u32 m0, s26, 9216
    s_nop 0
    buffer_load_dwordx4 v11, s[8:11], s44 offen lds
    v_mfma_f32_16x16x32_bf16 v[80:83], v[40:43], a[68:71], v[80:83]
    ds_read_b128 v[32:35], v15 offset:21504
    v_mfma_f32_16x16x32_bf16 v[84:87], v[40:43], a[148:151], v[84:87]
    v_mfma_f32_16x16x32_bf16 v[88:91], v[40:43], a[228:231], v[88:91]
    s_waitcnt lgkmcnt(2)
    v_mfma_f32_16x16x32_bf16 v[68:71], v[20:23], a[72:75], v[68:71]
    v_mfma_f32_16x16x32_bf16 v[72:75], v[20:23], a[152:155], v[72:75]
    v_mfma_f32_16x16x32_bf16 v[76:79], v[20:23], a[232:235], v[76:79]
    v_mfma_f32_16x16x32_bf16 v[80:83], v[24:27], a[72:75], v[80:83]
    v_mfma_f32_16x16x32_bf16 v[84:87], v[24:27], a[152:155], v[84:87]
    v_mfma_f32_16x16x32_bf16 v[88:91], v[24:27], a[232:235], v[88:91]
    s_waitcnt lgkmcnt(0)
    v_mfma_f32_16x16x32_bf16 v[68:71], v[28:31], a[76:79], v[68:71]
    v_mfma_f32_16x16x32_bf16 v[72:75], v[28:31], a[156:159], v[72:75]
    v_mfma_f32_16x16x32_bf16 v[76:79], v[28:31], a[236:239], v[76:79]
    v_mfma_f32_16x16x32_bf16 v[80:83], v[32:35], a[76:79], v[80:83]
    v_mfma_f32_16x16x32_bf16 v[84:87], v[32:35], a[156:159], v[84:87]
    v_mfma_f32_16x16x32_bf16 v[88:91], v[32:35], a[236:239], v[88:91]
    s_add_u32 s17, s17, 1
    s_waitcnt vmcnt(10)
    s_cmp_lt_u32 s17, 64
    s_cbranch_scc1 L_qkv_loop_V
    s_mov_b32 s45, s18
    s_add_u32 s45, s45, 24772608
    s_nop 7
    v_cvt_pk_bf16_f32 v92, v68, v69
    v_cvt_pk_bf16_f32 v93, v70, v71
    v_cvt_pk_bf16_f32 v94, v80, v81
    v_cvt_pk_bf16_f32 v95, v82, v83
    buffer_store_dwordx4 v[92:95], v1, s[4:7], s45 offen offset:0 sc1
    v_cvt_pk_bf16_f32 v96, v72, v73
    v_cvt_pk_bf16_f32 v97, v74, v75
    v_cvt_pk_bf16_f32 v98, v84, v85
    v_cvt_pk_bf16_f32 v99, v86, v87
    buffer_store_dwordx4 v[96:99], v1, s[4:7], s45 offen offset:1024 sc1
    v_cvt_pk_bf16_f32 v100, v76, v77
    v_cvt_pk_bf16_f32 v101, v78, v79
    v_cvt_pk_bf16_f32 v102, v88, v89
    v_cvt_pk_bf16_f32 v103, v90, v91
    buffer_store_dwordx4 v[100:103], v1, s[4:7], s45 offen offset:2048 sc1
    s_waitcnt vmcnt(0)
    v_mov_b32 v104, 64
    v_mov_b32 v105, 0
    s_mov_b64 exec, 1
    buffer_store_dword v104, v105, s[4:7], s19 offen sc1
    s_mov_b64 exec, -1
    s_waitcnt vmcnt(0)
Lq_415:
    s_cmp_lt_u32 s94, 80
    s_cbranch_scc0 L_exit
    s_barrier
    s_mul_i32 s13, s94, 52429
    s_lshr_b32 s13, s13, 20
    s_mul_i32 s20, s13, 20
    s_sub_u32 s12, s94, s20
    v_lshlrev_b32 v1, 4, v0
    v_lshrrev_b32 v24, 2, v0
    v_mul_u32_u24 v24, 1280, v24
    v_and_b32 v25, 3, v0
    v_lshlrev_b32 v25, 4, v25
    v_add_u32 v2, v24, v25
    v_lshrrev_b32 v24, 2, v0
    v_lshlrev_b32 v24, 6, v24
    v_and_b32 v25, 3, v0
    v_lshlrev_b32 v25, 3, v25
    v_add_u32 v3, v24, v25
    s_mul_i32 s20, s16, 36864
    v_add_u32 v3, s20, v3
    s_load_dwordx2 s[8:9], s[96:97], 64
    s_load_dwordx2 s[28:29], s[96:97], 80
    s_mov_b32 s10, 7864320
    s_mov_b32 s11, 0x00020000
    s_mov_b32 s30, 5242880
    s_mov_b32 s31, 0x00020000
    s_waitcnt lgkmcnt(0)
    s_lshl_b32 s20, s16, 3
    s_add_u32 s20, s20, 0
    s_mul_i32 s20, s20, 245760
    s_lshl_b32 s21, s12, 6
    s_add_u32 s20, s20, s21
    s_mul_i32 s21, s16, 36864
    s_add_u32 s21, s21, 0
    s_mov_b32 m0, s21
    s_add_u32 s21, s21, 1024
    buffer_load_dwordx4 v2, s[8:11], s20 offen lds
    s_add_u32 s20, s20, 20480
    s_mov_b32 m0, s21
    s_add_u32 s21, s21, 1024
    buffer_load_dwordx4 v2, s[8:11], s20 offen lds
    s_add_u32 s20, s20, 20480
    s_mov_b32 m0, s21
    s_add_u32 s21, s21, 1024
    buffer_load_dwordx4 v2, s[8:11], s20 offen lds
    s_add_u32 s20, s20, 20480
    s_mov_b32 m0, s21
    s_add_u32 s21, s21, 1024
    buffer_load_dwordx4 v2, s[8:11], s20 offen lds
    s_add_u32 s20, s20, 20480
    s_mov_b32 m0, s21
    s_add_u32 s21, s21, 1024
    buffer_load_dwordx4 v2, s[8:11], s20 offen lds
    s_add_u32 s20, s20, 20480
    s_mov_b32 m0, s21
    s_add_u32 s21, s21, 1024
    buffer_load_dwordx4 v2, s[8:11], s20 offen lds
    s_add_u32 s20, s20, 20480
    s_mov_b32 m0, s21
    s_add_u32 s21, s21, 1024
    buffer_load_dwordx4 v2, s[8:11], s20 offen lds
    s_add_u32 s20, s20, 20480
    s_mov_b32 m0, s21
    s_add_u32 s21, s21, 1024
    buffer_load_dwordx4 v2, s[8:11], s20 offen lds
    s_add_u32 s20, s20, 20480
    s_mov_b32 m0, s21
    s_add_u32 s21, s21, 1024
    buffer_load_dwordx4 v2, s[8:11], s20 offen lds
    s_add_u32 s20, s20, 20480
    s_mov_b32 m0, s21
    s_add_u32 s21, s21, 1024
    buffer_load_dwordx4 v2, s[8:11], s20 offen lds
    s_add_u32 s20, s20, 20480
    s_mov_b32 m0, s21
    s_add_u32 s21, s21, 1024
    buffer_load_dwordx4 v2, s[8:11], s20 offen lds
    s_add_u32 s20, s20, 20480
    s_mov_b32 m0, s21
    s_add_u32 s21, s21, 1024
    buffer_load_dwordx4 v2, s[8:11], s20 offen lds
    s_add_u32 s20, s20, 20480
    s_lshl_b32 s20, s16, 3
    s_add_u32 s20, s20, 1
    s_mul_i32 s20, s20, 245760
    s_lshl_b32 s21, s12, 6
    s_add_u32 s20, s20, s21
    s_mul_i32 s21, s16, 36864
    s_add_u32 s21, s21, 12288
    s_mov_b32 m0, s21
    s_add_u32 s21, s21, 1024
    buffer_load_dwordx4 v2, s[8:11], s20 offen lds
    s_add_u32 s20, s20, 20480
    s_mov_b32 m0, s21
    s_add_u32 s21, s21, 1024
    buffer_load_dwordx4 v2, s[8:11], s20 offen lds
    s_add_u32 s20, s20, 20480
    s_mov_b32 m0, s21
    s_add_u32 s21, s21, 1024
    buffer_load_dwordx4 v2, s[8:11], s20 offen lds
    s_add_u32 s20, s20, 20480
    s_mov_b32 m0, s21
    s_add_u32 s21, s21, 1024
    buffer_load_dwordx4 v2, s[8:11], s20 offen lds
    s_add_u32 s20, s20, 20480
    s_mov_b32 m0, s21
    s_add_u32 s21, s21, 1024
    buffer_load_dwordx4 v2, s[8:11], s20 offen lds
    s_add_u32 s20, s20, 20480
    s_mov_b32 m0, s21
    s_add_u32 s21, s21, 1024
    buffer_load_dwordx4 v2, s[8:11], s20 offen lds
    s_add_u32 s20, s20, 20480
    s_mov_b32 m0, s21
    s_add_u32 s21, s21, 1024
    buffer_load_dwordx4 v2, s[8:11], s20 offen lds
    s_add_u32 s20, s20, 20480
    s_mov_b32 m0, s21
    s_add_u32 s21, s21, 1024
    buffer_load_dwordx4 v2, s[8:11], s20 offen lds
    s_add_u32 s20, s20, 20480
    s_mov_b32 m0, s21
    s_add_u32 s21, s21, 1024
    buffer_load_dwordx4 v2, s[8:11], s20 offen lds
    s_add_u32 s20, s20, 20480
    s_mov_b32 m0, s21
    s_add_u32 s21, s21, 1024
    buffer_load_dwordx4 v2, s[8:11], s20 offen lds
    s_add_u32 s20, s20, 20480
    s_mov_b32 m0, s21
    s_add_u32 s21, s21, 1024
    buffer_load_dwordx4 v2, s[8:11], s20 offen lds
    s_add_u32 s20, s20, 20480
    s_mov_b32 m0, s21
    s_add_u32 s21, s21, 1024
    buffer_load_dwordx4 v2, s[8:11], s20 offen lds
    s_add_u32 s20, s20, 20480
    s_lshl_b32 s20, s16, 3
    s_add_u32 s20, s20, 2
    s_mul_i32 s20, s20, 245760
    s_lshl_b32 s21, s12, 6
    s_add_u32 s20, s20, s21
    s_mul_i32 s21, s16, 36864
    s_add_u32 s21, s21, 24576
    s_mov_b32 m0, s21
    s_add_u32 s21, s21, 1024
    buffer_load_dwordx4 v2, s[8:11], s20 offen lds
    s_add_u32 s20, s20, 20480
    s_mov_b32 m0, s21
    s_add_u32 s21, s21, 1024
    buffer_load_dwordx4 v2, s[8:11], s20 offen lds
    s_add_u32 s20, s20, 20480
    s_mov_b32 m0, s21
    s_add_u32 s21, s21, 1024
    buffer_load_dwordx4 v2, s[8:11], s20 offen lds
    s_add_u32 s20, s20, 20480
    s_mov_b32 m0, s21
    s_add_u32 s21, s21, 1024
    buffer_load_dwordx4 v2, s[8:11], s20 offen lds
    s_add_u32 s20, s20, 20480
    s_mov_b32 m0, s21
    s_add_u32 s21, s21, 1024
    buffer_load_dwordx4 v2, s[8:11], s20 offen lds
    s_add_u32 s20, s20, 20480
    s_mov_b32 m0, s21
    s_add_u32 s21, s21, 1024
    buffer_load_dwordx4 v2, s[8:11], s20 offen lds
    s_add_u32 s20, s20, 20480
    s_mov_b32 m0, s21
    s_add_u32 s21, s21, 1024
    buffer_load_dwordx4 v2, s[8:11], s20 offen lds
    s_add_u32 s20, s20, 20480
    s_mov_b32 m0, s21
    s_add_u32 s21, s21, 1024
    buffer_load_dwordx4 v2, s[8:11], s20 offen lds
    s_add_u32 s20, s20, 20480
    s_mov_b32 m0, s21
    s_add_u32 s21, s21, 1024
    buffer_load_dwordx4 v2, s[8:11], s20 offen lds
    s_add_u32 s20, s20, 20480
    s_mov_b32 m0, s21
    s_add_u32 s21, s21, 1024
    buffer_load_dwordx4 v2, s[8:11], s20 offen lds
    s_add_u32 s20, s20, 20480
    s_mov_b32 m0, s21
    s_add_u32 s21, s21, 1024
    buffer_load_dwordx4 v2, s[8:11], s20 offen lds
    s_add_u32 s20, s20, 20480
    s_mov_b32 m0, s21
    s_add_u32 s21, s21, 1024
    buffer_load_dwordx4 v2, s[8:11], s20 offen lds
    s_add_u32 s20, s20, 20480
    s_waitcnt vmcnt(24)
    ds_read_b64_tr_b16 a[0:1], v3 offset:0
    ds_read_b64_tr_b16 a[2:3], v3 offset:1024
    ds_read_b64_tr_b16 a[4:5], v3 offset:32
    ds_read_b64_tr_b16 a[6:7], v3 offset:1056
    ds_read_b64_tr_b16 a[8:9], v3 offset:2048
    ds_read_b64_tr_b16 a[10:11], v3 offset:3072
    ds_read_b64_tr_b16 a[12:13], v3 offset:2080
    ds_read_b64_tr_b16 a[14:15], v3 offset:3104
    ds_read_b64_tr_b16 a[16:17], v3 offset:4096
    ds_read_b64_tr_b16 a[18:19], v3 offset:5120
    ds_read_b64_tr_b16 a[20:21], v3 offset:4128
    ds_read_b64_tr_b16 a[22:23], v3 offset:5152
    ds_read_b64_tr_b16 a[24:25], v3 offset:6144
    ds_read_b64_tr_b16 a[26:27], v3 offset:7168
    ds_read_b64_tr_b16 a[28:29], v3 offset:6176
    ds_read_b64_tr_b16 a[30:31], v3 offset:7200
    ds_read_b64_tr_b16 a[32:33], v3 offset:8192
    ds_read_b64_tr_b16 a[34:35], v3 offset:9216
    ds_read_b64_tr_b16 a[36:37], v3 offset:8224
    ds_read_b64_tr_b16 a[38:39], v3 offset:9248
    ds_read_b64_tr_b16 a[40:41], v3 offset:10240
    ds_read_b64_tr_b16 a[42:43], v3 offset:11264
    ds_read_b64_tr_b16 a[44:45], v3 offset:10272
    ds_read_b64_tr_b16 a[46:47], v3 offset:11296
    s_waitcnt lgkmcnt(0)
    s_lshl_b32 s20, s16, 3
    s_add_u32 s20, s20, 3
    s_mul_i32 s20, s20, 245760
    s_lshl_b32 s21, s12, 6
    s_add_u32 s20, s20, s21
    s_mul_i32 s21, s16, 36864
    s_add_u32 s21, s21, 0
    s_mov_b32 m0, s21
    s_add_u32 s21, s21, 1024
    buffer_load_dwordx4 v2, s[8:11], s20 offen lds
    s_add_u32 s20, s20, 20480
    s_mov_b32 m0, s21
    s_add_u32 s21, s21, 1024
    buffer_load_dwordx4 v2, s[8:11], s20 offen lds
    s_add_u32 s20, s20, 20480
    s_mov_b32 m0, s21
    s_add_u32 s21, s21, 1024
    buffer_load_dwordx4 v2, s[8:11], s20 offen lds
    s_add_u32 s20, s20, 20480
    s_mov_b32 m0, s21
    s_add_u32 s21, s21, 1024
    buffer_load_dwordx4 v2, s[8:11], s20 offen lds
    s_add_u32 s20, s20, 20480
    s_mov_b32 m0, s21
    s_add_u32 s21, s21, 1024
    buffer_load_dwordx4 v2, s[8:11], s20 offen lds
    s_add_u32 s20, s20, 20480
    s_mov_b32 m0, s21
    s_add_u32 s21, s21, 1024
    buffer_load_dwordx4 v2, s[8:11], s20 offen lds
    s_add_u32 s20, s20, 20480
    s_mov_b32 m0, s21
    s_add_u32 s21, s21, 1024
    buffer_load_dwordx4 v2, s[8:11], s20 offen lds
    s_add_u32 s20, s20, 20480
    s_mov_b32 m0, s21
    s_add_u32 s21, s21, 1024
    buffer_load_dwordx4 v2, s[8:11], s20 offen lds
    s_add_u32 s20, s20, 20480
    s_mov_b32 m0, s21
    s_add_u32 s21, s21, 1024
    buffer_load_dwordx4 v2, s[8:11], s20 offen lds
    s_add_u32 s20, s20, 20480
    s_mov_b32 m0, s21
    s_add_u32 s21, s21, 1024
    buffer_load_dwordx4 v2, s[8:11], s20 offen lds
    s_add_u32 s20, s20, 20480
    s_mov_b32 m0, s21
    s_add_u32 s21, s21, 1024
    buffer_load_dwordx4 v2, s[8:11], s20 offen lds
    s_add_u32 s20, s20, 20480
    s_mov_b32 m0, s21
    s_add_u32 s21, s21, 1024
    buffer_load_dwordx4 v2, s[8:11], s20 offen lds
    s_add_u32 s20, s20, 20480
    s_waitcnt vmcnt(24)
    ds_read_b64_tr_b16 a[48:49], v3 offset:12288
    ds_read_b64_tr_b16 a[50:51], v3 offset:13312
    ds_read_b64_tr_b16 a[52:53], v3 offset:12320
    ds_read_b64_tr_b16 a[54:55], v3 offset:13344
    ds_read_b64_tr_b16 a[56:57], v3 offset:14336
    ds_read_b64_tr_b16 a[58:59], v3 offset:15360
    ds_read_b64_tr_b16 a[60:61], v3 offset:14368
    ds_read_b64_tr_b16 a[62:63], v3 offset:15392
    ds_read_b64_tr_b16 a[64:65], v3 offset:16384
    ds_read_b64_tr_b16 a[66:67], v3 offset:17408
    ds_read_b64_tr_b16 a[68:69], v3 offset:16416
    ds_read_b64_tr_b16 a[70:71], v3 offset:17440
    ds_read_b64_tr_b16 a[72:73], v3 offset:18432
    ds_read_b64_tr_b16 a[74:75], v3 offset:19456
    ds_read_b64_tr_b16 a[76:77], v3 offset:18464
    ds_read_b64_tr_b16 a[78:79], v3 offset:19488
    ds_read_b64_tr_b16 a[80:81], v3 offset:20480
    ds_read_b64_tr_b16 a[82:83], v3 offset:21504
    ds_read_b64_tr_b16 a[84:85], v3 offset:20512
    ds_read_b64_tr_b16 a[86:87], v3 offset:21536
    ds_read_b64_tr_b16 a[88:89], v3 offset:22528
    ds_read_b64_tr_b16 a[90:91], v3 offset:23552
    ds_read_b64_tr_b16 a[92:93], v3 offset:22560
    ds_read_b64_tr_b16 a[94:95], v3 offset:23584
    s_waitcnt lgkmcnt(0)
    s_lshl_b32 s20, s16, 3
    s_add_u32 s20, s20, 4
    s_mul_i32 s20, s20, 245760
    s_lshl_b32 s21, s12, 6
    s_add_u32 s20, s20, s21
    s_mul_i32 s21, s16, 36864
    s_add_u32 s21, s21, 12288
    s_mov_b32 m0, s21
    s_add_u32 s21, s21, 1024
    buffer_load_dwordx4 v2, s[8:11], s20 offen lds
    s_add_u32 s20, s20, 20480
    s_mov_b32 m0, s21
    s_add_u32 s21, s21, 1024
    buffer_load_dwordx4 v2, s[8:11], s20 offen lds
    s_add_u32 s20, s20, 20480
    s_mov_b32 m0, s21
    s_add_u32 s21, s21, 1024
    buffer_load_dwordx4 v2, s[8:11], s20 offen lds
    s_add_u32 s20, s20, 20480
    s_mov_b32 m0, s21
    s_add_u32 s21, s21, 1024
    buffer_load_dwordx4 v2, s[8:11], s20 offen lds
    s_add_u32 s20, s20, 20480
    s_mov_b32 m0, s21
    s_add_u32 s21, s21, 1024
    buffer_load_dwordx4 v2, s[8:11], s20 offen lds
    s_add_u32 s20, s20, 20480
    s_mov_b32 m0, s21
    s_add_u32 s21, s21, 1024
    buffer_load_dwordx4 v2, s[8:11], s20 offen lds
    s_add_u32 s20, s20, 20480
    s_mov_b32 m0, s21
    s_add_u32 s21, s21, 1024
    buffer_load_dwordx4 v2, s[8:11], s20 offen lds
    s_add_u32 s20, s20, 20480
    s_mov_b32 m0, s21
    s_add_u32 s21, s21, 1024
    buffer_load_dwordx4 v2, s[8:11], s20 offen lds
    s_add_u32 s20, s20, 20480
    s_mov_b32 m0, s21
    s_add_u32 s21, s21, 1024
    buffer_load_dwordx4 v2, s[8:11], s20 offen lds
    s_add_u32 s20, s20, 20480
    s_mov_b32 m0, s21
    s_add_u32 s21, s21, 1024
    buffer_load_dwordx4 v2, s[8:11], s20 offen lds
    s_add_u32 s20, s20, 20480
    s_mov_b32 m0, s21
    s_add_u32 s21, s21, 1024
    buffer_load_dwordx4 v2, s[8:11], s20 offen lds
    s_add_u32 s20, s20, 20480
    s_mov_b32 m0, s21
    s_add_u32 s21, s21, 1024
    buffer_load_dwordx4 v2, s[8:11], s20 offen lds
    s_add_u32 s20, s20, 20480
    s_waitcnt vmcnt(24)
    ds_read_b64_tr_b16 a[96:97], v3 offset:24576
    ds_read_b64_tr_b16 a[98:99], v3 offset:25600
    ds_read_b64_tr_b16 a[100:101], v3 offset:24608
    ds_read_b64_tr_b16 a[102:103], v3 offset:25632
    ds_read_b64_tr_b16 a[104:105], v3 offset:26624
    ds_read_b64_tr_b16 a[106:107], v3 offset:27648
    ds_read_b64_tr_b16 a[108:109], v3 offset:26656
    ds_read_b64_tr_b16 a[110:111], v3 offset:27680
    ds_read_b64_tr_b16 a[112:113], v3 offset:28672
    ds_read_b64_tr_b16 a[114:115], v3 offset:29696
    ds_read_b64_tr_b16 a[116:117], v3 offset:28704
    ds_read_b64_tr_b16 a[118:119], v3 offset:29728
    ds_read_b64_tr_b16 a[120:121], v3 offset:30720
    ds_read_b64_tr_b16 a[122:123], v3 offset:31744
    ds_read_b64_tr_b16 a[124:125], v3 offset:30752
    ds_read_b64_tr_b16 a[126:127], v3 offset:31776
    ds_read_b64_tr_b16 a[128:129], v3 offset:32768
    ds_read_b64_tr_b16 a[130:131], v3 offset:33792
    ds_read_b64_tr_b16 a[132:133], v3 offset:32800
    ds_read_b64_tr_b16 a[134:135], v3 offset:33824
    ds_read_b64_tr_b16 a[136:137], v3 offset:34816
    ds_read_b64_tr_b16 a[138:139], v3 offset:35840
    ds_read_b64_tr_b16 a[140:141], v3 offset:34848
    ds_read_b64_tr_b16 a[142:143], v3 offset:35872
    s_waitcnt lgkmcnt(0)
    s_lshl_b32 s20, s16, 3
    s_add_u32 s20, s20, 5
    s_mul_i32 s20, s20, 245760
    s_lshl_b32 s21, s12, 6
    s_add_u32 s20, s20, s21
    s_mul_i32 s21, s16, 36864
    s_add_u32 s21, s21, 24576
    s_mov_b32 m0, s21
    s_add_u32 s21, s21, 1024
    buffer_load_dwordx4 v2, s[8:11], s20 offen lds
    s_add_u32 s20, s20, 20480
    s_mov_b32 m0, s21
    s_add_u32 s21, s21, 1024
    buffer_load_dwordx4 v2, s[8:11], s20 offen lds
    s_add_u32 s20, s20, 20480
    s_mov_b32 m0, s21
    s_add_u32 s21, s21, 1024
    buffer_load_dwordx4 v2, s[8:11], s20 offen lds
    s_add_u32 s20, s20, 20480
    s_mov_b32 m0, s21
    s_add_u32 s21, s21, 1024
    buffer_load_dwordx4 v2, s[8:11], s20 offen lds
    s_add_u32 s20, s20, 20480
    s_mov_b32 m0, s21
    s_add_u32 s21, s21, 1024
    buffer_load_dwordx4 v2, s[8:11], s20 offen lds
    s_add_u32 s20, s20, 20480
    s_mov_b32 m0, s21
    s_add_u32 s21, s21, 1024
    buffer_load_dwordx4 v2, s[8:11], s20 offen lds
    s_add_u32 s20, s20, 20480
    s_mov_b32 m0, s21
    s_add_u32 s21, s21, 1024
    buffer_load_dwordx4 v2, s[8:11], s20 offen lds
    s_add_u32 s20, s20, 20480
    s_mov_b32 m0, s21
    s_add_u32 s21, s21, 1024
    buffer_load_dwordx4 v2, s[8:11], s20 offen lds
    s_add_u32 s20, s20, 20480
    s_mov_b32 m0, s21
    s_add_u32 s21, s21, 1024
    buffer_load_dwordx4 v2, s[8:11], s20 offen lds
    s_add_u32 s20, s20, 20480
    s_mov_b32 m0, s21
    s_add_u32 s21, s21, 1024
    buffer_load_dwordx4 v2, s[8:11], s20 offen lds
    s_add_u32 s20, s20, 20480
    s_mov_b32 m0, s21
    s_add_u32 s21, s21, 1024
    buffer_load_dwordx4 v2, s[8:11], s20 offen lds
    s_add_u32 s20, s20, 20480
    s_mov_b32 m0, s21
    s_add_u32 s21, s21, 1024
    buffer_load_dwordx4 v2, s[8:11], s20 offen lds
    s_add_u32 s20, s20, 20480
    s_waitcnt vmcnt(24)
    ds_read_b64_tr_b16 a[144:145], v3 offset:0
    ds_read_b64_tr_b16 a[146:147], v3 offset:1024
    ds_read_b64_tr_b16 a[148:149], v3 offset:32
    ds_read_b64_tr_b16 a[150:151], v3 offset:1056
    ds_read_b64_tr_b16 a[152:153], v3 offset:2048
    ds_read_b64_tr_b16 a[154:155], v3 offset:3072
    ds_read_b64_tr_b16 a[156:157], v3 offset:2080
    ds_read_b64_tr_b16 a[158:159], v3 offset:3104
    ds_read_b64_tr_b16 a[160:161], v3 offset:4096
    ds_read_b64_tr_b16 a[162:163], v3 offset:5120
    ds_read_b64_tr_b16 a[164:165], v3 offset:4128
    ds_read_b64_tr_b16 a[166:167], v3 offset:5152
    ds_read_b64_tr_b16 a[168:169], v3 offset:6144
    ds_read_b64_tr_b16 a[170:171], v3 offset:7168
    ds_read_b64_tr_b16 a[172:173], v3 offset:6176
    ds_read_b64_tr_b16 a[174:175], v3 offset:7200
    ds_read_b64_tr_b16 a[176:177], v3 offset:8192
    ds_read_b64_tr_b16 a[178:179], v3 offset:9216
    ds_read_b64_tr_b16 a[180:181], v3 offset:8224
    ds_read_b64_tr_b16 a[182:183], v3 offset:9248
    ds_read_b64_tr_b16 a[184:185], v3 offset:10240
    ds_read_b64_tr_b16 a[186:187], v3 offset:11264
    ds_read_b64_tr_b16 a[188:189], v3 offset:10272
    ds_read_b64_tr_b16 a[190:191], v3 offset:11296
    s_waitcnt lgkmcnt(0)
    s_lshl_b32 s20, s16, 3
    s_add_u32 s20, s20, 6
    s_mul_i32 s20, s20, 245760
    s_lshl_b32 s21, s12, 6
    s_add_u32 s20, s20, s21
    s_mul_i32 s21, s16, 36864
    s_add_u32 s21, s21, 0
    s_mov_b32 m0, s21
    s_add_u32 s21, s21, 1024
    buffer_load_dwordx4 v2, s[8:11], s20 offen lds
    s_add_u32 s20, s20, 20480
    s_mov_b32 m0, s21
    s_add_u32 s21, s21, 1024
    buffer_load_dwordx4 v2, s[8:11], s20 offen lds
    s_add_u32 s20, s20, 20480
    s_mov_b32 m0, s21
    s_add_u32 s21, s21, 1024
    buffer_load_dwordx4 v2, s[8:11], s20 offen lds
    s_add_u32 s20, s20, 20480
    s_mov_b32 m0, s21
    s_add_u32 s21, s21, 1024
    buffer_load_dwordx4 v2, s[8:11], s20 offen lds
    s_add_u32 s20, s20, 20480
    s_mov_b32 m0, s21
    s_add_u32 s21, s21, 1024
    buffer_load_dwordx4 v2, s[8:11], s20 offen lds
    s_add_u32 s20, s20, 20480
    s_mov_b32 m0, s21
    s_add_u32 s21, s21, 1024
    buffer_load_dwordx4 v2, s[8:11], s20 offen lds
    s_add_u32 s20, s20, 20480
    s_mov_b32 m0, s21
    s_add_u32 s21, s21, 1024
    buffer_load_dwordx4 v2, s[8:11], s20 offen lds
    s_add_u32 s20, s20, 20480
    s_mov_b32 m0, s21
    s_add_u32 s21, s21, 1024
    buffer_load_dwordx4 v2, s[8:11], s20 offen lds
    s_add_u32 s20, s20, 20480
    s_mov_b32 m0, s21
    s_add_u32 s21, s21, 1024
    buffer_load_dwordx4 v2, s[8:11], s20 offen lds
    s_add_u32 s20, s20, 20480
    s_mov_b32 m0, s21
    s_add_u32 s21, s21, 1024
    buffer_load_dwordx4 v2, s[8:11], s20 offen lds
    s_add_u32 s20, s20, 20480
    s_mov_b32 m0, s21
    s_add_u32 s21, s21, 1024
    buffer_load_dwordx4 v2, s[8:11], s20 offen lds
    s_add_u32 s20, s20, 20480
    s_mov_b32 m0, s21
    s_add_u32 s21, s21, 1024
    buffer_load_dwordx4 v2, s[8:11], s20 offen lds
    s_add_u32 s20, s20, 20480
    s_waitcnt vmcnt(24)
    ds_read_b64_tr_b16 a[192:193], v3 offset:12288
    ds_read_b64_tr_b16 a[194:195], v3 offset:13312
    ds_read_b64_tr_b16 a[196:197], v3 offset:12320
    ds_read_b64_tr_b16 a[198:199], v3 offset:13344
    ds_read_b64_tr_b16 a[200:201], v3 offset:14336
    ds_read_b64_tr_b16 a[202:203], v3 offset:15360
    ds_read_b64_tr_b16 a[204:205], v3 offset:14368
    ds_read_b64_tr_b16 a[206:207], v3 offset:15392
    ds_read_b64_tr_b16 a[208:209], v3 offset:16384
    ds_read_b64_tr_b16 a[210:211], v3 offset:17408
    ds_read_b64_tr_b16 a[212:213], v3 offset:16416
    ds_read_b64_tr_b16 a[214:215], v3 offset:17440
    ds_read_b64_tr_b16 a[216:217], v3 offset:18432
    ds_read_b64_tr_b16 a[218:219], v3 offset:19456
    ds_read_b64_tr_b16 a[220:221], v3 offset:18464
    ds_read_b64_tr_b16 a[222:223], v3 offset:19488
    ds_read_b64_tr_b16 a[224:225], v3 offset:20480
    ds_read_b64_tr_b16 a[226:227], v3 offset:21504
    ds_read_b64_tr_b16 a[228:229], v3 offset:20512
    ds_read_b64_tr_b16 a[230:231], v3 offset:21536
    ds_read_b64_tr_b16 a[232:233], v3 offset:22528
    ds_read_b64_tr_b16 a[234:235], v3 offset:23552
    ds_read_b64_tr_b16 a[236:237], v3 offset:22560
    ds_read_b64_tr_b16 a[238:239], v3 offset:23584
    s_waitcnt lgkmcnt(0)
    s_lshl_b32 s20, s16, 3
    s_add_u32 s20, s20, 7
    s_mul_i32 s20, s20, 245760
    s_lshl_b32 s21, s12, 6
    s_add_u32 s20, s20, s21
    s_mul_i32 s21, s16, 36864
    s_add_u32 s21, s21, 12288
    s_mov_b32 m0, s21
    s_add_u32 s21, s21, 1024
    buffer_load_dwordx4 v2, s[8:11], s20 offen lds
    s_add_u32 s20, s20, 20480
    s_mov_b32 m0, s21
    s_add_u32 s21, s21, 1024
    buffer_load_dwordx4 v2, s[8:11], s20 offen lds
    s_add_u32 s20, s20, 20480
    s_mov_b32 m0, s21
    s_add_u32 s21, s21, 1024
    buffer_load_dwordx4 v2, s[8:11], s20 offen lds
    s_add_u32 s20, s20, 20480
    s_mov_b32 m0, s21
    s_add_u32 s21, s21, 1024
    buffer_load_dwordx4 v2, s[8:11], s20 offen lds
    s_add_u32 s20, s20, 20480
    s_mov_b32 m0, s21
    s_add_u32 s21, s21, 1024
    buffer_load_dwordx4 v2, s[8:11], s20 offen lds
    s_add_u32 s20, s20, 20480
    s_mov_b32 m0, s21
    s_add_u32 s21, s21, 1024
    buffer_load_dwordx4 v2, s[8:11], s20 offen lds
    s_add_u32 s20, s20, 20480
    s_mov_b32 m0, s21
    s_add_u32 s21, s21, 1024
    buffer_load_dwordx4 v2, s[8:11], s20 offen lds
    s_add_u32 s20, s20, 20480
    s_mov_b32 m0, s21
    s_add_u32 s21, s21, 1024
    buffer_load_dwordx4 v2, s[8:11], s20 offen lds
    s_add_u32 s20, s20, 20480
    s_mov_b32 m0, s21
    s_add_u32 s21, s21, 1024
    buffer_load_dwordx4 v2, s[8:11], s20 offen lds
    s_add_u32 s20, s20, 20480
    s_mov_b32 m0, s21
    s_add_u32 s21, s21, 1024
    buffer_load_dwordx4 v2, s[8:11], s20 offen lds
    s_add_u32 s20, s20, 20480
    s_mov_b32 m0, s21
    s_add_u32 s21, s21, 1024
    buffer_load_dwordx4 v2, s[8:11], s20 offen lds
    s_add_u32 s20, s20, 20480
    s_mov_b32 m0, s21
    s_add_u32 s21, s21, 1024
    buffer_load_dwordx4 v2, s[8:11], s20 offen lds
    s_add_u32 s20, s20, 20480
    s_waitcnt vmcnt(24)
    ds_read_b64_tr_b16 a[240:241], v3 offset:24576
    ds_read_b64_tr_b16 a[242:243], v3 offset:25600
    ds_read_b64_tr_b16 a[244:245], v3 offset:24608
    ds_read_b64_tr_b16 a[246:247], v3 offset:25632
    ds_read_b64_tr_b16 a[248:249], v3 offset:26624
    ds_read_b64_tr_b16 a[250:251], v3 offset:27648
    ds_read_b64_tr_b16 a[252:253], v3 offset:26656
    ds_read_b64_tr_b16 a[254:255], v3 offset:27680
    ds_read_b64_tr_b16 v[128:129], v3 offset:28672
    ds_read_b64_tr_b16 v[130:131], v3 offset:29696
    ds_read_b64_tr_b16 v[132:133], v3 offset:28704
    ds_read_b64_tr_b16 v[134:135], v3 offset:29728
    ds_read_b64_tr_b16 v[136:137], v3 offset:30720
    ds_read_b64_tr_b16 v[138:139], v3 offset:31744
    ds_read_b64_tr_b16 v[140:141], v3 offset:30752
    ds_read_b64_tr_b16 v[142:143], v3 offset:31776
    ds_read_b64_tr_b16 v[144:145], v3 offset:32768
    ds_read_b64_tr_b16 v[146:147], v3 offset:33792
    ds_read_b64_tr_b16 v[148:149], v3 offset:32800
    ds_read_b64_tr_b16 v[150:151], v3 offset:33824
    ds_read_b64_tr_b16 v[152:153], v3 offset:34816
    ds_read_b64_tr_b16 v[154:155], v3 offset:35840
    ds_read_b64_tr_b16 v[156:157], v3 offset:34848
    ds_read_b64_tr_b16 v[158:159], v3 offset:35872
    s_waitcnt lgkmcnt(0)
    s_waitcnt vmcnt(12)
    ds_read_b64_tr_b16 v[160:161], v3 offset:0
    ds_read_b64_tr_b16 v[162:163], v3 offset:1024
    ds_read_b64_tr_b16 v[164:165], v3 offset:32
    ds_read_b64_tr_b16 v[166:167], v3 offset:1056
    ds_read_b64_tr_b16 v[168:169], v3 offset:2048
    ds_read_b64_tr_b16 v[170:171], v3 offset:3072
    ds_read_b64_tr_b16 v[172:173], v3 offset:2080
    ds_read_b64_tr_b16 v[174:175], v3 offset:3104
    ds_read_b64_tr_b16 v[176:177], v3 offset:4096
    ds_read_b64_tr_b16 v[178:179], v3 offset:5120
    ds_read_b64_tr_b16 v[180:181], v3 offset:4128
    ds_read_b64_tr_b16 v[182:183], v3 offset:5152
    ds_read_b64_tr_b16 v[184:185], v3 offset:6144
    ds_read_b64_tr_b16 v[186:187], v3 offset:7168
    ds_read_b64_tr_b16 v[188:189], v3 offset:6176
    ds_read_b64_tr_b16 v[190:191], v3 offset:7200
    ds_read_b64_tr_b16 v[192:193], v3 offset:8192
    ds_read_b64_tr_b16 v[194:195], v3 offset:9216
    ds_read_b64_tr_b16 v[196:197], v3 offset:8224
    ds_read_b64_tr_b16 v[198:199], v3 offset:9248
    ds_read_b64_tr_b16 v[200:201], v3 offset:10240
    ds_read_b64_tr_b16 v[202:203], v3 offset:11264
    ds_read_b64_tr_b16 v[204:205], v3 offset:10272
    ds_read_b64_tr_b16 v[206:207], v3 offset:11296
    s_waitcnt lgkmcnt(0)
    s_waitcnt vmcnt(0)
    ds_read_b64_tr_b16 v[208:209], v3 offset:12288
    ds_read_b64_tr_b16 v[210:211], v3 offset:13312
    ds_read_b64_tr_b16 v[212:213], v3 offset:12320
    ds_read_b64_tr_b16 v[214:215], v3 offset:13344
    ds_read_b64_tr_b16 v[216:217], v3 offset:14336
    ds_read_b64_tr_b16 v[218:219], v3 offset:15360
    ds_read_b64_tr_b16 v[220:221], v3 offset:14368
    ds_read_b64_tr_b16 v[222:223], v3 offset:15392
    ds_read_b64_tr_b16 v[224:225], v3 offset:16384
    ds_read_b64_tr_b16 v[226:227], v3 offset:17408
    ds_read_b64_tr_b16 v[228:229], v3 offset:16416
    ds_read_b64_tr_b16 v[230:231], v3 offset:17440
    ds_read_b64_tr_b16 v[232:233], v3 offset:18432
    ds_read_b64_tr_b16 v[234:235], v3 offset:19456
    ds_read_b64_tr_b16 v[236:237], v3 offset:18464
    ds_read_b64_tr_b16 v[238:239], v3 offset:19488
    ds_read_b64_tr_b16 v[240:241], v3 offset:20480
    ds_read_b64_tr_b16 v[242:243], v3 offset:21504
    ds_read_b64_tr_b16 v[244:245], v3 offset:20512
    ds_read_b64_tr_b16 v[246:247], v3 offset:21536
    ds_read_b64_tr_b16 v[248:249], v3 offset:22528
    ds_read_b64_tr_b16 v[250:251], v3 offset:23552
    ds_read_b64_tr_b16 v[252:253], v3 offset:22560
    ds_read_b64_tr_b16 v[254:255], v3 offset:23584
    s_waitcnt lgkmcnt(0)
    v_and_b32 v24, 15, v0
    v_mul_u32_u24 v24, 2560, v24
    v_lshrrev_b32 v25, 4, v0
    v_lshlrev_b32 v25, 3, v25
    v_add_u32 v6, v24, v25
    s_lshl_b32 s20, s16, 12
    s_add_u32 s20, s20, 147456
    v_add_u32 v7, s20, v1
    s_mov_b32 s17, s13
    s_barrier
L_oproj_loop:
    s_add_u32 s18, s17, 1
    s_and_b32 s20, s17, 7
    s_lshl_b32 s20, s20, 7
    s_add_u32 s42, s20, 125837312
    s_lshl_b32 s20, s16, 5
    s_add_u32 s42, s42, s20
    v_and_b32 v4, 7, v0
    v_lshlrev_b32 v4, 2, v4
    s_mov_b32 s24, 0
Lo_420:
    buffer_load_dword v5, v4, s[4:7], s42 offen sc1
    s_waitcnt vmcnt(0)
    v_cmp_gt_u32 vcc, s18, v5
    s_cbranch_vccz Lo_421
    s_sleep 16
    s_add_u32 s24, s24, 1
    s_cmp_lt_u32 s24, 1600000
    s_cbranch_scc1 Lo_420
    s_branch L_abort
Lo_421:
    s_lshl_b32 s20, s17, 5
    s_lshl_b32 s21, s16, 3
    s_add_u32 s20, s20, s21
    s_mul_i32 s19, s20, 12288
    s_add_u32 s19, s19, 75497472
    s_add_u32 s23, s19, 0
    buffer_load_dwordx4 v[24:27], v1, s[4:7], s23 offen sc1
    s_add_u32 s23, s19, 6144
    buffer_load_dwordx4 v[28:31], v1, s[4:7], s23 offen sc1
    s_add_u32 s23, s19, 1024
    buffer_load_dwordx4 v[32:35], v1, s[4:7], s23 offen sc1
    s_add_u32 s23, s19, 7168
    buffer_load_dwordx4 v[36:39], v1, s[4:7], s23 offen sc1
    s_add_u32 s23, s19, 2048
    buffer_load_dwordx4 v[40:43], v1, s[4:7], s23 offen sc1
    s_add_u32 s23, s19, 8192
    buffer_load_dwordx4 v[44:47], v1, s[4:7], s23 offen sc1
    s_add_u32 s23, s19, 3072
    buffer_load_dwordx4 v[48:51], v1, s[4:7], s23 offen sc1
    s_add_u32 s23, s19, 9216
    buffer_load_dwordx4 v[52:55], v1, s[4:7], s23 offen sc1
    s_add_u32 s23, s19, 4096
    buffer_load_dwordx4 v[56:59], v1, s[4:7], s23 offen sc1
    s_add_u32 s23, s19, 10240
    buffer_load_dwordx4 v[60:63], v1, s[4:7], s23 offen sc1
    s_add_u32 s23, s19, 5120
    buffer_load_dwordx4 v[64:67], v1, s[4:7], s23 offen sc1
    s_add_u32 s23, s19, 11264
    buffer_load_dwordx4 v[68:71], v1, s[4:7], s23 offen sc1
    s_add_u32 s23, s19, 12288
    buffer_load_dwordx4 v[72:75], v1, s[4:7], s23 offen sc1
    s_add_u32 s23, s19, 18432
    buffer_load_dwordx4 v[76:79], v1, s[4:7], s23 offen sc1
    s_add_u32 s23, s19, 13312
    buffer_load_dwordx4 v[80:83], v1, s[4:7], s23 offen sc1
    s_add_u32 s23, s19, 19456
    buffer_load_dwordx4 v[84:87], v1, s[4:7], s23 offen sc1
    s_add_u32 s23, s19, 14336
    buffer_load_dwordx4 v[88:91], v1, s[4:7], s23 offen sc1
    s_add_u32 s23, s19, 20480
    buffer_load_dwordx4 v[92:95], v1, s[4:7], s23 offen sc1
    s_add_u32 s23, s19, 15360
    buffer_load_dwordx4 v[96:99], v1, s[4:7], s23 offen sc1
    s_add_u32 s23, s19, 21504
    buffer_load_dwordx4 v[100:103], v1, s[4:7], s23 offen sc1
    s_add_u32 s23, s19, 16384
    buffer_load_dwordx4 v[104:107], v1, s[4:7], s23 offen sc1
    s_add_u32 s23, s19, 22528
    buffer_load_dwordx4 v[108:111], v1, s[4:7], s23 offen sc1
    s_add_u32 s23, s19, 17408
    buffer_load_dwordx4 v[112:115], v1, s[4:7], s23 offen sc1
    s_add_u32 s23, s19, 23552
    buffer_load_dwordx4 v[116:119], v1, s[4:7], s23 offen sc1
    s_waitcnt vmcnt(23)
    v_mfma_f32_16x16x32_bf16 v[8:11], a[0:3], v[24:27], 0
    v_mfma_f32_16x16x32_bf16 v[12:15], a[4:7], v[24:27], 0
    s_add_u32 s23, s19, 24576
    buffer_load_dwordx4 v[24:27], v1, s[4:7], s23 offen sc1
    s_waitcnt vmcnt(23)
    v_mfma_f32_16x16x32_bf16 v[16:19], a[0:3], v[28:31], 0
    v_mfma_f32_16x16x32_bf16 v[20:23], a[4:7], v[28:31], 0
    s_add_u32 s23, s19, 30720
    buffer_load_dwordx4 v[28:31], v1, s[4:7], s23 offen sc1
    s_waitcnt vmcnt(23)
    v_mfma_f32_16x16x32_bf16 v[8:11], a[8:11], v[32:35], v[8:11]
    v_mfma_f32_16x16x32_bf16 v[12:15], a[12:15], v[32:35], v[12:15]
    s_add_u32 s23, s19, 25600
    buffer_load_dwordx4 v[32:35], v1, s[4:7], s23 offen sc1
    s_waitcnt vmcnt(23)
    v_mfma_f32_16x16x32_bf16 v[16:19], a[8:11], v[36:39], v[16:19]
    v_mfma_f32_16x16x32_bf16 v[20:23], a[12:15], v[36:39], v[20:23]
    s_add_u32 s23, s19, 31744
    buffer_load_dwordx4 v[36:39], v1, s[4:7], s23 offen sc1
    s_waitcnt vmcnt(23)
    v_mfma_f32_16x16x32_bf16 v[8:11], a[16:19], v[40:43], v[8:11]
    v_mfma_f32_16x16x32_bf16 v[12:15], a[20:23], v[40:43], v[12:15]
    s_add_u32 s23, s19, 26624
    buffer_load_dwordx4 v[40:43], v1, s[4:7], s23 offen sc1
    s_waitcnt vmcnt(23)
    v_mfma_f32_16x16x32_bf16 v[16:19], a[16:19], v[44:47], v[16:19]
    v_mfma_f32_16x16x32_bf16 v[20:23], a[20:23], v[44:47], v[20:23]
    s_add_u32 s23, s19, 32768
    buffer_load_dwordx4 v[44:47], v1, s[4:7], s23 offen sc1
    s_waitcnt vmcnt(23)
    v_mfma_f32_16x16x32_bf16 v[8:11], a[24:27], v[48:51], v[8:11]
    v_mfma_f32_16x16x32_bf16 v[12:15], a[28:31], v[48:51], v[12:15]
    s_add_u32 s23, s19, 27648
    buffer_load_dwordx4 v[48:51], v1, s[4:7], s23 offen sc1
    s_waitcnt vmcnt(23)
    v_mfma_f32_16x16x32_bf16 v[16:19], a[24:27], v[52:55], v[16:19]
    v_mfma_f32_16x16x32_bf16 v[20:23], a[28:31], v[52:55], v[20:23]
    s_add_u32 s23, s19, 33792
    buffer_load_dwordx4 v[52:55], v1, s[4:7], s23 offen sc1
    s_waitcnt vmcnt(23)
    v_mfma_f32_16x16x32_bf16 v[8:11], a[32:35], v[56:59], v[8:11]
    v_mfma_f32_16x16x32_bf16 v[12:15], a[36:39], v[56:59], v[12:15]
    s_add_u32 s23, s19, 28672
    buffer_load_dwordx4 v[56:59], v1, s[4:7], s23 offen sc1
    s_waitcnt vmcnt(23)
    v_mfma_f32_16x16x32_bf16 v[16:19], a[32:35], v[60:63], v[16:19]
    v_mfma_f32_16x16x32_bf16 v[20:23], a[36:39], v[60:63], v[20:23]
    s_add_u32 s23, s19, 34816
    buffer_load_dwordx4 v[60:63], v1, s[4:7], s23 offen sc1
    s_waitcnt vmcnt(23)
    v_mfma_f32_16x16x32_bf16 v[8:11], a[40:43], v[64:67], v[8:11]
    v_mfma_f32_16x16x32_bf16 v[12:15], a[44:47], v[64:67], v[12:15]
    s_add_u32 s23, s19, 29696
    buffer_load_dwordx4 v[64:67], v1, s[4:7], s23 offen sc1
    s_waitcnt vmcnt(23)
    v_mfma_f32_16x16x32_bf16 v[16:19], a[40:43], v[68:71], v[16:19]
    v_mfma_f32_16x16x32_bf16 v[20:23], a[44:47], v[68:71], v[20:23]
    s_add_u32 s23, s19, 35840
    buffer_load_dwordx4 v[68:71], v1, s[4:7], s23 offen sc1
    s_waitcnt vmcnt(23)
    v_mfma_f32_16x16x32_bf16 v[8:11], a[48:51], v[72:75], v[8:11]
    v_mfma_f32_16x16x32_bf16 v[12:15], a[52:55], v[72:75], v[12:15]
    s_add_u32 s23, s19, 36864
    buffer_load_dwordx4 v[72:75], v1, s[4:7], s23 offen sc1
    s_waitcnt vmcnt(23)
    v_mfma_f32_16x16x32_bf16 v[16:19], a[48:51], v[76:79], v[16:19]
    v_mfma_f32_16x16x32_bf16 v[20:23], a[52:55], v[76:79], v[20:23]
    s_add_u32 s23, s19, 43008
    buffer_load_dwordx4 v[76:79], v1, s[4:7], s23 offen sc1
    s_waitcnt vmcnt(23)
    v_mfma_f32_16x16x32_bf16 v[8:11], a[56:59], v[80:83], v[8:11]
    v_mfma_f32_16x16x32_bf16 v[12:15], a[60:63], v[80:83], v[12:15]
    s_add_u32 s23, s19, 37888
    buffer_load_dwordx4 v[80:83], v1, s[4:7], s23 offen sc1
    s_waitcnt vmcnt(23)
    v_mfma_f32_16x16x32_bf16 v[16:19], a[56:59], v[84:87], v[16:19]
    v_mfma_f32_16x16x32_bf16 v[20:23], a[60:63], v[84:87], v[20:23]
    s_add_u32 s23, s19, 44032
    buffer_load_dwordx4 v[84:87], v1, s[4:7], s23 offen sc1
    s_waitcnt vmcnt(23)
    v_mfma_f32_16x16x32_bf16 v[8:11], a[64:67], v[88:91], v[8:11]
    v_mfma_f32_16x16x32_bf16 v[12:15], a[68:71], v[88:91], v[12:15]
    s_add_u32 s23, s19, 38912
    buffer_load_dwordx4 v[88:91], v1, s[4:7], s23 offen sc1
    s_waitcnt vmcnt(23)
    v_mfma_f32_16x16x32_bf16 v[16:19], a[64:67], v[92:95], v[16:19]
    v_mfma_f32_16x16x32_bf16 v[20:23], a[68:71], v[92:95], v[20:23]
    s_add_u32 s23, s19, 45056
    buffer_load_dwordx4 v[92:95], v1, s[4:7], s23 offen sc1
    s_waitcnt vmcnt(23)
    v_mfma_f32_16x16x32_bf16 v[8:11], a[72:75], v[96:99], v[8:11]
    v_mfma_f32_16x16x32_bf16 v[12:15], a[76:79], v[96:99], v[12:15]
    s_add_u32 s23, s19, 39936
    buffer_load_dwordx4 v[96:99], v1, s[4:7], s23 offen sc1
    s_waitcnt vmcnt(23)
    v_mfma_f32_16x16x32_bf16 v[16:19], a[72:75], v[100:103], v[16:19]
    v_mfma_f32_16x16x32_bf16 v[20:23], a[76:79], v[100:103], v[20:23]
    s_add_u32 s23, s19, 46080
    buffer_load_dwordx4 v[100:103], v1, s[4:7], s23 offen sc1
    s_waitcnt vmcnt(23)
    v_mfma_f32_16x16x32_bf16 v[8:11], a[80:83], v[104:107], v[8:11]
    v_mfma_f32_16x16x32_bf16 v[12:15], a[84:87], v[104:107], v[12:15]
    s_add_u32 s23, s19, 40960
    buffer_load_dwordx4 v[104:107], v1, s[4:7], s23 offen sc1
    s_waitcnt vmcnt(23)
    v_mfma_f32_16x16x32_bf16 v[16:19], a[80:83], v[108:111], v[16:19]
    v_mfma_f32_16x16x32_bf16 v[20:23], a[84:87], v[108:111], v[20:23]
    s_add_u32 s23, s19, 47104
    buffer_load_dwordx4 v[108:111], v1, s[4:7], s23 offen sc1
    s_waitcnt vmcnt(23)
    v_mfma_f32_16x16x32_bf16 v[8:11], a[88:91], v[112:115], v[8:11]
    v_mfma_f32_16x16x32_bf16 v[12:15], a[92:95], v[112:115], v[12:15]
    s_add_u32 s23, s19, 41984
    buffer_load_dwordx4 v[112:115], v1, s[4:7], s23 offen sc1
    s_waitcnt vmcnt(23)
    v_mfma_f32_16x16x32_bf16 v[16:19], a[88:91], v[116:119], v[16:19]
    v_mfma_f32_16x16x32_bf16 v[20:23], a[92:95], v[116:119], v[20:23]
    s_add_u32 s23, s19, 48128
    buffer_load_dwordx4 v[116:119], v1, s[4:7], s23 offen sc1
    s_waitcnt vmcnt(23)
    v_mfma_f32_16x16x32_bf16 v[8:11], a[96:99], v[24:27], v[8:11]
    v_mfma_f32_16x16x32_bf16 v[12:15], a[100:103], v[24:27], v[12:15]
    s_add_u32 s23, s19, 49152
    buffer_load_dwordx4 v[24:27], v1, s[4:7], s23 offen sc1
    s_waitcnt vmcnt(23)
    v_mfma_f32_16x16x32_bf16 v[16:19], a[96:99], v[28:31], v[16:19]
    v_mfma_f32_16x16x32_bf16 v[20:23], a[100:103], v[28:31], v[20:23]
    s_add_u32 s23, s19, 55296
    buffer_load_dwordx4 v[28:31], v1, s[4:7], s23 offen sc1
    s_waitcnt vmcnt(23)
    v_mfma_f32_16x16x32_bf16 v[8:11], a[104:107], v[32:35], v[8:11]
    v_mfma_f32_16x16x32_bf16 v[12:15], a[108:111], v[32:35], v[12:15]
    s_add_u32 s23, s19, 50176
    buffer_load_dwordx4 v[32:35], v1, s[4:7], s23 offen sc1
    s_waitcnt vmcnt(23)
    v_mfma_f32_16x16x32_bf16 v[16:19], a[104:107], v[36:39], v[16:19]
    v_mfma_f32_16x16x32_bf16 v[20:23], a[108:111], v[36:39], v[20:23]
    s_add_u32 s23, s19, 56320
    buffer_load_dwordx4 v[36:39], v1, s[4:7], s23 offen sc1
    s_waitcnt vmcnt(23)
    v_mfma_f32_16x16x32_bf16 v[8:11], a[112:115], v[40:43], v[8:11]
    v_mfma_f32_16x16x32_bf16 v[12:15], a[116:119], v[40:43], v[12:15]
    s_add_u32 s23, s19, 51200
    buffer_load_dwordx4 v[40:43], v1, s[4:7], s23 offen sc1
    s_waitcnt vmcnt(23)
    v_mfma_f32_16x16x32_bf16 v[16:19], a[112:115], v[44:47], v[16:19]
    v_mfma_f32_16x16x32_bf16 v[20:23], a[116:119], v[44:47], v[20:23]
    s_add_u32 s23, s19, 57344
    buffer_load_dwordx4 v[44:47], v1, s[4:7], s23 offen sc1
    s_waitcnt vmcnt(23)
    v_mfma_f32_16x16x32_bf16 v[8:11], a[120:123], v[48:51], v[8:11]
    v_mfma_f32_16x16x32_bf16 v[12:15], a[124:127], v[48:51], v[12:15]
    s_add_u32 s23, s19, 52224
    buffer_load_dwordx4 v[48:51], v1, s[4:7], s23 offen sc1
    s_waitcnt vmcnt(23)
    v_mfma_f32_16x16x32_bf16 v[16:19], a[120:123], v[52:55], v[16:19]
    v_mfma_f32_16x16x32_bf16 v[20:23], a[124:127], v[52:55], v[20:23]
    s_add_u32 s23, s19, 58368
    buffer_load_dwordx4 v[52:55], v1, s[4:7], s23 offen sc1
    s_waitcnt vmcnt(23)
    v_mfma_f32_16x16x32_bf16 v[8:11], a[128:131], v[56:59], v[8:11]
    v_mfma_f32_16x16x32_bf16 v[12:15], a[132:135], v[56:59], v[12:15]
    s_add_u32 s23, s19, 53248
    buffer_load_dwordx4 v[56:59], v1, s[4:7], s23 offen sc1
    s_waitcnt vmcnt(23)
    v_mfma_f32_16x16x32_bf16 v[16:19], a[128:131], v[60:63], v[16:19]
    v_mfma_f32_16x16x32_bf16 v[20:23], a[132:135], v[60:63], v[20:23]
    s_add_u32 s23, s19, 59392
    buffer_load_dwordx4 v[60:63], v1, s[4:7], s23 offen sc1
    s_waitcnt vmcnt(23)
    v_mfma_f32_16x16x32_bf16 v[8:11], a[136:139], v[64:67], v[8:11]
    v_mfma_f32_16x16x32_bf16 v[12:15], a[140:143], v[64:67], v[12:15]
    s_add_u32 s23, s19, 54272
    buffer_load_dwordx4 v[64:67], v1, s[4:7], s23 offen sc1
    s_waitcnt vmcnt(23)
    v_mfma_f32_16x16x32_bf16 v[16:19], a[136:139], v[68:71], v[16:19]
    v_mfma_f32_16x16x32_bf16 v[20:23], a[140:143], v[68:71], v[20:23]
    s_add_u32 s23, s19, 60416
    buffer_load_dwordx4 v[68:71], v1, s[4:7], s23 offen sc1
    s_waitcnt vmcnt(23)
    v_mfma_f32_16x16x32_bf16 v[8:11], a[144:147], v[72:75], v[8:11]
    v_mfma_f32_16x16x32_bf16 v[12:15], a[148:151], v[72:75], v[12:15]
    s_add_u32 s23, s19, 61440
    buffer_load_dwordx4 v[72:75], v1, s[4:7], s23 offen sc1
    s_waitcnt vmcnt(23)
    v_mfma_f32_16x16x32_bf16 v[16:19], a[144:147], v[76:79], v[16:19]
    v_mfma_f32_16x16x32_bf16 v[20:23], a[148:151], v[76:79], v[20:23]
    s_add_u32 s23, s19, 67584
    buffer_load_dwordx4 v[76:79], v1, s[4:7], s23 offen sc1
    s_waitcnt vmcnt(23)
    v_mfma_f32_16x16x32_bf16 v[8:11], a[152:155], v[80:83], v[8:11]
    v_mfma_f32_16x16x32_bf16 v[12:15], a[156:159], v[80:83], v[12:15]
    s_add_u32 s23, s19, 62464
    buffer_load_dwordx4 v[80:83], v1, s[4:7], s23 offen sc1
    s_waitcnt vmcnt(23)
    v_mfma_f32_16x16x32_bf16 v[16:19], a[152:155], v[84:87], v[16:19]
    v_mfma_f32_16x16x32_bf16 v[20:23], a[156:159], v[84:87], v[20:23]
    s_add_u32 s23, s19, 68608
    buffer_load_dwordx4 v[84:87], v1, s[4:7], s23 offen sc1
    s_waitcnt vmcnt(23)
    v_mfma_f32_16x16x32_bf16 v[8:11], a[160:163], v[88:91], v[8:11]
    v_mfma_f32_16x16x32_bf16 v[12:15], a[164:167], v[88:91], v[12:15]
    s_add_u32 s23, s19, 63488
    buffer_load_dwordx4 v[88:91], v1, s[4:7], s23 offen sc1
    s_waitcnt vmcnt(23)
    v_mfma_f32_16x16x32_bf16 v[16:19], a[160:163], v[92:95], v[16:19]
    v_mfma_f32_16x16x32_bf16 v[20:23], a[164:167], v[92:95], v[20:23]
    s_add_u32 s23, s19, 69632
    buffer_load_dwordx4 v[92:95], v1, s[4:7], s23 offen sc1
    s_waitcnt vmcnt(23)
    v_mfma_f32_16x16x32_bf16 v[8:11], a[168:171], v[96:99], v[8:11]
    v_mfma_f32_16x16x32_bf16 v[12:15], a[172:175], v[96:99], v[12:15]
    s_add_u32 s23, s19, 64512
    buffer_load_dwordx4 v[96:99], v1, s[4:7], s23 offen sc1
    s_waitcnt vmcnt(23)
    v_mfma_f32_16x16x32_bf16 v[16:19], a[168:171], v[100:103], v[16:19]
    v_mfma_f32_16x16x32_bf16 v[20:23], a[172:175], v[100:103], v[20:23]
    s_add_u32 s23, s19, 70656
    buffer_load_dwordx4 v[100:103], v1, s[4:7], s23 offen sc1
    s_waitcnt vmcnt(23)
    v_mfma_f32_16x16x32_bf16 v[8:11], a[176:179], v[104:107], v[8:11]
    v_mfma_f32_16x16x32_bf16 v[12:15], a[180:183], v[104:107], v[12:15]
    s_add_u32 s23, s19, 65536
    buffer_load_dwordx4 v[104:107], v1, s[4:7], s23 offen sc1
    s_waitcnt vmcnt(23)
    v_mfma_f32_16x16x32_bf16 v[16:19], a[176:179], v[108:111], v[16:19]
    v_mfma_f32_16x16x32_bf16 v[20:23], a[180:183], v[108:111], v[20:23]
    s_add_u32 s23, s19, 71680
    buffer_load_dwordx4 v[108:111], v1, s[4:7], s23 offen sc1
    s_waitcnt vmcnt(23)
    v_mfma_f32_16x16x32_bf16 v[8:11], a[184:187], v[112:115], v[8:11]
    v_mfma_f32_16x16x32_bf16 v[12:15], a[188:191], v[112:115], v[12:15]
    s_add_u32 s23, s19, 66560
    buffer_load_dwordx4 v[112:115], v1, s[4:7], s23 offen sc1
    s_waitcnt vmcnt(23)
    v_mfma_f32_16x16x32_bf16 v[16:19], a[184:187], v[116:119], v[16:19]
    v_mfma_f32_16x16x32_bf16 v[20:23], a[188:191], v[116:119], v[20:23]
    s_add_u32 s23, s19, 72704
    buffer_load_dwordx4 v[116:119], v1, s[4:7], s23 offen sc1
    s_waitcnt vmcnt(23)
    v_mfma_f32_16x16x32_bf16 v[8:11], a[192:195], v[24:27], v[8:11]
    v_mfma_f32_16x16x32_bf16 v[12:15], a[196:199], v[24:27], v[12:15]
    s_add_u32 s23, s19, 73728
    buffer_load_dwordx4 v[24:27], v1, s[4:7], s23 offen sc1
    s_waitcnt vmcnt(23)
    v_mfma_f32_16x16x32_bf16 v[16:19], a[192:195], v[28:31], v[16:19]
    v_mfma_f32_16x16x32_bf16 v[20:23], a[196:199], v[28:31], v[20:23]
    s_add_u32 s23, s19, 79872
    buffer_load_dwordx4 v[28:31], v1, s[4:7], s23 offen sc1
    s_waitcnt vmcnt(23)
    v_mfma_f32_16x16x32_bf16 v[8:11], a[200:203], v[32:35], v[8:11]
    v_mfma_f32_16x16x32_bf16 v[12:15], a[204:207], v[32:35], v[12:15]
    s_add_u32 s23, s19, 74752
    buffer_load_dwordx4 v[32:35], v1, s[4:7], s23 offen sc1
    s_waitcnt vmcnt(23)
    v_mfma_f32_16x16x32_bf16 v[16:19], a[200:203], v[36:39], v[16:19]
    v_mfma_f32_16x16x32_bf16 v[20:23], a[204:207], v[36:39], v[20:23]
    s_add_u32 s23, s19, 80896
    buffer_load_dwordx4 v[36:39], v1, s[4:7], s23 offen sc1
    s_waitcnt vmcnt(23)
    v_mfma_f32_16x16x32_bf16 v[8:11], a[208:211], v[40:43], v[8:11]
    v_mfma_f32_16x16x32_bf16 v[12:15], a[212:215], v[40:43], v[12:15]
    s_add_u32 s23, s19, 75776
    buffer_load_dwordx4 v[40:43], v1, s[4:7], s23 offen sc1
    s_waitcnt vmcnt(23)
    v_mfma_f32_16x16x32_bf16 v[16:19], a[208:211], v[44:47], v[16:19]
    v_mfma_f32_16x16x32_bf16 v[20:23], a[212:215], v[44:47], v[20:23]
    s_add_u32 s23, s19, 81920
    buffer_load_dwordx4 v[44:47], v1, s[4:7], s23 offen sc1
    s_waitcnt vmcnt(23)
    v_mfma_f32_16x16x32_bf16 v[8:11], a[216:219], v[48:51], v[8:11]
    v_mfma_f32_16x16x32_bf16 v[12:15], a[220:223], v[48:51], v[12:15]
    s_add_u32 s23, s19, 76800
    buffer_load_dwordx4 v[48:51], v1, s[4:7], s23 offen sc1
    s_waitcnt vmcnt(23)
    v_mfma_f32_16x16x32_bf16 v[16:19], a[216:219], v[52:55], v[16:19]
    v_mfma_f32_16x16x32_bf16 v[20:23], a[220:223], v[52:55], v[20:23]
    s_add_u32 s23, s19, 82944
    buffer_load_dwordx4 v[52:55], v1, s[4:7], s23 offen sc1
    s_waitcnt vmcnt(23)
    v_mfma_f32_16x16x32_bf16 v[8:11], a[224:227], v[56:59], v[8:11]
    v_mfma_f32_16x16x32_bf16 v[12:15], a[228:231], v[56:59], v[12:15]
    s_add_u32 s23, s19, 77824
    buffer_load_dwordx4 v[56:59], v1, s[4:7], s23 offen sc1
    s_waitcnt vmcnt(23)
    v_mfma_f32_16x16x32_bf16 v[16:19], a[224:227], v[60:63], v[16:19]
    v_mfma_f32_16x16x32_bf16 v[20:23], a[228:231], v[60:63], v[20:23]
    s_add_u32 s23, s19, 83968
    buffer_load_dwordx4 v[60:63], v1, s[4:7], s23 offen sc1
    s_waitcnt vmcnt(23)
    v_mfma_f32_16x16x32_bf16 v[8:11], a[232:235], v[64:67], v[8:11]
    v_mfma_f32_16x16x32_bf16 v[12:15], a[236:239], v[64:67], v[12:15]
    s_add_u32 s23, s19, 78848
    buffer_load_dwordx4 v[64:67], v1, s[4:7], s23 offen sc1
    s_waitcnt vmcnt(23)
    v_mfma_f32_16x16x32_bf16 v[16:19], a[232:235], v[68:71], v[16:19]
    v_mfma_f32_16x16x32_bf16 v[20:23], a[236:239], v[68:71], v[20:23]
    s_add_u32 s23, s19, 84992
    buffer_load_dwordx4 v[68:71], v1, s[4:7], s23 offen sc1
    s_waitcnt vmcnt(23)
    v_mfma_f32_16x16x32_bf16 v[8:11], a[240:243], v[72:75], v[8:11]
    v_mfma_f32_16x16x32_bf16 v[12:15], a[244:247], v[72:75], v[12:15]
    s_add_u32 s23, s19, 86016
    buffer_load_dwordx4 v[72:75], v1, s[4:7], s23 offen sc1
    s_waitcnt vmcnt(23)
    v_mfma_f32_16x16x32_bf16 v[16:19], a[240:243], v[76:79], v[16:19]
    v_mfma_f32_16x16x32_bf16 v[20:23], a[244:247], v[76:79], v[20:23]
    s_add_u32 s23, s19, 92160
    buffer_load_dwordx4 v[76:79], v1, s[4:7], s23 offen sc1
    s_waitcnt vmcnt(23)
    v_mfma_f32_16x16x32_bf16 v[8:11], a[248:251], v[80:83], v[8:11]
    v_mfma_f32_16x16x32_bf16 v[12:15], a[252:255], v[80:83], v[12:15]
    s_add_u32 s23, s19, 87040
    buffer_load_dwordx4 v[80:83], v1, s[4:7], s23 offen sc1
    s_waitcnt vmcnt(23)
    v_mfma_f32_16x16x32_bf16 v[16:19], a[248:251], v[84:87], v[16:19]
    v_mfma_f32_16x16x32_bf16 v[20:23], a[252:255], v[84:87], v[20:23]
    s_add_u32 s23, s19, 93184
    buffer_load_dwordx4 v[84:87], v1, s[4:7], s23 offen sc1
    s_waitcnt vmcnt(23)
    v_mfma_f32_16x16x32_bf16 v[8:11], v[128:131], v[88:91], v[8:11]
    v_mfma_f32_16x16x32_bf16 v[12:15], v[132:135], v[88:91], v[12:15]
    s_add_u32 s23, s19, 88064
    buffer_load_dwordx4 v[88:91], v1, s[4:7], s23 offen sc1
    s_waitcnt vmcnt(23)
    v_mfma_f32_16x16x32_bf16 v[16:19], v[128:131], v[92:95], v[16:19]
    v_mfma_f32_16x16x32_bf16 v[20:23], v[132:135], v[92:95], v[20:23]
    s_add_u32 s23, s19, 94208
    buffer_load_dwordx4 v[92:95], v1, s[4:7], s23 offen sc1
    s_waitcnt vmcnt(23)
    v_mfma_f32_16x16x32_bf16 v[8:11], v[136:139], v[96:99], v[8:11]
    v_mfma_f32_16x16x32_bf16 v[12:15], v[140:143], v[96:99], v[12:15]
    s_add_u32 s23, s19, 89088
    buffer_load_dwordx4 v[96:99], v1, s[4:7], s23 offen sc1
    s_waitcnt vmcnt(23)
    v_mfma_f32_16x16x32_bf16 v[16:19], v[136:139], v[100:103], v[16:19]
    v_mfma_f32_16x16x32_bf16 v[20:23], v[140:143], v[100:103], v[20:23]
    s_add_u32 s23, s19, 95232
    buffer_load_dwordx4 v[100:103], v1, s[4:7], s23 offen sc1
    s_waitcnt vmcnt(23)
    v_mfma_f32_16x16x32_bf16 v[8:11], v[144:147], v[104:107], v[8:11]
    v_mfma_f32_16x16x32_bf16 v[12:15], v[148:151], v[104:107], v[12:15]
    s_add_u32 s23, s19, 90112
    buffer_load_dwordx4 v[104:107], v1, s[4:7], s23 offen sc1
    s_waitcnt vmcnt(23)
    v_mfma_f32_16x16x32_bf16 v[16:19], v[144:147], v[108:111], v[16:19]
    v_mfma_f32_16x16x32_bf16 v[20:23], v[148:151], v[108:111], v[20:23]
    s_add_u32 s23, s19, 96256
    buffer_load_dwordx4 v[108:111], v1, s[4:7], s23 offen sc1
    s_waitcnt vmcnt(23)
    v_mfma_f32_16x16x32_bf16 v[8:11], v[152:155], v[112:115], v[8:11]
    v_mfma_f32_16x16x32_bf16 v[12:15], v[156:159], v[112:115], v[12:15]
    s_add_u32 s23, s19, 91136
    buffer_load_dwordx4 v[112:115], v1, s[4:7], s23 offen sc1
    s_waitcnt vmcnt(23)
    v_mfma_f32_16x16x32_bf16 v[16:19], v[152:155], v[116:119], v[16:19]
    v_mfma_f32_16x16x32_bf16 v[20:23], v[156:159], v[116:119], v[20:23]
    s_add_u32 s23, s19, 97280
    buffer_load_dwordx4 v[116:119], v1, s[4:7], s23 offen sc1
    s_waitcnt vmcnt(23)
    v_mfma_f32_16x16x32_bf16 v[8:11], v[160:163], v[24:27], v[8:11]
    v_mfma_f32_16x16x32_bf16 v[12:15], v[164:167], v[24:27], v[12:15]
    s_waitcnt vmcnt(22)
    v_mfma_f32_16x16x32_bf16 v[16:19], v[160:163], v[28:31], v[16:19]
    v_mfma_f32_16x16x32_bf16 v[20:23], v[164:167], v[28:31], v[20:23]
    s_waitcnt vmcnt(21)
    v_mfma_f32_16x16x32_bf16 v[8:11], v[168:171], v[32:35], v[8:11]
    v_mfma_f32_16x16x32_bf16 v[12:15], v[172:175], v[32:35], v[12:15]
    s_waitcnt vmcnt(20)
    v_mfma_f32_16x16x32_bf16 v[16:19], v[168:171], v[36:39], v[16:19]
    v_mfma_f32_16x16x32_bf16 v[20:23], v[172:175], v[36:39], v[20:23]
    s_waitcnt vmcnt(19)
    v_mfma_f32_16x16x32_bf16 v[8:11], v[176:179], v[40:43], v[8:11]
    v_mfma_f32_16x16x32_bf16 v[12:15], v[180:183], v[40:43], v[12:15]
    s_waitcnt vmcnt(18)
    v_mfma_f32_16x16x32_bf16 v[16:19], v[176:179], v[44:47], v[16:19]
    v_mfma_f32_16x16x32_bf16 v[20:23], v[180:183], v[44:47], v[20:23]
    s_waitcnt vmcnt(17)
    v_mfma_f32_16x16x32_bf16 v[8:11], v[184:187], v[48:51], v[8:11]
    v_mfma_f32_16x16x32_bf16 v[12:15], v[188:191], v[48:51], v[12:15]
    s_waitcnt vmcnt(16)
    v_mfma_f32_16x16x32_bf16 v[16:19], v[184:187], v[52:55], v[16:19]
    v_mfma_f32_16x16x32_bf16 v[20:23], v[188:191], v[52:55], v[20:23]
    s_waitcnt vmcnt(15)
    v_mfma_f32_16x16x32_bf16 v[8:11], v[192:195], v[56:59], v[8:11]
    v_mfma_f32_16x16x32_bf16 v[12:15], v[196:199], v[56:59], v[12:15]
    s_waitcnt vmcnt(14)
    v_mfma_f32_16x16x32_bf16 v[16:19], v[192:195], v[60:63], v[16:19]
    v_mfma_f32_16x16x32_bf16 v[20:23], v[196:199], v[60:63], v[20:23]
    s_waitcnt vmcnt(13)
    v_mfma_f32_16x16x32_bf16 v[8:11], v[200:203], v[64:67], v[8:11]
    v_mfma_f32_16x16x32_bf16 v[12:15], v[204:207], v[64:67], v[12:15]
    s_waitcnt vmcnt(12)
    v_mfma_f32_16x16x32_bf16 v[16:19], v[200:203], v[68:71], v[16:19]
    v_mfma_f32_16x16x32_bf16 v[20:23], v[204:207], v[68:71], v[20:23]
    s_waitcnt vmcnt(11)
    v_mfma_f32_16x16x32_bf16 v[8:11], v[208:211], v[72:75], v[8:11]
    v_mfma_f32_16x16x32_bf16 v[12:15], v[212:215], v[72:75], v[12:15]
    s_waitcnt vmcnt(10)
    v_mfma_f32_16x16x32_bf16 v[16:19], v[208:211], v[76:79], v[16:19]
    v_mfma_f32_16x16x32_bf16 v[20:23], v[212:215], v[76:79], v[20:23]
    s_waitcnt vmcnt(9)
    v_mfma_f32_16x16x32_bf16 v[8:11], v[216:219], v[80:83], v[8:11]
    v_mfma_f32_16x16x32_bf16 v[12:15], v[220:223], v[80:83], v[12:15]
    s_waitcnt vmcnt(8)
    v_mfma_f32_16x16x32_bf16 v[16:19], v[216:219], v[84:87], v[16:19]
    v_mfma_f32_16x16x32_bf16 v[20:23], v[220:223], v[84:87], v[20:23]
    s_waitcnt vmcnt(7)
    v_mfma_f32_16x16x32_bf16 v[8:11], v[224:227], v[88:91], v[8:11]
    v_mfma_f32_16x16x32_bf16 v[12:15], v[228:231], v[88:91], v[12:15]
    s_waitcnt vmcnt(6)
    v_mfma_f32_16x16x32_bf16 v[16:19], v[224:227], v[92:95], v[16:19]
    v_mfma_f32_16x16x32_bf16 v[20:23], v[228:231], v[92:95], v[20:23]
    s_waitcnt vmcnt(5)
    v_mfma_f32_16x16x32_bf16 v[8:11], v[232:235], v[96:99], v[8:11]
    v_mfma_f32_16x16x32_bf16 v[12:15], v[236:239], v[96:99], v[12:15]
    s_waitcnt vmcnt(4)
    v_mfma_f32_16x16x32_bf16 v[16:19], v[232:235], v[100:103], v[16:19]
    v_mfma_f32_16x16x32_bf16 v[20:23], v[236:239], v[100:103], v[20:23]
    s_waitcnt vmcnt(3)
    v_mfma_f32_16x16x32_bf16 v[8:11], v[240:243], v[104:107], v[8:11]
    v_mfma_f32_16x16x32_bf16 v[12:15], v[244:247], v[104:107], v[12:15]
    s_waitcnt vmcnt(2)
    v_mfma_f32_16x16x32_bf16 v[16:19], v[240:243], v[108:111], v[16:19]
    v_mfma_f32_16x16x32_bf16 v[20:23], v[244:247], v[108:111], v[20:23]
    s_waitcnt vmcnt(1)
    v_mfma_f32_16x16x32_bf16 v[8:11], v[248:251], v[112:115], v[8:11]
    v_mfma_f32_16x16x32_bf16 v[12:15], v[252:255], v[112:115], v[12:15]
    s_waitcnt vmcnt(0)
    v_mfma_f32_16x16x32_bf16 v[16:19], v[248:251], v[116:119], v[16:19]
    v_mfma_f32_16x16x32_bf16 v[20:23], v[252:255], v[116:119], v[20:23]
    s_nop 7
    s_nop 1
    ds_write_b128 v7, v[8:11] offset:0
    ds_write_b128 v7, v[12:15] offset:1024
    ds_write_b128 v7, v[16:19] offset:2048
    ds_write_b128 v7, v[20:23] offset:3072
    s_waitcnt lgkmcnt(0)
    s_barrier
    s_lshl_b32 s20, s16, 10
    s_add_u32 s20, s20, 147456
    v_add_u32 v40, s20, v1
    ds_read_b128 v[24:27], v40 offset:0
    ds_read_b128 v[28:31], v40 offset:4096
    ds_read_b128 v[32:35], v40 offset:8192
    ds_read_b128 v[36:39], v40 offset:12288
    s_waitcnt lgkmcnt(0)
    s_barrier
    v_add_f32 v24, v24, v28
    v_add_f32 v32, v32, v36
    v_add_f32 v25, v25, v29
    v_add_f32 v33, v33, v37
    v_add_f32 v26, v26, v30
    v_add_f32 v34, v34, v38
    v_add_f32 v27, v27, v31
    v_add_f32 v35, v35, v39
    v_add_f32 v24, v24, v32
    v_add_f32 v25, v25, v33
    v_add_f32 v26, v26, v34
    v_add_f32 v27, v27, v35
    v_cvt_pk_bf16_f32 v24, v24, v25
    v_cvt_pk_bf16_f32 v25, v26, v27
    s_lshl_b32 s20, s17, 5
    s_lshr_b32 s21, s16, 1
    s_lshl_b32 s21, s21, 4
    s_add_u32 s20, s20, s21
    s_mul_i32 s20, s20, 2560
    s_lshl_b32 s21, s12, 6
    s_add_u32 s20, s20, s21
    s_and_b32 s21, s16, 1
    s_lshl_b32 s21, s21, 5
    s_add_u32 s20, s20, s21
    s_add_u32 s20, s20, 1280
    buffer_store_dwordx2 v[24:25], v6, s[28:31], s20 offen
    s_add_u32 s17, s17, 4
    s_cmp_lt_u32 s17, 64
    s_cbranch_scc1 L_oproj_loop
    s_waitcnt vmcnt(0)
    s_branch L_exit
L_w_notqkv:
    s_cmp_ge_u32 s94, 128
    s_cbranch_scc0 L_w_notattn
    s_cmp_eq_u32 s94, 128
    s_cbranch_scc0 Lc_422
    s_cmp_eq_u32 s16, 0
    s_cbranch_scc0 Lc_422
    s_waitcnt vmcnt(0)
    v_mov_b32 v240, 0
    v_mov_b32 v241, 0
    s_mov_b64 exec, 1
    s_mov_b32 s42, 0x7fffffff
    s_mov_b32 s43, 0x7fffffff
    s_mov_b32 s20, 128974848
    s_memtime s[48:49]
    s_waitcnt lgkmcnt(0)
    buffer_store_dword v241, v240, s[4:7], s20 offen sc1
    s_waitcnt vmcnt(0)
    s_memtime s[50:51]
    s_waitcnt lgkmcnt(0)
    s_sub_u32 s21, s50, s48
    s_min_u32 s42, s42, s21
    s_mov_b32 s20, 128983040
    s_memtime s[48:49]
    s_waitcnt lgkmcnt(0)
    buffer_store_dword v241, v240, s[4:7], s20 offen sc1
    s_waitcnt vmcnt(0)
    s_memtime s[50:51]
    s_waitcnt lgkmcnt(0)
    s_sub_u32 s21, s50, s48
    s_min_u32 s43, s43, s21
    s_mov_b32 s20, 128975104
    s_memtime s[48:49]
    s_waitcnt lgkmcnt(0)
    buffer_store_dword v241, v240, s[4:7], s20 offen sc1
    s_waitcnt vmcnt(0)
    s_memtime s[50:51]
    s_waitcnt lgkmcnt(0)
    s_sub_u32 s21, s50, s48
    s_min_u32 s42, s42, s21
    s_mov_b32 s20, 128983296
    s_memtime s[48:49]
    s_waitcnt lgkmcnt(0)
    buffer_store_dword v241, v240, s[4:7], s20 offen sc1
    s_waitcnt vmcnt(0)
    s_memtime s[50:51]
    s_waitcnt lgkmcnt(0)
    s_sub_u32 s21, s50, s48
    s_min_u32 s43, s43, s21
    s_mov_b32 s20, 128975360
    s_memtime s[48:49]
    s_waitcnt lgkmcnt(0)
    buffer_store_dword v241, v240, s[4:7], s20 offen sc1
    s_waitcnt vmcnt(0)
    s_memtime s[50:51]
    s_waitcnt lgkmcnt(0)
    s_sub_u32 s21, s50, s48
    s_min_u32 s42, s42, s21
    s_mov_b32 s20, 128983552
    s_memtime s[48:49]
    s_waitcnt lgkmcnt(0)
    buffer_store_dword v241, v240, s[4:7], s20 offen sc1
    s_waitcnt vmcnt(0)
    s_memtime s[50:51]
    s_waitcnt lgkmcnt(0)
    s_sub_u32 s21, s50, s48
    s_min_u32 s43, s43, s21
    s_mov_b32 s20, 128975616
    s_memtime s[48:49]
    s_waitcnt lgkmcnt(0)
    buffer_store_dword v241, v240, s[4:7], s20 offen sc1
    s_waitcnt vmcnt(0)
    s_memtime s[50:51]
    s_waitcnt lgkmcnt(0)
    s_sub_u32 s21, s50, s48
    s_min_u32 s42, s42, s21
    s_mov_b32 s20, 128983808
    s_memtime s[48:49]
    s_waitcnt lgkmcnt(0)
    buffer_store_dword v241, v240, s[4:7], s20 offen sc1
    s_waitcnt vmcnt(0)
    s_memtime s[50:51]
    s_waitcnt lgkmcnt(0)
    s_sub_u32 s21, s50, s48
    s_min_u32 s43, s43, s21
    s_mov_b32 s20, 128975872
    s_memtime s[48:49]
    s_waitcnt lgkmcnt(0)
    buffer_store_dword v241, v240, s[4:7], s20 offen sc1
    s_waitcnt vmcnt(0)
    s_memtime s[50:51]
    s_waitcnt lgkmcnt(0)
    s_sub_u32 s21, s50, s48
    s_min_u32 s42, s42, s21
    s_mov_b32 s20, 128984064
    s_memtime s[48:49]
    s_waitcnt lgkmcnt(0)
    buffer_store_dword v241, v240, s[4:7], s20 offen sc1
    s_waitcnt vmcnt(0)
    s_memtime s[50:51]
    s_waitcnt lgkmcnt(0)
    s_sub_u32 s21, s50, s48
    s_min_u32 s43, s43, s21
    s_mov_b32 s20, 128976128
    s_memtime s[48:49]
    s_waitcnt lgkmcnt(0)
    buffer_store_dword v241, v240, s[4:7], s20 offen sc1
    s_waitcnt vmcnt(0)
    s_memtime s[50:51]
    s_waitcnt lgkmcnt(0)
    s_sub_u32 s21, s50, s48
    s_min_u32 s42, s42, s21
    s_mov_b32 s20, 128984320
    s_memtime s[48:49]
    s_waitcnt lgkmcnt(0)
    buffer_store_dword v241, v240, s[4:7], s20 offen sc1
    s_waitcnt vmcnt(0)
    s_memtime s[50:51]
    s_waitcnt lgkmcnt(0)
    s_sub_u32 s21, s50, s48
    s_min_u32 s43, s43, s21
    s_mov_b32 s20, 128976384
    s_memtime s[48:49]
    s_waitcnt lgkmcnt(0)
    buffer_store_dword v241, v240, s[4:7], s20 offen sc1
    s_waitcnt vmcnt(0)
    s_memtime s[50:51]
    s_waitcnt lgkmcnt(0)
    s_sub_u32 s21, s50, s48
    s_min_u32 s42, s42, s21
    s_mov_b32 s20, 128984576
    s_memtime s[48:49]
    s_waitcnt lgkmcnt(0)
    buffer_store_dword v241, v240, s[4:7], s20 offen sc1
    s_waitcnt vmcnt(0)
    s_memtime s[50:51]
    s_waitcnt lgkmcnt(0)
    s_sub_u32 s21, s50, s48
    s_min_u32 s43, s43, s21
    s_mov_b32 s20, 128976640
    s_memtime s[48:49]
    s_waitcnt lgkmcnt(0)
    buffer_store_dword v241, v240, s[4:7], s20 offen sc1
    s_waitcnt vmcnt(0)
    s_memtime s[50:51]
    s_waitcnt lgkmcnt(0)
    s_sub_u32 s21, s50, s48
    s_min_u32 s42, s42, s21
    s_mov_b32 s20, 128984832
    s_memtime s[48:49]
    s_waitcnt lgkmcnt(0)
    buffer_store_dword v241, v240, s[4:7], s20 offen sc1
    s_waitcnt vmcnt(0)
    s_memtime s[50:51]
    s_waitcnt lgkmcnt(0)
    s_sub_u32 s21, s50, s48
    s_min_u32 s43, s43, s21
    s_cmp_lt_u32 s43, s42
    s_cselect_b32 s20, 1, 0
    s_lshr_b32 s21, s93, 2
    s_xor_b32 s20, s20, s21
    s_add_u32 s20, s20, 1
    v_mov_b32 v241, s20
    v_mov_b32 v240, 20
    global_store_dword v240, v241, s[90:91] sc1
    v_mov_b32 v241, s42
    v_mov_b32 v240, 24
    global_store_dword v240, v241, s[90:91] sc1
    v_mov_b32 v241, s43
    v_mov_b32 v240, 28
    global_store_dword v240, v241, s[90:91] sc1
    s_waitcnt vmcnt(0)
    s_mov_b64 exec, -1
Lc_422:
    s_cmp_eq_u32 s16, 0
    s_cbranch_scc0 Lz_425
    v_mov_b32 v250, 200
    s_mov_b32 s24, 0
Lz_423:
    global_load_dword v251, v250, s[90:91] sc1
    s_waitcnt vmcnt(0)
    v_readfirstlane_b32 s20, v251
    s_nop 3
    s_cmp_ge_u32 s20, 256
    s_cbranch_scc1 Lz_424
    s_sleep 4
    s_add_u32 s24, s24, 1
    s_cmp_lt_u32 s24, 400000
    s_cbranch_scc1 Lz_423
    s_branch L_abort
Lz_424:
Lz_425:
    s_barrier
    s_sub_u32 s20, s94, 128
    s_lshl_b32 s20, s20, 2
    s_add_u32 s20, s20, s16
    s_and_b32 s13, s20, 31
    s_lshr_b32 s14, s20, 5
    v_lshlrev_b32 v1, 4, v0
    v_and_b32 v8, 15, v0
    v_lshrrev_b32 v160, 4, v0
    v_lshlrev_b32 v9, 2, v160
    v_lshrrev_b32 v161, 1, v160
    v_mul_u32_u24 v161, 3072, v161
    v_and_b32 v162, 1, v160
    v_lshlrev_b32 v162, 5, v162
    v_add_u32 v162, v162, v8
    v_lshlrev_b32 v162, 4, v162
    v_add_u32 v2, v161, v162
    v_add_u32 v2, 2048, v2
    v_and_b32 v161, 7, v8
    v_mul_u32_u24 v161, 384, v161
    v_lshlrev_b32 v162, 4, v160
    v_add_u32 v3, v161, v162
    v_lshrrev_b32 v162, 1, v160
    v_mul_u32_u24 v162, 6, v162
    v_and_b32 v163, 1, v160
    v_add_u32 v162, v162, v163
    v_add_u32 v162, 4, v162
    v_lshlrev_b32 v162, 4, v162
    v_add_u32 v4, v161, v162
    v_lshlrev_b32 v161, 4, v8
    v_lshlrev_b32 v163, 3, v163
    v_add_u32 v5, v161, v163
    s_lshl_b32 s26, s13, 6
    s_add_u32 s26, s26, 125829120
    s_lshl_b32 s27, s13, 8
    s_add_u32 s27, s27, 125845504
    s_lshl_b32 s28, s14, 7
    s_lshl_b32 s20, s13, 2
    s_add_u32 s28, s28, s20
    s_add_u32 s28, s28, 125837312
    s_mov_b32 s17, s14
L_attn_loop:
    s_add_u32 s29, s17, 1
    s_lshl_b32 s20, s17, 5
    s_add_u32 s20, s20, s13
    s_mul_i32 s18, s20, 12288
    s_mul_i32 s19, s20, 3072
    v_and_b32 v6, 15, v0
    v_min_u32 v6, 11, v6
    v_lshlrev_b32 v6, 2, v6
    s_mov_b32 s24, 0
La_426:
    buffer_load_dword v7, v6, s[4:7], s26 offen sc1
    s_waitcnt vmcnt(0)
    v_cmp_gt_u32 vcc, s29, v7
    s_cbranch_vccz La_427
    s_sleep 16
    s_add_u32 s24, s24, 1
    s_cmp_lt_u32 s24, 1600000
    s_cbranch_scc1 La_426
    s_branch L_abort
La_427:
    s_add_u32 s42, s18, 50331648
    s_mov_b32 s43, s18
    s_add_u32 s44, s18, 25165824
    buffer_load_dwordx4 a[0:3], v1, s[4:7], s42 offen sc1
    buffer_load_dwordx4 a[4:7], v1, s[4:7], s42 offen offset:3072 sc1
    s_add_u32 s23, s42, 4096
    buffer_load_dwordx4 a[8:11], v1, s[4:7], s23 offen offset:2048 sc1
    s_add_u32 s23, s42, 8192
    buffer_load_dwordx4 a[12:15], v1, s[4:7], s23 offen offset:1024 sc1
    buffer_load_dwordx4 a[16:19], v2, s[4:7], s42 offen sc1
    s_add_u32 s23, s42, 4096
    buffer_load_dwordx4 a[20:23], v2, s[4:7], s23 offen offset:2048 sc1
    buffer_load_dwordx4 a[24:27], v1, s[4:7], s42 offen offset:1024 sc1
    s_add_u32 s23, s42, 4096
    buffer_load_dwordx4 a[28:31], v1, s[4:7], s23 offen sc1
    s_add_u32 s23, s42, 4096
    buffer_load_dwordx4 a[32:35], v1, s[4:7], s23 offen offset:3072 sc1
    s_add_u32 s23, s42, 8192
    buffer_load_dwordx4 a[36:39], v1, s[4:7], s23 offen offset:2048 sc1
    buffer_load_dwordx4 a[40:43], v2, s[4:7], s42 offen offset:256 sc1
    s_add_u32 s23, s42, 4096
    buffer_load_dwordx4 a[44:47], v2, s[4:7], s23 offen offset:2304 sc1
    buffer_load_dwordx4 a[48:51], v1, s[4:7], s43 offen sc1
    buffer_load_dwordx4 a[52:55], v1, s[4:7], s43 offen offset:3072 sc1
    s_add_u32 s23, s43, 4096
    buffer_load_dwordx4 a[56:59], v1, s[4:7], s23 offen offset:2048 sc1
    s_add_u32 s23, s43, 8192
    buffer_load_dwordx4 a[60:63], v1, s[4:7], s23 offen offset:1024 sc1
    buffer_load_dwordx4 a[64:67], v2, s[4:7], s43 offen sc1
    s_add_u32 s23, s43, 4096
    buffer_load_dwordx4 a[68:71], v2, s[4:7], s23 offen offset:2048 sc1
    buffer_load_dwordx4 a[72:75], v1, s[4:7], s43 offen offset:1024 sc1
    s_add_u32 s23, s43, 4096
    buffer_load_dwordx4 a[76:79], v1, s[4:7], s23 offen sc1
    s_add_u32 s23, s43, 4096
    buffer_load_dwordx4 a[80:83], v1, s[4:7], s23 offen offset:3072 sc1
    s_add_u32 s23, s43, 8192
    buffer_load_dwordx4 a[84:87], v1, s[4:7], s23 offen offset:2048 sc1
    buffer_load_dwordx4 a[88:91], v2, s[4:7], s43 offen offset:256 sc1
    s_add_u32 s23, s43, 4096
    buffer_load_dwordx4 a[92:95], v2, s[4:7], s23 offen offset:2304 sc1
    buffer_load_dwordx4 a[120:123], v1, s[4:7], s44 offen sc1
    buffer_load_dwordx4 a[124:127], v1, s[4:7], s44 offen offset:1024 sc1
    buffer_load_dwordx4 a[128:131], v1, s[4:7], s44 offen offset:2048 sc1
    buffer_load_dwordx4 a[132:135], v1, s[4:7], s44 offen offset:3072 sc1
    s_add_u32 s23, s44, 4096
    buffer_load_dwordx4 a[136:139], v1, s[4:7], s23 offen sc1
    s_add_u32 s23, s44, 4096
    buffer_load_dwordx4 a[140:143], v1, s[4:7], s23 offen offset:1024 sc1
    s_add_u32 s23, s44, 4096
    buffer_load_dwordx4 a[144:147], v1, s[4:7], s23 offen offset:2048 sc1
    s_add_u32 s23, s44, 4096
    buffer_load_dwordx4 a[148:151], v1, s[4:7], s23 offen offset:3072 sc1
    s_add_u32 s23, s44, 8192
    buffer_load_dwordx4 a[152:155], v1, s[4:7], s23 offen sc1
    s_add_u32 s23, s44, 8192
    buffer_load_dwordx4 a[156:159], v1, s[4:7], s23 offen offset:1024 sc1
    s_add_u32 s23, s44, 8192
    buffer_load_dwordx4 a[160:163], v1, s[4:7], s23 offen offset:2048 sc1
    s_add_u32 s23, s44, 8192
    buffer_load_dwordx4 a[164:167], v1, s[4:7], s23 offen offset:3072 sc1
    s_waitcnt vmcnt(12)
    v_mfma_f32_16x16x32_bf16 v[16:19], a[48:51], a[0:3], 0
    v_mfma_f32_16x16x32_bf16 v[20:23], a[72:75], a[0:3], 0
    v_mfma_f32_16x16x32_bf16 v[28:31], a[48:51], a[24:27], 0
    v_mfma_f32_16x16x32_bf16 v[32:35], a[72:75], a[24:27], 0
    v_mfma_f32_16x16x32_bf16 v[16:19], a[52:55], a[4:7], v[16:19]
    v_mfma_f32_16x16x32_bf16 v[20:23], a[76:79], a[4:7], v[20:23]
    v_mfma_f32_16x16x32_bf16 v[28:31], a[52:55], a[28:31], v[28:31]
    v_mfma_f32_16x16x32_bf16 v[32:35], a[76:79], a[28:31], v[32:35]
    v_mfma_f32_16x16x32_bf16 v[16:19], a[56:59], a[8:11], v[16:19]
    v_mfma_f32_16x16x32_bf16 v[20:23], a[80:83], a[8:11], v[20:23]
    v_mfma_f32_16x16x32_bf16 v[28:31], a[56:59], a[32:35], v[28:31]
    v_mfma_f32_16x16x32_bf16 v[32:35], a[80:83], a[32:35], v[32:35]
    v_mfma_f32_16x16x32_bf16 v[16:19], a[60:63], a[12:15], v[16:19]
    v_mfma_f32_16x16x32_bf16 v[20:23], a[84:87], a[12:15], v[20:23]
    v_mfma_f32_16x16x32_bf16 v[28:31], a[60:63], a[36:39], v[28:31]
    v_mfma_f32_16x16x32_bf16 v[32:35], a[84:87], a[36:39], v[32:35]
    v_mfma_f32_16x16x32_bf16 v[16:19], a[64:67], a[16:19], v[16:19]
    v_mfma_f32_16x16x32_bf16 v[20:23], a[88:91], a[16:19], v[20:23]
    v_mfma_f32_16x16x32_bf16 v[28:31], a[64:67], a[40:43], v[28:31]
    v_mfma_f32_16x16x32_bf16 v[32:35], a[88:91], a[40:43], v[32:35]
    v_mfma_f32_16x16x32_bf16 v[16:19], a[68:71], a[20:23], v[16:19]
    v_mfma_f32_16x16x32_bf16 v[20:23], a[92:95], a[20:23], v[20:23]
    v_mfma_f32_16x16x32_bf16 v[28:31], a[68:71], a[44:47], v[28:31]
    v_mfma_f32_16x16x32_bf16 v[32:35], a[92:95], a[44:47], v[32:35]
    v_and_b32 v6, 1, v0
    v_lshlrev_b32 v6, 7, v6
    s_mov_b32 s24, 0
La_428:
    buffer_load_dword v7, v6, s[4:7], s27 offen sc1
    s_waitcnt vmcnt(0)
    v_cmp_gt_u32 vcc, s29, v7
    s_cbranch_vccz La_429
    s_sleep 16
    s_add_u32 s24, s24, 1
    s_cmp_lt_u32 s24, 1600000
    s_cbranch_scc1 La_428
    s_branch L_abort
La_429:
    s_add_u32 s42, s19, 100663296
    s_add_u32 s43, s19, 106954752
    buffer_load_dwordx4 a[96:99], v3, s[4:7], s42 offen sc1
    buffer_load_dwordx4 a[100:103], v3, s[4:7], s42 offen offset:96 sc1
    buffer_load_dwordx4 a[104:107], v3, s[4:7], s42 offen offset:192 sc1
    buffer_load_dwordx4 a[108:111], v3, s[4:7], s42 offen offset:288 sc1
    buffer_load_dwordx4 a[112:115], v4, s[4:7], s42 offen sc1
    buffer_load_dwordx4 a[116:119], v4, s[4:7], s42 offen offset:192 sc1
    buffer_load_dwordx2 a[168:169], v5, s[4:7], s43 offen sc1
    buffer_load_dwordx2 a[170:171], v5, s[4:7], s43 offen offset:256 sc1
    buffer_load_dwordx2 a[172:173], v5, s[4:7], s43 offen offset:512 sc1
    buffer_load_dwordx2 a[174:175], v5, s[4:7], s43 offen offset:768 sc1
    buffer_load_dwordx2 a[176:177], v5, s[4:7], s43 offen offset:1024 sc1
    buffer_load_dwordx2 a[178:179], v5, s[4:7], s43 offen offset:1280 sc1
    buffer_load_dwordx2 a[180:181], v5, s[4:7], s43 offen offset:1536 sc1
    buffer_load_dwordx2 a[182:183], v5, s[4:7], s43 offen offset:1792 sc1
    buffer_load_dwordx2 a[184:185], v5, s[4:7], s43 offen offset:2048 sc1
    buffer_load_dwordx2 a[186:187], v5, s[4:7], s43 offen offset:2304 sc1
    buffer_load_dwordx2 a[188:189], v5, s[4:7], s43 offen offset:2560 sc1
    buffer_load_dwordx2 a[190:191], v5, s[4:7], s43 offen offset:2816 sc1
    s_waitcnt vmcnt(12)
    v_mfma_f32_16x16x32_bf16 v[24:27], a[96:99], a[0:3], 0
    v_mfma_f32_16x16x32_bf16 v[36:39], a[96:99], a[24:27], 0
    v_mfma_f32_16x16x32_bf16 v[24:27], a[100:103], a[4:7], v[24:27]
    v_mfma_f32_16x16x32_bf16 v[36:39], a[100:103], a[28:31], v[36:39]
    v_mfma_f32_16x16x32_bf16 v[24:27], a[104:107], a[8:11], v[24:27]
    v_mfma_f32_16x16x32_bf16 v[36:39], a[104:107], a[32:35], v[36:39]
    v_mfma_f32_16x16x32_bf16 v[24:27], a[108:111], a[12:15], v[24:27]
    v_mfma_f32_16x16x32_bf16 v[36:39], a[108:111], a[36:39], v[36:39]
    v_mfma_f32_16x16x32_bf16 v[24:27], a[112:115], a[16:19], v[24:27]
    v_mfma_f32_16x16x32_bf16 v[36:39], a[112:115], a[40:43], v[36:39]
    v_mfma_f32_16x16x32_bf16 v[24:27], a[116:119], a[20:23], v[24:27]
    v_mfma_f32_16x16x32_bf16 v[36:39], a[116:119], a[44:47], v[36:39]
    s_nop 7
    s_nop 1
    s_mov_b32 s42, 0x3dd53b95
    s_mov_b32 s43, 0xf149f2ca
    v_mov_b32 v168, s43
    v_add_u32 v160, 0, v9
    v_cmp_le_u32 vcc, v160, v8
    s_nop 1
    v_cndmask_b32 v16, v168, v16, vcc
    v_add_u32 v160, 1, v9
    v_cmp_le_u32 vcc, v160, v8
    s_nop 1
    v_cndmask_b32 v17, v168, v17, vcc
    v_add_u32 v160, 2, v9
    v_cmp_le_u32 vcc, v160, v8
    s_nop 1
    v_cndmask_b32 v18, v168, v18, vcc
    v_add_u32 v160, 3, v9
    v_cmp_le_u32 vcc, v160, v8
    s_nop 1
    v_cndmask_b32 v19, v168, v19, vcc
    v_mov_b32 v20, v168
    v_mov_b32 v21, v168
    v_mov_b32 v22, v168
    v_mov_b32 v23, v168
    v_cmp_gt_u32 vcc, 8, v9
    s_nop 1
    v_cndmask_b32 v24, v168, v24, vcc
    v_cndmask_b32 v25, v168, v25, vcc
    v_cndmask_b32 v26, v168, v26, vcc
    v_cndmask_b32 v27, v168, v27, vcc
    v_max3_f32 v160, v16, v17, v18
    v_max3_f32 v161, v19, v20, v21
    v_max3_f32 v160, v160, v22, v23
    v_max3_f32 v161, v161, v24, v25
    v_max3_f32 v160, v160, v26, v27
    v_max_f32 v160, v160, v161
    v_mov_b32 v161, v160
    s_nop 1
    v_permlane16_swap_b32 v160, v161
    v_max_f32 v160, v160, v161
    v_mov_b32 v161, v160
    s_nop 1
    v_permlane32_swap_b32 v160, v161
    v_max_f32 v160, v160, v161
    v_mul_f32 v160, s42, v160
    v_fma_f32 v16, v16, s42, -v160
    v_fma_f32 v17, v17, s42, -v160
    v_fma_f32 v18, v18, s42, -v160
    v_fma_f32 v19, v19, s42, -v160
    v_fma_f32 v20, v20, s42, -v160
    v_fma_f32 v21, v21, s42, -v160
    v_fma_f32 v22, v22, s42, -v160
    v_fma_f32 v23, v23, s42, -v160
    v_fma_f32 v24, v24, s42, -v160
    v_fma_f32 v25, v25, s42, -v160
    v_fma_f32 v26, v26, s42, -v160
    v_fma_f32 v27, v27, s42, -v160
    v_exp_f32 v16, v16
    v_exp_f32 v17, v17
    v_exp_f32 v18, v18
    v_exp_f32 v19, v19
    v_exp_f32 v20, v20
    v_exp_f32 v21, v21
    v_exp_f32 v22, v22
    v_exp_f32 v23, v23
    v_exp_f32 v24, v24
    v_exp_f32 v25, v25
    v_exp_f32 v26, v26
    v_exp_f32 v27, v27
    s_nop 0
    v_add_f32 v160, v16, v17
    v_add_f32 v160, v160, v18
    v_add_f32 v160, v160, v19
    v_add_f32 v160, v160, v20
    v_add_f32 v160, v160, v21
    v_add_f32 v160, v160, v22
    v_add_f32 v160, v160, v23
    v_add_f32 v160, v160, v24
    v_add_f32 v160, v160, v25
    v_add_f32 v160, v160, v26
    v_add_f32 v160, v160, v27
    v_mov_b32 v161, v160
    s_nop 1
    v_permlane16_swap_b32 v160, v161
    v_add_f32 v160, v160, v161
    v_mov_b32 v161, v160
    s_nop 1
    v_permlane32_swap_b32 v160, v161
    v_add_f32 v160, v160, v161
    v_rcp_f32 v160, v160
    s_nop 0
    v_mul_f32 v16, v16, v160
    v_mul_f32 v17, v17, v160
    v_mul_f32 v18, v18, v160
    v_mul_f32 v19, v19, v160
    v_mul_f32 v20, v20, v160
    v_mul_f32 v21, v21, v160
    v_mul_f32 v22, v22, v160
    v_mul_f32 v23, v23, v160
    v_mul_f32 v24, v24, v160
    v_mul_f32 v25, v25, v160
    v_mul_f32 v26, v26, v160
    v_mul_f32 v27, v27, v160
    v_cvt_pk_bf16_f32 v144, v16, v17
    v_cvt_pk_bf16_f32 v145, v18, v19
    v_cvt_pk_bf16_f32 v146, v20, v21
    v_cvt_pk_bf16_f32 v147, v22, v23
    v_cvt_pk_bf16_f32 v148, v24, v25
    v_cvt_pk_bf16_f32 v149, v26, v27
    v_add_u32 v160, 0, v9
    v_cmp_le_u32 vcc, v160, v8
    s_nop 1
    v_cndmask_b32 v32, v168, v32, vcc
    v_add_u32 v160, 1, v9
    v_cmp_le_u32 vcc, v160, v8
    s_nop 1
    v_cndmask_b32 v33, v168, v33, vcc
    v_add_u32 v160, 2, v9
    v_cmp_le_u32 vcc, v160, v8
    s_nop 1
    v_cndmask_b32 v34, v168, v34, vcc
    v_add_u32 v160, 3, v9
    v_cmp_le_u32 vcc, v160, v8
    s_nop 1
    v_cndmask_b32 v35, v168, v35, vcc
    v_cmp_gt_u32 vcc, 8, v9
    s_nop 1
    v_cndmask_b32 v36, v168, v36, vcc
    v_cndmask_b32 v37, v168, v37, vcc
    v_cndmask_b32 v38, v168, v38, vcc
    v_cndmask_b32 v39, v168, v39, vcc
    v_max3_f32 v160, v28, v29, v30
    v_max3_f32 v161, v31, v32, v33
    v_max3_f32 v160, v160, v34, v35
    v_max3_f32 v161, v161, v36, v37
    v_max3_f32 v160, v160, v38, v39
    v_max_f32 v160, v160, v161
    v_mov_b32 v161, v160
    s_nop 1
    v_permlane16_swap_b32 v160, v161
    v_max_f32 v160, v160, v161
    v_mov_b32 v161, v160
    s_nop 1
    v_permlane32_swap_b32 v160, v161
    v_max_f32 v160, v160, v161
    v_mul_f32 v160, s42, v160
    v_fma_f32 v28, v28, s42, -v160
    v_fma_f32 v29, v29, s42, -v160
    v_fma_f32 v30, v30, s42, -v160
    v_fma_f32 v31, v31, s42, -v160
    v_fma_f32 v32, v32, s42, -v160
    v_fma_f32 v33, v33, s42, -v160
    v_fma_f32 v34, v34, s42, -v160
    v_fma_f32 v35, v35, s42, -v160
    v_fma_f32 v36, v36, s42, -v160
    v_fma_f32 v37, v37, s42, -v160
    v_fma_f32 v38, v38, s42, -v160
    v_fma_f32 v39, v39, s42, -v160
    v_exp_f32 v28, v28
    v_exp_f32 v29, v29
    v_exp_f32 v30, v30
    v_exp_f32 v31, v31
    v_exp_f32 v32, v32
    v_exp_f32 v33, v33
    v_exp_f32 v34, v34
    v_exp_f32 v35, v35
    v_exp_f32 v36, v36
    v_exp_f32 v37, v37
    v_exp_f32 v38, v38
    v_exp_f32 v39, v39
    s_nop 0
    v_add_f32 v160, v28, v29
    v_add_f32 v160, v160, v30
    v_add_f32 v160, v160, v31
    v_add_f32 v160, v160, v32
    v_add_f32 v160, v160, v33
    v_add_f32 v160, v160, v34
    v_add_f32 v160, v160, v35
    v_add_f32 v160, v160, v36
    v_add_f32 v160, v160, v37
    v_add_f32 v160, v160, v38
    v_add_f32 v160, v160, v39
    v_mov_b32 v161, v160
    s_nop 1
    v_permlane16_swap_b32 v160, v161
    v_add_f32 v160, v160, v161
    v_mov_b32 v161, v160
    s_nop 1
    v_permlane32_swap_b32 v160, v161
    v_add_f32 v160, v160, v161
    v_rcp_f32 v160, v160
    s_nop 0
    v_mul_f32 v28, v28, v160
    v_mul_f32 v29, v29, v160
    v_mul_f32 v30, v30, v160
    v_mul_f32 v31, v31, v160
    v_mul_f32 v32, v32, v160
    v_mul_f32 v33, v33, v160
    v_mul_f32 v34, v34, v160
    v_mul_f32 v35, v35, v160
    v_mul_f32 v36, v36, v160
    v_mul_f32 v37, v37, v160
    v_mul_f32 v38, v38, v160
    v_mul_f32 v39, v39, v160
    v_cvt_pk_bf16_f32 v150, v28, v29
    v_cvt_pk_bf16_f32 v151, v30, v31
    v_cvt_pk_bf16_f32 v152, v32, v33
    v_cvt_pk_bf16_f32 v153, v34, v35
    v_cvt_pk_bf16_f32 v154, v36, v37
    v_cvt_pk_bf16_f32 v155, v38, v39
    s_waitcnt vmcnt(0)
    s_nop 1
    v_mfma_f32_16x16x32_bf16 v[48:51], a[120:123], v[144:147], 0
    v_mfma_f32_16x16x32_bf16 v[52:55], a[124:127], v[144:147], 0
    v_mfma_f32_16x16x32_bf16 v[56:59], a[128:131], v[144:147], 0
    v_mfma_f32_16x16x32_bf16 v[60:63], a[132:135], v[144:147], 0
    v_mfma_f32_16x16x32_bf16 v[64:67], a[136:139], v[144:147], 0
    v_mfma_f32_16x16x32_bf16 v[68:71], a[140:143], v[144:147], 0
    v_mfma_f32_16x16x32_bf16 v[72:75], a[144:147], v[144:147], 0
    v_mfma_f32_16x16x32_bf16 v[76:79], a[148:151], v[144:147], 0
    v_mfma_f32_16x16x32_bf16 v[80:83], a[152:155], v[144:147], 0
    v_mfma_f32_16x16x32_bf16 v[84:87], a[156:159], v[144:147], 0
    v_mfma_f32_16x16x32_bf16 v[88:91], a[160:163], v[144:147], 0
    v_mfma_f32_16x16x32_bf16 v[92:95], a[164:167], v[144:147], 0
    v_mfma_f32_16x16x32_bf16 v[96:99], a[120:123], v[150:153], 0
    v_mfma_f32_16x16x32_bf16 v[100:103], a[124:127], v[150:153], 0
    v_mfma_f32_16x16x32_bf16 v[104:107], a[128:131], v[150:153], 0
    v_mfma_f32_16x16x32_bf16 v[108:111], a[132:135], v[150:153], 0
    v_mfma_f32_16x16x32_bf16 v[112:115], a[136:139], v[150:153], 0
    v_mfma_f32_16x16x32_bf16 v[116:119], a[140:143], v[150:153], 0
    v_mfma_f32_16x16x32_bf16 v[120:123], a[144:147], v[150:153], 0
    v_mfma_f32_16x16x32_bf16 v[124:127], a[148:151], v[150:153], 0
    v_mfma_f32_16x16x32_bf16 v[128:131], a[152:155], v[150:153], 0
    v_mfma_f32_16x16x32_bf16 v[132:135], a[156:159], v[150:153], 0
    v_mfma_f32_16x16x32_bf16 v[136:139], a[160:163], v[150:153], 0
    v_mfma_f32_16x16x32_bf16 v[140:143], a[164:167], v[150:153], 0
    v_mfma_f32_16x16x16_bf16 v[48:51], a[168:169], v[148:149], v[48:51]
    v_mfma_f32_16x16x16_bf16 v[52:55], a[170:171], v[148:149], v[52:55]
    v_mfma_f32_16x16x16_bf16 v[56:59], a[172:173], v[148:149], v[56:59]
    v_mfma_f32_16x16x16_bf16 v[60:63], a[174:175], v[148:149], v[60:63]
    v_mfma_f32_16x16x16_bf16 v[64:67], a[176:177], v[148:149], v[64:67]
    v_mfma_f32_16x16x16_bf16 v[68:71], a[178:179], v[148:149], v[68:71]
    v_mfma_f32_16x16x16_bf16 v[72:75], a[180:181], v[148:149], v[72:75]
    v_mfma_f32_16x16x16_bf16 v[76:79], a[182:183], v[148:149], v[76:79]
    v_mfma_f32_16x16x16_bf16 v[80:83], a[184:185], v[148:149], v[80:83]
    v_mfma_f32_16x16x16_bf16 v[84:87], a[186:187], v[148:149], v[84:87]
    v_mfma_f32_16x16x16_bf16 v[88:91], a[188:189], v[148:149], v[88:91]
    v_mfma_f32_16x16x16_bf16 v[92:95], a[190:191], v[148:149], v[92:95]
    v_mfma_f32_16x16x16_bf16 v[96:99], a[168:169], v[154:155], v[96:99]
    v_mfma_f32_16x16x16_bf16 v[100:103], a[170:171], v[154:155], v[100:103]
    v_mfma_f32_16x16x16_bf16 v[104:107], a[172:173], v[154:155], v[104:107]
    v_mfma_f32_16x16x16_bf16 v[108:111], a[174:175], v[154:155], v[108:111]
    v_mfma_f32_16x16x16_bf16 v[112:115], a[176:177], v[154:155], v[112:115]
    v_mfma_f32_16x16x16_bf16 v[116:119], a[178:179], v[154:155], v[116:119]
    v_mfma_f32_16x16x16_bf16 v[120:123], a[180:181], v[154:155], v[120:123]
    v_mfma_f32_16x16x16_bf16 v[124:127], a[182:183], v[154:155], v[124:127]
    v_mfma_f32_16x16x16_bf16 v[128:131], a[184:185], v[154:155], v[128:131]
    v_mfma_f32_16x16x16_bf16 v[132:135], a[186:187], v[154:155], v[132:135]
    v_mfma_f32_16x16x16_bf16 v[136:139], a[188:189], v[154:155], v[136:139]
    v_mfma_f32_16x16x16_bf16 v[140:143], a[190:191], v[154:155], v[140:143]
    s_add_u32 s42, s18, 75497472
    s_nop 7
    v_cvt_pk_bf16_f32 v172, v48, v49
    v_cvt_pk_bf16_f32 v173, v50, v51
    v_cvt_pk_bf16_f32 v174, v52, v53
    v_cvt_pk_bf16_f32 v175, v54, v55
    s_add_u32 s43, s42, 0
    buffer_store_dwordx4 v[172:175], v1, s[4:7], s43 offen offset:0 sc1
    v_cvt_pk_bf16_f32 v176, v56, v57
    v_cvt_pk_bf16_f32 v177, v58, v59
    v_cvt_pk_bf16_f32 v178, v60, v61
    v_cvt_pk_bf16_f32 v179, v62, v63
    buffer_store_dwordx4 v[176:179], v1, s[4:7], s43 offen offset:1024 sc1
    v_cvt_pk_bf16_f32 v180, v64, v65
    v_cvt_pk_bf16_f32 v181, v66, v67
    v_cvt_pk_bf16_f32 v182, v68, v69
    v_cvt_pk_bf16_f32 v183, v70, v71
    buffer_store_dwordx4 v[180:183], v1, s[4:7], s43 offen offset:2048 sc1
    v_cvt_pk_bf16_f32 v184, v72, v73
    v_cvt_pk_bf16_f32 v185, v74, v75
    v_cvt_pk_bf16_f32 v186, v76, v77
    v_cvt_pk_bf16_f32 v187, v78, v79
    buffer_store_dwordx4 v[184:187], v1, s[4:7], s43 offen offset:3072 sc1
    v_cvt_pk_bf16_f32 v172, v80, v81
    v_cvt_pk_bf16_f32 v173, v82, v83
    v_cvt_pk_bf16_f32 v174, v84, v85
    v_cvt_pk_bf16_f32 v175, v86, v87
    s_add_u32 s43, s42, 4096
    buffer_store_dwordx4 v[172:175], v1, s[4:7], s43 offen offset:0 sc1
    v_cvt_pk_bf16_f32 v176, v88, v89
    v_cvt_pk_bf16_f32 v177, v90, v91
    v_cvt_pk_bf16_f32 v178, v92, v93
    v_cvt_pk_bf16_f32 v179, v94, v95
    buffer_store_dwordx4 v[176:179], v1, s[4:7], s43 offen offset:1024 sc1
    v_cvt_pk_bf16_f32 v180, v96, v97
    v_cvt_pk_bf16_f32 v181, v98, v99
    v_cvt_pk_bf16_f32 v182, v100, v101
    v_cvt_pk_bf16_f32 v183, v102, v103
    buffer_store_dwordx4 v[180:183], v1, s[4:7], s43 offen offset:2048 sc1
    v_cvt_pk_bf16_f32 v184, v104, v105
    v_cvt_pk_bf16_f32 v185, v106, v107
    v_cvt_pk_bf16_f32 v186, v108, v109
    v_cvt_pk_bf16_f32 v187, v110, v111
    buffer_store_dwordx4 v[184:187], v1, s[4:7], s43 offen offset:3072 sc1
    v_cvt_pk_bf16_f32 v172, v112, v113
    v_cvt_pk_bf16_f32 v173, v114, v115
    v_cvt_pk_bf16_f32 v174, v116, v117
    v_cvt_pk_bf16_f32 v175, v118, v119
    s_add_u32 s43, s42, 8192
    buffer_store_dwordx4 v[172:175], v1, s[4:7], s43 offen offset:0 sc1
    v_cvt_pk_bf16_f32 v176, v120, v121
    v_cvt_pk_bf16_f32 v177, v122, v123
    v_cvt_pk_bf16_f32 v178, v124, v125
    v_cvt_pk_bf16_f32 v179, v126, v127
    buffer_store_dwordx4 v[176:179], v1, s[4:7], s43 offen offset:1024 sc1
    v_cvt_pk_bf16_f32 v180, v128, v129
    v_cvt_pk_bf16_f32 v181, v130, v131
    v_cvt_pk_bf16_f32 v182, v132, v133
    v_cvt_pk_bf16_f32 v183, v134, v135
    buffer_store_dwordx4 v[180:183], v1, s[4:7], s43 offen offset:2048 sc1
    v_cvt_pk_bf16_f32 v184, v136, v137
    v_cvt_pk_bf16_f32 v185, v138, v139
    v_cvt_pk_bf16_f32 v186, v140, v141
    v_cvt_pk_bf16_f32 v187, v142, v143
    buffer_store_dwordx4 v[184:187], v1, s[4:7], s43 offen offset:3072 sc1
    s_waitcnt vmcnt(0)
    v_mov_b32 v160, s29
    v_mov_b32 v161, 0
    s_mov_b64 exec, 1
    buffer_store_dword v160, v161, s[4:7], s28 offen sc1
    s_mov_b64 exec, -1
    s_add_u32 s17, s17, 8
    s_cmp_lt_u32 s17, 64
    s_cbranch_scc1 L_attn_loop
    s_waitcnt vmcnt(0)
    s_branch L_exit
L_w_notattn:
    s_getpc_b64 s[40:41]
L_pc2:
    s_add_u32 s40, s40, L_table_qkv-L_pc2
    s_addc_u32 s41, s41, 0
    s_getpc_b64 s[88:89]
L_pc3:
    s_add_u32 s88, s88, L_table_a-L_pc3
    s_addc_u32 s89, s89, 0
    s_cmp_eq_u32 s16, 0
    s_cbranch_scc0 Lz_432
    v_mov_b32 v250, 200
    s_mov_b32 s24, 0
Lz_430:
    global_load_dword v251, v250, s[90:91] sc1
    s_waitcnt vmcnt(0)
    v_readfirstlane_b32 s20, v251
    s_nop 3
    s_cmp_ge_u32 s20, 256
    s_cbranch_scc1 Lz_431
    s_sleep 4
    s_add_u32 s24, s24, 1
    s_cmp_lt_u32 s24, 400000
    s_cbranch_scc1 Lz_430
    s_branch L_abort
Lz_431:
Lz_432:
    s_barrier
    s_sub_u32 s36, s94, 96
    s_and_b32 s12, s36, 7
    s_lshr_b32 s13, s36, 3
    s_lshl_b32 s20, s16, 8
    v_lshlrev_b32 v124, 2, v0
    v_add_u32 v124, s20, v124
    s_mov_b32 s42, s88
    s_mov_b32 s43, s89
    global_load_dword v100, v124, s[42:43]
    s_add_u32 s42, s42, 1024
    s_addc_u32 s43, s43, 0
    global_load_dword v101, v124, s[42:43]
    s_add_u32 s42, s42, 1024
    s_addc_u32 s43, s43, 0
    global_load_dword v102, v124, s[42:43]
    s_add_u32 s42, s42, 1024
    s_addc_u32 s43, s43, 0
    global_load_dword v103, v124, s[42:43]
    s_add_u32 s42, s42, 1024
    s_addc_u32 s43, s43, 0
    global_load_dword v104, v124, s[42:43]
    s_add_u32 s42, s42, 1024
    s_addc_u32 s43, s43, 0
    global_load_dword v105, v124, s[42:43]
    s_add_u32 s42, s42, 1024
    s_addc_u32 s43, s43, 0
    global_load_dword v106, v124, s[42:43]
    s_add_u32 s42, s42, 1024
    s_addc_u32 s43, s43, 0
    global_load_dword v107, v124, s[42:43]
    s_add_u32 s42, s42, 1024
    s_addc_u32 s43, s43, 0
    global_load_dword v108, v124, s[42:43]
    s_add_u32 s42, s42, 1024
    s_addc_u32 s43, s43, 0
    global_load_dword v109, v124, s[42:43]
    s_add_u32 s42, s42, 1024
    s_addc_u32 s43, s43, 0
    global_load_dword v110, v124, s[42:43]
    s_add_u32 s42, s42, 1024
    s_addc_u32 s43, s43, 0
    global_load_dword v111, v124, s[42:43]
    s_waitcnt vmcnt(0)
    s_lshl_b32 s20, s16, 8
    v_lshlrev_b32 v124, 2, v0
    v_add_u32 v124, s20, v124
    s_mov_b32 s42, s40
    s_mov_b32 s43, s41
    s_add_u32 s42, s42, 12288
    s_addc_u32 s43, s43, 0
    global_load_dword v2, v124, s[42:43]
    s_add_u32 s42, s42, 1024
    s_addc_u32 s43, s43, 0
    global_load_dword v3, v124, s[42:43]
    s_add_u32 s42, s42, 1024
    s_addc_u32 s43, s43, 0
    global_load_dword v4, v124, s[42:43]
    s_add_u32 s42, s42, 1024
    s_addc_u32 s43, s43, 0
    global_load_dword v5, v124, s[42:43]
    s_add_u32 s42, s42, 1024
    s_addc_u32 s43, s43, 0
    global_load_dword v6, v124, s[42:43]
    s_add_u32 s42, s42, 1024
    s_addc_u32 s43, s43, 0
    global_load_dword v7, v124, s[42:43]
    s_add_u32 s42, s42, 1024
    s_addc_u32 s43, s43, 0
    global_load_dword v8, v124, s[42:43]
    s_add_u32 s42, s42, 1024
    s_addc_u32 s43, s43, 0
    global_load_dword v9, v124, s[42:43]
    s_add_u32 s42, s42, 1024
    s_addc_u32 s43, s43, 0
    global_load_dword v10, v124, s[42:43]
    s_add_u32 s42, s42, 1024
    s_addc_u32 s43, s43, 0
    global_load_dword v11, v124, s[42:43]
    s_add_u32 s42, s42, 1024
    s_addc_u32 s43, s43, 0
    global_load_dword v16, v124, s[42:43]
    s_add_u32 s42, s42, 1024
    s_addc_u32 s43, s43, 0
    global_load_dword v17, v124, s[42:43]
    s_add_u32 s42, s42, 1024
    s_addc_u32 s43, s43, 0
    global_load_dword v18, v124, s[42:43]
    s_add_u32 s42, s42, 1024
    s_addc_u32 s43, s43, 0
    global_load_dword v19, v124, s[42:43]
    s_waitcnt vmcnt(0)
    v_lshlrev_b32 v1, 4, v0
    v_and_b32 v124, 15, v0
    v_lshrrev_b32 v124, 2, v124
    v_cmp_eq_u32 s[32:33], s16, v124
    v_lshrrev_b32 v124, 4, v0
    v_cmp_eq_u32 s[34:35], s16, v124
    s_load_dwordx2 s[8:9], s[96:97], 8
    s_mov_b32 s10, 2457600
    s_mov_b32 s11, 0x00020000
    s_waitcnt lgkmcnt(0)
    s_mul_i32 s20, s12, 160
    s_add_u32 s20, s20, 0
    s_min_u32 s21, s16, 2
    s_lshl_b32 s21, s21, 3
    s_cmp_eq_u32 s16, 3
    s_cselect_b32 s21, 23, s21
    s_lshl_b32 s21, s21, 10
    s_add_u32 s21, s21, 0
    s_mov_b32 m0, s21
    s_add_u32 s21, s21, 1024
    buffer_load_dwordx4 v100, s[8:11], s20 offen lds
    s_mov_b32 m0, s21
    s_add_u32 s21, s21, 1024
    buffer_load_dwordx4 v101, s[8:11], s20 offen lds
    s_mov_b32 m0, s21
    s_add_u32 s21, s21, 1024
    buffer_load_dwordx4 v102, s[8:11], s20 offen lds
    s_mov_b32 m0, s21
    s_add_u32 s21, s21, 1024
    buffer_load_dwordx4 v103, s[8:11], s20 offen lds
    s_mov_b32 m0, s21
    s_add_u32 s21, s21, 1024
    buffer_load_dwordx4 v104, s[8:11], s20 offen lds
    s_mov_b32 m0, s21
    s_add_u32 s21, s21, 1024
    buffer_load_dwordx4 v105, s[8:11], s20 offen lds
    s_mov_b32 m0, s21
    s_add_u32 s21, s21, 1024
    buffer_load_dwordx4 v106, s[8:11], s20 offen lds
    s_cmp_ge_u32 s16, 2
    s_cbranch_scc1 Lx_433
    s_mov_b32 m0, s21
    s_add_u32 s21, s21, 1024
    buffer_load_dwordx4 v107, s[8:11], s20 offen lds
Lx_433:
    s_mul_i32 s20, s12, 160
    s_add_u32 s20, s20, 245760
    s_min_u32 s21, s16, 2
    s_lshl_b32 s21, s21, 3
    s_cmp_eq_u32 s16, 3
    s_cselect_b32 s21, 23, s21
    s_lshl_b32 s21, s21, 10
    s_add_u32 s21, s21, 30720
    s_mov_b32 m0, s21
    s_add_u32 s21, s21, 1024
    buffer_load_dwordx4 v100, s[8:11], s20 offen lds
    s_mov_b32 m0, s21
    s_add_u32 s21, s21, 1024
    buffer_load_dwordx4 v101, s[8:11], s20 offen lds
    s_mov_b32 m0, s21
    s_add_u32 s21, s21, 1024
    buffer_load_dwordx4 v102, s[8:11], s20 offen lds
    s_mov_b32 m0, s21
    s_add_u32 s21, s21, 1024
    buffer_load_dwordx4 v103, s[8:11], s20 offen lds
    s_mov_b32 m0, s21
    s_add_u32 s21, s21, 1024
    buffer_load_dwordx4 v104, s[8:11], s20 offen lds
    s_mov_b32 m0, s21
    s_add_u32 s21, s21, 1024
    buffer_load_dwordx4 v105, s[8:11], s20 offen lds
    s_mov_b32 m0, s21
    s_add_u32 s21, s21, 1024
    buffer_load_dwordx4 v106, s[8:11], s20 offen lds
    s_cmp_ge_u32 s16, 2
    s_cbranch_scc1 Lx_434
    s_mov_b32 m0, s21
    s_add_u32 s21, s21, 1024
    buffer_load_dwordx4 v107, s[8:11], s20 offen lds
Lx_434:
    s_mul_i32 s20, s12, 160
    s_add_u32 s20, s20, 491520
    s_min_u32 s21, s16, 2
    s_lshl_b32 s21, s21, 3
    s_cmp_eq_u32 s16, 3
    s_cselect_b32 s21, 23, s21
    s_lshl_b32 s21, s21, 10
    s_add_u32 s21, s21, 61440
    s_mov_b32 m0, s21
    s_add_u32 s21, s21, 1024
    buffer_load_dwordx4 v100, s[8:11], s20 offen lds
    s_mov_b32 m0, s21
    s_add_u32 s21, s21, 1024
    buffer_load_dwordx4 v101, s[8:11], s20 offen lds
    s_mov_b32 m0, s21
    s_add_u32 s21, s21, 1024
    buffer_load_dwordx4 v102, s[8:11], s20 offen lds
    s_mov_b32 m0, s21
    s_add_u32 s21, s21, 1024
    buffer_load_dwordx4 v103, s[8:11], s20 offen lds
    s_mov_b32 m0, s21
    s_add_u32 s21, s21, 1024
    buffer_load_dwordx4 v104, s[8:11], s20 offen lds
    s_mov_b32 m0, s21
    s_add_u32 s21, s21, 1024
    buffer_load_dwordx4 v105, s[8:11], s20 offen lds
    s_mov_b32 m0, s21
    s_add_u32 s21, s21, 1024
    buffer_load_dwordx4 v106, s[8:11], s20 offen lds
    s_cmp_ge_u32 s16, 2
    s_cbranch_scc1 Lx_435
    s_mov_b32 m0, s21
    s_add_u32 s21, s21, 1024
    buffer_load_dwordx4 v107, s[8:11], s20 offen lds
Lx_435:
    s_mul_i32 s20, s12, 160
    s_add_u32 s20, s20, 737280
    s_min_u32 s21, s16, 2
    s_lshl_b32 s21, s21, 3
    s_cmp_eq_u32 s16, 3
    s_cselect_b32 s21, 23, s21
    s_lshl_b32 s21, s21, 10
    s_add_u32 s21, s21, 92160
    s_mov_b32 m0, s21
    s_add_u32 s21, s21, 1024
    buffer_load_dwordx4 v100, s[8:11], s20 offen lds
    s_mov_b32 m0, s21
    s_add_u32 s21, s21, 1024
    buffer_load_dwordx4 v101, s[8:11], s20 offen lds
    s_mov_b32 m0, s21
    s_add_u32 s21, s21, 1024
    buffer_load_dwordx4 v102, s[8:11], s20 offen lds
    s_mov_b32 m0, s21
    s_add_u32 s21, s21, 1024
    buffer_load_dwordx4 v103, s[8:11], s20 offen lds
    s_mov_b32 m0, s21
    s_add_u32 s21, s21, 1024
    buffer_load_dwordx4 v104, s[8:11], s20 offen lds
    s_mov_b32 m0, s21
    s_add_u32 s21, s21, 1024
    buffer_load_dwordx4 v105, s[8:11], s20 offen lds
    s_mov_b32 m0, s21
    s_add_u32 s21, s21, 1024
    buffer_load_dwordx4 v106, s[8:11], s20 offen lds
    s_cmp_ge_u32 s16, 2
    s_cbranch_scc1 Lx_436
    s_mov_b32 m0, s21
    s_add_u32 s21, s21, 1024
    buffer_load_dwordx4 v107, s[8:11], s20 offen lds
Lx_436:
    s_mul_i32 s20, s12, 160
    s_add_u32 s20, s20, 983040
    s_min_u32 s21, s16, 2
    s_lshl_b32 s21, s21, 3
    s_cmp_eq_u32 s16, 3
    s_cselect_b32 s21, 23, s21
    s_lshl_b32 s21, s21, 10
    s_add_u32 s21, s21, 122880
    s_mov_b32 m0, s21
    s_add_u32 s21, s21, 1024
    buffer_load_dwordx4 v100, s[8:11], s20 offen lds
    s_mov_b32 m0, s21
    s_add_u32 s21, s21, 1024
    buffer_load_dwordx4 v101, s[8:11], s20 offen lds
    s_mov_b32 m0, s21
    s_add_u32 s21, s21, 1024
    buffer_load_dwordx4 v102, s[8:11], s20 offen lds
    s_mov_b32 m0, s21
    s_add_u32 s21, s21, 1024
    buffer_load_dwordx4 v103, s[8:11], s20 offen lds
    s_mov_b32 m0, s21
    s_add_u32 s21, s21, 1024
    buffer_load_dwordx4 v104, s[8:11], s20 offen lds
    s_mov_b32 m0, s21
    s_add_u32 s21, s21, 1024
    buffer_load_dwordx4 v105, s[8:11], s20 offen lds
    s_mov_b32 m0, s21
    s_add_u32 s21, s21, 1024
    buffer_load_dwordx4 v106, s[8:11], s20 offen lds
    s_cmp_ge_u32 s16, 2
    s_cbranch_scc1 Lx_437
    s_mov_b32 m0, s21
    s_add_u32 s21, s21, 1024
    buffer_load_dwordx4 v107, s[8:11], s20 offen lds
Lx_437:
    s_waitcnt vmcnt(0)
    s_barrier
    v_add_u32 v124, 0, v108
    ds_read_b64_tr_b16 a[0:1], v124 offset:0
    ds_read_b64_tr_b16 a[2:3], v124 offset:1920
    ds_read_b64_tr_b16 a[4:5], v124 offset:15360
    ds_read_b64_tr_b16 a[6:7], v124 offset:17280
    v_add_u32 v124, 0, v109
    ds_read_b64_tr_b16 a[80:81], v124 offset:0
    ds_read_b64_tr_b16 a[82:83], v124 offset:1920
    ds_read_b64_tr_b16 a[84:85], v124 offset:15360
    ds_read_b64_tr_b16 a[86:87], v124 offset:17280
    v_add_u32 v124, 0, v110
    ds_read_b64_tr_b16 a[160:161], v124 offset:0
    ds_read_b64_tr_b16 a[162:163], v124 offset:1920
    ds_read_b64_tr_b16 a[164:165], v124 offset:15360
    ds_read_b64_tr_b16 a[166:167], v124 offset:17280
    v_add_u32 v124, 0, v111
    ds_read_b64_tr_b16 v[176:177], v124 offset:0
    ds_read_b64_tr_b16 v[178:179], v124 offset:1920
    ds_read_b64_tr_b16 v[180:181], v124 offset:15360
    ds_read_b64_tr_b16 v[182:183], v124 offset:17280
    s_waitcnt lgkmcnt(0)
    s_barrier
    s_mul_i32 s20, s12, 160
    s_add_u32 s20, s20, 1228800
    s_min_u32 s21, s16, 2
    s_lshl_b32 s21, s21, 3
    s_cmp_eq_u32 s16, 3
    s_cselect_b32 s21, 23, s21
    s_lshl_b32 s21, s21, 10
    s_add_u32 s21, s21, 0
    s_mov_b32 m0, s21
    s_add_u32 s21, s21, 1024
    buffer_load_dwordx4 v100, s[8:11], s20 offen lds
    s_mov_b32 m0, s21
    s_add_u32 s21, s21, 1024
    buffer_load_dwordx4 v101, s[8:11], s20 offen lds
    s_mov_b32 m0, s21
    s_add_u32 s21, s21, 1024
    buffer_load_dwordx4 v102, s[8:11], s20 offen lds
    s_mov_b32 m0, s21
    s_add_u32 s21, s21, 1024
    buffer_load_dwordx4 v103, s[8:11], s20 offen lds
    s_mov_b32 m0, s21
    s_add_u32 s21, s21, 1024
    buffer_load_dwordx4 v104, s[8:11], s20 offen lds
    s_mov_b32 m0, s21
    s_add_u32 s21, s21, 1024
    buffer_load_dwordx4 v105, s[8:11], s20 offen lds
    s_mov_b32 m0, s21
    s_add_u32 s21, s21, 1024
    buffer_load_dwordx4 v106, s[8:11], s20 offen lds
    s_cmp_ge_u32 s16, 2
    s_cbranch_scc1 Lx_438
    s_mov_b32 m0, s21
    s_add_u32 s21, s21, 1024
    buffer_load_dwordx4 v107, s[8:11], s20 offen lds
Lx_438:
    s_waitcnt vmcnt(0)
    s_barrier
    v_add_u32 v124, 30720, v108
    ds_read_b64_tr_b16 a[8:9], v124 offset:0
    ds_read_b64_tr_b16 a[10:11], v124 offset:1920
    ds_read_b64_tr_b16 a[12:13], v124 offset:15360
    ds_read_b64_tr_b16 a[14:15], v124 offset:17280
    v_add_u32 v124, 30720, v109
    ds_read_b64_tr_b16 a[88:89], v124 offset:0
    ds_read_b64_tr_b16 a[90:91], v124 offset:1920
    ds_read_b64_tr_b16 a[92:93], v124 offset:15360
    ds_read_b64_tr_b16 a[94:95], v124 offset:17280
    v_add_u32 v124, 30720, v110
    ds_read_b64_tr_b16 a[168:169], v124 offset:0
    ds_read_b64_tr_b16 a[170:171], v124 offset:1920
    ds_read_b64_tr_b16 a[172:173], v124 offset:15360
    ds_read_b64_tr_b16 a[174:175], v124 offset:17280
    v_add_u32 v124, 30720, v111
    ds_read_b64_tr_b16 v[184:185], v124 offset:0
    ds_read_b64_tr_b16 v[186:187], v124 offset:1920
    ds_read_b64_tr_b16 v[188:189], v124 offset:15360
    ds_read_b64_tr_b16 v[190:191], v124 offset:17280
    s_waitcnt lgkmcnt(0)
    s_barrier
    s_mul_i32 s20, s12, 160
    s_add_u32 s20, s20, 1474560
    s_min_u32 s21, s16, 2
    s_lshl_b32 s21, s21, 3
    s_cmp_eq_u32 s16, 3
    s_cselect_b32 s21, 23, s21
    s_lshl_b32 s21, s21, 10
    s_add_u32 s21, s21, 30720
    s_mov_b32 m0, s21
    s_add_u32 s21, s21, 1024
    buffer_load_dwordx4 v100, s[8:11], s20 offen lds
    s_mov_b32 m0, s21
    s_add_u32 s21, s21, 1024
    buffer_load_dwordx4 v101, s[8:11], s20 offen lds
    s_mov_b32 m0, s21
    s_add_u32 s21, s21, 1024
    buffer_load_dwordx4 v102, s[8:11], s20 offen lds
    s_mov_b32 m0, s21
    s_add_u32 s21, s21, 1024
    buffer_load_dwordx4 v103, s[8:11], s20 offen lds
    s_mov_b32 m0, s21
    s_add_u32 s21, s21, 1024
    buffer_load_dwordx4 v104, s[8:11], s20 offen lds
    s_mov_b32 m0, s21
    s_add_u32 s21, s21, 1024
    buffer_load_dwordx4 v105, s[8:11], s20 offen lds
    s_mov_b32 m0, s21
    s_add_u32 s21, s21, 1024
    buffer_load_dwordx4 v106, s[8:11], s20 offen lds
    s_cmp_ge_u32 s16, 2
    s_cbranch_scc1 Lx_439
    s_mov_b32 m0, s21
    s_add_u32 s21, s21, 1024
    buffer_load_dwordx4 v107, s[8:11], s20 offen lds
Lx_439:
    s_waitcnt vmcnt(0)
    s_barrier
    v_add_u32 v124, 61440, v108
    ds_read_b64_tr_b16 a[16:17], v124 offset:0
    ds_read_b64_tr_b16 a[18:19], v124 offset:1920
    ds_read_b64_tr_b16 a[20:21], v124 offset:15360
    ds_read_b64_tr_b16 a[22:23], v124 offset:17280
    v_add_u32 v124, 61440, v109
    ds_read_b64_tr_b16 a[96:97], v124 offset:0
    ds_read_b64_tr_b16 a[98:99], v124 offset:1920
    ds_read_b64_tr_b16 a[100:101], v124 offset:15360
    ds_read_b64_tr_b16 a[102:103], v124 offset:17280
    v_add_u32 v124, 61440, v110
    ds_read_b64_tr_b16 a[176:177], v124 offset:0
    ds_read_b64_tr_b16 a[178:179], v124 offset:1920
    ds_read_b64_tr_b16 a[180:181], v124 offset:15360
    ds_read_b64_tr_b16 a[182:183], v124 offset:17280
    v_add_u32 v124, 61440, v111
    ds_read_b64_tr_b16 v[192:193], v124 offset:0
    ds_read_b64_tr_b16 v[194:195], v124 offset:1920
    ds_read_b64_tr_b16 v[196:197], v124 offset:15360
    ds_read_b64_tr_b16 v[198:199], v124 offset:17280
    s_waitcnt lgkmcnt(0)
    s_barrier
    s_mul_i32 s20, s12, 160
    s_add_u32 s20, s20, 1720320
    s_min_u32 s21, s16, 2
    s_lshl_b32 s21, s21, 3
    s_cmp_eq_u32 s16, 3
    s_cselect_b32 s21, 23, s21
    s_lshl_b32 s21, s21, 10
    s_add_u32 s21, s21, 61440
    s_mov_b32 m0, s21
    s_add_u32 s21, s21, 1024
    buffer_load_dwordx4 v100, s[8:11], s20 offen lds
    s_mov_b32 m0, s21
    s_add_u32 s21, s21, 1024
    buffer_load_dwordx4 v101, s[8:11], s20 offen lds
    s_mov_b32 m0, s21
    s_add_u32 s21, s21, 1024
    buffer_load_dwordx4 v102, s[8:11], s20 offen lds
    s_mov_b32 m0, s21
    s_add_u32 s21, s21, 1024
    buffer_load_dwordx4 v103, s[8:11], s20 offen lds
    s_mov_b32 m0, s21
    s_add_u32 s21, s21, 1024
    buffer_load_dwordx4 v104, s[8:11], s20 offen lds
    s_mov_b32 m0, s21
    s_add_u32 s21, s21, 1024
    buffer_load_dwordx4 v105, s[8:11], s20 offen lds
    s_mov_b32 m0, s21
    s_add_u32 s21, s21, 1024
    buffer_load_dwordx4 v106, s[8:11], s20 offen lds
    s_cmp_ge_u32 s16, 2
    s_cbranch_scc1 Lx_440
    s_mov_b32 m0, s21
    s_add_u32 s21, s21, 1024
    buffer_load_dwordx4 v107, s[8:11], s20 offen lds
Lx_440:
    s_waitcnt vmcnt(0)
    s_barrier
    v_add_u32 v124, 92160, v108
    ds_read_b64_tr_b16 a[24:25], v124 offset:0
    ds_read_b64_tr_b16 a[26:27], v124 offset:1920
    ds_read_b64_tr_b16 a[28:29], v124 offset:15360
    ds_read_b64_tr_b16 a[30:31], v124 offset:17280
    v_add_u32 v124, 92160, v109
    ds_read_b64_tr_b16 a[104:105], v124 offset:0
    ds_read_b64_tr_b16 a[106:107], v124 offset:1920
    ds_read_b64_tr_b16 a[108:109], v124 offset:15360
    ds_read_b64_tr_b16 a[110:111], v124 offset:17280
    v_add_u32 v124, 92160, v110
    ds_read_b64_tr_b16 a[184:185], v124 offset:0
    ds_read_b64_tr_b16 a[186:187], v124 offset:1920
    ds_read_b64_tr_b16 a[188:189], v124 offset:15360
    ds_read_b64_tr_b16 a[190:191], v124 offset:17280
    v_add_u32 v124, 92160, v111
    ds_read_b64_tr_b16 v[200:201], v124 offset:0
    ds_read_b64_tr_b16 v[202:203], v124 offset:1920
    ds_read_b64_tr_b16 v[204:205], v124 offset:15360
    ds_read_b64_tr_b16 v[206:207], v124 offset:17280
    s_waitcnt lgkmcnt(0)
    s_barrier
    s_mul_i32 s20, s12, 160
    s_add_u32 s20, s20, 1966080
    s_min_u32 s21, s16, 2
    s_lshl_b32 s21, s21, 3
    s_cmp_eq_u32 s16, 3
    s_cselect_b32 s21, 23, s21
    s_lshl_b32 s21, s21, 10
    s_add_u32 s21, s21, 92160
    s_mov_b32 m0, s21
    s_add_u32 s21, s21, 1024
    buffer_load_dwordx4 v100, s[8:11], s20 offen lds
    s_mov_b32 m0, s21
    s_add_u32 s21, s21, 1024
    buffer_load_dwordx4 v101, s[8:11], s20 offen lds
    s_mov_b32 m0, s21
    s_add_u32 s21, s21, 1024
    buffer_load_dwordx4 v102, s[8:11], s20 offen lds
    s_mov_b32 m0, s21
    s_add_u32 s21, s21, 1024
    buffer_load_dwordx4 v103, s[8:11], s20 offen lds
    s_mov_b32 m0, s21
    s_add_u32 s21, s21, 1024
    buffer_load_dwordx4 v104, s[8:11], s20 offen lds
    s_mov_b32 m0, s21
    s_add_u32 s21, s21, 1024
    buffer_load_dwordx4 v105, s[8:11], s20 offen lds
    s_mov_b32 m0, s21
    s_add_u32 s21, s21, 1024
    buffer_load_dwordx4 v106, s[8:11], s20 offen lds
    s_cmp_ge_u32 s16, 2
    s_cbranch_scc1 Lx_441
    s_mov_b32 m0, s21
    s_add_u32 s21, s21, 1024
    buffer_load_dwordx4 v107, s[8:11], s20 offen lds
Lx_441:
    s_waitcnt vmcnt(0)
    s_barrier
    v_add_u32 v124, 122880, v108
    ds_read_b64_tr_b16 a[32:33], v124 offset:0
    ds_read_b64_tr_b16 a[34:35], v124 offset:1920
    ds_read_b64_tr_b16 a[36:37], v124 offset:15360
    ds_read_b64_tr_b16 a[38:39], v124 offset:17280
    v_add_u32 v124, 122880, v109
    ds_read_b64_tr_b16 a[112:113], v124 offset:0
    ds_read_b64_tr_b16 a[114:115], v124 offset:1920
    ds_read_b64_tr_b16 a[116:117], v124 offset:15360
    ds_read_b64_tr_b16 a[118:119], v124 offset:17280
    v_add_u32 v124, 122880, v110
    ds_read_b64_tr_b16 a[192:193], v124 offset:0
    ds_read_b64_tr_b16 a[194:195], v124 offset:1920
    ds_read_b64_tr_b16 a[196:197], v124 offset:15360
    ds_read_b64_tr_b16 a[198:199], v124 offset:17280
    v_add_u32 v124, 122880, v111
    ds_read_b64_tr_b16 v[208:209], v124 offset:0
    ds_read_b64_tr_b16 v[210:211], v124 offset:1920
    ds_read_b64_tr_b16 v[212:213], v124 offset:15360
    ds_read_b64_tr_b16 v[214:215], v124 offset:17280
    s_waitcnt lgkmcnt(0)
    s_barrier
    s_mul_i32 s20, s12, 160
    s_add_u32 s20, s20, 2211840
    s_min_u32 s21, s16, 2
    s_lshl_b32 s21, s21, 3
    s_cmp_eq_u32 s16, 3
    s_cselect_b32 s21, 23, s21
    s_lshl_b32 s21, s21, 10
    s_add_u32 s21, s21, 122880
    s_mov_b32 m0, s21
    s_add_u32 s21, s21, 1024
    buffer_load_dwordx4 v100, s[8:11], s20 offen lds
    s_mov_b32 m0, s21
    s_add_u32 s21, s21, 1024
    buffer_load_dwordx4 v101, s[8:11], s20 offen lds
    s_mov_b32 m0, s21
    s_add_u32 s21, s21, 1024
    buffer_load_dwordx4 v102, s[8:11], s20 offen lds
    s_mov_b32 m0, s21
    s_add_u32 s21, s21, 1024
    buffer_load_dwordx4 v103, s[8:11], s20 offen lds
    s_mov_b32 m0, s21
    s_add_u32 s21, s21, 1024
    buffer_load_dwordx4 v104, s[8:11], s20 offen lds
    s_mov_b32 m0, s21
    s_add_u32 s21, s21, 1024
    buffer_load_dwordx4 v105, s[8:11], s20 offen lds
    s_mov_b32 m0, s21
    s_add_u32 s21, s21, 1024
    buffer_load_dwordx4 v106, s[8:11], s20 offen lds
    s_cmp_ge_u32 s16, 2
    s_cbranch_scc1 Lx_442
    s_mov_b32 m0, s21
    s_add_u32 s21, s21, 1024
    buffer_load_dwordx4 v107, s[8:11], s20 offen lds
Lx_442:
    s_waitcnt vmcnt(0)
    s_barrier
    v_add_u32 v124, 0, v108
    ds_read_b64_tr_b16 a[40:41], v124 offset:0
    ds_read_b64_tr_b16 a[42:43], v124 offset:1920
    ds_read_b64_tr_b16 a[44:45], v124 offset:15360
    ds_read_b64_tr_b16 a[46:47], v124 offset:17280
    v_add_u32 v124, 0, v109
    ds_read_b64_tr_b16 a[120:121], v124 offset:0
    ds_read_b64_tr_b16 a[122:123], v124 offset:1920
    ds_read_b64_tr_b16 a[124:125], v124 offset:15360
    ds_read_b64_tr_b16 a[126:127], v124 offset:17280
    v_add_u32 v124, 0, v110
    ds_read_b64_tr_b16 a[200:201], v124 offset:0
    ds_read_b64_tr_b16 a[202:203], v124 offset:1920
    ds_read_b64_tr_b16 a[204:205], v124 offset:15360
    ds_read_b64_tr_b16 a[206:207], v124 offset:17280
    v_add_u32 v124, 0, v111
    ds_read_b64_tr_b16 v[216:217], v124 offset:0
    ds_read_b64_tr_b16 v[218:219], v124 offset:1920
    ds_read_b64_tr_b16 v[220:221], v124 offset:15360
    ds_read_b64_tr_b16 v[222:223], v124 offset:17280
    s_waitcnt lgkmcnt(0)
    s_waitcnt vmcnt(0)
    s_barrier
    v_add_u32 v124, 30720, v108
    ds_read_b64_tr_b16 a[48:49], v124 offset:0
    ds_read_b64_tr_b16 a[50:51], v124 offset:1920
    ds_read_b64_tr_b16 a[52:53], v124 offset:15360
    ds_read_b64_tr_b16 a[54:55], v124 offset:17280
    v_add_u32 v124, 30720, v109
    ds_read_b64_tr_b16 a[128:129], v124 offset:0
    ds_read_b64_tr_b16 a[130:131], v124 offset:1920
    ds_read_b64_tr_b16 a[132:133], v124 offset:15360
    ds_read_b64_tr_b16 a[134:135], v124 offset:17280
    v_add_u32 v124, 30720, v110
    ds_read_b64_tr_b16 a[208:209], v124 offset:0
    ds_read_b64_tr_b16 a[210:211], v124 offset:1920
    ds_read_b64_tr_b16 a[212:213], v124 offset:15360
    ds_read_b64_tr_b16 a[214:215], v124 offset:17280
    v_add_u32 v124, 30720, v111
    ds_read_b64_tr_b16 v[224:225], v124 offset:0
    ds_read_b64_tr_b16 v[226:227], v124 offset:1920
    ds_read_b64_tr_b16 v[228:229], v124 offset:15360
    ds_read_b64_tr_b16 v[230:231], v124 offset:17280
    s_waitcnt lgkmcnt(0)
    s_waitcnt vmcnt(0)
    s_barrier
    v_add_u32 v124, 61440, v108
    ds_read_b64_tr_b16 a[56:57], v124 offset:0
    ds_read_b64_tr_b16 a[58:59], v124 offset:1920
    ds_read_b64_tr_b16 a[60:61], v124 offset:15360
    ds_read_b64_tr_b16 a[62:63], v124 offset:17280
    v_add_u32 v124, 61440, v109
    ds_read_b64_tr_b16 a[136:137], v124 offset:0
    ds_read_b64_tr_b16 a[138:139], v124 offset:1920
    ds_read_b64_tr_b16 a[140:141], v124 offset:15360
    ds_read_b64_tr_b16 a[142:143], v124 offset:17280
    v_add_u32 v124, 61440, v110
    ds_read_b64_tr_b16 a[216:217], v124 offset:0
    ds_read_b64_tr_b16 a[218:219], v124 offset:1920
    ds_read_b64_tr_b16 a[220:221], v124 offset:15360
    ds_read_b64_tr_b16 a[222:223], v124 offset:17280
    v_add_u32 v124, 61440, v111
    ds_read_b64_tr_b16 v[232:233], v124 offset:0
    ds_read_b64_tr_b16 v[234:235], v124 offset:1920
    ds_read_b64_tr_b16 v[236:237], v124 offset:15360
    ds_read_b64_tr_b16 v[238:239], v124 offset:17280
    s_waitcnt lgkmcnt(0)
    s_waitcnt vmcnt(0)
    s_barrier
    v_add_u32 v124, 92160, v108
    ds_read_b64_tr_b16 a[64:65], v124 offset:0
    ds_read_b64_tr_b16 a[66:67], v124 offset:1920
    ds_read_b64_tr_b16 a[68:69], v124 offset:15360
    ds_read_b64_tr_b16 a[70:71], v124 offset:17280
    v_add_u32 v124, 92160, v109
    ds_read_b64_tr_b16 a[144:145], v124 offset:0
    ds_read_b64_tr_b16 a[146:147], v124 offset:1920
    ds_read_b64_tr_b16 a[148:149], v124 offset:15360
    ds_read_b64_tr_b16 a[150:151], v124 offset:17280
    v_add_u32 v124, 92160, v110
    ds_read_b64_tr_b16 a[224:225], v124 offset:0
    ds_read_b64_tr_b16 a[226:227], v124 offset:1920
    ds_read_b64_tr_b16 a[228:229], v124 offset:15360
    ds_read_b64_tr_b16 a[230:231], v124 offset:17280
    v_add_u32 v124, 92160, v111
    ds_read_b64_tr_b16 v[240:241], v124 offset:0
    ds_read_b64_tr_b16 v[242:243], v124 offset:1920
    ds_read_b64_tr_b16 v[244:245], v124 offset:15360
    ds_read_b64_tr_b16 v[246:247], v124 offset:17280
    s_waitcnt lgkmcnt(0)
    s_waitcnt vmcnt(0)
    s_barrier
    v_add_u32 v124, 122880, v108
    ds_read_b64_tr_b16 a[72:73], v124 offset:0
    ds_read_b64_tr_b16 a[74:75], v124 offset:1920
    ds_read_b64_tr_b16 a[76:77], v124 offset:15360
    ds_read_b64_tr_b16 a[78:79], v124 offset:17280
    v_add_u32 v124, 122880, v109
    ds_read_b64_tr_b16 a[152:153], v124 offset:0
    ds_read_b64_tr_b16 a[154:155], v124 offset:1920
    ds_read_b64_tr_b16 a[156:157], v124 offset:15360
    ds_read_b64_tr_b16 a[158:159], v124 offset:17280
    v_add_u32 v124, 122880, v110
    ds_read_b64_tr_b16 a[232:233], v124 offset:0
    ds_read_b64_tr_b16 a[234:235], v124 offset:1920
    ds_read_b64_tr_b16 a[236:237], v124 offset:15360
    ds_read_b64_tr_b16 a[238:239], v124 offset:17280
    v_add_u32 v124, 122880, v111
    ds_read_b64_tr_b16 v[248:249], v124 offset:0
    ds_read_b64_tr_b16 v[250:251], v124 offset:1920
    ds_read_b64_tr_b16 v[252:253], v124 offset:15360
    ds_read_b64_tr_b16 v[254:255], v124 offset:17280
    s_waitcnt lgkmcnt(0)
    s_barrier
    s_load_dwordx2 s[8:9], s[96:97], 0
    s_mov_b32 s10, 2621440
    s_mov_b32 s11, 0x00020000
    s_waitcnt lgkmcnt(0)
    v_mov_b32 v76, 0
    v_mov_b32 v77, 0
    v_mov_b32 v78, 0
    v_mov_b32 v79, 0
    v_mov_b32 v80, 0
    v_mov_b32 v81, 0
    v_mov_b32 v82, 0
    v_mov_b32 v83, 0
    v_mov_b32 v84, 0
    v_mov_b32 v85, 0
    v_mov_b32 v86, 0
    v_mov_b32 v87, 0
    v_mov_b32 v88, 0
    v_mov_b32 v89, 0
    v_mov_b32 v90, 0
    v_mov_b32 v91, 0
    v_mov_b32 v92, 0
    v_mov_b32 v93, 0
    v_mov_b32 v94, 0
    v_mov_b32 v95, 0
    v_mov_b32 v96, 0
    v_mov_b32 v97, 0
    v_mov_b32 v98, 0
    v_mov_b32 v99, 0
    s_mul_i32 s23, s16, 10240
    s_lshl_b32 s17, s13, 4
    s_mov_b32 s27, 0
    s_mov_b32 s26, s23
    s_mul_i32 s42, s17, 40960
    s_add_u32 m0, s26, 0
    s_nop 0
    buffer_load_dwordx4 v2, s[8:11], s42 offen lds
    s_add_u32 m0, s26, 1024
    s_nop 0
    buffer_load_dwordx4 v3, s[8:11], s42 offen lds
    s_add_u32 m0, s26, 2048
    s_nop 0
    buffer_load_dwordx4 v4, s[8:11], s42 offen lds
    s_add_u32 m0, s26, 3072
    s_nop 0
    buffer_load_dwordx4 v5, s[8:11], s42 offen lds
    s_add_u32 m0, s26, 4096
    s_nop 0
    buffer_load_dwordx4 v6, s[8:11], s42 offen lds
    s_add_u32 m0, s26, 5120
    s_nop 0
    buffer_load_dwordx4 v7, s[8:11], s42 offen lds
    s_add_u32 m0, s26, 6144
    s_nop 0
    buffer_load_dwordx4 v8, s[8:11], s42 offen lds
    s_add_u32 m0, s26, 7168
    s_nop 0
    buffer_load_dwordx4 v9, s[8:11], s42 offen lds
    s_add_u32 m0, s26, 8192
    s_nop 0
    buffer_load_dwordx4 v10, s[8:11], s42 offen lds
    s_add_u32 m0, s26, 9216
    s_nop 0
    buffer_load_dwordx4 v11, s[8:11], s42 offen lds
L_a1_loop:
    s_and_b32 s18, s27, 1
    s_mul_i32 s19, s18, 40960
    s_xor_b32 s20, s18, 1
    s_mul_i32 s26, s20, 40960
    s_add_u32 s26, s26, s23
    s_add_u32 s20, s17, 1
    s_min_u32 s20, s20, 63
    s_mul_i32 s42, s20, 40960
    s_waitcnt vmcnt(0)
    s_barrier
    s_add_u32 m0, s26, 0
    s_nop 0
    buffer_load_dwordx4 v2, s[8:11], s42 offen lds
    s_add_u32 m0, s26, 1024
    s_nop 0
    buffer_load_dwordx4 v3, s[8:11], s42 offen lds
    s_add_u32 m0, s26, 2048
    s_nop 0
    buffer_load_dwordx4 v4, s[8:11], s42 offen lds
    s_add_u32 m0, s26, 3072
    s_nop 0
    buffer_load_dwordx4 v5, s[8:11], s42 offen lds
    s_add_u32 m0, s26, 4096
    s_nop 0
    buffer_load_dwordx4 v6, s[8:11], s42 offen lds
    s_add_u32 m0, s26, 5120
    s_nop 0
    buffer_load_dwordx4 v7, s[8:11], s42 offen lds
    s_add_u32 m0, s26, 6144
    s_nop 0
    buffer_load_dwordx4 v8, s[8:11], s42 offen lds
    s_add_u32 m0, s26, 7168
    s_nop 0
    buffer_load_dwordx4 v9, s[8:11], s42 offen lds
    s_add_u32 m0, s26, 8192
    s_nop 0
    buffer_load_dwordx4 v10, s[8:11], s42 offen lds
    s_add_u32 m0, s26, 9216
    s_nop 0
    buffer_load_dwordx4 v11, s[8:11], s42 offen lds
    v_add_u32 v12, s19, v16
    v_add_u32 v13, s19, v17
    v_add_u32 v14, s19, v18
    v_add_u32 v15, s19, v19
    ds_read_b128 v[20:23], v12 offset:0
    ds_read_b128 v[24:27], v12 offset:20480
    ds_read_b128 v[28:31], v13 offset:0
    ds_read_b128 v[32:35], v13 offset:20480
    s_cmp_eq_u32 s16, 0
    s_cbranch_scc0 La_443
    ds_read_b128 v[36:39], v14 offset:0
    ds_read_b128 v[40:43], v14 offset:20480
    s_waitcnt lgkmcnt(4)
    v_mfma_f32_16x16x32_bf16 v[44:47], a[0:3], v[20:23], 0
    v_mfma_f32_16x16x32_bf16 v[48:51], v[20:23], a[80:83], 0
    v_mfma_f32_16x16x32_bf16 v[52:55], v[20:23], a[160:163], 0
    v_mfma_f32_16x16x32_bf16 v[56:59], v[176:179], v[20:23], 0
    v_mfma_f32_16x16x32_bf16 v[60:63], a[0:3], v[24:27], 0
    v_mfma_f32_16x16x32_bf16 v[64:67], v[24:27], a[80:83], 0
    v_mfma_f32_16x16x32_bf16 v[68:71], v[24:27], a[160:163], 0
    v_mfma_f32_16x16x32_bf16 v[72:75], v[176:179], v[24:27], 0
    ds_read_b128 v[20:23], v15 offset:0
    ds_read_b128 v[24:27], v15 offset:20480
    s_waitcnt lgkmcnt(4)
    v_mfma_f32_16x16x32_bf16 v[44:47], a[4:7], v[28:31], v[44:47]
    v_mfma_f32_16x16x32_bf16 v[48:51], v[28:31], a[84:87], v[48:51]
    v_mfma_f32_16x16x32_bf16 v[52:55], v[28:31], a[164:167], v[52:55]
    v_mfma_f32_16x16x32_bf16 v[56:59], v[180:183], v[28:31], v[56:59]
    v_mfma_f32_16x16x32_bf16 v[60:63], a[4:7], v[32:35], v[60:63]
    v_mfma_f32_16x16x32_bf16 v[64:67], v[32:35], a[84:87], v[64:67]
    v_mfma_f32_16x16x32_bf16 v[68:71], v[32:35], a[164:167], v[68:71]
    v_mfma_f32_16x16x32_bf16 v[72:75], v[180:183], v[32:35], v[72:75]
    ds_read_b128 v[28:31], v12 offset:256
    ds_read_b128 v[32:35], v12 offset:20736
    s_waitcnt lgkmcnt(4)
    v_mfma_f32_16x16x32_bf16 v[44:47], a[8:11], v[36:39], v[44:47]
    v_mfma_f32_16x16x32_bf16 v[48:51], v[36:39], a[88:91], v[48:51]
    v_mfma_f32_16x16x32_bf16 v[52:55], v[36:39], a[168:171], v[52:55]
    v_mfma_f32_16x16x32_bf16 v[56:59], v[184:187], v[36:39], v[56:59]
    v_mfma_f32_16x16x32_bf16 v[60:63], a[8:11], v[40:43], v[60:63]
    v_mfma_f32_16x16x32_bf16 v[64:67], v[40:43], a[88:91], v[64:67]
    v_mfma_f32_16x16x32_bf16 v[68:71], v[40:43], a[168:171], v[68:71]
    v_mfma_f32_16x16x32_bf16 v[72:75], v[184:187], v[40:43], v[72:75]
    ds_read_b128 v[36:39], v13 offset:256
    ds_read_b128 v[40:43], v13 offset:20736
    s_waitcnt lgkmcnt(4)
    v_mfma_f32_16x16x32_bf16 v[44:47], a[12:15], v[20:23], v[44:47]
    v_mfma_f32_16x16x32_bf16 v[48:51], v[20:23], a[92:95], v[48:51]
    v_mfma_f32_16x16x32_bf16 v[52:55], v[20:23], a[172:175], v[52:55]
    v_mfma_f32_16x16x32_bf16 v[56:59], v[188:191], v[20:23], v[56:59]
    v_mfma_f32_16x16x32_bf16 v[60:63], a[12:15], v[24:27], v[60:63]
    v_mfma_f32_16x16x32_bf16 v[64:67], v[24:27], a[92:95], v[64:67]
    v_mfma_f32_16x16x32_bf16 v[68:71], v[24:27], a[172:175], v[68:71]
    v_mfma_f32_16x16x32_bf16 v[72:75], v[188:191], v[24:27], v[72:75]
    ds_read_b128 v[20:23], v14 offset:256
    ds_read_b128 v[24:27], v14 offset:20736
    s_waitcnt lgkmcnt(4)
    v_mfma_f32_16x16x32_bf16 v[44:47], a[16:19], v[28:31], v[44:47]
    v_mfma_f32_16x16x32_bf16 v[48:51], v[28:31], a[96:99], v[48:51]
    v_mfma_f32_16x16x32_bf16 v[52:55], v[28:31], a[176:179], v[52:55]
    v_mfma_f32_16x16x32_bf16 v[56:59], v[192:195], v[28:31], v[56:59]
    v_mfma_f32_16x16x32_bf16 v[60:63], a[16:19], v[32:35], v[60:63]
    v_mfma_f32_16x16x32_bf16 v[64:67], v[32:35], a[96:99], v[64:67]
    v_mfma_f32_16x16x32_bf16 v[68:71], v[32:35], a[176:179], v[68:71]
    v_mfma_f32_16x16x32_bf16 v[72:75], v[192:195], v[32:35], v[72:75]
    ds_read_b128 v[28:31], v15 offset:256
    ds_read_b128 v[32:35], v15 offset:20736
    s_waitcnt lgkmcnt(4)
    v_mfma_f32_16x16x32_bf16 v[44:47], a[20:23], v[36:39], v[44:47]
    v_mfma_f32_16x16x32_bf16 v[48:51], v[36:39], a[100:103], v[48:51]
    v_mfma_f32_16x16x32_bf16 v[52:55], v[36:39], a[180:183], v[52:55]
    v_mfma_f32_16x16x32_bf16 v[56:59], v[196:199], v[36:39], v[56:59]
    v_mfma_f32_16x16x32_bf16 v[60:63], a[20:23], v[40:43], v[60:63]
    v_mfma_f32_16x16x32_bf16 v[64:67], v[40:43], a[100:103], v[64:67]
    v_mfma_f32_16x16x32_bf16 v[68:71], v[40:43], a[180:183], v[68:71]
    v_mfma_f32_16x16x32_bf16 v[72:75], v[196:199], v[40:43], v[72:75]
    ds_read_b128 v[36:39], v12 offset:512
    ds_read_b128 v[40:43], v12 offset:20992
    s_waitcnt lgkmcnt(4)
    v_mfma_f32_16x16x32_bf16 v[44:47], a[24:27], v[20:23], v[44:47]
    v_mfma_f32_16x16x32_bf16 v[48:51], v[20:23], a[104:107], v[48:51]
    v_mfma_f32_16x16x32_bf16 v[52:55], v[20:23], a[184:187], v[52:55]
    v_mfma_f32_16x16x32_bf16 v[56:59], v[200:203], v[20:23], v[56:59]
    v_mfma_f32_16x16x32_bf16 v[60:63], a[24:27], v[24:27], v[60:63]
    v_mfma_f32_16x16x32_bf16 v[64:67], v[24:27], a[104:107], v[64:67]
    v_mfma_f32_16x16x32_bf16 v[68:71], v[24:27], a[184:187], v[68:71]
    v_mfma_f32_16x16x32_bf16 v[72:75], v[200:203], v[24:27], v[72:75]
    ds_read_b128 v[20:23], v13 offset:512
    ds_read_b128 v[24:27], v13 offset:20992
    s_waitcnt lgkmcnt(4)
    v_mfma_f32_16x16x32_bf16 v[44:47], a[28:31], v[28:31], v[44:47]
    v_mfma_f32_16x16x32_bf16 v[48:51], v[28:31], a[108:111], v[48:51]
    v_mfma_f32_16x16x32_bf16 v[52:55], v[28:31], a[188:191], v[52:55]
    v_mfma_f32_16x16x32_bf16 v[56:59], v[204:207], v[28:31], v[56:59]
    v_mfma_f32_16x16x32_bf16 v[60:63], a[28:31], v[32:35], v[60:63]
    v_mfma_f32_16x16x32_bf16 v[64:67], v[32:35], a[108:111], v[64:67]
    v_mfma_f32_16x16x32_bf16 v[68:71], v[32:35], a[188:191], v[68:71]
    v_mfma_f32_16x16x32_bf16 v[72:75], v[204:207], v[32:35], v[72:75]
    ds_read_b128 v[28:31], v14 offset:512
    ds_read_b128 v[32:35], v14 offset:20992
    s_waitcnt lgkmcnt(4)
    v_mfma_f32_16x16x32_bf16 v[44:47], a[32:35], v[36:39], v[44:47]
    v_mfma_f32_16x16x32_bf16 v[48:51], v[36:39], a[112:115], v[48:51]
    v_mfma_f32_16x16x32_bf16 v[52:55], v[36:39], a[192:195], v[52:55]
    v_mfma_f32_16x16x32_bf16 v[56:59], v[208:211], v[36:39], v[56:59]
    v_mfma_f32_16x16x32_bf16 v[60:63], a[32:35], v[40:43], v[60:63]
    v_mfma_f32_16x16x32_bf16 v[64:67], v[40:43], a[112:115], v[64:67]
    v_mfma_f32_16x16x32_bf16 v[68:71], v[40:43], a[192:195], v[68:71]
    v_mfma_f32_16x16x32_bf16 v[72:75], v[208:211], v[40:43], v[72:75]
    ds_read_b128 v[36:39], v15 offset:512
    ds_read_b128 v[40:43], v15 offset:20992
    s_waitcnt lgkmcnt(4)
    v_mfma_f32_16x16x32_bf16 v[44:47], a[36:39], v[20:23], v[44:47]
    v_mfma_f32_16x16x32_bf16 v[48:51], v[20:23], a[116:119], v[48:51]
    v_mfma_f32_16x16x32_bf16 v[52:55], v[20:23], a[196:199], v[52:55]
    v_mfma_f32_16x16x32_bf16 v[56:59], v[212:215], v[20:23], v[56:59]
    v_mfma_f32_16x16x32_bf16 v[60:63], a[36:39], v[24:27], v[60:63]
    v_mfma_f32_16x16x32_bf16 v[64:67], v[24:27], a[116:119], v[64:67]
    v_mfma_f32_16x16x32_bf16 v[68:71], v[24:27], a[196:199], v[68:71]
    v_mfma_f32_16x16x32_bf16 v[72:75], v[212:215], v[24:27], v[72:75]
    ds_read_b128 v[20:23], v12 offset:768
    ds_read_b128 v[24:27], v12 offset:21248
    s_waitcnt lgkmcnt(4)
    v_mfma_f32_16x16x32_bf16 v[44:47], a[40:43], v[28:31], v[44:47]
    v_mfma_f32_16x16x32_bf16 v[48:51], v[28:31], a[120:123], v[48:51]
    v_mfma_f32_16x16x32_bf16 v[52:55], v[28:31], a[200:203], v[52:55]
    v_mfma_f32_16x16x32_bf16 v[56:59], v[216:219], v[28:31], v[56:59]
    v_mfma_f32_16x16x32_bf16 v[60:63], a[40:43], v[32:35], v[60:63]
    v_mfma_f32_16x16x32_bf16 v[64:67], v[32:35], a[120:123], v[64:67]
    v_mfma_f32_16x16x32_bf16 v[68:71], v[32:35], a[200:203], v[68:71]
    v_mfma_f32_16x16x32_bf16 v[72:75], v[216:219], v[32:35], v[72:75]
    ds_read_b128 v[28:31], v13 offset:768
    ds_read_b128 v[32:35], v13 offset:21248
    s_waitcnt lgkmcnt(4)
    v_mfma_f32_16x16x32_bf16 v[44:47], a[44:47], v[36:39], v[44:47]
    v_mfma_f32_16x16x32_bf16 v[48:51], v[36:39], a[124:127], v[48:51]
    v_mfma_f32_16x16x32_bf16 v[52:55], v[36:39], a[204:207], v[52:55]
    v_mfma_f32_16x16x32_bf16 v[56:59], v[220:223], v[36:39], v[56:59]
    v_mfma_f32_16x16x32_bf16 v[60:63], a[44:47], v[40:43], v[60:63]
    v_mfma_f32_16x16x32_bf16 v[64:67], v[40:43], a[124:127], v[64:67]
    v_mfma_f32_16x16x32_bf16 v[68:71], v[40:43], a[204:207], v[68:71]
    v_mfma_f32_16x16x32_bf16 v[72:75], v[220:223], v[40:43], v[72:75]
    ds_read_b128 v[36:39], v14 offset:768
    ds_read_b128 v[40:43], v14 offset:21248
    s_waitcnt lgkmcnt(4)
    v_mfma_f32_16x16x32_bf16 v[44:47], a[48:51], v[20:23], v[44:47]
    v_mfma_f32_16x16x32_bf16 v[48:51], v[20:23], a[128:131], v[48:51]
    v_mfma_f32_16x16x32_bf16 v[52:55], v[20:23], a[208:211], v[52:55]
    v_mfma_f32_16x16x32_bf16 v[56:59], v[224:227], v[20:23], v[56:59]
    v_mfma_f32_16x16x32_bf16 v[60:63], a[48:51], v[24:27], v[60:63]
    v_mfma_f32_16x16x32_bf16 v[64:67], v[24:27], a[128:131], v[64:67]
    v_mfma_f32_16x16x32_bf16 v[68:71], v[24:27], a[208:211], v[68:71]
    v_mfma_f32_16x16x32_bf16 v[72:75], v[224:227], v[24:27], v[72:75]
    ds_read_b128 v[20:23], v15 offset:768
    ds_read_b128 v[24:27], v15 offset:21248
    s_waitcnt lgkmcnt(4)
    v_mfma_f32_16x16x32_bf16 v[44:47], a[52:55], v[28:31], v[44:47]
    v_mfma_f32_16x16x32_bf16 v[48:51], v[28:31], a[132:135], v[48:51]
    v_mfma_f32_16x16x32_bf16 v[52:55], v[28:31], a[212:215], v[52:55]
    v_mfma_f32_16x16x32_bf16 v[56:59], v[228:231], v[28:31], v[56:59]
    v_mfma_f32_16x16x32_bf16 v[60:63], a[52:55], v[32:35], v[60:63]
    v_mfma_f32_16x16x32_bf16 v[64:67], v[32:35], a[132:135], v[64:67]
    v_mfma_f32_16x16x32_bf16 v[68:71], v[32:35], a[212:215], v[68:71]
    v_mfma_f32_16x16x32_bf16 v[72:75], v[228:231], v[32:35], v[72:75]
    ds_read_b128 v[28:31], v12 offset:1024
    ds_read_b128 v[32:35], v12 offset:21504
    s_waitcnt lgkmcnt(4)
    v_mfma_f32_16x16x32_bf16 v[44:47], a[56:59], v[36:39], v[44:47]
    v_mfma_f32_16x16x32_bf16 v[48:51], v[36:39], a[136:139], v[48:51]
    v_mfma_f32_16x16x32_bf16 v[52:55], v[36:39], a[216:219], v[52:55]
    v_mfma_f32_16x16x32_bf16 v[56:59], v[232:235], v[36:39], v[56:59]
    v_mfma_f32_16x16x32_bf16 v[60:63], a[56:59], v[40:43], v[60:63]
    v_mfma_f32_16x16x32_bf16 v[64:67], v[40:43], a[136:139], v[64:67]
    v_mfma_f32_16x16x32_bf16 v[68:71], v[40:43], a[216:219], v[68:71]
    v_mfma_f32_16x16x32_bf16 v[72:75], v[232:235], v[40:43], v[72:75]
    ds_read_b128 v[36:39], v13 offset:1024
    ds_read_b128 v[40:43], v13 offset:21504
    s_waitcnt lgkmcnt(4)
    v_mfma_f32_16x16x32_bf16 v[44:47], a[60:63], v[20:23], v[44:47]
    v_mfma_f32_16x16x32_bf16 v[48:51], v[20:23], a[140:143], v[48:51]
    v_mfma_f32_16x16x32_bf16 v[52:55], v[20:23], a[220:223], v[52:55]
    v_mfma_f32_16x16x32_bf16 v[56:59], v[236:239], v[20:23], v[56:59]
    v_mfma_f32_16x16x32_bf16 v[60:63], a[60:63], v[24:27], v[60:63]
    v_mfma_f32_16x16x32_bf16 v[64:67], v[24:27], a[140:143], v[64:67]
    v_mfma_f32_16x16x32_bf16 v[68:71], v[24:27], a[220:223], v[68:71]
    v_mfma_f32_16x16x32_bf16 v[72:75], v[236:239], v[24:27], v[72:75]
    ds_read_b128 v[20:23], v14 offset:1024
    ds_read_b128 v[24:27], v14 offset:21504
    s_waitcnt lgkmcnt(4)
    v_mfma_f32_16x16x32_bf16 v[44:47], a[64:67], v[28:31], v[44:47]
    v_mfma_f32_16x16x32_bf16 v[48:51], v[28:31], a[144:147], v[48:51]
    v_mfma_f32_16x16x32_bf16 v[52:55], v[28:31], a[224:227], v[52:55]
    v_mfma_f32_16x16x32_bf16 v[56:59], v[240:243], v[28:31], v[56:59]
    v_mfma_f32_16x16x32_bf16 v[60:63], a[64:67], v[32:35], v[60:63]
    v_mfma_f32_16x16x32_bf16 v[64:67], v[32:35], a[144:147], v[64:67]
    v_mfma_f32_16x16x32_bf16 v[68:71], v[32:35], a[224:227], v[68:71]
    v_mfma_f32_16x16x32_bf16 v[72:75], v[240:243], v[32:35], v[72:75]
    ds_read_b128 v[28:31], v15 offset:1024
    ds_read_b128 v[32:35], v15 offset:21504
    s_waitcnt lgkmcnt(4)
    v_mfma_f32_16x16x32_bf16 v[44:47], a[68:71], v[36:39], v[44:47]
    v_mfma_f32_16x16x32_bf16 v[48:51], v[36:39], a[148:151], v[48:51]
    v_mfma_f32_16x16x32_bf16 v[52:55], v[36:39], a[228:231], v[52:55]
    v_mfma_f32_16x16x32_bf16 v[56:59], v[244:247], v[36:39], v[56:59]
    v_mfma_f32_16x16x32_bf16 v[60:63], a[68:71], v[40:43], v[60:63]
    v_mfma_f32_16x16x32_bf16 v[64:67], v[40:43], a[148:151], v[64:67]
    v_mfma_f32_16x16x32_bf16 v[68:71], v[40:43], a[228:231], v[68:71]
    v_mfma_f32_16x16x32_bf16 v[72:75], v[244:247], v[40:43], v[72:75]
    s_waitcnt lgkmcnt(2)
    v_mfma_f32_16x16x32_bf16 v[44:47], a[72:75], v[20:23], v[44:47]
    v_mfma_f32_16x16x32_bf16 v[48:51], v[20:23], a[152:155], v[48:51]
    v_mfma_f32_16x16x32_bf16 v[52:55], v[20:23], a[232:235], v[52:55]
    v_mfma_f32_16x16x32_bf16 v[56:59], v[248:251], v[20:23], v[56:59]
    v_mfma_f32_16x16x32_bf16 v[60:63], a[72:75], v[24:27], v[60:63]
    v_mfma_f32_16x16x32_bf16 v[64:67], v[24:27], a[152:155], v[64:67]
    v_mfma_f32_16x16x32_bf16 v[68:71], v[24:27], a[232:235], v[68:71]
    v_mfma_f32_16x16x32_bf16 v[72:75], v[248:251], v[24:27], v[72:75]
    s_waitcnt lgkmcnt(0)
    v_mfma_f32_16x16x32_bf16 v[44:47], a[76:79], v[28:31], v[44:47]
    v_mfma_f32_16x16x32_bf16 v[48:51], v[28:31], a[156:159], v[48:51]
    v_mfma_f32_16x16x32_bf16 v[52:55], v[28:31], a[236:239], v[52:55]
    v_mfma_f32_16x16x32_bf16 v[56:59], v[252:255], v[28:31], v[56:59]
    v_mfma_f32_16x16x32_bf16 v[60:63], a[76:79], v[32:35], v[60:63]
    v_mfma_f32_16x16x32_bf16 v[64:67], v[32:35], a[156:159], v[64:67]
    v_mfma_f32_16x16x32_bf16 v[68:71], v[32:35], a[236:239], v[68:71]
    v_mfma_f32_16x16x32_bf16 v[72:75], v[252:255], v[32:35], v[72:75]
    s_branch La_444
La_443:
    ds_read_b128 v[36:39], v14 offset:0
    ds_read_b128 v[40:43], v14 offset:20480
    s_waitcnt lgkmcnt(4)
    v_mfma_f32_16x16x32_bf16 v[44:47], a[0:3], v[20:23], 0
    v_mfma_f32_16x16x32_bf16 v[48:51], v[20:23], a[80:83], 0
    v_mfma_f32_16x16x32_bf16 v[52:55], v[20:23], a[160:163], 0
    v_mfma_f32_16x16x32_bf16 v[56:59], v[20:23], v[176:179], 0
    v_mfma_f32_16x16x32_bf16 v[60:63], a[0:3], v[24:27], 0
    v_mfma_f32_16x16x32_bf16 v[64:67], v[24:27], a[80:83], 0
    v_mfma_f32_16x16x32_bf16 v[68:71], v[24:27], a[160:163], 0
    v_mfma_f32_16x16x32_bf16 v[72:75], v[24:27], v[176:179], 0
    ds_read_b128 v[20:23], v15 offset:0
    ds_read_b128 v[24:27], v15 offset:20480
    s_waitcnt lgkmcnt(4)
    v_mfma_f32_16x16x32_bf16 v[44:47], a[4:7], v[28:31], v[44:47]
    v_mfma_f32_16x16x32_bf16 v[48:51], v[28:31], a[84:87], v[48:51]
    v_mfma_f32_16x16x32_bf16 v[52:55], v[28:31], a[164:167], v[52:55]
    v_mfma_f32_16x16x32_bf16 v[56:59], v[28:31], v[180:183], v[56:59]
    v_mfma_f32_16x16x32_bf16 v[60:63], a[4:7], v[32:35], v[60:63]
    v_mfma_f32_16x16x32_bf16 v[64:67], v[32:35], a[84:87], v[64:67]
    v_mfma_f32_16x16x32_bf16 v[68:71], v[32:35], a[164:167], v[68:71]
    v_mfma_f32_16x16x32_bf16 v[72:75], v[32:35], v[180:183], v[72:75]
    ds_read_b128 v[28:31], v12 offset:256
    ds_read_b128 v[32:35], v12 offset:20736
    s_waitcnt lgkmcnt(4)
    v_mfma_f32_16x16x32_bf16 v[44:47], a[8:11], v[36:39], v[44:47]
    v_mfma_f32_16x16x32_bf16 v[48:51], v[36:39], a[88:91], v[48:51]
    v_mfma_f32_16x16x32_bf16 v[52:55], v[36:39], a[168:171], v[52:55]
    v_mfma_f32_16x16x32_bf16 v[56:59], v[36:39], v[184:187], v[56:59]
    v_mfma_f32_16x16x32_bf16 v[60:63], a[8:11], v[40:43], v[60:63]
    v_mfma_f32_16x16x32_bf16 v[64:67], v[40:43], a[88:91], v[64:67]
    v_mfma_f32_16x16x32_bf16 v[68:71], v[40:43], a[168:171], v[68:71]
    v_mfma_f32_16x16x32_bf16 v[72:75], v[40:43], v[184:187], v[72:75]
    ds_read_b128 v[36:39], v13 offset:256
    ds_read_b128 v[40:43], v13 offset:20736
    s_waitcnt lgkmcnt(4)
    v_mfma_f32_16x16x32_bf16 v[44:47], a[12:15], v[20:23], v[44:47]
    v_mfma_f32_16x16x32_bf16 v[48:51], v[20:23], a[92:95], v[48:51]
    v_mfma_f32_16x16x32_bf16 v[52:55], v[20:23], a[172:175], v[52:55]
    v_mfma_f32_16x16x32_bf16 v[56:59], v[20:23], v[188:191], v[56:59]
    v_mfma_f32_16x16x32_bf16 v[60:63], a[12:15], v[24:27], v[60:63]
    v_mfma_f32_16x16x32_bf16 v[64:67], v[24:27], a[92:95], v[64:67]
    v_mfma_f32_16x16x32_bf16 v[68:71], v[24:27], a[172:175], v[68:71]
    v_mfma_f32_16x16x32_bf16 v[72:75], v[24:27], v[188:191], v[72:75]
    ds_read_b128 v[20:23], v14 offset:256
    ds_read_b128 v[24:27], v14 offset:20736
    s_waitcnt lgkmcnt(4)
    v_mfma_f32_16x16x32_bf16 v[44:47], a[16:19], v[28:31], v[44:47]
    v_mfma_f32_16x16x32_bf16 v[48:51], v[28:31], a[96:99], v[48:51]
    v_mfma_f32_16x16x32_bf16 v[52:55], v[28:31], a[176:179], v[52:55]
    v_mfma_f32_16x16x32_bf16 v[56:59], v[28:31], v[192:195], v[56:59]
    v_mfma_f32_16x16x32_bf16 v[60:63], a[16:19], v[32:35], v[60:63]
    v_mfma_f32_16x16x32_bf16 v[64:67], v[32:35], a[96:99], v[64:67]
    v_mfma_f32_16x16x32_bf16 v[68:71], v[32:35], a[176:179], v[68:71]
    v_mfma_f32_16x16x32_bf16 v[72:75], v[32:35], v[192:195], v[72:75]
    ds_read_b128 v[28:31], v15 offset:256
    ds_read_b128 v[32:35], v15 offset:20736
    s_waitcnt lgkmcnt(4)
    v_mfma_f32_16x16x32_bf16 v[44:47], a[20:23], v[36:39], v[44:47]
    v_mfma_f32_16x16x32_bf16 v[48:51], v[36:39], a[100:103], v[48:51]
    v_mfma_f32_16x16x32_bf16 v[52:55], v[36:39], a[180:183], v[52:55]
    v_mfma_f32_16x16x32_bf16 v[56:59], v[36:39], v[196:199], v[56:59]
    v_mfma_f32_16x16x32_bf16 v[60:63], a[20:23], v[40:43], v[60:63]
    v_mfma_f32_16x16x32_bf16 v[64:67], v[40:43], a[100:103], v[64:67]
    v_mfma_f32_16x16x32_bf16 v[68:71], v[40:43], a[180:183], v[68:71]
    v_mfma_f32_16x16x32_bf16 v[72:75], v[40:43], v[196:199], v[72:75]
    ds_read_b128 v[36:39], v12 offset:512
    ds_read_b128 v[40:43], v12 offset:20992
    s_waitcnt lgkmcnt(4)
    v_mfma_f32_16x16x32_bf16 v[44:47], a[24:27], v[20:23], v[44:47]
    v_mfma_f32_16x16x32_bf16 v[48:51], v[20:23], a[104:107], v[48:51]
    v_mfma_f32_16x16x32_bf16 v[52:55], v[20:23], a[184:187], v[52:55]
    v_mfma_f32_16x16x32_bf16 v[56:59], v[20:23], v[200:203], v[56:59]
    v_mfma_f32_16x16x32_bf16 v[60:63], a[24:27], v[24:27], v[60:63]
    v_mfma_f32_16x16x32_bf16 v[64:67], v[24:27], a[104:107], v[64:67]
    v_mfma_f32_16x16x32_bf16 v[68:71], v[24:27], a[184:187], v[68:71]
    v_mfma_f32_16x16x32_bf16 v[72:75], v[24:27], v[200:203], v[72:75]
    ds_read_b128 v[20:23], v13 offset:512
    ds_read_b128 v[24:27], v13 offset:20992
    s_waitcnt lgkmcnt(4)
    v_mfma_f32_16x16x32_bf16 v[44:47], a[28:31], v[28:31], v[44:47]
    v_mfma_f32_16x16x32_bf16 v[48:51], v[28:31], a[108:111], v[48:51]
    v_mfma_f32_16x16x32_bf16 v[52:55], v[28:31], a[188:191], v[52:55]
    v_mfma_f32_16x16x32_bf16 v[56:59], v[28:31], v[204:207], v[56:59]
    v_mfma_f32_16x16x32_bf16 v[60:63], a[28:31], v[32:35], v[60:63]
    v_mfma_f32_16x16x32_bf16 v[64:67], v[32:35], a[108:111], v[64:67]
    v_mfma_f32_16x16x32_bf16 v[68:71], v[32:35], a[188:191], v[68:71]
    v_mfma_f32_16x16x32_bf16 v[72:75], v[32:35], v[204:207], v[72:75]
    ds_read_b128 v[28:31], v14 offset:512
    ds_read_b128 v[32:35], v14 offset:20992
    s_waitcnt lgkmcnt(4)
    v_mfma_f32_16x16x32_bf16 v[44:47], a[32:35], v[36:39], v[44:47]
    v_mfma_f32_16x16x32_bf16 v[48:51], v[36:39], a[112:115], v[48:51]
    v_mfma_f32_16x16x32_bf16 v[52:55], v[36:39], a[192:195], v[52:55]
    v_mfma_f32_16x16x32_bf16 v[56:59], v[36:39], v[208:211], v[56:59]
    v_mfma_f32_16x16x32_bf16 v[60:63], a[32:35], v[40:43], v[60:63]
    v_mfma_f32_16x16x32_bf16 v[64:67], v[40:43], a[112:115], v[64:67]
    v_mfma_f32_16x16x32_bf16 v[68:71], v[40:43], a[192:195], v[68:71]
    v_mfma_f32_16x16x32_bf16 v[72:75], v[40:43], v[208:211], v[72:75]
    ds_read_b128 v[36:39], v15 offset:512
    ds_read_b128 v[40:43], v15 offset:20992
    s_waitcnt lgkmcnt(4)
    v_mfma_f32_16x16x32_bf16 v[44:47], a[36:39], v[20:23], v[44:47]
    v_mfma_f32_16x16x32_bf16 v[48:51], v[20:23], a[116:119], v[48:51]
    v_mfma_f32_16x16x32_bf16 v[52:55], v[20:23], a[196:199], v[52:55]
    v_mfma_f32_16x16x32_bf16 v[56:59], v[20:23], v[212:215], v[56:59]
    v_mfma_f32_16x16x32_bf16 v[60:63], a[36:39], v[24:27], v[60:63]
    v_mfma_f32_16x16x32_bf16 v[64:67], v[24:27], a[116:119], v[64:67]
    v_mfma_f32_16x16x32_bf16 v[68:71], v[24:27], a[196:199], v[68:71]
    v_mfma_f32_16x16x32_bf16 v[72:75], v[24:27], v[212:215], v[72:75]
    ds_read_b128 v[20:23], v12 offset:768
    ds_read_b128 v[24:27], v12 offset:21248
    s_waitcnt lgkmcnt(4)
    v_mfma_f32_16x16x32_bf16 v[44:47], a[40:43], v[28:31], v[44:47]
    v_mfma_f32_16x16x32_bf16 v[48:51], v[28:31], a[120:123], v[48:51]
    v_mfma_f32_16x16x32_bf16 v[52:55], v[28:31], a[200:203], v[52:55]
    v_mfma_f32_16x16x32_bf16 v[56:59], v[28:31], v[216:219], v[56:59]
    v_mfma_f32_16x16x32_bf16 v[60:63], a[40:43], v[32:35], v[60:63]
    v_mfma_f32_16x16x32_bf16 v[64:67], v[32:35], a[120:123], v[64:67]
    v_mfma_f32_16x16x32_bf16 v[68:71], v[32:35], a[200:203], v[68:71]
    v_mfma_f32_16x16x32_bf16 v[72:75], v[32:35], v[216:219], v[72:75]
    ds_read_b128 v[28:31], v13 offset:768
    ds_read_b128 v[32:35], v13 offset:21248
    s_waitcnt lgkmcnt(4)
    v_mfma_f32_16x16x32_bf16 v[44:47], a[44:47], v[36:39], v[44:47]
    v_mfma_f32_16x16x32_bf16 v[48:51], v[36:39], a[124:127], v[48:51]
    v_mfma_f32_16x16x32_bf16 v[52:55], v[36:39], a[204:207], v[52:55]
    v_mfma_f32_16x16x32_bf16 v[56:59], v[36:39], v[220:223], v[56:59]
    v_mfma_f32_16x16x32_bf16 v[60:63], a[44:47], v[40:43], v[60:63]
    v_mfma_f32_16x16x32_bf16 v[64:67], v[40:43], a[124:127], v[64:67]
    v_mfma_f32_16x16x32_bf16 v[68:71], v[40:43], a[204:207], v[68:71]
    v_mfma_f32_16x16x32_bf16 v[72:75], v[40:43], v[220:223], v[72:75]
    ds_read_b128 v[36:39], v14 offset:768
    ds_read_b128 v[40:43], v14 offset:21248
    s_waitcnt lgkmcnt(4)
    v_mfma_f32_16x16x32_bf16 v[44:47], a[48:51], v[20:23], v[44:47]
    v_mfma_f32_16x16x32_bf16 v[48:51], v[20:23], a[128:131], v[48:51]
    v_mfma_f32_16x16x32_bf16 v[52:55], v[20:23], a[208:211], v[52:55]
    v_mfma_f32_16x16x32_bf16 v[56:59], v[20:23], v[224:227], v[56:59]
    v_mfma_f32_16x16x32_bf16 v[60:63], a[48:51], v[24:27], v[60:63]
    v_mfma_f32_16x16x32_bf16 v[64:67], v[24:27], a[128:131], v[64:67]
    v_mfma_f32_16x16x32_bf16 v[68:71], v[24:27], a[208:211], v[68:71]
    v_mfma_f32_16x16x32_bf16 v[72:75], v[24:27], v[224:227], v[72:75]
    ds_read_b128 v[20:23], v15 offset:768
    ds_read_b128 v[24:27], v15 offset:21248
    s_waitcnt lgkmcnt(4)
    v_mfma_f32_16x16x32_bf16 v[44:47], a[52:55], v[28:31], v[44:47]
    v_mfma_f32_16x16x32_bf16 v[48:51], v[28:31], a[132:135], v[48:51]
    v_mfma_f32_16x16x32_bf16 v[52:55], v[28:31], a[212:215], v[52:55]
    v_mfma_f32_16x16x32_bf16 v[56:59], v[28:31], v[228:231], v[56:59]
    v_mfma_f32_16x16x32_bf16 v[60:63], a[52:55], v[32:35], v[60:63]
    v_mfma_f32_16x16x32_bf16 v[64:67], v[32:35], a[132:135], v[64:67]
    v_mfma_f32_16x16x32_bf16 v[68:71], v[32:35], a[212:215], v[68:71]
    v_mfma_f32_16x16x32_bf16 v[72:75], v[32:35], v[228:231], v[72:75]
    ds_read_b128 v[28:31], v12 offset:1024
    ds_read_b128 v[32:35], v12 offset:21504
    s_waitcnt lgkmcnt(4)
    v_mfma_f32_16x16x32_bf16 v[44:47], a[56:59], v[36:39], v[44:47]
    v_mfma_f32_16x16x32_bf16 v[48:51], v[36:39], a[136:139], v[48:51]
    v_mfma_f32_16x16x32_bf16 v[52:55], v[36:39], a[216:219], v[52:55]
    v_mfma_f32_16x16x32_bf16 v[56:59], v[36:39], v[232:235], v[56:59]
    v_mfma_f32_16x16x32_bf16 v[60:63], a[56:59], v[40:43], v[60:63]
    v_mfma_f32_16x16x32_bf16 v[64:67], v[40:43], a[136:139], v[64:67]
    v_mfma_f32_16x16x32_bf16 v[68:71], v[40:43], a[216:219], v[68:71]
    v_mfma_f32_16x16x32_bf16 v[72:75], v[40:43], v[232:235], v[72:75]
    ds_read_b128 v[36:39], v13 offset:1024
    ds_read_b128 v[40:43], v13 offset:21504
    s_waitcnt lgkmcnt(4)
    v_mfma_f32_16x16x32_bf16 v[44:47], a[60:63], v[20:23], v[44:47]
    v_mfma_f32_16x16x32_bf16 v[48:51], v[20:23], a[140:143], v[48:51]
    v_mfma_f32_16x16x32_bf16 v[52:55], v[20:23], a[220:223], v[52:55]
    v_mfma_f32_16x16x32_bf16 v[56:59], v[20:23], v[236:239], v[56:59]
    v_mfma_f32_16x16x32_bf16 v[60:63], a[60:63], v[24:27], v[60:63]
    v_mfma_f32_16x16x32_bf16 v[64:67], v[24:27], a[140:143], v[64:67]
    v_mfma_f32_16x16x32_bf16 v[68:71], v[24:27], a[220:223], v[68:71]
    v_mfma_f32_16x16x32_bf16 v[72:75], v[24:27], v[236:239], v[72:75]
    ds_read_b128 v[20:23], v14 offset:1024
    ds_read_b128 v[24:27], v14 offset:21504
    s_waitcnt lgkmcnt(4)
    v_mfma_f32_16x16x32_bf16 v[44:47], a[64:67], v[28:31], v[44:47]
    v_mfma_f32_16x16x32_bf16 v[48:51], v[28:31], a[144:147], v[48:51]
    v_mfma_f32_16x16x32_bf16 v[52:55], v[28:31], a[224:227], v[52:55]
    v_mfma_f32_16x16x32_bf16 v[56:59], v[28:31], v[240:243], v[56:59]
    v_mfma_f32_16x16x32_bf16 v[60:63], a[64:67], v[32:35], v[60:63]
    v_mfma_f32_16x16x32_bf16 v[64:67], v[32:35], a[144:147], v[64:67]
    v_mfma_f32_16x16x32_bf16 v[68:71], v[32:35], a[224:227], v[68:71]
    v_mfma_f32_16x16x32_bf16 v[72:75], v[32:35], v[240:243], v[72:75]
    ds_read_b128 v[28:31], v15 offset:1024
    ds_read_b128 v[32:35], v15 offset:21504
    s_waitcnt lgkmcnt(4)
    v_mfma_f32_16x16x32_bf16 v[44:47], a[68:71], v[36:39], v[44:47]
    v_mfma_f32_16x16x32_bf16 v[48:51], v[36:39], a[148:151], v[48:51]
    v_mfma_f32_16x16x32_bf16 v[52:55], v[36:39], a[228:231], v[52:55]
    v_mfma_f32_16x16x32_bf16 v[56:59], v[36:39], v[244:247], v[56:59]
    v_mfma_f32_16x16x32_bf16 v[60:63], a[68:71], v[40:43], v[60:63]
    v_mfma_f32_16x16x32_bf16 v[64:67], v[40:43], a[148:151], v[64:67]
    v_mfma_f32_16x16x32_bf16 v[68:71], v[40:43], a[228:231], v[68:71]
    v_mfma_f32_16x16x32_bf16 v[72:75], v[40:43], v[244:247], v[72:75]
    s_waitcnt lgkmcnt(2)
    v_mfma_f32_16x16x32_bf16 v[44:47], a[72:75], v[20:23], v[44:47]
    v_mfma_f32_16x16x32_bf16 v[48:51], v[20:23], a[152:155], v[48:51]
    v_mfma_f32_16x16x32_bf16 v[52:55], v[20:23], a[232:235], v[52:55]
    v_mfma_f32_16x16x32_bf16 v[56:59], v[20:23], v[248:251], v[56:59]
    v_mfma_f32_16x16x32_bf16 v[60:63], a[72:75], v[24:27], v[60:63]
    v_mfma_f32_16x16x32_bf16 v[64:67], v[24:27], a[152:155], v[64:67]
    v_mfma_f32_16x16x32_bf16 v[68:71], v[24:27], a[232:235], v[68:71]
    v_mfma_f32_16x16x32_bf16 v[72:75], v[24:27], v[248:251], v[72:75]
    s_waitcnt lgkmcnt(0)
    v_mfma_f32_16x16x32_bf16 v[44:47], a[76:79], v[28:31], v[44:47]
    v_mfma_f32_16x16x32_bf16 v[48:51], v[28:31], a[156:159], v[48:51]
    v_mfma_f32_16x16x32_bf16 v[52:55], v[28:31], a[236:239], v[52:55]
    v_mfma_f32_16x16x32_bf16 v[56:59], v[28:31], v[252:255], v[56:59]
    v_mfma_f32_16x16x32_bf16 v[60:63], a[76:79], v[32:35], v[60:63]
    v_mfma_f32_16x16x32_bf16 v[64:67], v[32:35], a[156:159], v[64:67]
    v_mfma_f32_16x16x32_bf16 v[68:71], v[32:35], a[236:239], v[68:71]
    v_mfma_f32_16x16x32_bf16 v[72:75], v[32:35], v[252:255], v[72:75]
La_444:
    s_nop 7
    s_nop 1
    s_mov_b32 s44, 0x3fb8aa3b
    s_mov_b32 s45, 0x358637bd
    s_mov_b32 s43, 0x3f800008
    v_mul_f32 v124, s44, v44
    v_exp_f32 v124, v124
    v_cmp_lt_f32 vcc, 0, v44
    v_add_f32 v125, s43, v44
    v_add_f32 v124, s45, v124
    v_cndmask_b32 v44, v124, v125, vcc
    v_mul_f32 v124, s44, v45
    v_exp_f32 v124, v124
    v_cmp_lt_f32 vcc, 0, v45
    v_add_f32 v125, s43, v45
    v_add_f32 v124, s45, v124
    v_cndmask_b32 v45, v124, v125, vcc
    v_mul_f32 v124, s44, v46
    v_exp_f32 v124, v124
    v_cmp_lt_f32 vcc, 0, v46
    v_add_f32 v125, s43, v46
    v_add_f32 v124, s45, v124
    v_cndmask_b32 v46, v124, v125, vcc
    v_mul_f32 v124, s44, v47
    v_exp_f32 v124, v124
    v_cmp_lt_f32 vcc, 0, v47
    v_add_f32 v125, s43, v47
    v_add_f32 v124, s45, v124
    v_cndmask_b32 v47, v124, v125, vcc
    v_mul_f32 v124, s44, v60
    v_exp_f32 v124, v124
    v_cmp_lt_f32 vcc, 0, v60
    v_add_f32 v125, s43, v60
    v_add_f32 v124, s45, v124
    v_cndmask_b32 v60, v124, v125, vcc
    v_mul_f32 v124, s44, v61
    v_exp_f32 v124, v124
    v_cmp_lt_f32 vcc, 0, v61
    v_add_f32 v125, s43, v61
    v_add_f32 v124, s45, v124
    v_cndmask_b32 v61, v124, v125, vcc
    v_mul_f32 v124, s44, v62
    v_exp_f32 v124, v124
    v_cmp_lt_f32 vcc, 0, v62
    v_add_f32 v125, s43, v62
    v_add_f32 v124, s45, v124
    v_cndmask_b32 v62, v124, v125, vcc
    v_mul_f32 v124, s44, v63
    v_exp_f32 v124, v124
    v_cmp_lt_f32 vcc, 0, v63
    v_add_f32 v125, s43, v63
    v_add_f32 v124, s45, v124
    v_cndmask_b32 v63, v124, v125, vcc
    v_mul_f32 v124, s44, v48
    v_exp_f32 v124, v124
    v_cmp_lt_f32 vcc, 0, v48
    v_add_f32 v125, s43, v48
    v_add_f32 v124, s45, v124
    v_cndmask_b32 v48, v124, v125, vcc
    v_mul_f32 v124, s44, v49
    v_exp_f32 v124, v124
    v_cmp_lt_f32 vcc, 0, v49
    v_add_f32 v125, s43, v49
    v_add_f32 v124, s45, v124
    v_cndmask_b32 v49, v124, v125, vcc
    v_mul_f32 v124, s44, v50
    v_exp_f32 v124, v124
    v_cmp_lt_f32 vcc, 0, v50
    v_add_f32 v125, s43, v50
    v_add_f32 v124, s45, v124
    v_cndmask_b32 v50, v124, v125, vcc
    v_mul_f32 v124, s44, v51
    v_exp_f32 v124, v124
    v_cmp_lt_f32 vcc, 0, v51
    v_add_f32 v125, s43, v51
    v_add_f32 v124, s45, v124
    v_cndmask_b32 v51, v124, v125, vcc
    v_mul_f32 v124, s44, v64
    v_exp_f32 v124, v124
    v_cmp_lt_f32 vcc, 0, v64
    v_add_f32 v125, s43, v64
    v_add_f32 v124, s45, v124
    v_cndmask_b32 v64, v124, v125, vcc
    v_mul_f32 v124, s44, v65
    v_exp_f32 v124, v124
    v_cmp_lt_f32 vcc, 0, v65
    v_add_f32 v125, s43, v65
    v_add_f32 v124, s45, v124
    v_cndmask_b32 v65, v124, v125, vcc
    v_mul_f32 v124, s44, v66
    v_exp_f32 v124, v124
    v_cmp_lt_f32 vcc, 0, v66
    v_add_f32 v125, s43, v66
    v_add_f32 v124, s45, v124
    v_cndmask_b32 v66, v124, v125, vcc
    v_mul_f32 v124, s44, v67
    v_exp_f32 v124, v124
    v_cmp_lt_f32 vcc, 0, v67
    v_add_f32 v125, s43, v67
    v_add_f32 v124, s45, v124
    v_cndmask_b32 v67, v124, v125, vcc
    s_cmp_ge_u32 s16, 2
    s_cbranch_scc1 La_445
    v_mul_f32 v124, s44, v56
    v_exp_f32 v124, v124
    v_cmp_lt_f32 vcc, 0, v56
    v_add_f32 v125, s43, v56
    v_add_f32 v124, s45, v124
    v_cndmask_b32 v56, v124, v125, vcc
    v_mul_f32 v124, s44, v57
    v_exp_f32 v124, v124
    v_cmp_lt_f32 vcc, 0, v57
    v_add_f32 v125, s43, v57
    v_add_f32 v124, s45, v124
    v_cndmask_b32 v57, v124, v125, vcc
    v_mul_f32 v124, s44, v58
    v_exp_f32 v124, v124
    v_cmp_lt_f32 vcc, 0, v58
    v_add_f32 v125, s43, v58
    v_add_f32 v124, s45, v124
    v_cndmask_b32 v58, v124, v125, vcc
    v_mul_f32 v124, s44, v59
    v_exp_f32 v124, v124
    v_cmp_lt_f32 vcc, 0, v59
    v_add_f32 v125, s43, v59
    v_add_f32 v124, s45, v124
    v_cndmask_b32 v59, v124, v125, vcc
    v_mul_f32 v124, s44, v72
    v_exp_f32 v124, v124
    v_cmp_lt_f32 vcc, 0, v72
    v_add_f32 v125, s43, v72
    v_add_f32 v124, s45, v124
    v_cndmask_b32 v72, v124, v125, vcc
    v_mul_f32 v124, s44, v73
    v_exp_f32 v124, v124
    v_cmp_lt_f32 vcc, 0, v73
    v_add_f32 v125, s43, v73
    v_add_f32 v124, s45, v124
    v_cndmask_b32 v73, v124, v125, vcc
    v_mul_f32 v124, s44, v74
    v_exp_f32 v124, v124
    v_cmp_lt_f32 vcc, 0, v74
    v_add_f32 v125, s43, v74
    v_add_f32 v124, s45, v124
    v_cndmask_b32 v74, v124, v125, vcc
    v_mul_f32 v124, s44, v75
    v_exp_f32 v124, v124
    v_cmp_lt_f32 vcc, 0, v75
    v_add_f32 v125, s43, v75
    v_add_f32 v124, s45, v124
    v_cndmask_b32 v75, v124, v125, vcc
La_445:
    v_cvt_pk_bf16_f32 v100, v44, v45
    v_cvt_pk_bf16_f32 v101, v46, v47
    v_cvt_pk_bf16_f32 v102, v60, v61
    v_cvt_pk_bf16_f32 v103, v62, v63
    v_cvt_pk_bf16_f32 v104, v48, v49
    v_cvt_pk_bf16_f32 v105, v50, v51
    v_cvt_pk_bf16_f32 v106, v64, v65
    v_cvt_pk_bf16_f32 v107, v66, v67
    v_cvt_pk_bf16_f32 v108, v52, v53
    v_cvt_pk_bf16_f32 v109, v54, v55
    v_cvt_pk_bf16_f32 v110, v68, v69
    v_cvt_pk_bf16_f32 v111, v70, v71
    v_cvt_pk_bf16_f32 v112, v56, v57
    v_cvt_pk_bf16_f32 v113, v58, v59
    v_cvt_pk_bf16_f32 v114, v72, v73
    v_cvt_pk_bf16_f32 v115, v74, v75
    v_lshlrev_b32 v126, 3, v0
    s_lshl_b32 s20, s17, 5
    s_lshl_b32 s21, s12, 2
    s_add_u32 s20, s20, s21
    s_add_u32 s20, s20, s16
    s_lshl_b32 s20, s20, 10
    s_add_u32 s20, s20, 134217728
    buffer_store_dwordx2 v[100:101], v126, s[4:7], s20 offen
    buffer_store_dwordx2 v[102:103], v126, s[4:7], s20 offen offset:512
    s_cmp_eq_u32 s16, 0
    s_cbranch_scc0 La_446
    s_lshl_b32 s20, s17, 3
    s_add_u32 s20, s20, s12
    s_lshl_b32 s20, s20, 10
    s_add_u32 s20, s20, 136314880
    buffer_store_dwordx2 v[112:113], v126, s[4:7], s20 offen
    buffer_store_dwordx2 v[114:115], v126, s[4:7], s20 offen offset:512
La_446:
    s_sub_u32 s20, s16, 1
    s_cmp_lt_u32 s20, 2
    s_cbranch_scc0 La_447
    s_lshl_b32 s20, s20, 10
    s_add_u32 s20, s20, 122880
    v_add_u32 v127, s20, v1
    ds_write_b128 v127, v[112:115]
La_447:
    s_waitcnt lgkmcnt(0)
    s_barrier
    v_add_u32 v127, 122880, v1
    ds_read_b128 v[116:119], v127
    ds_read_b128 v[128:131], v127 offset:1024
    v_mov_b32 v120, 0x3f803f80
    v_mov_b32 v121, 0x3f803f80
    v_mov_b32 v122, 0x3f803f80
    v_mov_b32 v123, 0x3f803f80
    s_waitcnt lgkmcnt(0)
    v_mfma_f32_16x16x32_bf16 v[76:79], v[104:107], v[108:111], v[76:79]
    v_mfma_f32_16x16x32_bf16 v[80:83], v[104:107], v[128:131], v[80:83]
    v_mfma_f32_16x16x32_bf16 v[84:87], v[116:119], v[108:111], v[84:87]
    v_mfma_f32_16x16x32_bf16 v[88:91], v[116:119], v[128:131], v[88:91]
    v_mfma_f32_16x16x32_bf16 v[92:95], v[104:107], v[120:123], v[92:95]
    v_mfma_f32_16x16x32_bf16 v[96:99], v[116:119], v[120:123], v[96:99]
    s_add_u32 s17, s17, 1
    s_add_u32 s27, s27, 1
    s_cmp_lt_u32 s27, 16
    s_cbranch_scc1 L_a1_loop
    s_nop 7
    s_nop 1
    s_lshl_b32 s20, s12, 2
    s_add_u32 s20, s20, s13
    s_lshl_b32 s20, s20, 2
    s_add_u32 s20, s20, s16
    s_mul_i32 s20, s20, 6144
    s_add_u32 s42, s20, 137363456
    buffer_store_dwordx4 v[76:79], v1, s[4:7], s42 offen offset:0 sc1
    buffer_store_dwordx4 v[80:83], v1, s[4:7], s42 offen offset:1024 sc1
    buffer_store_dwordx4 v[84:87], v1, s[4:7], s42 offen offset:2048 sc1
    buffer_store_dwordx4 v[88:91], v1, s[4:7], s42 offen offset:3072 sc1
    s_add_u32 s42, s42, 4096
    buffer_store_dwordx4 v[92:95], v1, s[4:7], s42 offen offset:0 sc1
    buffer_store_dwordx4 v[96:99], v1, s[4:7], s42 offen offset:1024 sc1
    s_lshl_b32 s20, s12, 6
    s_lshl_b32 s21, s13, 4
    s_add_u32 s20, s20, s21
    s_lshl_b32 s21, s16, 2
    s_add_u32 s20, s20, s21
    s_add_u32 s42, s20, 125841408
    s_waitcnt vmcnt(0)
    v_mov_b32 v124, 1
    v_mov_b32 v125, 0
    s_mov_b64 exec, 1
    buffer_store_dword v124, v125, s[4:7], s42 offen sc1
    s_mov_b64 exec, -1
    s_lshl_b32 s42, s12, 6
    s_add_u32 s42, s42, 125841408
    v_and_b32 v124, 15, v0
    v_lshlrev_b32 v124, 2, v124
    s_mov_b32 s24, 0
La_448:
    buffer_load_dword v125, v124, s[4:7], s42 offen sc1
    s_waitcnt vmcnt(0)
    v_cmp_gt_u32 vcc, 1, v125
    s_cbranch_vccz La_449
    s_sleep 4
    s_add_u32 s24, s24, 1
    s_cmp_lt_u32 s24, 1600000
    s_cbranch_scc1 La_448
    s_branch L_abort
La_449:
    v_mov_b32 v76, 0
    v_mov_b32 v77, 0
    v_mov_b32 v78, 0
    v_mov_b32 v79, 0
    v_mov_b32 v80, 0
    v_mov_b32 v81, 0
    v_mov_b32 v82, 0
    v_mov_b32 v83, 0
    v_mov_b32 v84, 0
    v_mov_b32 v85, 0
    v_mov_b32 v86, 0
    v_mov_b32 v87, 0
    v_mov_b32 v88, 0
    v_mov_b32 v89, 0
    v_mov_b32 v90, 0
    v_mov_b32 v91, 0
    v_mov_b32 v92, 0
    v_mov_b32 v93, 0
    v_mov_b32 v94, 0
    v_mov_b32 v95, 0
    v_mov_b32 v96, 0
    v_mov_b32 v97, 0
    v_mov_b32 v98, 0
    v_mov_b32 v99, 0
    s_lshl_b32 s20, s12, 2
    s_add_u32 s20, s20, 0
    s_lshl_b32 s20, s20, 2
    s_add_u32 s20, s20, s16
    s_mul_i32 s20, s20, 6144
    s_add_u32 s42, s20, 137363456
    buffer_load_dwordx4 v[20:23], v1, s[4:7], s42 offen offset:0 sc1
    buffer_load_dwordx4 v[24:27], v1, s[4:7], s42 offen offset:1024 sc1
    buffer_load_dwordx4 v[28:31], v1, s[4:7], s42 offen offset:2048 sc1
    buffer_load_dwordx4 v[32:35], v1, s[4:7], s42 offen offset:3072 sc1
    s_add_u32 s42, s42, 4096
    buffer_load_dwordx4 v[36:39], v1, s[4:7], s42 offen offset:0 sc1
    buffer_load_dwordx4 v[40:43], v1, s[4:7], s42 offen offset:1024 sc1
    s_waitcnt vmcnt(0)
    v_add_f32 v76, v76, v20
    v_add_f32 v77, v77, v21
    v_add_f32 v78, v78, v22
    v_add_f32 v79, v79, v23
    v_add_f32 v80, v80, v24
    v_add_f32 v81, v81, v25
    v_add_f32 v82, v82, v26
    v_add_f32 v83, v83, v27
    v_add_f32 v84, v84, v28
    v_add_f32 v85, v85, v29
    v_add_f32 v86, v86, v30
    v_add_f32 v87, v87, v31
    v_add_f32 v88, v88, v32
    v_add_f32 v89, v89, v33
    v_add_f32 v90, v90, v34
    v_add_f32 v91, v91, v35
    v_add_f32 v92, v92, v36
    v_add_f32 v93, v93, v37
    v_add_f32 v94, v94, v38
    v_add_f32 v95, v95, v39
    v_add_f32 v96, v96, v40
    v_add_f32 v97, v97, v41
    v_add_f32 v98, v98, v42
    v_add_f32 v99, v99, v43
    s_lshl_b32 s20, s12, 2
    s_add_u32 s20, s20, 1
    s_lshl_b32 s20, s20, 2
    s_add_u32 s20, s20, s16
    s_mul_i32 s20, s20, 6144
    s_add_u32 s42, s20, 137363456
    buffer_load_dwordx4 v[20:23], v1, s[4:7], s42 offen offset:0 sc1
    buffer_load_dwordx4 v[24:27], v1, s[4:7], s42 offen offset:1024 sc1
    buffer_load_dwordx4 v[28:31], v1, s[4:7], s42 offen offset:2048 sc1
    buffer_load_dwordx4 v[32:35], v1, s[4:7], s42 offen offset:3072 sc1
    s_add_u32 s42, s42, 4096
    buffer_load_dwordx4 v[36:39], v1, s[4:7], s42 offen offset:0 sc1
    buffer_load_dwordx4 v[40:43], v1, s[4:7], s42 offen offset:1024 sc1
    s_waitcnt vmcnt(0)
    v_add_f32 v76, v76, v20
    v_add_f32 v77, v77, v21
    v_add_f32 v78, v78, v22
    v_add_f32 v79, v79, v23
    v_add_f32 v80, v80, v24
    v_add_f32 v81, v81, v25
    v_add_f32 v82, v82, v26
    v_add_f32 v83, v83, v27
    v_add_f32 v84, v84, v28
    v_add_f32 v85, v85, v29
    v_add_f32 v86, v86, v30
    v_add_f32 v87, v87, v31
    v_add_f32 v88, v88, v32
    v_add_f32 v89, v89, v33
    v_add_f32 v90, v90, v34
    v_add_f32 v91, v91, v35
    v_add_f32 v92, v92, v36
    v_add_f32 v93, v93, v37
    v_add_f32 v94, v94, v38
    v_add_f32 v95, v95, v39
    v_add_f32 v96, v96, v40
    v_add_f32 v97, v97, v41
    v_add_f32 v98, v98, v42
    v_add_f32 v99, v99, v43
    s_lshl_b32 s20, s12, 2
    s_add_u32 s20, s20, 2
    s_lshl_b32 s20, s20, 2
    s_add_u32 s20, s20, s16
    s_mul_i32 s20, s20, 6144
    s_add_u32 s42, s20, 137363456
    buffer_load_dwordx4 v[20:23], v1, s[4:7], s42 offen offset:0 sc1
    buffer_load_dwordx4 v[24:27], v1, s[4:7], s42 offen offset:1024 sc1
    buffer_load_dwordx4 v[28:31], v1, s[4:7], s42 offen offset:2048 sc1
    buffer_load_dwordx4 v[32:35], v1, s[4:7], s42 offen offset:3072 sc1
    s_add_u32 s42, s42, 4096
    buffer_load_dwordx4 v[36:39], v1, s[4:7], s42 offen offset:0 sc1
    buffer_load_dwordx4 v[40:43], v1, s[4:7], s42 offen offset:1024 sc1
    s_waitcnt vmcnt(0)
    v_add_f32 v76, v76, v20
    v_add_f32 v77, v77, v21
    v_add_f32 v78, v78, v22
    v_add_f32 v79, v79, v23
    v_add_f32 v80, v80, v24
    v_add_f32 v81, v81, v25
    v_add_f32 v82, v82, v26
    v_add_f32 v83, v83, v27
    v_add_f32 v84, v84, v28
    v_add_f32 v85, v85, v29
    v_add_f32 v86, v86, v30
    v_add_f32 v87, v87, v31
    v_add_f32 v88, v88, v32
    v_add_f32 v89, v89, v33
    v_add_f32 v90, v90, v34
    v_add_f32 v91, v91, v35
    v_add_f32 v92, v92, v36
    v_add_f32 v93, v93, v37
    v_add_f32 v94, v94, v38
    v_add_f32 v95, v95, v39
    v_add_f32 v96, v96, v40
    v_add_f32 v97, v97, v41
    v_add_f32 v98, v98, v42
    v_add_f32 v99, v99, v43
    s_lshl_b32 s20, s12, 2
    s_add_u32 s20, s20, 3
    s_lshl_b32 s20, s20, 2
    s_add_u32 s20, s20, s16
    s_mul_i32 s20, s20, 6144
    s_add_u32 s42, s20, 137363456
    buffer_load_dwordx4 v[20:23], v1, s[4:7], s42 offen offset:0 sc1
    buffer_load_dwordx4 v[24:27], v1, s[4:7], s42 offen offset:1024 sc1
    buffer_load_dwordx4 v[28:31], v1, s[4:7], s42 offen offset:2048 sc1
    buffer_load_dwordx4 v[32:35], v1, s[4:7], s42 offen offset:3072 sc1
    s_add_u32 s42, s42, 4096
    buffer_load_dwordx4 v[36:39], v1, s[4:7], s42 offen offset:0 sc1
    buffer_load_dwordx4 v[40:43], v1, s[4:7], s42 offen offset:1024 sc1
    s_waitcnt vmcnt(0)
    v_add_f32 v76, v76, v20
    v_add_f32 v77, v77, v21
    v_add_f32 v78, v78, v22
    v_add_f32 v79, v79, v23
    v_add_f32 v80, v80, v24
    v_add_f32 v81, v81, v25
    v_add_f32 v82, v82, v26
    v_add_f32 v83, v83, v27
    v_add_f32 v84, v84, v28
    v_add_f32 v85, v85, v29
    v_add_f32 v86, v86, v30
    v_add_f32 v87, v87, v31
    v_add_f32 v88, v88, v32
    v_add_f32 v89, v89, v33
    v_add_f32 v90, v90, v34
    v_add_f32 v91, v91, v35
    v_add_f32 v92, v92, v36
    v_add_f32 v93, v93, v37
    v_add_f32 v94, v94, v38
    v_add_f32 v95, v95, v39
    v_add_f32 v96, v96, v40
    v_add_f32 v97, v97, v41
    v_add_f32 v98, v98, v42
    v_add_f32 v99, v99, v43
    v_cvt_pk_bf16_f32 v44, v76, v77
    v_cvt_pk_bf16_f32 v45, v78, v79
    v_cvt_pk_bf16_f32 v46, v84, v85
    v_cvt_pk_bf16_f32 v47, v86, v87
    v_cvt_pk_bf16_f32 v48, v80, v81
    v_cvt_pk_bf16_f32 v49, v82, v83
    v_cvt_pk_bf16_f32 v50, v88, v89
    v_cvt_pk_bf16_f32 v51, v90, v91
    v_cvt_pk_bf16_f32 v52, v92, v93
    v_cvt_pk_bf16_f32 v53, v94, v95
    v_cvt_pk_bf16_f32 v54, v96, v97
    v_cvt_pk_bf16_f32 v55, v98, v99
    v_mov_b32 v124, 0
    s_nop 1
    v_cndmask_b32 v46, v124, v46, s[34:35]
    v_cndmask_b32 v47, v124, v47, s[34:35]
    v_cndmask_b32 v54, v124, v54, s[34:35]
    v_cndmask_b32 v55, v124, v55, s[34:35]
    v_cndmask_b32 v50, v124, v50, s[34:35]
    v_cndmask_b32 v51, v124, v51, s[34:35]
    v_cndmask_b32 v48, v124, v48, s[32:33]
    v_cndmask_b32 v49, v124, v49, s[32:33]
    v_cndmask_b32 v50, v124, v50, s[32:33]
    v_cndmask_b32 v51, v124, v51, s[32:33]
    s_waitcnt vmcnt(0)
    s_barrier
    s_lshl_b32 s17, s13, 4
    s_mov_b32 s27, 0
L_a3_loop:
    v_lshlrev_b32 v126, 3, v0
    s_lshl_b32 s20, s17, 5
    s_lshl_b32 s21, s12, 2
    s_add_u32 s20, s20, s21
    s_add_u32 s20, s20, s16
    s_lshl_b32 s20, s20, 10
    s_add_u32 s42, s20, 134217728
    s_lshl_b32 s20, s17, 3
    s_add_u32 s20, s20, s12
    s_lshl_b32 s20, s20, 10
    s_add_u32 s22, s20, 136314880
    buffer_load_dwordx2 v[20:21], v126, s[4:7], s42 offen offset:0 sc1
    buffer_load_dwordx2 v[22:23], v126, s[4:7], s22 offen offset:0 sc1
    buffer_load_dwordx2 v[24:25], v126, s[4:7], s42 offen offset:512 sc1
    buffer_load_dwordx2 v[26:27], v126, s[4:7], s22 offen offset:512 sc1
    s_waitcnt vmcnt(0)
    v_mfma_f32_16x16x32_bf16 v[56:59], v[44:47], v[20:23], 0
    v_mfma_f32_16x16x32_bf16 v[60:63], v[48:51], v[20:23], 0
    v_mfma_f32_16x16x32_bf16 v[64:67], v[52:55], v[20:23], 0
    v_mfma_f32_16x16x32_bf16 v[68:71], v[44:47], v[24:27], 0
    v_mfma_f32_16x16x32_bf16 v[72:75], v[48:51], v[24:27], 0
    v_mfma_f32_16x16x32_bf16 v[76:79], v[52:55], v[24:27], 0
    s_nop 7
    s_nop 1
    s_mov_b32 s45, 0x358637bd
    v_add_f32 v64, s45, v64
    v_rcp_f32 v64, v64
    s_nop 0
    v_mul_f32 v56, v56, v64
    v_mul_f32 v57, v57, v64
    v_mul_f32 v58, v58, v64
    v_mul_f32 v59, v59, v64
    v_mul_f32 v60, v60, v64
    v_mul_f32 v61, v61, v64
    v_mul_f32 v62, v62, v64
    v_mul_f32 v63, v63, v64
    v_cvt_pk_bf16_f32 v100, v56, v57
    v_cvt_pk_bf16_f32 v101, v58, v59
    v_cvt_pk_bf16_f32 v102, v60, v61
    v_cvt_pk_bf16_f32 v103, v62, v63
    s_lshl_b32 s20, s17, 1
    s_add_u32 s20, s20, 0
    s_lshl_b32 s20, s20, 5
    s_lshl_b32 s21, s12, 2
    s_add_u32 s20, s20, s21
    s_add_u32 s20, s20, s16
    s_lshl_b32 s20, s20, 10
    s_add_u32 s20, s20, 138412032
    buffer_store_dwordx4 v[100:103], v1, s[4:7], s20 offen sc1
    v_add_f32 v76, s45, v76
    v_rcp_f32 v76, v76
    s_nop 0
    v_mul_f32 v68, v68, v76
    v_mul_f32 v69, v69, v76
    v_mul_f32 v70, v70, v76
    v_mul_f32 v71, v71, v76
    v_mul_f32 v72, v72, v76
    v_mul_f32 v73, v73, v76
    v_mul_f32 v74, v74, v76
    v_mul_f32 v75, v75, v76
    v_cvt_pk_bf16_f32 v104, v68, v69
    v_cvt_pk_bf16_f32 v105, v70, v71
    v_cvt_pk_bf16_f32 v106, v72, v73
    v_cvt_pk_bf16_f32 v107, v74, v75
    s_lshl_b32 s20, s17, 1
    s_add_u32 s20, s20, 1
    s_lshl_b32 s20, s20, 5
    s_lshl_b32 s21, s12, 2
    s_add_u32 s20, s20, s21
    s_add_u32 s20, s20, s16
    s_lshl_b32 s20, s20, 10
    s_add_u32 s20, s20, 138412032
    buffer_store_dwordx4 v[104:107], v1, s[4:7], s20 offen sc1
    s_add_u32 s17, s17, 1
    s_add_u32 s27, s27, 1
    s_cmp_lt_u32 s27, 16
    s_cbranch_scc1 L_a3_loop
    s_lshl_b32 s20, s13, 7
    s_lshl_b32 s21, s12, 4
    s_add_u32 s20, s20, s21
    s_lshl_b32 s21, s16, 2
    s_add_u32 s20, s20, s21
    s_add_u32 s42, s20, 125842432
    s_waitcnt vmcnt(0)
    v_mov_b32 v124, 1
    v_mov_b32 v125, 0
    s_mov_b64 exec, 1
    buffer_store_dword v124, v125, s[4:7], s42 offen sc1
    s_mov_b64 exec, -1
    s_and_b32 s37, s36, 3
    s_lshr_b32 s38, s36, 2
    s_barrier
    s_lshl_b32 s20, s16, 8
    v_lshlrev_b32 v124, 2, v0
    v_add_u32 v124, s20, v124
    s_mov_b32 s42, s88
    s_mov_b32 s43, s89
    s_add_u32 s42, s42, 12288
    s_addc_u32 s43, s43, 0
    global_load_dword v100, v124, s[42:43]
    s_add_u32 s42, s42, 1024
    s_addc_u32 s43, s43, 0
    global_load_dword v101, v124, s[42:43]
    s_add_u32 s42, s42, 1024
    s_addc_u32 s43, s43, 0
    global_load_dword v102, v124, s[42:43]
    s_add_u32 s42, s42, 1024
    s_addc_u32 s43, s43, 0
    global_load_dword v103, v124, s[42:43]
    s_add_u32 s42, s42, 1024
    s_addc_u32 s43, s43, 0
    global_load_dword v104, v124, s[42:43]
    s_add_u32 s42, s42, 1024
    s_addc_u32 s43, s43, 0
    global_load_dword v105, v124, s[42:43]
    s_add_u32 s42, s42, 1024
    s_addc_u32 s43, s43, 0
    global_load_dword v106, v124, s[42:43]
    s_add_u32 s42, s42, 1024
    s_addc_u32 s43, s43, 0
    global_load_dword v108, v124, s[42:43]
    s_add_u32 s42, s42, 1024
    s_addc_u32 s43, s43, 0
    global_load_dword v109, v124, s[42:43]
    s_waitcnt vmcnt(0)
    s_load_dwordx2 s[8:9], s[96:97], 16
    s_load_dwordx2 s[28:29], s[96:97], 80
    s_mov_b32 s10, 819200
    s_mov_b32 s11, 0x00020000
    s_mov_b32 s30, 5242880
    s_mov_b32 s31, 0x00020000
    s_waitcnt lgkmcnt(0)
    s_mul_i32 s20, s37, 320
    s_add_u32 s20, s20, 0
    s_mul_i32 s21, s16, 6
    s_add_u32 s21, s21, 1
    s_cmp_eq_u32 s16, 0
    s_cselect_b32 s21, 0, s21
    s_lshl_b32 s21, s21, 10
    s_add_u32 s21, s21, 0
    s_mov_b32 m0, s21
    s_add_u32 s21, s21, 1024
    buffer_load_dwordx4 v100, s[8:11], s20 offen lds
    s_mov_b32 m0, s21
    s_add_u32 s21, s21, 1024
    buffer_load_dwordx4 v101, s[8:11], s20 offen lds
    s_mov_b32 m0, s21
    s_add_u32 s21, s21, 1024
    buffer_load_dwordx4 v102, s[8:11], s20 offen lds
    s_mov_b32 m0, s21
    s_add_u32 s21, s21, 1024
    buffer_load_dwordx4 v103, s[8:11], s20 offen lds
    s_mov_b32 m0, s21
    s_add_u32 s21, s21, 1024
    buffer_load_dwordx4 v104, s[8:11], s20 offen lds
    s_mov_b32 m0, s21
    s_add_u32 s21, s21, 1024
    buffer_load_dwordx4 v105, s[8:11], s20 offen lds
    s_cmp_eq_u32 s16, 0
    s_cbranch_scc0 Lx_450
    s_mov_b32 m0, s21
    s_add_u32 s21, s21, 1024
    buffer_load_dwordx4 v106, s[8:11], s20 offen lds
Lx_450:
    s_mul_i32 s20, s37, 320
    s_add_u32 s20, s20, 102400
    s_mul_i32 s21, s16, 6
    s_add_u32 s21, s21, 1
    s_cmp_eq_u32 s16, 0
    s_cselect_b32 s21, 0, s21
    s_lshl_b32 s21, s21, 10
    s_add_u32 s21, s21, 25600
    s_mov_b32 m0, s21
    s_add_u32 s21, s21, 1024
    buffer_load_dwordx4 v100, s[8:11], s20 offen lds
    s_mov_b32 m0, s21
    s_add_u32 s21, s21, 1024
    buffer_load_dwordx4 v101, s[8:11], s20 offen lds
    s_mov_b32 m0, s21
    s_add_u32 s21, s21, 1024
    buffer_load_dwordx4 v102, s[8:11], s20 offen lds
    s_mov_b32 m0, s21
    s_add_u32 s21, s21, 1024
    buffer_load_dwordx4 v103, s[8:11], s20 offen lds
    s_mov_b32 m0, s21
    s_add_u32 s21, s21, 1024
    buffer_load_dwordx4 v104, s[8:11], s20 offen lds
    s_mov_b32 m0, s21
    s_add_u32 s21, s21, 1024
    buffer_load_dwordx4 v105, s[8:11], s20 offen lds
    s_cmp_eq_u32 s16, 0
    s_cbranch_scc0 Lx_451
    s_mov_b32 m0, s21
    s_add_u32 s21, s21, 1024
    buffer_load_dwordx4 v106, s[8:11], s20 offen lds
Lx_451:
    s_mul_i32 s20, s37, 320
    s_add_u32 s20, s20, 204800
    s_mul_i32 s21, s16, 6
    s_add_u32 s21, s21, 1
    s_cmp_eq_u32 s16, 0
    s_cselect_b32 s21, 0, s21
    s_lshl_b32 s21, s21, 10
    s_add_u32 s21, s21, 51200
    s_mov_b32 m0, s21
    s_add_u32 s21, s21, 1024
    buffer_load_dwordx4 v100, s[8:11], s20 offen lds
    s_mov_b32 m0, s21
    s_add_u32 s21, s21, 1024
    buffer_load_dwordx4 v101, s[8:11], s20 offen lds
    s_mov_b32 m0, s21
    s_add_u32 s21, s21, 1024
    buffer_load_dwordx4 v102, s[8:11], s20 offen lds
    s_mov_b32 m0, s21
    s_add_u32 s21, s21, 1024
    buffer_load_dwordx4 v103, s[8:11], s20 offen lds
    s_mov_b32 m0, s21
    s_add_u32 s21, s21, 1024
    buffer_load_dwordx4 v104, s[8:11], s20 offen lds
    s_mov_b32 m0, s21
    s_add_u32 s21, s21, 1024
    buffer_load_dwordx4 v105, s[8:11], s20 offen lds
    s_cmp_eq_u32 s16, 0
    s_cbranch_scc0 Lx_452
    s_mov_b32 m0, s21
    s_add_u32 s21, s21, 1024
    buffer_load_dwordx4 v106, s[8:11], s20 offen lds
Lx_452:
    s_mul_i32 s20, s37, 320
    s_add_u32 s20, s20, 307200
    s_mul_i32 s21, s16, 6
    s_add_u32 s21, s21, 1
    s_cmp_eq_u32 s16, 0
    s_cselect_b32 s21, 0, s21
    s_lshl_b32 s21, s21, 10
    s_add_u32 s21, s21, 76800
    s_mov_b32 m0, s21
    s_add_u32 s21, s21, 1024
    buffer_load_dwordx4 v100, s[8:11], s20 offen lds
    s_mov_b32 m0, s21
    s_add_u32 s21, s21, 1024
    buffer_load_dwordx4 v101, s[8:11], s20 offen lds
    s_mov_b32 m0, s21
    s_add_u32 s21, s21, 1024
    buffer_load_dwordx4 v102, s[8:11], s20 offen lds
    s_mov_b32 m0, s21
    s_add_u32 s21, s21, 1024
    buffer_load_dwordx4 v103, s[8:11], s20 offen lds
    s_mov_b32 m0, s21
    s_add_u32 s21, s21, 1024
    buffer_load_dwordx4 v104, s[8:11], s20 offen lds
    s_mov_b32 m0, s21
    s_add_u32 s21, s21, 1024
    buffer_load_dwordx4 v105, s[8:11], s20 offen lds
    s_cmp_eq_u32 s16, 0
    s_cbranch_scc0 Lx_453
    s_mov_b32 m0, s21
    s_add_u32 s21, s21, 1024
    buffer_load_dwordx4 v106, s[8:11], s20 offen lds
Lx_453:
    s_mul_i32 s20, s37, 320
    s_add_u32 s20, s20, 409600
    s_mul_i32 s21, s16, 6
    s_add_u32 s21, s21, 1
    s_cmp_eq_u32 s16, 0
    s_cselect_b32 s21, 0, s21
    s_lshl_b32 s21, s21, 10
    s_add_u32 s21, s21, 102400
    s_mov_b32 m0, s21
    s_add_u32 s21, s21, 1024
    buffer_load_dwordx4 v100, s[8:11], s20 offen lds
    s_mov_b32 m0, s21
    s_add_u32 s21, s21, 1024
    buffer_load_dwordx4 v101, s[8:11], s20 offen lds
    s_mov_b32 m0, s21
    s_add_u32 s21, s21, 1024
    buffer_load_dwordx4 v102, s[8:11], s20 offen lds
    s_mov_b32 m0, s21
    s_add_u32 s21, s21, 1024
    buffer_load_dwordx4 v103, s[8:11], s20 offen lds
    s_mov_b32 m0, s21
    s_add_u32 s21, s21, 1024
    buffer_load_dwordx4 v104, s[8:11], s20 offen lds
    s_mov_b32 m0, s21
    s_add_u32 s21, s21, 1024
    buffer_load_dwordx4 v105, s[8:11], s20 offen lds
    s_cmp_eq_u32 s16, 0
    s_cbranch_scc0 Lx_454
    s_mov_b32 m0, s21
    s_add_u32 s21, s21, 1024
    buffer_load_dwordx4 v106, s[8:11], s20 offen lds
Lx_454:
    s_waitcnt vmcnt(0)
    s_barrier
    v_add_u32 v124, 0, v108
    v_add_u32 v125, 0, v109
    ds_read_b64_tr_b16 a[0:1], v124
    ds_read_b64_tr_b16 a[2:3], v125
    v_add_u32 v124, 128, v108
    v_add_u32 v125, 128, v109
    ds_read_b64_tr_b16 a[128:129], v124
    ds_read_b64_tr_b16 a[130:131], v125
    v_add_u32 v124, 256, v108
    v_add_u32 v125, 256, v109
    ds_read_b64_tr_b16 v[128:129], v124
    ds_read_b64_tr_b16 v[130:131], v125
    s_waitcnt lgkmcnt(0)
    v_add_u32 v124, 6400, v108
    v_add_u32 v125, 6400, v109
    ds_read_b64_tr_b16 a[4:5], v124
    ds_read_b64_tr_b16 a[6:7], v125
    v_add_u32 v124, 6528, v108
    v_add_u32 v125, 6528, v109
    ds_read_b64_tr_b16 a[132:133], v124
    ds_read_b64_tr_b16 a[134:135], v125
    v_add_u32 v124, 6656, v108
    v_add_u32 v125, 6656, v109
    ds_read_b64_tr_b16 v[132:133], v124
    ds_read_b64_tr_b16 v[134:135], v125
    s_waitcnt lgkmcnt(0)
    v_add_u32 v124, 12800, v108
    v_add_u32 v125, 12800, v109
    ds_read_b64_tr_b16 a[8:9], v124
    ds_read_b64_tr_b16 a[10:11], v125
    v_add_u32 v124, 12928, v108
    v_add_u32 v125, 12928, v109
    ds_read_b64_tr_b16 a[136:137], v124
    ds_read_b64_tr_b16 a[138:139], v125
    v_add_u32 v124, 13056, v108
    v_add_u32 v125, 13056, v109
    ds_read_b64_tr_b16 v[136:137], v124
    ds_read_b64_tr_b16 v[138:139], v125
    s_waitcnt lgkmcnt(0)
    v_add_u32 v124, 19200, v108
    v_add_u32 v125, 19200, v109
    ds_read_b64_tr_b16 a[12:13], v124
    ds_read_b64_tr_b16 a[14:15], v125
    v_add_u32 v124, 19328, v108
    v_add_u32 v125, 19328, v109
    ds_read_b64_tr_b16 a[140:141], v124
    ds_read_b64_tr_b16 a[142:143], v125
    v_add_u32 v124, 19456, v108
    v_add_u32 v125, 19456, v109
    ds_read_b64_tr_b16 v[140:141], v124
    ds_read_b64_tr_b16 v[142:143], v125
    s_waitcnt lgkmcnt(0)
    s_barrier
    s_mul_i32 s20, s37, 320
    s_add_u32 s20, s20, 512000
    s_mul_i32 s21, s16, 6
    s_add_u32 s21, s21, 1
    s_cmp_eq_u32 s16, 0
    s_cselect_b32 s21, 0, s21
    s_lshl_b32 s21, s21, 10
    s_add_u32 s21, s21, 0
    s_mov_b32 m0, s21
    s_add_u32 s21, s21, 1024
    buffer_load_dwordx4 v100, s[8:11], s20 offen lds
    s_mov_b32 m0, s21
    s_add_u32 s21, s21, 1024
    buffer_load_dwordx4 v101, s[8:11], s20 offen lds
    s_mov_b32 m0, s21
    s_add_u32 s21, s21, 1024
    buffer_load_dwordx4 v102, s[8:11], s20 offen lds
    s_mov_b32 m0, s21
    s_add_u32 s21, s21, 1024
    buffer_load_dwordx4 v103, s[8:11], s20 offen lds
    s_mov_b32 m0, s21
    s_add_u32 s21, s21, 1024
    buffer_load_dwordx4 v104, s[8:11], s20 offen lds
    s_mov_b32 m0, s21
    s_add_u32 s21, s21, 1024
    buffer_load_dwordx4 v105, s[8:11], s20 offen lds
    s_cmp_eq_u32 s16, 0
    s_cbranch_scc0 Lx_455
    s_mov_b32 m0, s21
    s_add_u32 s21, s21, 1024
    buffer_load_dwordx4 v106, s[8:11], s20 offen lds
Lx_455:
    s_waitcnt vmcnt(0)
    s_barrier
    v_add_u32 v124, 25600, v108
    v_add_u32 v125, 25600, v109
    ds_read_b64_tr_b16 a[16:17], v124
    ds_read_b64_tr_b16 a[18:19], v125
    v_add_u32 v124, 25728, v108
    v_add_u32 v125, 25728, v109
    ds_read_b64_tr_b16 a[144:145], v124
    ds_read_b64_tr_b16 a[146:147], v125
    v_add_u32 v124, 25856, v108
    v_add_u32 v125, 25856, v109
    ds_read_b64_tr_b16 v[144:145], v124
    ds_read_b64_tr_b16 v[146:147], v125
    s_waitcnt lgkmcnt(0)
    v_add_u32 v124, 32000, v108
    v_add_u32 v125, 32000, v109
    ds_read_b64_tr_b16 a[20:21], v124
    ds_read_b64_tr_b16 a[22:23], v125
    v_add_u32 v124, 32128, v108
    v_add_u32 v125, 32128, v109
    ds_read_b64_tr_b16 a[148:149], v124
    ds_read_b64_tr_b16 a[150:151], v125
    v_add_u32 v124, 32256, v108
    v_add_u32 v125, 32256, v109
    ds_read_b64_tr_b16 v[148:149], v124
    ds_read_b64_tr_b16 v[150:151], v125
    s_waitcnt lgkmcnt(0)
    v_add_u32 v124, 38400, v108
    v_add_u32 v125, 38400, v109
    ds_read_b64_tr_b16 a[24:25], v124
    ds_read_b64_tr_b16 a[26:27], v125
    v_add_u32 v124, 38528, v108
    v_add_u32 v125, 38528, v109
    ds_read_b64_tr_b16 a[152:153], v124
    ds_read_b64_tr_b16 a[154:155], v125
    v_add_u32 v124, 38656, v108
    v_add_u32 v125, 38656, v109
    ds_read_b64_tr_b16 v[152:153], v124
    ds_read_b64_tr_b16 v[154:155], v125
    s_waitcnt lgkmcnt(0)
    v_add_u32 v124, 44800, v108
    v_add_u32 v125, 44800, v109
    ds_read_b64_tr_b16 a[28:29], v124
    ds_read_b64_tr_b16 a[30:31], v125
    v_add_u32 v124, 44928, v108
    v_add_u32 v125, 44928, v109
    ds_read_b64_tr_b16 a[156:157], v124
    ds_read_b64_tr_b16 a[158:159], v125
    v_add_u32 v124, 45056, v108
    v_add_u32 v125, 45056, v109
    ds_read_b64_tr_b16 v[156:157], v124
    ds_read_b64_tr_b16 v[158:159], v125
    s_waitcnt lgkmcnt(0)
    s_barrier
    s_mul_i32 s20, s37, 320
    s_add_u32 s20, s20, 614400
    s_mul_i32 s21, s16, 6
    s_add_u32 s21, s21, 1
    s_cmp_eq_u32 s16, 0
    s_cselect_b32 s21, 0, s21
    s_lshl_b32 s21, s21, 10
    s_add_u32 s21, s21, 25600
    s_mov_b32 m0, s21
    s_add_u32 s21, s21, 1024
    buffer_load_dwordx4 v100, s[8:11], s20 offen lds
    s_mov_b32 m0, s21
    s_add_u32 s21, s21, 1024
    buffer_load_dwordx4 v101, s[8:11], s20 offen lds
    s_mov_b32 m0, s21
    s_add_u32 s21, s21, 1024
    buffer_load_dwordx4 v102, s[8:11], s20 offen lds
    s_mov_b32 m0, s21
    s_add_u32 s21, s21, 1024
    buffer_load_dwordx4 v103, s[8:11], s20 offen lds
    s_mov_b32 m0, s21
    s_add_u32 s21, s21, 1024
    buffer_load_dwordx4 v104, s[8:11], s20 offen lds
    s_mov_b32 m0, s21
    s_add_u32 s21, s21, 1024
    buffer_load_dwordx4 v105, s[8:11], s20 offen lds
    s_cmp_eq_u32 s16, 0
    s_cbranch_scc0 Lx_456
    s_mov_b32 m0, s21
    s_add_u32 s21, s21, 1024
    buffer_load_dwordx4 v106, s[8:11], s20 offen lds
Lx_456:
    s_waitcnt vmcnt(0)
    s_barrier
    v_add_u32 v124, 51200, v108
    v_add_u32 v125, 51200, v109
    ds_read_b64_tr_b16 a[32:33], v124
    ds_read_b64_tr_b16 a[34:35], v125
    v_add_u32 v124, 51328, v108
    v_add_u32 v125, 51328, v109
    ds_read_b64_tr_b16 a[160:161], v124
    ds_read_b64_tr_b16 a[162:163], v125
    v_add_u32 v124, 51456, v108
    v_add_u32 v125, 51456, v109
    ds_read_b64_tr_b16 v[160:161], v124
    ds_read_b64_tr_b16 v[162:163], v125
    s_waitcnt lgkmcnt(0)
    v_add_u32 v124, 57600, v108
    v_add_u32 v125, 57600, v109
    ds_read_b64_tr_b16 a[36:37], v124
    ds_read_b64_tr_b16 a[38:39], v125
    v_add_u32 v124, 57728, v108
    v_add_u32 v125, 57728, v109
    ds_read_b64_tr_b16 a[164:165], v124
    ds_read_b64_tr_b16 a[166:167], v125
    v_add_u32 v124, 57856, v108
    v_add_u32 v125, 57856, v109
    ds_read_b64_tr_b16 v[164:165], v124
    ds_read_b64_tr_b16 v[166:167], v125
    s_waitcnt lgkmcnt(0)
    v_add_u32 v124, 64000, v108
    v_add_u32 v125, 64000, v109
    ds_read_b64_tr_b16 a[40:41], v124
    ds_read_b64_tr_b16 a[42:43], v125
    v_add_u32 v124, 64128, v108
    v_add_u32 v125, 64128, v109
    ds_read_b64_tr_b16 a[168:169], v124
    ds_read_b64_tr_b16 a[170:171], v125
    v_add_u32 v124, 64256, v108
    v_add_u32 v125, 64256, v109
    ds_read_b64_tr_b16 v[168:169], v124
    ds_read_b64_tr_b16 v[170:171], v125
    s_waitcnt lgkmcnt(0)
    v_add_u32 v124, 70400, v108
    v_add_u32 v125, 70400, v109
    ds_read_b64_tr_b16 a[44:45], v124
    ds_read_b64_tr_b16 a[46:47], v125
    v_add_u32 v124, 70528, v108
    v_add_u32 v125, 70528, v109
    ds_read_b64_tr_b16 a[172:173], v124
    ds_read_b64_tr_b16 a[174:175], v125
    v_add_u32 v124, 70656, v108
    v_add_u32 v125, 70656, v109
    ds_read_b64_tr_b16 v[172:173], v124
    ds_read_b64_tr_b16 v[174:175], v125
    s_waitcnt lgkmcnt(0)
    s_barrier
    s_mul_i32 s20, s37, 320
    s_add_u32 s20, s20, 716800
    s_mul_i32 s21, s16, 6
    s_add_u32 s21, s21, 1
    s_cmp_eq_u32 s16, 0
    s_cselect_b32 s21, 0, s21
    s_lshl_b32 s21, s21, 10
    s_add_u32 s21, s21, 51200
    s_mov_b32 m0, s21
    s_add_u32 s21, s21, 1024
    buffer_load_dwordx4 v100, s[8:11], s20 offen lds
    s_mov_b32 m0, s21
    s_add_u32 s21, s21, 1024
    buffer_load_dwordx4 v101, s[8:11], s20 offen lds
    s_mov_b32 m0, s21
    s_add_u32 s21, s21, 1024
    buffer_load_dwordx4 v102, s[8:11], s20 offen lds
    s_mov_b32 m0, s21
    s_add_u32 s21, s21, 1024
    buffer_load_dwordx4 v103, s[8:11], s20 offen lds
    s_mov_b32 m0, s21
    s_add_u32 s21, s21, 1024
    buffer_load_dwordx4 v104, s[8:11], s20 offen lds
    s_mov_b32 m0, s21
    s_add_u32 s21, s21, 1024
    buffer_load_dwordx4 v105, s[8:11], s20 offen lds
    s_cmp_eq_u32 s16, 0
    s_cbranch_scc0 Lx_457
    s_mov_b32 m0, s21
    s_add_u32 s21, s21, 1024
    buffer_load_dwordx4 v106, s[8:11], s20 offen lds
Lx_457:
    s_waitcnt vmcnt(0)
    s_barrier
    v_add_u32 v124, 76800, v108
    v_add_u32 v125, 76800, v109
    ds_read_b64_tr_b16 a[48:49], v124
    ds_read_b64_tr_b16 a[50:51], v125
    v_add_u32 v124, 76928, v108
    v_add_u32 v125, 76928, v109
    ds_read_b64_tr_b16 a[176:177], v124
    ds_read_b64_tr_b16 a[178:179], v125
    v_add_u32 v124, 77056, v108
    v_add_u32 v125, 77056, v109
    ds_read_b64_tr_b16 v[176:177], v124
    ds_read_b64_tr_b16 v[178:179], v125
    s_waitcnt lgkmcnt(0)
    v_add_u32 v124, 83200, v108
    v_add_u32 v125, 83200, v109
    ds_read_b64_tr_b16 a[52:53], v124
    ds_read_b64_tr_b16 a[54:55], v125
    v_add_u32 v124, 83328, v108
    v_add_u32 v125, 83328, v109
    ds_read_b64_tr_b16 a[180:181], v124
    ds_read_b64_tr_b16 a[182:183], v125
    v_add_u32 v124, 83456, v108
    v_add_u32 v125, 83456, v109
    ds_read_b64_tr_b16 v[180:181], v124
    ds_read_b64_tr_b16 v[182:183], v125
    s_waitcnt lgkmcnt(0)
    v_add_u32 v124, 89600, v108
    v_add_u32 v125, 89600, v109
    ds_read_b64_tr_b16 a[56:57], v124
    ds_read_b64_tr_b16 a[58:59], v125
    v_add_u32 v124, 89728, v108
    v_add_u32 v125, 89728, v109
    ds_read_b64_tr_b16 a[184:185], v124
    ds_read_b64_tr_b16 a[186:187], v125
    v_add_u32 v124, 89856, v108
    v_add_u32 v125, 89856, v109
    ds_read_b64_tr_b16 v[184:185], v124
    ds_read_b64_tr_b16 v[186:187], v125
    s_waitcnt lgkmcnt(0)
    v_add_u32 v124, 96000, v108
    v_add_u32 v125, 96000, v109
    ds_read_b64_tr_b16 a[60:61], v124
    ds_read_b64_tr_b16 a[62:63], v125
    v_add_u32 v124, 96128, v108
    v_add_u32 v125, 96128, v109
    ds_read_b64_tr_b16 a[188:189], v124
    ds_read_b64_tr_b16 a[190:191], v125
    v_add_u32 v124, 96256, v108
    v_add_u32 v125, 96256, v109
    ds_read_b64_tr_b16 v[188:189], v124
    ds_read_b64_tr_b16 v[190:191], v125
    s_waitcnt lgkmcnt(0)
    s_waitcnt vmcnt(0)
    s_barrier
    v_add_u32 v124, 102400, v108
    v_add_u32 v125, 102400, v109
    ds_read_b64_tr_b16 a[64:65], v124
    ds_read_b64_tr_b16 a[66:67], v125
    v_add_u32 v124, 102528, v108
    v_add_u32 v125, 102528, v109
    ds_read_b64_tr_b16 a[192:193], v124
    ds_read_b64_tr_b16 a[194:195], v125
    v_add_u32 v124, 102656, v108
    v_add_u32 v125, 102656, v109
    ds_read_b64_tr_b16 v[192:193], v124
    ds_read_b64_tr_b16 v[194:195], v125
    s_waitcnt lgkmcnt(0)
    v_add_u32 v124, 108800, v108
    v_add_u32 v125, 108800, v109
    ds_read_b64_tr_b16 a[68:69], v124
    ds_read_b64_tr_b16 a[70:71], v125
    v_add_u32 v124, 108928, v108
    v_add_u32 v125, 108928, v109
    ds_read_b64_tr_b16 a[196:197], v124
    ds_read_b64_tr_b16 a[198:199], v125
    v_add_u32 v124, 109056, v108
    v_add_u32 v125, 109056, v109
    ds_read_b64_tr_b16 v[196:197], v124
    ds_read_b64_tr_b16 v[198:199], v125
    s_waitcnt lgkmcnt(0)
    v_add_u32 v124, 115200, v108
    v_add_u32 v125, 115200, v109
    ds_read_b64_tr_b16 a[72:73], v124
    ds_read_b64_tr_b16 a[74:75], v125
    v_add_u32 v124, 115328, v108
    v_add_u32 v125, 115328, v109
    ds_read_b64_tr_b16 a[200:201], v124
    ds_read_b64_tr_b16 a[202:203], v125
    v_add_u32 v124, 115456, v108
    v_add_u32 v125, 115456, v109
    ds_read_b64_tr_b16 v[200:201], v124
    ds_read_b64_tr_b16 v[202:203], v125
    s_waitcnt lgkmcnt(0)
    v_add_u32 v124, 121600, v108
    v_add_u32 v125, 121600, v109
    ds_read_b64_tr_b16 a[76:77], v124
    ds_read_b64_tr_b16 a[78:79], v125
    v_add_u32 v124, 121728, v108
    v_add_u32 v125, 121728, v109
    ds_read_b64_tr_b16 a[204:205], v124
    ds_read_b64_tr_b16 a[206:207], v125
    v_add_u32 v124, 121856, v108
    v_add_u32 v125, 121856, v109
    ds_read_b64_tr_b16 v[204:205], v124
    ds_read_b64_tr_b16 v[206:207], v125
    s_waitcnt lgkmcnt(0)
    s_waitcnt vmcnt(0)
    s_barrier
    v_add_u32 v124, 0, v108
    v_add_u32 v125, 0, v109
    ds_read_b64_tr_b16 a[80:81], v124
    ds_read_b64_tr_b16 a[82:83], v125
    v_add_u32 v124, 128, v108
    v_add_u32 v125, 128, v109
    ds_read_b64_tr_b16 a[208:209], v124
    ds_read_b64_tr_b16 a[210:211], v125
    v_add_u32 v124, 256, v108
    v_add_u32 v125, 256, v109
    ds_read_b64_tr_b16 v[208:209], v124
    ds_read_b64_tr_b16 v[210:211], v125
    s_waitcnt lgkmcnt(0)
    v_add_u32 v124, 6400, v108
    v_add_u32 v125, 6400, v109
    ds_read_b64_tr_b16 a[84:85], v124
    ds_read_b64_tr_b16 a[86:87], v125
    v_add_u32 v124, 6528, v108
    v_add_u32 v125, 6528, v109
    ds_read_b64_tr_b16 a[212:213], v124
    ds_read_b64_tr_b16 a[214:215], v125
    v_add_u32 v124, 6656, v108
    v_add_u32 v125, 6656, v109
    ds_read_b64_tr_b16 v[212:213], v124
    ds_read_b64_tr_b16 v[214:215], v125
    s_waitcnt lgkmcnt(0)
    v_add_u32 v124, 12800, v108
    v_add_u32 v125, 12800, v109
    ds_read_b64_tr_b16 a[88:89], v124
    ds_read_b64_tr_b16 a[90:91], v125
    v_add_u32 v124, 12928, v108
    v_add_u32 v125, 12928, v109
    ds_read_b64_tr_b16 a[216:217], v124
    ds_read_b64_tr_b16 a[218:219], v125
    v_add_u32 v124, 13056, v108
    v_add_u32 v125, 13056, v109
    ds_read_b64_tr_b16 v[216:217], v124
    ds_read_b64_tr_b16 v[218:219], v125
    s_waitcnt lgkmcnt(0)
    v_add_u32 v124, 19200, v108
    v_add_u32 v125, 19200, v109
    ds_read_b64_tr_b16 a[92:93], v124
    ds_read_b64_tr_b16 a[94:95], v125
    v_add_u32 v124, 19328, v108
    v_add_u32 v125, 19328, v109
    ds_read_b64_tr_b16 a[220:221], v124
    ds_read_b64_tr_b16 a[222:223], v125
    v_add_u32 v124, 19456, v108
    v_add_u32 v125, 19456, v109
    ds_read_b64_tr_b16 v[220:221], v124
    ds_read_b64_tr_b16 v[222:223], v125
    s_waitcnt lgkmcnt(0)
    s_waitcnt vmcnt(0)
    s_barrier
    v_add_u32 v124, 25600, v108
    v_add_u32 v125, 25600, v109
    ds_read_b64_tr_b16 a[96:97], v124
    ds_read_b64_tr_b16 a[98:99], v125
    v_add_u32 v124, 25728, v108
    v_add_u32 v125, 25728, v109
    ds_read_b64_tr_b16 a[224:225], v124
    ds_read_b64_tr_b16 a[226:227], v125
    v_add_u32 v124, 25856, v108
    v_add_u32 v125, 25856, v109
    ds_read_b64_tr_b16 v[224:225], v124
    ds_read_b64_tr_b16 v[226:227], v125
    s_waitcnt lgkmcnt(0)
    v_add_u32 v124, 32000, v108
    v_add_u32 v125, 32000, v109
    ds_read_b64_tr_b16 a[100:101], v124
    ds_read_b64_tr_b16 a[102:103], v125
    v_add_u32 v124, 32128, v108
    v_add_u32 v125, 32128, v109
    ds_read_b64_tr_b16 a[228:229], v124
    ds_read_b64_tr_b16 a[230:231], v125
    v_add_u32 v124, 32256, v108
    v_add_u32 v125, 32256, v109
    ds_read_b64_tr_b16 v[228:229], v124
    ds_read_b64_tr_b16 v[230:231], v125
    s_waitcnt lgkmcnt(0)
    v_add_u32 v124, 38400, v108
    v_add_u32 v125, 38400, v109
    ds_read_b64_tr_b16 a[104:105], v124
    ds_read_b64_tr_b16 a[106:107], v125
    v_add_u32 v124, 38528, v108
    v_add_u32 v125, 38528, v109
    ds_read_b64_tr_b16 a[232:233], v124
    ds_read_b64_tr_b16 a[234:235], v125
    v_add_u32 v124, 38656, v108
    v_add_u32 v125, 38656, v109
    ds_read_b64_tr_b16 v[232:233], v124
    ds_read_b64_tr_b16 v[234:235], v125
    s_waitcnt lgkmcnt(0)
    v_add_u32 v124, 44800, v108
    v_add_u32 v125, 44800, v109
    ds_read_b64_tr_b16 a[108:109], v124
    ds_read_b64_tr_b16 a[110:111], v125
    v_add_u32 v124, 44928, v108
    v_add_u32 v125, 44928, v109
    ds_read_b64_tr_b16 a[236:237], v124
    ds_read_b64_tr_b16 a[238:239], v125
    v_add_u32 v124, 45056, v108
    v_add_u32 v125, 45056, v109
    ds_read_b64_tr_b16 v[236:237], v124
    ds_read_b64_tr_b16 v[238:239], v125
    s_waitcnt lgkmcnt(0)
    s_waitcnt vmcnt(0)
    s_barrier
    v_add_u32 v124, 51200, v108
    v_add_u32 v125, 51200, v109
    ds_read_b64_tr_b16 a[112:113], v124
    ds_read_b64_tr_b16 a[114:115], v125
    v_add_u32 v124, 51328, v108
    v_add_u32 v125, 51328, v109
    ds_read_b64_tr_b16 a[240:241], v124
    ds_read_b64_tr_b16 a[242:243], v125
    v_add_u32 v124, 51456, v108
    v_add_u32 v125, 51456, v109
    ds_read_b64_tr_b16 v[240:241], v124
    ds_read_b64_tr_b16 v[242:243], v125
    s_waitcnt lgkmcnt(0)
    v_add_u32 v124, 57600, v108
    v_add_u32 v125, 57600, v109
    ds_read_b64_tr_b16 a[116:117], v124
    ds_read_b64_tr_b16 a[118:119], v125
    v_add_u32 v124, 57728, v108
    v_add_u32 v125, 57728, v109
    ds_read_b64_tr_b16 a[244:245], v124
    ds_read_b64_tr_b16 a[246:247], v125
    v_add_u32 v124, 57856, v108
    v_add_u32 v125, 57856, v109
    ds_read_b64_tr_b16 v[244:245], v124
    ds_read_b64_tr_b16 v[246:247], v125
    s_waitcnt lgkmcnt(0)
    v_add_u32 v124, 64000, v108
    v_add_u32 v125, 64000, v109
    ds_read_b64_tr_b16 a[120:121], v124
    ds_read_b64_tr_b16 a[122:123], v125
    v_add_u32 v124, 64128, v108
    v_add_u32 v125, 64128, v109
    ds_read_b64_tr_b16 a[248:249], v124
    ds_read_b64_tr_b16 a[250:251], v125
    v_add_u32 v124, 64256, v108
    v_add_u32 v125, 64256, v109
    ds_read_b64_tr_b16 v[248:249], v124
    ds_read_b64_tr_b16 v[250:251], v125
    s_waitcnt lgkmcnt(0)
    v_add_u32 v124, 70400, v108
    v_add_u32 v125, 70400, v109
    ds_read_b64_tr_b16 a[124:125], v124
    ds_read_b64_tr_b16 a[126:127], v125
    v_add_u32 v124, 70528, v108
    v_add_u32 v125, 70528, v109
    ds_read_b64_tr_b16 a[252:253], v124
    ds_read_b64_tr_b16 a[254:255], v125
    v_add_u32 v124, 70656, v108
    v_add_u32 v125, 70656, v109
    ds_read_b64_tr_b16 v[252:253], v124
    ds_read_b64_tr_b16 v[254:255], v125
    s_waitcnt lgkmcnt(0)
    s_lshr_b32 s20, s38, 1
    s_lshl_b32 s20, s20, 7
    s_add_u32 s42, s20, 125842432
    v_and_b32 v124, 31, v0
    v_lshlrev_b32 v124, 2, v124
    s_mov_b32 s24, 0
La_458:
    buffer_load_dword v125, v124, s[4:7], s42 offen sc1
    s_waitcnt vmcnt(0)
    v_cmp_gt_u32 vcc, 1, v125
    s_cbranch_vccz La_459
    s_sleep 4
    s_add_u32 s24, s24, 1
    s_cmp_lt_u32 s24, 1600000
    s_cbranch_scc1 La_458
    s_branch L_abort
La_459:
    v_and_b32 v124, 15, v0
    v_mul_u32_u24 v124, 2560, v124
    v_lshrrev_b32 v125, 4, v0
    v_lshlrev_b32 v125, 3, v125
    v_add_u32 v2, v124, v125
    s_lshl_b32 s27, s38, 4
    s_add_u32 s45, s27, 16
L_a3b_loop:
    s_lshl_b32 s20, s27, 15
    s_add_u32 s42, s20, 138412032
    s_add_u32 s23, s42, 0
    buffer_load_dwordx4 v[24:27], v1, s[4:7], s23 offen sc1
    s_add_u32 s23, s42, 1024
    buffer_load_dwordx4 v[28:31], v1, s[4:7], s23 offen sc1
    s_add_u32 s23, s42, 2048
    buffer_load_dwordx4 v[32:35], v1, s[4:7], s23 offen sc1
    s_add_u32 s23, s42, 3072
    buffer_load_dwordx4 v[36:39], v1, s[4:7], s23 offen sc1
    s_add_u32 s23, s42, 4096
    buffer_load_dwordx4 v[40:43], v1, s[4:7], s23 offen sc1
    s_add_u32 s23, s42, 5120
    buffer_load_dwordx4 v[44:47], v1, s[4:7], s23 offen sc1
    s_add_u32 s23, s42, 6144
    buffer_load_dwordx4 v[48:51], v1, s[4:7], s23 offen sc1
    s_add_u32 s23, s42, 7168
    buffer_load_dwordx4 v[52:55], v1, s[4:7], s23 offen sc1
    s_add_u32 s23, s42, 8192
    buffer_load_dwordx4 v[56:59], v1, s[4:7], s23 offen sc1
    s_add_u32 s23, s42, 9216
    buffer_load_dwordx4 v[60:63], v1, s[4:7], s23 offen sc1
    s_add_u32 s23, s42, 10240
    buffer_load_dwordx4 v[64:67], v1, s[4:7], s23 offen sc1
    s_add_u32 s23, s42, 11264
    buffer_load_dwordx4 v[68:71], v1, s[4:7], s23 offen sc1
    s_add_u32 s23, s42, 12288
    buffer_load_dwordx4 v[72:75], v1, s[4:7], s23 offen sc1
    s_add_u32 s23, s42, 13312
    buffer_load_dwordx4 v[76:79], v1, s[4:7], s23 offen sc1
    s_add_u32 s23, s42, 14336
    buffer_load_dwordx4 v[80:83], v1, s[4:7], s23 offen sc1
    s_add_u32 s23, s42, 15360
    buffer_load_dwordx4 v[84:87], v1, s[4:7], s23 offen sc1
    s_waitcnt vmcnt(15)
    v_mfma_f32_16x16x32_bf16 v[8:11], a[0:3], v[24:27], 0
    v_mfma_f32_16x16x32_bf16 v[12:15], a[128:131], v[24:27], 0
    v_mfma_f32_16x16x32_bf16 v[16:19], v[128:131], v[24:27], 0
    s_add_u32 s23, s42, 16384
    buffer_load_dwordx4 v[24:27], v1, s[4:7], s23 offen sc1
    s_waitcnt vmcnt(15)
    v_mfma_f32_16x16x32_bf16 v[8:11], a[4:7], v[28:31], v[8:11]
    v_mfma_f32_16x16x32_bf16 v[12:15], a[132:135], v[28:31], v[12:15]
    v_mfma_f32_16x16x32_bf16 v[16:19], v[132:135], v[28:31], v[16:19]
    s_add_u32 s23, s42, 17408
    buffer_load_dwordx4 v[28:31], v1, s[4:7], s23 offen sc1
    s_waitcnt vmcnt(15)
    v_mfma_f32_16x16x32_bf16 v[8:11], a[8:11], v[32:35], v[8:11]
    v_mfma_f32_16x16x32_bf16 v[12:15], a[136:139], v[32:35], v[12:15]
    v_mfma_f32_16x16x32_bf16 v[16:19], v[136:139], v[32:35], v[16:19]
    s_add_u32 s23, s42, 18432
    buffer_load_dwordx4 v[32:35], v1, s[4:7], s23 offen sc1
    s_waitcnt vmcnt(15)
    v_mfma_f32_16x16x32_bf16 v[8:11], a[12:15], v[36:39], v[8:11]
    v_mfma_f32_16x16x32_bf16 v[12:15], a[140:143], v[36:39], v[12:15]
    v_mfma_f32_16x16x32_bf16 v[16:19], v[140:143], v[36:39], v[16:19]
    s_add_u32 s23, s42, 19456
    buffer_load_dwordx4 v[36:39], v1, s[4:7], s23 offen sc1
    s_waitcnt vmcnt(15)
    v_mfma_f32_16x16x32_bf16 v[8:11], a[16:19], v[40:43], v[8:11]
    v_mfma_f32_16x16x32_bf16 v[12:15], a[144:147], v[40:43], v[12:15]
    v_mfma_f32_16x16x32_bf16 v[16:19], v[144:147], v[40:43], v[16:19]
    s_add_u32 s23, s42, 20480
    buffer_load_dwordx4 v[40:43], v1, s[4:7], s23 offen sc1
    s_waitcnt vmcnt(15)
    v_mfma_f32_16x16x32_bf16 v[8:11], a[20:23], v[44:47], v[8:11]
    v_mfma_f32_16x16x32_bf16 v[12:15], a[148:151], v[44:47], v[12:15]
    v_mfma_f32_16x16x32_bf16 v[16:19], v[148:151], v[44:47], v[16:19]
    s_add_u32 s23, s42, 21504
    buffer_load_dwordx4 v[44:47], v1, s[4:7], s23 offen sc1
    s_waitcnt vmcnt(15)
    v_mfma_f32_16x16x32_bf16 v[8:11], a[24:27], v[48:51], v[8:11]
    v_mfma_f32_16x16x32_bf16 v[12:15], a[152:155], v[48:51], v[12:15]
    v_mfma_f32_16x16x32_bf16 v[16:19], v[152:155], v[48:51], v[16:19]
    s_add_u32 s23, s42, 22528
    buffer_load_dwordx4 v[48:51], v1, s[4:7], s23 offen sc1
    s_waitcnt vmcnt(15)
    v_mfma_f32_16x16x32_bf16 v[8:11], a[28:31], v[52:55], v[8:11]
    v_mfma_f32_16x16x32_bf16 v[12:15], a[156:159], v[52:55], v[12:15]
    v_mfma_f32_16x16x32_bf16 v[16:19], v[156:159], v[52:55], v[16:19]
    s_add_u32 s23, s42, 23552
    buffer_load_dwordx4 v[52:55], v1, s[4:7], s23 offen sc1
    s_waitcnt vmcnt(15)
    v_mfma_f32_16x16x32_bf16 v[8:11], a[32:35], v[56:59], v[8:11]
    v_mfma_f32_16x16x32_bf16 v[12:15], a[160:163], v[56:59], v[12:15]
    v_mfma_f32_16x16x32_bf16 v[16:19], v[160:163], v[56:59], v[16:19]
    s_add_u32 s23, s42, 24576
    buffer_load_dwordx4 v[56:59], v1, s[4:7], s23 offen sc1
    s_waitcnt vmcnt(15)
    v_mfma_f32_16x16x32_bf16 v[8:11], a[36:39], v[60:63], v[8:11]
    v_mfma_f32_16x16x32_bf16 v[12:15], a[164:167], v[60:63], v[12:15]
    v_mfma_f32_16x16x32_bf16 v[16:19], v[164:167], v[60:63], v[16:19]
    s_add_u32 s23, s42, 25600
    buffer_load_dwordx4 v[60:63], v1, s[4:7], s23 offen sc1
    s_waitcnt vmcnt(15)
    v_mfma_f32_16x16x32_bf16 v[8:11], a[40:43], v[64:67], v[8:11]
    v_mfma_f32_16x16x32_bf16 v[12:15], a[168:171], v[64:67], v[12:15]
    v_mfma_f32_16x16x32_bf16 v[16:19], v[168:171], v[64:67], v[16:19]
    s_add_u32 s23, s42, 26624
    buffer_load_dwordx4 v[64:67], v1, s[4:7], s23 offen sc1
    s_waitcnt vmcnt(15)
    v_mfma_f32_16x16x32_bf16 v[8:11], a[44:47], v[68:71], v[8:11]
    v_mfma_f32_16x16x32_bf16 v[12:15], a[172:175], v[68:71], v[12:15]
    v_mfma_f32_16x16x32_bf16 v[16:19], v[172:175], v[68:71], v[16:19]
    s_add_u32 s23, s42, 27648
    buffer_load_dwordx4 v[68:71], v1, s[4:7], s23 offen sc1
    s_waitcnt vmcnt(15)
    v_mfma_f32_16x16x32_bf16 v[8:11], a[48:51], v[72:75], v[8:11]
    v_mfma_f32_16x16x32_bf16 v[12:15], a[176:179], v[72:75], v[12:15]
    v_mfma_f32_16x16x32_bf16 v[16:19], v[176:179], v[72:75], v[16:19]
    s_add_u32 s23, s42, 28672
    buffer_load_dwordx4 v[72:75], v1, s[4:7], s23 offen sc1
    s_waitcnt vmcnt(15)
    v_mfma_f32_16x16x32_bf16 v[8:11], a[52:55], v[76:79], v[8:11]
    v_mfma_f32_16x16x32_bf16 v[12:15], a[180:183], v[76:79], v[12:15]
    v_mfma_f32_16x16x32_bf16 v[16:19], v[180:183], v[76:79], v[16:19]
    s_add_u32 s23, s42, 29696
    buffer_load_dwordx4 v[76:79], v1, s[4:7], s23 offen sc1
    s_waitcnt vmcnt(15)
    v_mfma_f32_16x16x32_bf16 v[8:11], a[56:59], v[80:83], v[8:11]
    v_mfma_f32_16x16x32_bf16 v[12:15], a[184:187], v[80:83], v[12:15]
    v_mfma_f32_16x16x32_bf16 v[16:19], v[184:187], v[80:83], v[16:19]
    s_add_u32 s23, s42, 30720
    buffer_load_dwordx4 v[80:83], v1, s[4:7], s23 offen sc1
    s_waitcnt vmcnt(15)
    v_mfma_f32_16x16x32_bf16 v[8:11], a[60:63], v[84:87], v[8:11]
    v_mfma_f32_16x16x32_bf16 v[12:15], a[188:191], v[84:87], v[12:15]
    v_mfma_f32_16x16x32_bf16 v[16:19], v[188:191], v[84:87], v[16:19]
    s_add_u32 s23, s42, 31744
    buffer_load_dwordx4 v[84:87], v1, s[4:7], s23 offen sc1
    s_waitcnt vmcnt(15)
    v_mfma_f32_16x16x32_bf16 v[8:11], a[64:67], v[24:27], v[8:11]
    v_mfma_f32_16x16x32_bf16 v[12:15], a[192:195], v[24:27], v[12:15]
    v_mfma_f32_16x16x32_bf16 v[16:19], v[192:195], v[24:27], v[16:19]
    s_waitcnt vmcnt(14)
    v_mfma_f32_16x16x32_bf16 v[8:11], a[68:71], v[28:31], v[8:11]
    v_mfma_f32_16x16x32_bf16 v[12:15], a[196:199], v[28:31], v[12:15]
    v_mfma_f32_16x16x32_bf16 v[16:19], v[196:199], v[28:31], v[16:19]
    s_waitcnt vmcnt(13)
    v_mfma_f32_16x16x32_bf16 v[8:11], a[72:75], v[32:35], v[8:11]
    v_mfma_f32_16x16x32_bf16 v[12:15], a[200:203], v[32:35], v[12:15]
    v_mfma_f32_16x16x32_bf16 v[16:19], v[200:203], v[32:35], v[16:19]
    s_waitcnt vmcnt(12)
    v_mfma_f32_16x16x32_bf16 v[8:11], a[76:79], v[36:39], v[8:11]
    v_mfma_f32_16x16x32_bf16 v[12:15], a[204:207], v[36:39], v[12:15]
    v_mfma_f32_16x16x32_bf16 v[16:19], v[204:207], v[36:39], v[16:19]
    s_waitcnt vmcnt(11)
    v_mfma_f32_16x16x32_bf16 v[8:11], a[80:83], v[40:43], v[8:11]
    v_mfma_f32_16x16x32_bf16 v[12:15], a[208:211], v[40:43], v[12:15]
    v_mfma_f32_16x16x32_bf16 v[16:19], v[208:211], v[40:43], v[16:19]
    s_waitcnt vmcnt(10)
    v_mfma_f32_16x16x32_bf16 v[8:11], a[84:87], v[44:47], v[8:11]
    v_mfma_f32_16x16x32_bf16 v[12:15], a[212:215], v[44:47], v[12:15]
    v_mfma_f32_16x16x32_bf16 v[16:19], v[212:215], v[44:47], v[16:19]
    s_waitcnt vmcnt(9)
    v_mfma_f32_16x16x32_bf16 v[8:11], a[88:91], v[48:51], v[8:11]
    v_mfma_f32_16x16x32_bf16 v[12:15], a[216:219], v[48:51], v[12:15]
    v_mfma_f32_16x16x32_bf16 v[16:19], v[216:219], v[48:51], v[16:19]
    s_waitcnt vmcnt(8)
    v_mfma_f32_16x16x32_bf16 v[8:11], a[92:95], v[52:55], v[8:11]
    v_mfma_f32_16x16x32_bf16 v[12:15], a[220:223], v[52:55], v[12:15]
    v_mfma_f32_16x16x32_bf16 v[16:19], v[220:223], v[52:55], v[16:19]
    s_waitcnt vmcnt(7)
    v_mfma_f32_16x16x32_bf16 v[8:11], a[96:99], v[56:59], v[8:11]
    v_mfma_f32_16x16x32_bf16 v[12:15], a[224:227], v[56:59], v[12:15]
    v_mfma_f32_16x16x32_bf16 v[16:19], v[224:227], v[56:59], v[16:19]
    s_waitcnt vmcnt(6)
    v_mfma_f32_16x16x32_bf16 v[8:11], a[100:103], v[60:63], v[8:11]
    v_mfma_f32_16x16x32_bf16 v[12:15], a[228:231], v[60:63], v[12:15]
    v_mfma_f32_16x16x32_bf16 v[16:19], v[228:231], v[60:63], v[16:19]
    s_waitcnt vmcnt(5)
    v_mfma_f32_16x16x32_bf16 v[8:11], a[104:107], v[64:67], v[8:11]
    v_mfma_f32_16x16x32_bf16 v[12:15], a[232:235], v[64:67], v[12:15]
    v_mfma_f32_16x16x32_bf16 v[16:19], v[232:235], v[64:67], v[16:19]
    s_waitcnt vmcnt(4)
    v_mfma_f32_16x16x32_bf16 v[8:11], a[108:111], v[68:71], v[8:11]
    v_mfma_f32_16x16x32_bf16 v[12:15], a[236:239], v[68:71], v[12:15]
    v_mfma_f32_16x16x32_bf16 v[16:19], v[236:239], v[68:71], v[16:19]
    s_waitcnt vmcnt(3)
    v_mfma_f32_16x16x32_bf16 v[8:11], a[112:115], v[72:75], v[8:11]
    v_mfma_f32_16x16x32_bf16 v[12:15], a[240:243], v[72:75], v[12:15]
    v_mfma_f32_16x16x32_bf16 v[16:19], v[240:243], v[72:75], v[16:19]
    s_waitcnt vmcnt(2)
    v_mfma_f32_16x16x32_bf16 v[8:11], a[116:119], v[76:79], v[8:11]
    v_mfma_f32_16x16x32_bf16 v[12:15], a[244:247], v[76:79], v[12:15]
    v_mfma_f32_16x16x32_bf16 v[16:19], v[244:247], v[76:79], v[16:19]
    s_waitcnt vmcnt(1)
    v_mfma_f32_16x16x32_bf16 v[8:11], a[120:123], v[80:83], v[8:11]
    v_mfma_f32_16x16x32_bf16 v[12:15], a[248:251], v[80:83], v[12:15]
    v_mfma_f32_16x16x32_bf16 v[16:19], v[248:251], v[80:83], v[16:19]
    s_waitcnt vmcnt(0)
    v_mfma_f32_16x16x32_bf16 v[8:11], a[124:127], v[84:87], v[8:11]
    v_mfma_f32_16x16x32_bf16 v[12:15], a[252:255], v[84:87], v[12:15]
    v_mfma_f32_16x16x32_bf16 v[16:19], v[252:255], v[84:87], v[16:19]
    s_nop 7
    s_nop 1
    s_mul_i32 s20, s27, 40960
    s_mul_i32 s21, s37, 320
    s_add_u32 s20, s20, s21
    s_lshl_b32 s21, s16, 5
    s_add_u32 s20, s20, s21
    v_cvt_pk_bf16_f32 v8, v8, v9
    v_cvt_pk_bf16_f32 v9, v10, v11
    buffer_store_dwordx2 v[8:9], v2, s[28:31], s20 offen offset:0
    v_cvt_pk_bf16_f32 v12, v12, v13
    v_cvt_pk_bf16_f32 v13, v14, v15
    buffer_store_dwordx2 v[12:13], v2, s[28:31], s20 offen offset:128
    s_cmp_ge_u32 s16, 2
    s_cbranch_scc1 Lx_460
    v_cvt_pk_bf16_f32 v16, v16, v17
    v_cvt_pk_bf16_f32 v17, v18, v19
    buffer_store_dwordx2 v[16:17], v2, s[28:31], s20 offen offset:256
Lx_460:
    s_add_u32 s27, s27, 1
    s_cmp_lt_u32 s27, s45
    s_cbranch_scc1 L_a3b_loop
    s_waitcnt vmcnt(0)
    s_branch L_exit
L_abort:
    s_mov_b64 exec, 1
    v_mov_b32 v2, 32
    v_mov_b32 v3, 1
    global_atomic_add v2, v3, s[90:91]
    s_waitcnt vmcnt(0)
L_exit:
    s_endpgm
.p2align 8
L_table:
  .long 133120,133152,133136,133168,133124,133156,133140,133172,133128,133160,133144,133176,133132,133164,133148,133180
  .long 133184,133216,133200,133232,133188,133220,133204,133236,133192,133224,133208,133240,133196,133228,133212,133244
  .long 133248,133280,133264,133296,133252,133284,133268,133300,133256,133288,133272,133304,133260,133292,133276,133308
  .long 133312,133344,133328,133360,133316,133348,133332,133364,133320,133352,133336,133368,133324,133356,133340,133372
  .long 133632,133664,133648,133680,133636,133668,133652,133684,133640,133672,133656,133688,133644,133676,133660,133692
  .long 133696,133728,133712,133744,133700,133732,133716,133748,133704,133736,133720,133752,133708,133740,133724,133756
  .long 133760,133792,133776,133808,133764,133796,133780,133812,133768,133800,133784,133816,133772,133804,133788,133820
  .long 133824,133856,133840,133872,133828,133860,133844,133876,133832,133864,133848,133880,133836,133868,133852,133884
  .long 134656,134864,134660,134868,134664,134872,134668,134876,134672,134880,134676,134884,134680,134888,134684,134892
  .long 135072,135280,135076,135284,135080,135288,135084,135292,135088,135296,135092,135300,135096,135304,135100,135308
  .long 135488,135696,135492,135700,135496,135704,135500,135708,135504,135712,135508,135716,135512,135720,135516,135724
  .long 135904,136112,135908,136116,135912,136120,135916,136124,135920,136128,135924,136132,135928,136136,135932,136140
  .long 134752,134960,134756,134964,134760,134968,134764,134972,134768,134976,134772,134980,134776,134984,134780,134988
  .long 135168,135376,135172,135380,135176,135384,135180,135388,135184,135392,135188,135396,135192,135400,135196,135404
  .long 135584,135792,135588,135796,135592,135800,135596,135804,135600,135808,135604,135812,135608,135816,135612,135820
  .long 136000,136208,136004,136212,136008,136216,136012,136220,136016,136224,136020,136228,136024,136232,136028,136236
  .long 133376,133408,133392,133424,133380,133412,133396,133428,133384,133416,133400,133432,133388,133420,133404,133436
  .long 133440,133472,133456,133488,133444,133476,133460,133492,133448,133480,133464,133496,133452,133484,133468,133500
  .long 133504,133536,133520,133552,133508,133540,133524,133556,133512,133544,133528,133560,133516,133548,133532,133564
  .long 133568,133600,133584,133616,133572,133604,133588,133620,133576,133608,133592,133624,133580,133612,133596,133628
  .long 133888,133920,133904,133936,133892,133924,133908,133940,133896,133928,133912,133944,133900,133932,133916,133948
  .long 133952,133984,133968,134000,133956,133988,133972,134004,133960,133992,133976,134008,133964,133996,133980,134012
  .long 134016,134048,134032,134064,134020,134052,134036,134068,134024,134056,134040,134072,134028,134060,134044,134076
  .long 134080,134112,134096,134128,134084,134116,134100,134132,134088,134120,134104,134136,134092,134124,134108,134140
  .long 134688,134896,134692,134900,134696,134904,134700,134908,134704,134912,134708,134916,134712,134920,134716,134924
  .long 135104,135312,135108,135316,135112,135320,135116,135324,135120,135328,135124,135332,135128,135336,135132,135340
  .long 135520,135728,135524,135732,135528,135736,135532,135740,135536,135744,135540,135748,135544,135752,135548,135756
  .long 135936,136144,135940,136148,135944,136152,135948,136156,135952,136160,135956,136164,135960,136168,135964,136172
  .long 134784,134992,134788,134996,134792,135000,134796,135004,134800,135008,134804,135012,134808,135016,134812,135020
  .long 135200,135408,135204,135412,135208,135416,135212,135420,135216,135424,135220,135428,135224,135432,135228,135436
  .long 135616,135824,135620,135828,135624,135832,135628,135836,135632,135840,135636,135844,135640,135848,135644,135852
  .long 136032,136240,136036,136244,136040,136248,136044,136252,136048,136256,136052,136260,136056,136264,136060,136268
  .long 134144,134160,134152,134168,134148,134164,134156,134172,134272,134288,134280,134296,134276,134292,134284,134300
  .long 134176,134192,134184,134200,134180,134196,134188,134204,134304,134320,134312,134328,134308,134324,134316,134332
  .long 134208,134224,134216,134232,134212,134228,134220,134236,134336,134352,134344,134360,134340,134356,134348,134364
  .long 134240,134256,134248,134264,134244,134260,134252,134268,134368,134384,134376,134392,134372,134388,134380,134396
  .long 134400,134416,134408,134424,134404,134420,134412,134428,134528,134544,134536,134552,134532,134548,134540,134556
  .long 134432,134448,134440,134456,134436,134452,134444,134460,134560,134576,134568,134584,134564,134580,134572,134588
  .long 134464,134480,134472,134488,134468,134484,134476,134492,134592,134608,134600,134616,134596,134612,134604,134620
  .long 134496,134512,134504,134520,134500,134516,134508,134524,134624,134640,134632,134648,134628,134644,134636,134652
  .long 134720,134928,134724,134932,134728,134936,134732,134940,134736,134944,134740,134948,134744,134952,134748,134956
  .long 135136,135344,135140,135348,135144,135352,135148,135356,135152,135360,135156,135364,135160,135368,135164,135372
  .long 135552,135760,135556,135764,135560,135768,135564,135772,135568,135776,135572,135780,135576,135784,135580,135788
  .long 135968,136176,135972,136180,135976,136184,135980,136188,135984,136192,135988,136196,135992,136200,135996,136204
  .long 134816,135024,134820,135028,134824,135032,134828,135036,134832,135040,134836,135044,134840,135048,134844,135052
  .long 135232,135440,135236,135444,135240,135448,135244,135452,135248,135456,135252,135460,135256,135464,135260,135468
  .long 135648,135856,135652,135860,135656,135864,135660,135868,135664,135872,135668,135876,135672,135880,135676,135884
  .long 136064,136272,136068,136276,136072,136280,136076,136284,136080,136288,136084,136292,136088,136296,136092,136300
  .long 0,8,16,24,3104,3112,3120,3128,192,200,208,216,3296,3304,3312,3320
  .long 384,392,400,408,3488,3496,3504,3512,576,584,592,600,3680,3688,3696,3704
  .long 768,776,784,792,3872,3880,3888,3896,960,968,976,984,4064,4072,4080,4088
  .long 1152,1160,1168,1176,4256,4264,4272,4280,1344,1352,1360,1368,4448,4456,4464,4472
  .long 32,40,48,56,3072,3080,3088,3096,224,232,240,248,3264,3272,3280,3288
  .long 416,424,432,440,3456,3464,3472,3480,608,616,624,632,3648,3656,3664,3672
  .long 800,808,816,824,3840,3848,3856,3864,992,1000,1008,1016,4032,4040,4048,4056
  .long 1184,1192,1200,1208,4224,4232,4240,4248,1376,1384,1392,1400,4416,4424,4432,4440
  .long 64,72,80,88,3168,3176,3184,3192,256,264,272,280,3360,3368,3376,3384
  .long 448,456,464,472,3552,3560,3568,3576,640,648,656,664,3744,3752,3760,3768
  .long 832,840,848,856,3936,3944,3952,3960,1024,1032,1040,1048,4128,4136,4144,4152
  .long 1216,1224,1232,1240,4320,4328,4336,4344,1408,1416,1424,1432,4512,4520,4528,4536
  .long 128,136,144,152,3232,3240,3248,3256,320,328,336,344,3424,3432,3440,3448
  .long 512,520,528,536,3616,3624,3632,3640,704,712,720,728,3808,3816,3824,3832
  .long 896,904,912,920,4000,4008,4016,4024,1088,1096,1104,1112,4192,4200,4208,4216
  .long 1280,1288,1296,1304,4384,4392,4400,4408,1472,1480,1488,1496,4576,4584,4592,4600
  .long 0,8,16,24,3104,3112,3120,3128,192,200,208,216,3296,3304,3312,3320
  .long 384,392,400,408,3488,3496,3504,3512,576,584,592,600,3680,3688,3696,3704
  .long 768,776,784,792,3872,3880,3888,3896,960,968,976,984,4064,4072,4080,4088
  .long 1152,1160,1168,1176,4256,4264,4272,4280,1344,1352,1360,1368,4448,4456,4464,4472
  .long 32,40,48,56,3072,3080,3088,3096,224,232,240,248,3264,3272,3280,3288
  .long 416,424,432,440,3456,3464,3472,3480,608,616,624,632,3648,3656,3664,3672
  .long 800,808,816,824,3840,3848,3856,3864,992,1000,1008,1016,4032,4040,4048,4056
  .long 1184,1192,1200,1208,4224,4232,4240,4248,1376,1384,1392,1400,4416,4424,4432,4440
  .long 96,104,112,120,3136,3144,3152,3160,288,296,304,312,3328,3336,3344,3352
  .long 480,488,496,504,3520,3528,3536,3544,672,680,688,696,3712,3720,3728,3736
  .long 864,872,880,888,3904,3912,3920,3928,1056,1064,1072,1080,4096,4104,4112,4120
  .long 1248,1256,1264,1272,4288,4296,4304,4312,1440,1448,1456,1464,4480,4488,4496,4504
  .long 160,168,176,184,3200,3208,3216,3224,352,360,368,376,3392,3400,3408,3416
  .long 544,552,560,568,3584,3592,3600,3608,736,744,752,760,3776,3784,3792,3800
  .long 928,936,944,952,3968,3976,3984,3992,1120,1128,1136,1144,4160,4168,4176,4184
  .long 1312,1320,1328,1336,4352,4360,4368,4376,1504,1512,1520,1528,4544,4552,4560,4568
  .long 136320,136324,136328,136332,136336,136340,136344,136348,137344,137348,137352,137356,137360,137364,137368,137372
  .long 136384,136388,136392,136396,136400,136404,136408,136412,137408,137412,137416,137420,137424,137428,137432,137436
  .long 136448,136452,136456,136460,136464,136468,136472,136476,137472,137476,137480,137484,137488,137492,137496,137500
  .long 136512,136516,136520,136524,136528,136532,136536,136540,137536,137540,137544,137548,137552,137556,137560,137564
  .long 136576,136580,136584,136588,136592,136596,136600,136604,137600,137604,137608,137612,137616,137620,137624,137628
  .long 136640,136644,136648,136652,136656,136660,136664,136668,137664,137668,137672,137676,137680,137684,137688,137692
  .long 136704,136708,136712,136716,136720,136724,136728,136732,137728,137732,137736,137740,137744,137748,137752,137756
  .long 136768,136772,136776,136780,136784,136788,136792,136796,137792,137796,137800,137804,137808,137812,137816,137820
  .long 136832,136836,136848,136852,137088,137092,137104,137108,136320,136320,136320,136320,136320,136320,136320,136320
  .long 136896,136900,136912,136916,137152,137156,137168,137172,136320,136320,136320,136320,136320,136320,136320,136320
  .long 136960,136964,136976,136980,137216,137220,137232,137236,136320,136320,136320,136320,136320,136320,136320,136320
  .long 137024,137028,137040,137044,137280,137284,137296,137300,136320,136320,136320,136320,136320,136320,136320,136320
  .long 136320,136320,136320,136320,136320,136320,136320,136320,136320,136320,136320,136320,136320,136320,136320,136320
  .long 136320,136320,136320,136320,136320,136320,136320,136320,136320,136320,136320,136320,136320,136320,136320,136320
  .long 136320,136320,136320,136320,136320,136320,136320,136320,136320,136320,136320,136320,136320,136320,136320,136320
  .long 136320,136320,136320,136320,136320,136320,136320,136320,136320,136320,136320,136320,136320,136320,136320,136320
  .long 0,4,8,12,16,20,24,28,1024,1028,1032,1036,1040,1044,1048,1052
  .long 64,68,72,76,80,84,88,92,1088,1092,1096,1100,1104,1108,1112,1116
  .long 128,132,136,140,144,148,152,156,1152,1156,1160,1164,1168,1172,1176,1180
  .long 192,196,200,204,208,212,216,220,1216,1220,1224,1228,1232,1236,1240,1244
  .long 256,260,264,268,272,276,280,284,1280,1284,1288,1292,1296,1300,1304,1308
  .long 320,324,328,332,336,340,344,348,1344,1348,1352,1356,1360,1364,1368,1372
  .long 384,388,392,396,400,404,408,412,1408,1412,1416,1420,1424,1428,1432,1436
  .long 448,452,456,460,464,468,472,476,1472,1476,1480,1484,1488,1492,1496,1500
  .long 512,516,528,532,768,772,784,788,0,0,0,0,0,0,0,0
  .long 576,580,592,596,832,836,848,852,0,0,0,0,0,0,0,0
  .long 640,644,656,660,896,900,912,916,0,0,0,0,0,0,0,0
  .long 704,708,720,724,960,964,976,980,0,0,0,0,0,0,0,0
  .long 0,0,0,0,0,0,0,0,0,0,0,0,0,0,0,0
  .long 0,0,0,0,0,0,0,0,0,0,0,0,0,0,0,0
  .long 0,0,0,0,0,0,0,0,0,0,0,0,0,0,0,0
  .long 0,0,0,0,0,0,0,0,0,0,0,0,0,0,0,0
  .long 0,8,16,24,32,40,48,56,64,72,80,88,96,104,112,120
  .long 128,136,144,152,160,168,176,184,192,200,208,216,224,232,240,248
  .long 256,264,272,280,288,296,304,312,320,328,336,344,352,360,368,376
  .long 384,392,400,408,416,424,432,440,448,456,464,472,480,488,496,504
  .long 0,8,16,24,32,40,48,56,64,72,80,88,96,104,112,120
  .long 128,136,144,152,160,168,176,184,192,200,208,216,224,232,240,248
  .long 256,264,272,280,288,296,304,312,320,328,336,344,352,360,368,376
  .long 384,392,400,408,416,424,432,440,448,456,464,472,480,488,496,504
  .long 0,8,16,24,32,40,48,56,64,72,80,88,96,104,112,120
  .long 128,136,144,152,160,168,176,184,192,200,208,216,224,232,240,248
  .long 256,264,272,280,288,296,304,312,320,328,336,344,352,360,368,376
  .long 384,392,400,408,416,424,432,440,448,456,464,472,480,488,496,504
  .long 0,8,16,24,32,40,48,56,64,72,80,88,96,104,112,120
  .long 128,136,144,152,160,168,176,184,192,200,208,216,224,232,240,248
  .long 256,264,272,280,288,296,304,312,320,328,336,344,352,360,368,376
  .long 384,392,400,408,416,424,432,440,448,456,464,472,480,488,496,504
  .long 0,0,0,0,0,0,0,0,0,0,0,0,0,0,0,0
  .long 0,0,0,0,0,0,0,0,0,0,0,0,0,0,0,0
  .long 0,0,0,0,0,0,0,0,0,0,0,0,0,0,0,0
  .long 0,0,0,0,0,0,0,0,0,0,0,0,0,0,0,0
  .long 0,0,0,0,0,0,0,0,0,0,0,0,0,0,0,0
  .long 0,0,0,0,0,0,0,0,0,0,0,0,0,0,0,0
  .long 0,0,0,0,0,0,0,0,0,0,0,0,0,0,0,0
  .long 0,0,0,0,0,0,0,0,0,0,0,0,0,0,0,0
  .long 0,0,0,0,0,0,0,0,0,0,0,0,0,0,0,0
  .long 0,0,0,0,0,0,0,0,0,0,0,0,0,0,0,0
  .long 0,0,0,0,0,0,0,0,0,0,0,0,0,0,0,0
  .long 0,0,0,0,0,0,0,0,0,0,0,0,0,0,0,0
  .long 0,0,0,0,0,0,0,0,0,0,0,0,0,0,0,0
  .long 0,0,0,0,0,0,0,0,0,0,0,0,0,0,0,0
  .long 0,0,0,0,0,0,0,0,0,0,0,0,0,0,0,0
  .long 0,0,0,0,0,0,0,0,0,0,0,0,0,0,0,0
  .long 138752,138768,139776,139792,138784,138800,139808,139824,138816,138832,139840,139856,138848,138864,139872,139888
  .long 139008,139024,140032,140048,139040,139056,140064,140080,139072,139088,140096,140112,139104,139120,140128,140144
  .long 139264,139280,140288,140304,139296,139312,140320,140336,139328,139344,140352,140368,139360,139376,140384,140400
  .long 139520,139536,140544,140560,139552,139568,140576,140592,139584,139600,140608,140624,139616,139632,140640,140656
  .long 138880,138896,139904,139920,138912,138928,139936,139952,138944,138960,139968,139984,138976,138992,140000,140016
  .long 139136,139152,140160,140176,139168,139184,140192,140208,139200,139216,140224,140240,139232,139248,140256,140272
  .long 139392,139408,140416,140432,139424,139440,140448,140464,139456,139472,140480,140496,139488,139504,140512,140528
  .long 139648,139664,140672,140688,139680,139696,140704,140720,139712,139728,140736,140752,139744,139760,140768,140784
  .long 134656,134864,135072,135280,135488,135696,135904,136112,134656,134864,135072,135280,135488,135696,135904,136112
  .long 134672,134880,135088,135296,135504,135712,135920,136128,134672,134880,135088,135296,135504,135712,135920,136128
  .long 134688,134896,135104,135312,135520,135728,135936,136144,134688,134896,135104,135312,135520,135728,135936,136144
  .long 134704,134912,135120,135328,135536,135744,135952,136160,134704,134912,135120,135328,135536,135744,135952,136160
  .long 134656,134864,135072,135280,135488,135696,135904,136112,134656,134864,135072,135280,135488,135696,135904,136112
  .long 134672,134880,135088,135296,135504,135712,135920,136128,134672,134880,135088,135296,135504,135712,135920,136128
  .long 134688,134896,135104,135312,135520,135728,135936,136144,134688,134896,135104,135312,135520,135728,135936,136144
  .long 134704,134912,135120,135328,135536,135744,135952,136160,134704,134912,135120,135328,135536,135744,135952,136160
  .long 140800,140816,141056,141072,140832,140848,141088,141104,140864,140880,141120,141136,140896,140912,141152,141168
  .long 141312,141328,141568,141584,141344,141360,141600,141616,141376,141392,141632,141648,141408,141424,141664,141680
  .long 143872,143888,144128,144144,143904,143920,144160,144176,143936,143952,144192,144208,143968,143984,144224,144240
  .long 144384,144400,144640,144656,144416,144432,144672,144688,144448,144464,144704,144720,144480,144496,144736,144752
  .long 140928,140944,141184,141200,140960,140976,141216,141232,140992,141008,141248,141264,141024,141040,141280,141296
  .long 141440,141456,141696,141712,141472,141488,141728,141744,141504,141520,141760,141776,141536,141552,141792,141808
  .long 144000,144016,144256,144272,144032,144048,144288,144304,144064,144080,144320,144336,144096,144112,144352,144368
  .long 144512,144528,144768,144784,144544,144560,144800,144816,144576,144592,144832,144848,144608,144624,144864,144880
  .long 134720,134928,135136,135344,135552,135760,135968,136176,134720,134928,135136,135344,135552,135760,135968,136176
  .long 134736,134944,135152,135360,135568,135776,135984,136192,134736,134944,135152,135360,135568,135776,135984,136192
  .long 134816,135024,135232,135440,135648,135856,136064,136272,134816,135024,135232,135440,135648,135856,136064,136272
  .long 134832,135040,135248,135456,135664,135872,136080,136288,134832,135040,135248,135456,135664,135872,136080,136288
  .long 134720,134928,135136,135344,135552,135760,135968,136176,134720,134928,135136,135344,135552,135760,135968,136176
  .long 134736,134944,135152,135360,135568,135776,135984,136192,134736,134944,135152,135360,135568,135776,135984,136192
  .long 134816,135024,135232,135440,135648,135856,136064,136272,134816,135024,135232,135440,135648,135856,136064,136272
  .long 134832,135040,135248,135456,135664,135872,136080,136288,134832,135040,135248,135456,135664,135872,136080,136288
  .long 0,16,32,48,64,80,96,112,128,144,160,176,192,208,224,240
  .long 4,20,36,52,68,84,100,116,132,148,164,180,196,212,228,244
  .long 8,24,40,56,72,88,104,120,136,152,168,184,200,216,232,248
  .long 12,28,44,60,76,92,108,124,140,156,172,188,204,220,236,252
  .long 256,272,288,304,320,336,352,368,384,400,416,432,448,464,480,496
  .long 260,276,292,308,324,340,356,372,388,404,420,436,452,468,484,500
  .long 264,280,296,312,328,344,360,376,392,408,424,440,456,472,488,504
  .long 268,284,300,316,332,348,364,380,396,412,428,444,460,476,492,508
  .long 512,528,544,560,576,592,608,624,640,656,672,688,704,720,736,752
  .long 516,532,548,564,580,596,612,628,644,660,676,692,708,724,740,756
  .long 520,536,552,568,584,600,616,632,648,664,680,696,712,728,744,760
  .long 524,540,556,572,588,604,620,636,652,668,684,700,716,732,748,764
  .long 1024,1040,1056,1072,1088,1104,1120,1136,1152,1168,1184,1200,1216,1232,1248,1264
  .long 1028,1044,1060,1076,1092,1108,1124,1140,1156,1172,1188,1204,1220,1236,1252,1268
  .long 1032,1048,1064,1080,1096,1112,1128,1144,1160,1176,1192,1208,1224,1240,1256,1272
  .long 1036,1052,1068,1084,1100,1116,1132,1148,1164,1180,1196,1212,1228,1244,1260,1276
  .long 0,16,32,48,64,80,96,112,128,144,160,176,192,208,224,240
  .long 0,16,32,48,64,80,96,112,128,144,160,176,192,208,224,240
  .long 8,24,40,56,72,88,104,120,136,152,168,184,200,216,232,248
  .long 8,24,40,56,72,88,104,120,136,152,168,184,200,216,232,248
  .long 768,784,800,816,832,848,864,880,896,912,928,944,960,976,992,1008
  .long 768,784,800,816,832,848,864,880,896,912,928,944,960,976,992,1008
  .long 776,792,808,824,840,856,872,888,904,920,936,952,968,984,1000,1016
  .long 776,792,808,824,840,856,872,888,904,920,936,952,968,984,1000,1016
  .long 1536,1552,1568,1584,1600,1616,1632,1648,1664,1680,1696,1712,1728,1744,1760,1776
  .long 1536,1552,1568,1584,1600,1616,1632,1648,1664,1680,1696,1712,1728,1744,1760,1776
  .long 1544,1560,1576,1592,1608,1624,1640,1656,1672,1688,1704,1720,1736,1752,1768,1784
  .long 1544,1560,1576,1592,1608,1624,1640,1656,1672,1688,1704,1720,1736,1752,1768,1784
  .long 2304,2320,2336,2352,2368,2384,2400,2416,2432,2448,2464,2480,2496,2512,2528,2544
  .long 2304,2320,2336,2352,2368,2384,2400,2416,2432,2448,2464,2480,2496,2512,2528,2544
  .long 2312,2328,2344,2360,2376,2392,2408,2424,2440,2456,2472,2488,2504,2520,2536,2552
  .long 2312,2328,2344,2360,2376,2392,2408,2424,2440,2456,2472,2488,2504,2520,2536,2552
  .long 133120,133152,133136,133168,133124,133156,133140,133172,133128,133160,133144,133176,133132,133164,133148,133180
  .long 133184,133216,133200,133232,133188,133220,133204,133236,133192,133224,133208,133240,133196,133228,133212,133244
  .long 133248,133280,133264,133296,133252,133284,133268,133300,133256,133288,133272,133304,133260,133292,133276,133308
  .long 133312,133344,133328,133360,133316,133348,133332,133364,133320,133352,133336,133368,133324,133356,133340,133372
  .long 133888,133920,133904,133936,133892,133924,133908,133940,133896,133928,133912,133944,133900,133932,133916,133948
  .long 133952,133984,133968,134000,133956,133988,133972,134004,133960,133992,133976,134008,133964,133996,133980,134012
  .long 134016,134048,134032,134064,134020,134052,134036,134068,134024,134056,134040,134072,134028,134060,134044,134076
  .long 134080,134112,134096,134128,134084,134116,134100,134132,134088,134120,134104,134136,134092,134124,134108,134140
  .long 134656,134688,134672,134704,134660,134692,134676,134708,134664,134696,134680,134712,134668,134700,134684,134716
  .long 134720,134752,134736,134768,134724,134756,134740,134772,134728,134760,134744,134776,134732,134764,134748,134780
  .long 134784,134816,134800,134832,134788,134820,134804,134836,134792,134824,134808,134840,134796,134828,134812,134844
  .long 134848,134880,134864,134896,134852,134884,134868,134900,134856,134888,134872,134904,134860,134892,134876,134908
  .long 135424,135456,135440,135472,135428,135460,135444,135476,135432,135464,135448,135480,135436,135468,135452,135484
  .long 135488,135520,135504,135536,135492,135524,135508,135540,135496,135528,135512,135544,135500,135532,135516,135548
  .long 135552,135584,135568,135600,135556,135588,135572,135604,135560,135592,135576,135608,135564,135596,135580,135612
  .long 135616,135648,135632,135664,135620,135652,135636,135668,135624,135656,135640,135672,135628,135660,135644,135676
  .long 133376,133408,133392,133424,133380,133412,133396,133428,133384,133416,133400,133432,133388,133420,133404,133436
  .long 133440,133472,133456,133488,133444,133476,133460,133492,133448,133480,133464,133496,133452,133484,133468,133500
  .long 133504,133536,133520,133552,133508,133540,133524,133556,133512,133544,133528,133560,133516,133548,133532,133564
  .long 133568,133600,133584,133616,133572,133604,133588,133620,133576,133608,133592,133624,133580,133612,133596,133628
  .long 134144,134176,134160,134192,134148,134180,134164,134196,134152,134184,134168,134200,134156,134188,134172,134204
  .long 134208,134240,134224,134256,134212,134244,134228,134260,134216,134248,134232,134264,134220,134252,134236,134268
  .long 134272,134304,134288,134320,134276,134308,134292,134324,134280,134312,134296,134328,134284,134316,134300,134332
  .long 134336,134368,134352,134384,134340,134372,134356,134388,134344,134376,134360,134392,134348,134380,134364,134396
  .long 134912,134944,134928,134960,134916,134948,134932,134964,134920,134952,134936,134968,134924,134956,134940,134972
  .long 134976,135008,134992,135024,134980,135012,134996,135028,134984,135016,135000,135032,134988,135020,135004,135036
  .long 135040,135072,135056,135088,135044,135076,135060,135092,135048,135080,135064,135096,135052,135084,135068,135100
  .long 135104,135136,135120,135152,135108,135140,135124,135156,135112,135144,135128,135160,135116,135148,135132,135164
  .long 135680,135712,135696,135728,135684,135716,135700,135732,135688,135720,135704,135736,135692,135724,135708,135740
  .long 135744,135776,135760,135792,135748,135780,135764,135796,135752,135784,135768,135800,135756,135788,135772,135804
  .long 135808,135840,135824,135856,135812,135844,135828,135860,135816,135848,135832,135864,135820,135852,135836,135868
  .long 135872,135904,135888,135920,135876,135908,135892,135924,135880,135912,135896,135928,135884,135916,135900,135932
  .long 133632,133664,133648,133680,133636,133668,133652,133684,133640,133672,133656,133688,133644,133676,133660,133692
  .long 133696,133728,133712,133744,133700,133732,133716,133748,133704,133736,133720,133752,133708,133740,133724,133756
  .long 133760,133792,133776,133808,133764,133796,133780,133812,133768,133800,133784,133816,133772,133804,133788,133820
  .long 133824,133856,133840,133872,133828,133860,133844,133876,133832,133864,133848,133880,133836,133868,133852,133884
  .long 134400,134432,134416,134448,134404,134436,134420,134452,134408,134440,134424,134456,134412,134444,134428,134460
  .long 134464,134496,134480,134512,134468,134500,134484,134516,134472,134504,134488,134520,134476,134508,134492,134524
  .long 134528,134560,134544,134576,134532,134564,134548,134580,134536,134568,134552,134584,134540,134572,134556,134588
  .long 134592,134624,134608,134640,134596,134628,134612,134644,134600,134632,134616,134648,134604,134636,134620,134652
  .long 135168,135200,135184,135216,135172,135204,135188,135220,135176,135208,135192,135224,135180,135212,135196,135228
  .long 135232,135264,135248,135280,135236,135268,135252,135284,135240,135272,135256,135288,135244,135276,135260,135292
  .long 135296,135328,135312,135344,135300,135332,135316,135348,135304,135336,135320,135352,135308,135340,135324,135356
  .long 135360,135392,135376,135408,135364,135396,135380,135412,135368,135400,135384,135416,135372,135404,135388,135420
  .long 135936,135968,135952,135984,135940,135972,135956,135988,135944,135976,135960,135992,135948,135980,135964,135996
  .long 136000,136032,136016,136048,136004,136036,136020,136052,136008,136040,136024,136056,136012,136044,136028,136060
  .long 136064,136096,136080,136112,136068,136100,136084,136116,136072,136104,136088,136120,136076,136108,136092,136124
  .long 136128,136160,136144,136176,136132,136164,136148,136180,136136,136168,136152,136184,136140,136172,136156,136188
  .long 0,32,16,48,4096,4128,4112,4144,8,40,24,56,4104,4136,4120,4152
  .long 64,96,80,112,4160,4192,4176,4208,72,104,88,120,4168,4200,4184,4216
  .long 2048,2080,2064,2096,6144,6176,6160,6192,2056,2088,2072,2104,6152,6184,6168,6200
  .long 2112,2144,2128,2160,6208,6240,6224,6256,2120,2152,2136,2168,6216,6248,6232,6264
  .long 24576,24608,24592,24624,28672,28704,28688,28720,24584,24616,24600,24632,28680,28712,28696,28728
  .long 24640,24672,24656,24688,28736,28768,28752,28784,24648,24680,24664,24696,28744,28776,28760,28792
  .long 26624,26656,26640,26672,30720,30752,30736,30768,26632,26664,26648,26680,30728,30760,30744,30776
  .long 26688,26720,26704,26736,30784,30816,30800,30832,26696,26728,26712,26744,30792,30824,30808,30840
  .long 0,0,0,0,0,0,0,0,0,0,0,0,0,0,0,0
  .long 0,0,0,0,0,0,0,0,0,0,0,0,0,0,0,0
  .long 0,0,0,0,0,0,0,0,0,0,0,0,0,0,0,0
  .long 0,0,0,0,0,0,0,0,0,0,0,0,0,0,0,0
  .long 0,0,0,0,0,0,0,0,0,0,0,0,0,0,0,0
  .long 0,0,0,0,0,0,0,0,0,0,0,0,0,0,0,0
  .long 0,0,0,0,0,0,0,0,0,0,0,0,0,0,0,0
  .long 0,0,0,0,0,0,0,0,0,0,0,0,0,0,0,0
  .long 8192,8224,8208,8240,12288,12320,12304,12336,8200,8232,8216,8248,12296,12328,12312,12344
  .long 8256,8288,8272,8304,12352,12384,12368,12400,8264,8296,8280,8312,12360,12392,12376,12408
  .long 10240,10272,10256,10288,14336,14368,14352,14384,10248,10280,10264,10296,14344,14376,14360,14392
  .long 10304,10336,10320,10352,14400,14432,14416,14448,10312,10344,10328,10360,14408,14440,14424,14456
  .long 32768,32800,32784,32816,36864,36896,36880,36912,32776,32808,32792,32824,36872,36904,36888,36920
  .long 32832,32864,32848,32880,36928,36960,36944,36976,32840,32872,32856,32888,36936,36968,36952,36984
  .long 34816,34848,34832,34864,38912,38944,38928,38960,34824,34856,34840,34872,38920,38952,38936,38968
  .long 34880,34912,34896,34928,38976,39008,38992,39024,34888,34920,34904,34936,38984,39016,39000,39032
  .long 49152,49184,49168,49200,53248,53280,53264,53296,49160,49192,49176,49208,53256,53288,53272,53304
  .long 49216,49248,49232,49264,53312,53344,53328,53360,49224,49256,49240,49272,53320,53352,53336,53368
  .long 51200,51232,51216,51248,55296,55328,55312,55344,51208,51240,51224,51256,55304,55336,55320,55352
  .long 51264,51296,51280,51312,55360,55392,55376,55408,51272,51304,51288,51320,55368,55400,55384,55416
  .long 65536,65568,65552,65584,69632,69664,69648,69680,65544,65576,65560,65592,69640,69672,69656,69688
  .long 65600,65632,65616,65648,69696,69728,69712,69744,65608,65640,65624,65656,69704,69736,69720,69752
  .long 67584,67616,67600,67632,71680,71712,71696,71728,67592,67624,67608,67640,71688,71720,71704,71736
  .long 67648,67680,67664,67696,71744,71776,71760,71792,67656,67688,67672,67704,71752,71784,71768,71800
  .long 16384,16416,16400,16432,20480,20512,20496,20528,16392,16424,16408,16440,20488,20520,20504,20536
  .long 16448,16480,16464,16496,20544,20576,20560,20592,16456,16488,16472,16504,20552,20584,20568,20600
  .long 18432,18464,18448,18480,22528,22560,22544,22576,18440,18472,18456,18488,22536,22568,22552,22584
  .long 18496,18528,18512,18544,22592,22624,22608,22640,18504,18536,18520,18552,22600,22632,22616,22648
  .long 40960,40992,40976,41008,45056,45088,45072,45104,40968,41000,40984,41016,45064,45096,45080,45112
  .long 41024,41056,41040,41072,45120,45152,45136,45168,41032,41064,41048,41080,45128,45160,45144,45176
  .long 43008,43040,43024,43056,47104,47136,47120,47152,43016,43048,43032,43064,47112,47144,47128,47160
  .long 43072,43104,43088,43120,47168,47200,47184,47216,43080,43112,43096,43128,47176,47208,47192,47224
  .long 57344,57376,57360,57392,61440,61472,61456,61488,57352,57384,57368,57400,61448,61480,61464,61496
  .long 57408,57440,57424,57456,61504,61536,61520,61552,57416,57448,57432,57464,61512,61544,61528,61560
  .long 59392,59424,59408,59440,63488,63520,63504,63536,59400,59432,59416,59448,63496,63528,63512,63544
  .long 59456,59488,59472,59504,63552,63584,63568,63600,59464,59496,59480,59512,63560,63592,63576,63608
  .long 73728,73760,73744,73776,77824,77856,77840,77872,73736,73768,73752,73784,77832,77864,77848,77880
  .long 73792,73824,73808,73840,77888,77920,77904,77936,73800,73832,73816,73848,77896,77928,77912,77944
  .long 75776,75808,75792,75824,79872,79904,79888,79920,75784,75816,75800,75832,79880,79912,79896,79928
  .long 75840,75872,75856,75888,79936,79968,79952,79984,75848,75880,75864,75896,79944,79976,79960,79992
  .long 0,8,16,24,3104,3112,3120,3128,192,200,208,216,3296,3304,3312,3320
  .long 384,392,400,408,3488,3496,3504,3512,576,584,592,600,3680,3688,3696,3704
  .long 768,776,784,792,3872,3880,3888,3896,960,968,976,984,4064,4072,4080,4088
  .long 1152,1160,1168,1176,4256,4264,4272,4280,1344,1352,1360,1368,4448,4456,4464,4472
  .long 96,104,112,120,3136,3144,3152,3160,288,296,304,312,3328,3336,3344,3352
  .long 480,488,496,504,3520,3528,3536,3544,672,680,688,696,3712,3720,3728,3736
  .long 864,872,880,888,3904,3912,3920,3928,1056,1064,1072,1080,4096,4104,4112,4120
  .long 1248,1256,1264,1272,4288,4296,4304,4312,1440,1448,1456,1464,4480,4488,4496,4504
  .long 0,8,16,24,3104,3112,3120,3128,192,200,208,216,3296,3304,3312,3320
  .long 384,392,400,408,3488,3496,3504,3512,576,584,592,600,3680,3688,3696,3704
  .long 768,776,784,792,3872,3880,3888,3896,960,968,976,984,4064,4072,4080,4088
  .long 1152,1160,1168,1176,4256,4264,4272,4280,1344,1352,1360,1368,4448,4456,4464,4472
  .long 96,104,112,120,3136,3144,3152,3160,288,296,304,312,3328,3336,3344,3352
  .long 480,488,496,504,3520,3528,3536,3544,672,680,688,696,3712,3720,3728,3736
  .long 864,872,880,888,3904,3912,3920,3928,1056,1064,1072,1080,4096,4104,4112,4120
  .long 1248,1256,1264,1272,4288,4296,4304,4312,1440,1448,1456,1464,4480,4488,4496,4504
  .long 32,40,48,56,3072,3080,3088,3096,224,232,240,248,3264,3272,3280,3288
  .long 416,424,432,440,3456,3464,3472,3480,608,616,624,632,3648,3656,3664,3672
  .long 800,808,816,824,3840,3848,3856,3864,992,1000,1008,1016,4032,4040,4048,4056
  .long 1184,1192,1200,1208,4224,4232,4240,4248,1376,1384,1392,1400,4416,4424,4432,4440
  .long 128,136,144,152,3232,3240,3248,3256,320,328,336,344,3424,3432,3440,3448
  .long 512,520,528,536,3616,3624,3632,3640,704,712,720,728,3808,3816,3824,3832
  .long 896,904,912,920,4000,4008,4016,4024,1088,1096,1104,1112,4192,4200,4208,4216
  .long 1280,1288,1296,1304,4384,4392,4400,4408,1472,1480,1488,1496,4576,4584,4592,4600
  .long 32,40,48,56,3072,3080,3088,3096,224,232,240,248,3264,3272,3280,3288
  .long 416,424,432,440,3456,3464,3472,3480,608,616,624,632,3648,3656,3664,3672
  .long 800,808,816,824,3840,3848,3856,3864,992,1000,1008,1016,4032,4040,4048,4056
  .long 1184,1192,1200,1208,4224,4232,4240,4248,1376,1384,1392,1400,4416,4424,4432,4440
  .long 128,136,144,152,3232,3240,3248,3256,320,328,336,344,3424,3432,3440,3448
  .long 512,520,528,536,3616,3624,3632,3640,704,712,720,728,3808,3816,3824,3832
  .long 896,904,912,920,4000,4008,4016,4024,1088,1096,1104,1112,4192,4200,4208,4216
  .long 1280,1288,1296,1304,4384,4392,4400,4408,1472,1480,1488,1496,4576,4584,4592,4600
  .long 64,72,80,88,3168,3176,3184,3192,256,264,272,280,3360,3368,3376,3384
  .long 448,456,464,472,3552,3560,3568,3576,640,648,656,664,3744,3752,3760,3768
  .long 832,840,848,856,3936,3944,3952,3960,1024,1032,1040,1048,4128,4136,4144,4152
  .long 1216,1224,1232,1240,4320,4328,4336,4344,1408,1416,1424,1432,4512,4520,4528,4536
  .long 160,168,176,184,3200,3208,3216,3224,352,360,368,376,3392,3400,3408,3416
  .long 544,552,560,568,3584,3592,3600,3608,736,744,752,760,3776,3784,3792,3800
  .long 928,936,944,952,3968,3976,3984,3992,1120,1128,1136,1144,4160,4168,4176,4184
  .long 1312,1320,1328,1336,4352,4360,4368,4376,1504,1512,1520,1528,4544,4552,4560,4568
  .long 64,72,80,88,3168,3176,3184,3192,256,264,272,280,3360,3368,3376,3384
  .long 448,456,464,472,3552,3560,3568,3576,640,648,656,664,3744,3752,3760,3768
  .long 832,840,848,856,3936,3944,3952,3960,1024,1032,1040,1048,4128,4136,4144,4152
  .long 1216,1224,1232,1240,4320,4328,4336,4344,1408,1416,1424,1432,4512,4520,4528,4536
  .long 160,168,176,184,3200,3208,3216,3224,352,360,368,376,3392,3400,3408,3416
  .long 544,552,560,568,3584,3592,3600,3608,736,744,752,760,3776,3784,3792,3800
  .long 928,936,944,952,3968,3976,3984,3992,1120,1128,1136,1144,4160,4168,4176,4184
  .long 1312,1320,1328,1336,4352,4360,4368,4376,1504,1512,1520,1528,4544,4552,4560,4568
  .long 0,16,32,48,64,80,96,112,128,144,160,176,12288,12304,12320,12336
  .long 12352,12368,12384,12400,12416,12432,12448,12464,24576,24592,24608,24624,24640,24656,24672,24688
  .long 24704,24720,24736,24752,36864,36880,36896,36912,36928,36944,36960,36976,36992,37008,37024,37040
  .long 49152,49168,49184,49200,49216,49232,49248,49264,49280,49296,49312,49328,61440,61456,61472,61488
  .long 393216,393232,393248,393264,393280,393296,393312,393328,393344,393360,393376,393392,405504,405520,405536,405552
  .long 405568,405584,405600,405616,405632,405648,405664,405680,417792,417808,417824,417840,417856,417872,417888,417904
  .long 417920,417936,417952,417968,430080,430096,430112,430128,430144,430160,430176,430192,430208,430224,430240,430256
  .long 442368,442384,442400,442416,442432,442448,442464,442480,442496,442512,442528,442544,454656,454672,454688,454704
  .long 786432,786448,786464,786480,786496,786512,786528,786544,786560,786576,786592,786608,798720,798736,798752,798768
  .long 798784,798800,798816,798832,798848,798864,798880,798896,811008,811024,811040,811056,811072,811088,811104,811120
  .long 811136,811152,811168,811184,823296,823312,823328,823344,823360,823376,823392,823408,823424,823440,823456,823472
  .long 835584,835600,835616,835632,835648,835664,835680,835696,835712,835728,835744,835760,847872,847888,847904,847920
  .long 1179648,1179664,1179680,1179696,1179712,1179728,1179744,1179760,1179776,1179792,1179808,1179824,1191936,1191952,1191968,1191984
  .long 1192000,1192016,1192032,1192048,1192064,1192080,1192096,1192112,1204224,1204240,1204256,1204272,1204288,1204304,1204320,1204336
  .long 1204352,1204368,1204384,1204400,1216512,1216528,1216544,1216560,1216576,1216592,1216608,1216624,1216640,1216656,1216672,1216688
  .long 1228800,1228816,1228832,1228848,1228864,1228880,1228896,1228912,1228928,1228944,1228960,1228976,1241088,1241104,1241120,1241136
  .long 61504,61520,61536,61552,61568,61584,61600,61616,73728,73744,73760,73776,73792,73808,73824,73840
  .long 73856,73872,73888,73904,86016,86032,86048,86064,86080,86096,86112,86128,86144,86160,86176,86192
  .long 98304,98320,98336,98352,98368,98384,98400,98416,98432,98448,98464,98480,110592,110608,110624,110640
  .long 110656,110672,110688,110704,110720,110736,110752,110768,122880,122896,122912,122928,122944,122960,122976,122992
  .long 454720,454736,454752,454768,454784,454800,454816,454832,466944,466960,466976,466992,467008,467024,467040,467056
  .long 467072,467088,467104,467120,479232,479248,479264,479280,479296,479312,479328,479344,479360,479376,479392,479408
  .long 491520,491536,491552,491568,491584,491600,491616,491632,491648,491664,491680,491696,503808,503824,503840,503856
  .long 503872,503888,503904,503920,503936,503952,503968,503984,516096,516112,516128,516144,516160,516176,516192,516208
  .long 847936,847952,847968,847984,848000,848016,848032,848048,860160,860176,860192,860208,860224,860240,860256,860272
  .long 860288,860304,860320,860336,872448,872464,872480,872496,872512,872528,872544,872560,872576,872592,872608,872624
  .long 884736,884752,884768,884784,884800,884816,884832,884848,884864,884880,884896,884912,897024,897040,897056,897072
  .long 897088,897104,897120,897136,897152,897168,897184,897200,909312,909328,909344,909360,909376,909392,909408,909424
  .long 1241152,1241168,1241184,1241200,1241216,1241232,1241248,1241264,1253376,1253392,1253408,1253424,1253440,1253456,1253472,1253488
  .long 1253504,1253520,1253536,1253552,1265664,1265680,1265696,1265712,1265728,1265744,1265760,1265776,1265792,1265808,1265824,1265840
  .long 1277952,1277968,1277984,1278000,1278016,1278032,1278048,1278064,1278080,1278096,1278112,1278128,1290240,1290256,1290272,1290288
  .long 1290304,1290320,1290336,1290352,1290368,1290384,1290400,1290416,1302528,1302544,1302560,1302576,1302592,1302608,1302624,1302640
  .long 123008,123024,123040,123056,135168,135184,135200,135216,135232,135248,135264,135280,135296,135312,135328,135344
  .long 147456,147472,147488,147504,147520,147536,147552,147568,147584,147600,147616,147632,159744,159760,159776,159792
  .long 159808,159824,159840,159856,159872,159888,159904,159920,172032,172048,172064,172080,172096,172112,172128,172144
  .long 172160,172176,172192,172208,184320,184336,184352,184368,184384,184400,184416,184432,184448,184464,184480,184496
  .long 516224,516240,516256,516272,528384,528400,528416,528432,528448,528464,528480,528496,528512,528528,528544,528560
  .long 540672,540688,540704,540720,540736,540752,540768,540784,540800,540816,540832,540848,552960,552976,552992,553008
  .long 553024,553040,553056,553072,553088,553104,553120,553136,565248,565264,565280,565296,565312,565328,565344,565360
  .long 565376,565392,565408,565424,577536,577552,577568,577584,577600,577616,577632,577648,577664,577680,577696,577712
  .long 909440,909456,909472,909488,921600,921616,921632,921648,921664,921680,921696,921712,921728,921744,921760,921776
  .long 933888,933904,933920,933936,933952,933968,933984,934000,934016,934032,934048,934064,946176,946192,946208,946224
  .long 946240,946256,946272,946288,946304,946320,946336,946352,958464,958480,958496,958512,958528,958544,958560,958576
  .long 958592,958608,958624,958640,970752,970768,970784,970800,970816,970832,970848,970864,970880,970896,970912,970928
  .long 1302656,1302672,1302688,1302704,1314816,1314832,1314848,1314864,1314880,1314896,1314912,1314928,1314944,1314960,1314976,1314992
  .long 1327104,1327120,1327136,1327152,1327168,1327184,1327200,1327216,1327232,1327248,1327264,1327280,1339392,1339408,1339424,1339440
  .long 1339456,1339472,1339488,1339504,1339520,1339536,1339552,1339568,1351680,1351696,1351712,1351728,1351744,1351760,1351776,1351792
  .long 1351808,1351824,1351840,1351856,1363968,1363984,1364000,1364016,1364032,1364048,1364064,1364080,1364096,1364112,1364128,1364144
  .long 196640,196656,196608,196624,196704,196720,196672,196688,196768,196784,196736,196752,208928,208944,208896,208912
  .long 208992,209008,208960,208976,209056,209072,209024,209040,221216,221232,221184,221200,221280,221296,221248,221264
  .long 221344,221360,221312,221328,233504,233520,233472,233488,233568,233584,233536,233552,233632,233648,233600,233616
  .long 245792,245808,245760,245776,245856,245872,245824,245840,245920,245936,245888,245904,258080,258096,258048,258064
  .long 589856,589872,589824,589840,589920,589936,589888,589904,589984,590000,589952,589968,602144,602160,602112,602128
  .long 602208,602224,602176,602192,602272,602288,602240,602256,614432,614448,614400,614416,614496,614512,614464,614480
  .long 614560,614576,614528,614544,626720,626736,626688,626704,626784,626800,626752,626768,626848,626864,626816,626832
  .long 639008,639024,638976,638992,639072,639088,639040,639056,639136,639152,639104,639120,651296,651312,651264,651280
  .long 983072,983088,983040,983056,983136,983152,983104,983120,983200,983216,983168,983184,995360,995376,995328,995344
  .long 995424,995440,995392,995408,995488,995504,995456,995472,1007648,1007664,1007616,1007632,1007712,1007728,1007680,1007696
  .long 1007776,1007792,1007744,1007760,1019936,1019952,1019904,1019920,1020000,1020016,1019968,1019984,1020064,1020080,1020032,1020048
  .long 1032224,1032240,1032192,1032208,1032288,1032304,1032256,1032272,1032352,1032368,1032320,1032336,1044512,1044528,1044480,1044496
  .long 1376288,1376304,1376256,1376272,1376352,1376368,1376320,1376336,1376416,1376432,1376384,1376400,1388576,1388592,1388544,1388560
  .long 1388640,1388656,1388608,1388624,1388704,1388720,1388672,1388688,1400864,1400880,1400832,1400848,1400928,1400944,1400896,1400912
  .long 1400992,1401008,1400960,1400976,1413152,1413168,1413120,1413136,1413216,1413232,1413184,1413200,1413280,1413296,1413248,1413264
  .long 1425440,1425456,1425408,1425424,1425504,1425520,1425472,1425488,1425568,1425584,1425536,1425552,1437728,1437744,1437696,1437712
  .long 258144,258160,258112,258128,258208,258224,258176,258192,270368,270384,270336,270352,270432,270448,270400,270416
  .long 270496,270512,270464,270480,282656,282672,282624,282640,282720,282736,282688,282704,282784,282800,282752,282768
  .long 294944,294960,294912,294928,295008,295024,294976,294992,295072,295088,295040,295056,307232,307248,307200,307216
  .long 307296,307312,307264,307280,307360,307376,307328,307344,319520,319536,319488,319504,319584,319600,319552,319568
  .long 651360,651376,651328,651344,651424,651440,651392,651408,663584,663600,663552,663568,663648,663664,663616,663632
  .long 663712,663728,663680,663696,675872,675888,675840,675856,675936,675952,675904,675920,676000,676016,675968,675984
  .long 688160,688176,688128,688144,688224,688240,688192,688208,688288,688304,688256,688272,700448,700464,700416,700432
  .long 700512,700528,700480,700496,700576,700592,700544,700560,712736,712752,712704,712720,712800,712816,712768,712784
  .long 1044576,1044592,1044544,1044560,1044640,1044656,1044608,1044624,1056800,1056816,1056768,1056784,1056864,1056880,1056832,1056848
  .long 1056928,1056944,1056896,1056912,1069088,1069104,1069056,1069072,1069152,1069168,1069120,1069136,1069216,1069232,1069184,1069200
  .long 1081376,1081392,1081344,1081360,1081440,1081456,1081408,1081424,1081504,1081520,1081472,1081488,1093664,1093680,1093632,1093648
  .long 1093728,1093744,1093696,1093712,1093792,1093808,1093760,1093776,1105952,1105968,1105920,1105936,1106016,1106032,1105984,1106000
  .long 1437792,1437808,1437760,1437776,1437856,1437872,1437824,1437840,1450016,1450032,1449984,1450000,1450080,1450096,1450048,1450064
  .long 1450144,1450160,1450112,1450128,1462304,1462320,1462272,1462288,1462368,1462384,1462336,1462352,1462432,1462448,1462400,1462416
  .long 1474592,1474608,1474560,1474576,1474656,1474672,1474624,1474640,1474720,1474736,1474688,1474704,1486880,1486896,1486848,1486864
  .long 1486944,1486960,1486912,1486928,1487008,1487024,1486976,1486992,1499168,1499184,1499136,1499152,1499232,1499248,1499200,1499216
  .long 319648,319664,319616,319632,331808,331824,331776,331792,331872,331888,331840,331856,331936,331952,331904,331920
  .long 344096,344112,344064,344080,344160,344176,344128,344144,344224,344240,344192,344208,356384,356400,356352,356368
  .long 356448,356464,356416,356432,356512,356528,356480,356496,368672,368688,368640,368656,368736,368752,368704,368720
  .long 368800,368816,368768,368784,380960,380976,380928,380944,381024,381040,380992,381008,381088,381104,381056,381072
  .long 712864,712880,712832,712848,725024,725040,724992,725008,725088,725104,725056,725072,725152,725168,725120,725136
  .long 737312,737328,737280,737296,737376,737392,737344,737360,737440,737456,737408,737424,749600,749616,749568,749584
  .long 749664,749680,749632,749648,749728,749744,749696,749712,761888,761904,761856,761872,761952,761968,761920,761936
  .long 762016,762032,761984,762000,774176,774192,774144,774160,774240,774256,774208,774224,774304,774320,774272,774288
  .long 1106080,1106096,1106048,1106064,1118240,1118256,1118208,1118224,1118304,1118320,1118272,1118288,1118368,1118384,1118336,1118352
  .long 1130528,1130544,1130496,1130512,1130592,1130608,1130560,1130576,1130656,1130672,1130624,1130640,1142816,1142832,1142784,1142800
  .long 1142880,1142896,1142848,1142864,1142944,1142960,1142912,1142928,1155104,1155120,1155072,1155088,1155168,1155184,1155136,1155152
  .long 1155232,1155248,1155200,1155216,1167392,1167408,1167360,1167376,1167456,1167472,1167424,1167440,1167520,1167536,1167488,1167504
  .long 1499296,1499312,1499264,1499280,1511456,1511472,1511424,1511440,1511520,1511536,1511488,1511504,1511584,1511600,1511552,1511568
  .long 1523744,1523760,1523712,1523728,1523808,1523824,1523776,1523792,1523872,1523888,1523840,1523856,1536032,1536048,1536000,1536016
  .long 1536096,1536112,1536064,1536080,1536160,1536176,1536128,1536144,1548320,1548336,1548288,1548304,1548384,1548400,1548352,1548368
  .long 1548448,1548464,1548416,1548432,1560608,1560624,1560576,1560592,1560672,1560688,1560640,1560656,1560736,1560752,1560704,1560720
  .long 0,16,32,48,64,80,96,112,128,144,160,176,192,208,224,240
  .long 256,272,288,304,1280,1296,1312,1328,1344,1360,1376,1392,1408,1424,1440,1456
  .long 1472,1488,1504,1520,1536,1552,1568,1584,2560,2576,2592,2608,2624,2640,2656,2672
  .long 2688,2704,2720,2736,2752,2768,2784,2800,2816,2832,2848,2864,3840,3856,3872,3888
  .long 20480,20496,20512,20528,20544,20560,20576,20592,20608,20624,20640,20656,20672,20688,20704,20720
  .long 20736,20752,20768,20784,21760,21776,21792,21808,21824,21840,21856,21872,21888,21904,21920,21936
  .long 21952,21968,21984,22000,22016,22032,22048,22064,23040,23056,23072,23088,23104,23120,23136,23152
  .long 23168,23184,23200,23216,23232,23248,23264,23280,23296,23312,23328,23344,24320,24336,24352,24368
  .long 40960,40976,40992,41008,41024,41040,41056,41072,41088,41104,41120,41136,41152,41168,41184,41200
  .long 41216,41232,41248,41264,42240,42256,42272,42288,42304,42320,42336,42352,42368,42384,42400,42416
  .long 42432,42448,42464,42480,42496,42512,42528,42544,43520,43536,43552,43568,43584,43600,43616,43632
  .long 43648,43664,43680,43696,43712,43728,43744,43760,43776,43792,43808,43824,44800,44816,44832,44848
  .long 61440,61456,61472,61488,61504,61520,61536,61552,61568,61584,61600,61616,61632,61648,61664,61680
  .long 61696,61712,61728,61744,62720,62736,62752,62768,62784,62800,62816,62832,62848,62864,62880,62896
  .long 62912,62928,62944,62960,62976,62992,63008,63024,64000,64016,64032,64048,64064,64080,64096,64112
  .long 64128,64144,64160,64176,64192,64208,64224,64240,64256,64272,64288,64304,65280,65296,65312,65328
  .long 3904,3920,3936,3952,3968,3984,4000,4016,4032,4048,4064,4080,4096,4112,4128,4144
  .long 5120,5136,5152,5168,5184,5200,5216,5232,5248,5264,5280,5296,5312,5328,5344,5360
  .long 5376,5392,5408,5424,6400,6416,6432,6448,6464,6480,6496,6512,6528,6544,6560,6576
  .long 6592,6608,6624,6640,6656,6672,6688,6704,7680,7696,7712,7728,7744,7760,7776,7792
  .long 24384,24400,24416,24432,24448,24464,24480,24496,24512,24528,24544,24560,24576,24592,24608,24624
  .long 25600,25616,25632,25648,25664,25680,25696,25712,25728,25744,25760,25776,25792,25808,25824,25840
  .long 25856,25872,25888,25904,26880,26896,26912,26928,26944,26960,26976,26992,27008,27024,27040,27056
  .long 27072,27088,27104,27120,27136,27152,27168,27184,28160,28176,28192,28208,28224,28240,28256,28272
  .long 44864,44880,44896,44912,44928,44944,44960,44976,44992,45008,45024,45040,45056,45072,45088,45104
  .long 46080,46096,46112,46128,46144,46160,46176,46192,46208,46224,46240,46256,46272,46288,46304,46320
  .long 46336,46352,46368,46384,47360,47376,47392,47408,47424,47440,47456,47472,47488,47504,47520,47536
  .long 47552,47568,47584,47600,47616,47632,47648,47664,48640,48656,48672,48688,48704,48720,48736,48752
  .long 65344,65360,65376,65392,65408,65424,65440,65456,65472,65488,65504,65520,65536,65552,65568,65584
  .long 66560,66576,66592,66608,66624,66640,66656,66672,66688,66704,66720,66736,66752,66768,66784,66800
  .long 66816,66832,66848,66864,67840,67856,67872,67888,67904,67920,67936,67952,67968,67984,68000,68016
  .long 68032,68048,68064,68080,68096,68112,68128,68144,69120,69136,69152,69168,69184,69200,69216,69232
  .long 7808,7824,7840,7856,7872,7888,7904,7920,7936,7952,7968,7984,8960,8976,8992,9008
  .long 9024,9040,9056,9072,9088,9104,9120,9136,9152,9168,9184,9200,9216,9232,9248,9264
  .long 10240,10256,10272,10288,10304,10320,10336,10352,10368,10384,10400,10416,10432,10448,10464,10480
  .long 10496,10512,10528,10544,11520,11536,11552,11568,11584,11600,11616,11632,11648,11664,11680,11696
  .long 28288,28304,28320,28336,28352,28368,28384,28400,28416,28432,28448,28464,29440,29456,29472,29488
  .long 29504,29520,29536,29552,29568,29584,29600,29616,29632,29648,29664,29680,29696,29712,29728,29744
  .long 30720,30736,30752,30768,30784,30800,30816,30832,30848,30864,30880,30896,30912,30928,30944,30960
  .long 30976,30992,31008,31024,32000,32016,32032,32048,32064,32080,32096,32112,32128,32144,32160,32176
  .long 48768,48784,48800,48816,48832,48848,48864,48880,48896,48912,48928,48944,49920,49936,49952,49968
  .long 49984,50000,50016,50032,50048,50064,50080,50096,50112,50128,50144,50160,50176,50192,50208,50224
  .long 51200,51216,51232,51248,51264,51280,51296,51312,51328,51344,51360,51376,51392,51408,51424,51440
  .long 51456,51472,51488,51504,52480,52496,52512,52528,52544,52560,52576,52592,52608,52624,52640,52656
  .long 69248,69264,69280,69296,69312,69328,69344,69360,69376,69392,69408,69424,70400,70416,70432,70448
  .long 70464,70480,70496,70512,70528,70544,70560,70576,70592,70608,70624,70640,70656,70672,70688,70704
  .long 71680,71696,71712,71728,71744,71760,71776,71792,71808,71824,71840,71856,71872,71888,71904,71920
  .long 71936,71952,71968,71984,72960,72976,72992,73008,73024,73040,73056,73072,73088,73104,73120,73136
  .long 11712,11728,11744,11760,11776,11792,11808,11824,12800,12816,12832,12848,12864,12880,12896,12912
  .long 12928,12944,12960,12976,12992,13008,13024,13040,13056,13072,13088,13104,14080,14096,14112,14128
  .long 14144,14160,14176,14192,14208,14224,14240,14256,14272,14288,14304,14320,14336,14352,14368,14384
  .long 15360,15376,15392,15408,15424,15440,15456,15472,15488,15504,15520,15536,15552,15568,15584,15600
  .long 32192,32208,32224,32240,32256,32272,32288,32304,33280,33296,33312,33328,33344,33360,33376,33392
  .long 33408,33424,33440,33456,33472,33488,33504,33520,33536,33552,33568,33584,34560,34576,34592,34608
  .long 34624,34640,34656,34672,34688,34704,34720,34736,34752,34768,34784,34800,34816,34832,34848,34864
  .long 35840,35856,35872,35888,35904,35920,35936,35952,35968,35984,36000,36016,36032,36048,36064,36080
  .long 52672,52688,52704,52720,52736,52752,52768,52784,53760,53776,53792,53808,53824,53840,53856,53872
  .long 53888,53904,53920,53936,53952,53968,53984,54000,54016,54032,54048,54064,55040,55056,55072,55088
  .long 55104,55120,55136,55152,55168,55184,55200,55216,55232,55248,55264,55280,55296,55312,55328,55344
  .long 56320,56336,56352,56368,56384,56400,56416,56432,56448,56464,56480,56496,56512,56528,56544,56560
  .long 73152,73168,73184,73200,73216,73232,73248,73264,74240,74256,74272,74288,74304,74320,74336,74352
  .long 74368,74384,74400,74416,74432,74448,74464,74480,74496,74512,74528,74544,75520,75536,75552,75568
  .long 75584,75600,75616,75632,75648,75664,75680,75696,75712,75728,75744,75760,75776,75792,75808,75824
  .long 76800,76816,76832,76848,76864,76880,76896,76912,76928,76944,76960,76976,76992,77008,77024,77040
  .long 15616,15632,15648,15664,16640,16656,16672,16688,16704,16720,16736,16752,16768,16784,16800,16816
  .long 16832,16848,16864,16880,16896,16912,16928,16944,17920,17936,17952,17968,17984,18000,18016,18032
  .long 18048,18064,18080,18096,18112,18128,18144,18160,18176,18192,18208,18224,19200,19216,19232,19248
  .long 19264,19280,19296,19312,19328,19344,19360,19376,19392,19408,19424,19440,19456,19472,19488,19504
  .long 36096,36112,36128,36144,37120,37136,37152,37168,37184,37200,37216,37232,37248,37264,37280,37296
  .long 37312,37328,37344,37360,37376,37392,37408,37424,38400,38416,38432,38448,38464,38480,38496,38512
  .long 38528,38544,38560,38576,38592,38608,38624,38640,38656,38672,38688,38704,39680,39696,39712,39728
  .long 39744,39760,39776,39792,39808,39824,39840,39856,39872,39888,39904,39920,39936,39952,39968,39984
  .long 56576,56592,56608,56624,57600,57616,57632,57648,57664,57680,57696,57712,57728,57744,57760,57776
  .long 57792,57808,57824,57840,57856,57872,57888,57904,58880,58896,58912,58928,58944,58960,58976,58992
  .long 59008,59024,59040,59056,59072,59088,59104,59120,59136,59152,59168,59184,60160,60176,60192,60208
  .long 60224,60240,60256,60272,60288,60304,60320,60336,60352,60368,60384,60400,60416,60432,60448,60464
  .long 77056,77072,77088,77104,78080,78096,78112,78128,78144,78160,78176,78192,78208,78224,78240,78256
  .long 78272,78288,78304,78320,78336,78352,78368,78384,79360,79376,79392,79408,79424,79440,79456,79472
  .long 79488,79504,79520,79536,79552,79568,79584,79600,79616,79632,79648,79664,80640,80656,80672,80688
  .long 80704,80720,80736,80752,80768,80784,80800,80816,80832,80848,80864,80880,80896,80912,80928,80944
  .long 0,8,16,24,320,328,336,344,640,648,656,664,960,968,976,984
  .long 2560,2568,2576,2584,2880,2888,2896,2904,3200,3208,3216,3224,3520,3528,3536,3544
  .long 5120,5128,5136,5144,5440,5448,5456,5464,5760,5768,5776,5784,6080,6088,6096,6104
  .long 7680,7688,7696,7704,8000,8008,8016,8024,8320,8328,8336,8344,8640,8648,8656,8664
  .long 0,8,16,24,320,328,336,344,640,648,656,664,960,968,976,984
  .long 2560,2568,2576,2584,2880,2888,2896,2904,3200,3208,3216,3224,3520,3528,3536,3544
  .long 5120,5128,5136,5144,5440,5448,5456,5464,5760,5768,5776,5784,6080,6088,6096,6104
  .long 7680,7688,7696,7704,8000,8008,8016,8024,8320,8328,8336,8344,8640,8648,8656,8664
  .long 0,8,16,24,320,328,336,344,640,648,656,664,960,968,976,984
  .long 2560,2568,2576,2584,2880,2888,2896,2904,3200,3208,3216,3224,3520,3528,3536,3544
  .long 5120,5128,5136,5144,5440,5448,5456,5464,5760,5768,5776,5784,6080,6088,6096,6104
  .long 7680,7688,7696,7704,8000,8008,8016,8024,8320,8328,8336,8344,8640,8648,8656,8664
  .long 0,8,16,24,320,328,336,344,640,648,656,664,960,968,976,984
  .long 2560,2568,2576,2584,2880,2888,2896,2904,3200,3208,3216,3224,3520,3528,3536,3544
  .long 5120,5128,5136,5144,5440,5448,5456,5464,5760,5768,5776,5784,6080,6088,6096,6104
  .long 7680,7688,7696,7704,8000,8008,8016,8024,8320,8328,8336,8344,8640,8648,8656,8664
.p2align 8
L_table_qkv:
  .long 0,16,32,48,64,80,96,112,128,144,160,176,192,208,224,240
  .long 256,272,288,304,320,336,352,368,12288,12304,12320,12336,12352,12368,12384,12400
  .long 12416,12432,12448,12464,12480,12496,12512,12528,12544,12560,12576,12592,12608,12624,12640,12656
  .long 24576,24592,24608,24624,24640,24656,24672,24688,24704,24720,24736,24752,24768,24784,24800,24816
  .long 196608,196624,196640,196656,196672,196688,196704,196720,196736,196752,196768,196784,196800,196816,196832,196848
  .long 196864,196880,196896,196912,196928,196944,196960,196976,208896,208912,208928,208944,208960,208976,208992,209008
  .long 209024,209040,209056,209072,209088,209104,209120,209136,209152,209168,209184,209200,209216,209232,209248,209264
  .long 221184,221200,221216,221232,221248,221264,221280,221296,221312,221328,221344,221360,221376,221392,221408,221424
  .long 393216,393232,393248,393264,393280,393296,393312,393328,393344,393360,393376,393392,393408,393424,393440,393456
  .long 393472,393488,393504,393520,393536,393552,393568,393584,405504,405520,405536,405552,405568,405584,405600,405616
  .long 405632,405648,405664,405680,405696,405712,405728,405744,405760,405776,405792,405808,405824,405840,405856,405872
  .long 417792,417808,417824,417840,417856,417872,417888,417904,417920,417936,417952,417968,417984,418000,418016,418032
  .long 589824,589840,589856,589872,589888,589904,589920,589936,589952,589968,589984,590000,590016,590032,590048,590064
  .long 590080,590096,590112,590128,590144,590160,590176,590192,602112,602128,602144,602160,602176,602192,602208,602224
  .long 602240,602256,602272,602288,602304,602320,602336,602352,602368,602384,602400,602416,602432,602448,602464,602480
  .long 614400,614416,614432,614448,614464,614480,614496,614512,614528,614544,614560,614576,614592,614608,614624,614640
  .long 24832,24848,24864,24880,24896,24912,24928,24944,36864,36880,36896,36912,36928,36944,36960,36976
  .long 36992,37008,37024,37040,37056,37072,37088,37104,37120,37136,37152,37168,37184,37200,37216,37232
  .long 49152,49168,49184,49200,49216,49232,49248,49264,49280,49296,49312,49328,49344,49360,49376,49392
  .long 49408,49424,49440,49456,49472,49488,49504,49520,61440,61456,61472,61488,61504,61520,61536,61552
  .long 221440,221456,221472,221488,221504,221520,221536,221552,233472,233488,233504,233520,233536,233552,233568,233584
  .long 233600,233616,233632,233648,233664,233680,233696,233712,233728,233744,233760,233776,233792,233808,233824,233840
  .long 245760,245776,245792,245808,245824,245840,245856,245872,245888,245904,245920,245936,245952,245968,245984,246000
  .long 246016,246032,246048,246064,246080,246096,246112,246128,258048,258064,258080,258096,258112,258128,258144,258160
  .long 418048,418064,418080,418096,418112,418128,418144,418160,430080,430096,430112,430128,430144,430160,430176,430192
  .long 430208,430224,430240,430256,430272,430288,430304,430320,430336,430352,430368,430384,430400,430416,430432,430448
  .long 442368,442384,442400,442416,442432,442448,442464,442480,442496,442512,442528,442544,442560,442576,442592,442608
  .long 442624,442640,442656,442672,442688,442704,442720,442736,454656,454672,454688,454704,454720,454736,454752,454768
  .long 614656,614672,614688,614704,614720,614736,614752,614768,626688,626704,626720,626736,626752,626768,626784,626800
  .long 626816,626832,626848,626864,626880,626896,626912,626928,626944,626960,626976,626992,627008,627024,627040,627056
  .long 638976,638992,639008,639024,639040,639056,639072,639088,639104,639120,639136,639152,639168,639184,639200,639216
  .long 639232,639248,639264,639280,639296,639312,639328,639344,651264,651280,651296,651312,651328,651344,651360,651376
  .long 61568,61584,61600,61616,61632,61648,61664,61680,61696,61712,61728,61744,61760,61776,61792,61808
  .long 73728,73744,73760,73776,73792,73808,73824,73840,73856,73872,73888,73904,73920,73936,73952,73968
  .long 73984,74000,74016,74032,74048,74064,74080,74096,86016,86032,86048,86064,86080,86096,86112,86128
  .long 86144,86160,86176,86192,86208,86224,86240,86256,86272,86288,86304,86320,86336,86352,86368,86384
  .long 258176,258192,258208,258224,258240,258256,258272,258288,258304,258320,258336,258352,258368,258384,258400,258416
  .long 270336,270352,270368,270384,270400,270416,270432,270448,270464,270480,270496,270512,270528,270544,270560,270576
  .long 270592,270608,270624,270640,270656,270672,270688,270704,282624,282640,282656,282672,282688,282704,282720,282736
  .long 282752,282768,282784,282800,282816,282832,282848,282864,282880,282896,282912,282928,282944,282960,282976,282992
  .long 454784,454800,454816,454832,454848,454864,454880,454896,454912,454928,454944,454960,454976,454992,455008,455024
  .long 466944,466960,466976,466992,467008,467024,467040,467056,467072,467088,467104,467120,467136,467152,467168,467184
  .long 467200,467216,467232,467248,467264,467280,467296,467312,479232,479248,479264,479280,479296,479312,479328,479344
  .long 479360,479376,479392,479408,479424,479440,479456,479472,479488,479504,479520,479536,479552,479568,479584,479600
  .long 651392,651408,651424,651440,651456,651472,651488,651504,651520,651536,651552,651568,651584,651600,651616,651632
  .long 663552,663568,663584,663600,663616,663632,663648,663664,663680,663696,663712,663728,663744,663760,663776,663792
  .long 663808,663824,663840,663856,663872,663888,663904,663920,675840,675856,675872,675888,675904,675920,675936,675952
  .long 675968,675984,676000,676016,676032,676048,676064,676080,676096,676112,676128,676144,676160,676176,676192,676208
  .long 98304,98320,98336,98352,98368,98384,98400,98416,98432,98448,98464,98480,98496,98512,98528,98544
  .long 98560,98576,98592,98608,98624,98640,98656,98672,110592,110608,110624,110640,110656,110672,110688,110704
  .long 110720,110736,110752,110768,110784,110800,110816,110832,110848,110864,110880,110896,110912,110928,110944,110960
  .long 122880,122896,122912,122928,122944,122960,122976,122992,123008,123024,123040,123056,123072,123088,123104,123120
  .long 294912,294928,294944,294960,294976,294992,295008,295024,295040,295056,295072,295088,295104,295120,295136,295152
  .long 295168,295184,295200,295216,295232,295248,295264,295280,307200,307216,307232,307248,307264,307280,307296,307312
  .long 307328,307344,307360,307376,307392,307408,307424,307440,307456,307472,307488,307504,307520,307536,307552,307568
  .long 319488,319504,319520,319536,319552,319568,319584,319600,319616,319632,319648,319664,319680,319696,319712,319728
  .long 491520,491536,491552,491568,491584,491600,491616,491632,491648,491664,491680,491696,491712,491728,491744,491760
  .long 491776,491792,491808,491824,491840,491856,491872,491888,503808,503824,503840,503856,503872,503888,503904,503920
  .long 503936,503952,503968,503984,504000,504016,504032,504048,504064,504080,504096,504112,504128,504144,504160,504176
  .long 516096,516112,516128,516144,516160,516176,516192,516208,516224,516240,516256,516272,516288,516304,516320,516336
  .long 688128,688144,688160,688176,688192,688208,688224,688240,688256,688272,688288,688304,688320,688336,688352,688368
  .long 688384,688400,688416,688432,688448,688464,688480,688496,700416,700432,700448,700464,700480,700496,700512,700528
  .long 700544,700560,700576,700592,700608,700624,700640,700656,700672,700688,700704,700720,700736,700752,700768,700784
  .long 712704,712720,712736,712752,712768,712784,712800,712816,712832,712848,712864,712880,712896,712912,712928,712944
  .long 123136,123152,123168,123184,123200,123216,123232,123248,135168,135184,135200,135216,135232,135248,135264,135280
  .long 135296,135312,135328,135344,135360,135376,135392,135408,135424,135440,135456,135472,135488,135504,135520,135536
  .long 147456,147472,147488,147504,147520,147536,147552,147568,147584,147600,147616,147632,147648,147664,147680,147696
  .long 147712,147728,147744,147760,147776,147792,147808,147824,159744,159760,159776,159792,159808,159824,159840,159856
  .long 319744,319760,319776,319792,319808,319824,319840,319856,331776,331792,331808,331824,331840,331856,331872,331888
  .long 331904,331920,331936,331952,331968,331984,332000,332016,332032,332048,332064,332080,332096,332112,332128,332144
  .long 344064,344080,344096,344112,344128,344144,344160,344176,344192,344208,344224,344240,344256,344272,344288,344304
  .long 344320,344336,344352,344368,344384,344400,344416,344432,356352,356368,356384,356400,356416,356432,356448,356464
  .long 516352,516368,516384,516400,516416,516432,516448,516464,528384,528400,528416,528432,528448,528464,528480,528496
  .long 528512,528528,528544,528560,528576,528592,528608,528624,528640,528656,528672,528688,528704,528720,528736,528752
  .long 540672,540688,540704,540720,540736,540752,540768,540784,540800,540816,540832,540848,540864,540880,540896,540912
  .long 540928,540944,540960,540976,540992,541008,541024,541040,552960,552976,552992,553008,553024,553040,553056,553072
  .long 712960,712976,712992,713008,713024,713040,713056,713072,724992,725008,725024,725040,725056,725072,725088,725104
  .long 725120,725136,725152,725168,725184,725200,725216,725232,725248,725264,725280,725296,725312,725328,725344,725360
  .long 737280,737296,737312,737328,737344,737360,737376,737392,737408,737424,737440,737456,737472,737488,737504,737520
  .long 737536,737552,737568,737584,737600,737616,737632,737648,749568,749584,749600,749616,749632,749648,749664,749680
  .long 159872,159888,159904,159920,159936,159952,159968,159984,160000,160016,160032,160048,160064,160080,160096,160112
  .long 172032,172048,172064,172080,172096,172112,172128,172144,172160,172176,172192,172208,172224,172240,172256,172272
  .long 172288,172304,172320,172336,172352,172368,172384,172400,184320,184336,184352,184368,184384,184400,184416,184432
  .long 184448,184464,184480,184496,184512,184528,184544,184560,184576,184592,184608,184624,184640,184656,184672,184688
  .long 356480,356496,356512,356528,356544,356560,356576,356592,356608,356624,356640,356656,356672,356688,356704,356720
  .long 368640,368656,368672,368688,368704,368720,368736,368752,368768,368784,368800,368816,368832,368848,368864,368880
  .long 368896,368912,368928,368944,368960,368976,368992,369008,380928,380944,380960,380976,380992,381008,381024,381040
  .long 381056,381072,381088,381104,381120,381136,381152,381168,381184,381200,381216,381232,381248,381264,381280,381296
  .long 553088,553104,553120,553136,553152,553168,553184,553200,553216,553232,553248,553264,553280,553296,553312,553328
  .long 565248,565264,565280,565296,565312,565328,565344,565360,565376,565392,565408,565424,565440,565456,565472,565488
  .long 565504,565520,565536,565552,565568,565584,565600,565616,577536,577552,577568,577584,577600,577616,577632,577648
  .long 577664,577680,577696,577712,577728,577744,577760,577776,577792,577808,577824,577840,577856,577872,577888,577904
  .long 749696,749712,749728,749744,749760,749776,749792,749808,749824,749840,749856,749872,749888,749904,749920,749936
  .long 761856,761872,761888,761904,761920,761936,761952,761968,761984,762000,762016,762032,762048,762064,762080,762096
  .long 762112,762128,762144,762160,762176,762192,762208,762224,774144,774160,774176,774192,774208,774224,774240,774256
  .long 774272,774288,774304,774320,774336,774352,774368,774384,774400,774416,774432,774448,774464,774480,774496,774512
  .long 0,16,32,48,384,400,416,432,768,784,800,816,1152,1168,1184,1200
  .long 3072,3088,3104,3120,3456,3472,3488,3504,3840,3856,3872,3888,4224,4240,4256,4272
  .long 6144,6160,6176,6192,6528,6544,6560,6576,6912,6928,6944,6960,7296,7312,7328,7344
  .long 9216,9232,9248,9264,9600,9616,9632,9648,9984,10000,10016,10032,10368,10384,10400,10416
  .long 96,112,128,144,480,496,512,528,864,880,896,912,1248,1264,1280,1296
  .long 3168,3184,3200,3216,3552,3568,3584,3600,3936,3952,3968,3984,4320,4336,4352,4368
  .long 6240,6256,6272,6288,6624,6640,6656,6672,7008,7024,7040,7056,7392,7408,7424,7440
  .long 9312,9328,9344,9360,9696,9712,9728,9744,10080,10096,10112,10128,10464,10480,10496,10512
  .long 192,208,224,240,576,592,608,624,960,976,992,1008,1344,1360,1376,1392
  .long 3264,3280,3296,3312,3648,3664,3680,3696,4032,4048,4064,4080,4416,4432,4448,4464
  .long 6336,6352,6368,6384,6720,6736,6752,6768,7104,7120,7136,7152,7488,7504,7520,7536
  .long 9408,9424,9440,9456,9792,9808,9824,9840,10176,10192,10208,10224,10560,10576,10592,10608
  .long 288,304,320,336,672,688,704,720,1056,1072,1088,1104,1440,1456,1472,1488
  .long 3360,3376,3392,3408,3744,3760,3776,3792,4128,4144,4160,4176,4512,4528,4544,4560
  .long 6432,6448,6464,6480,6816,6832,6848,6864,7200,7216,7232,7248,7584,7600,7616,7632
  .long 9504,9520,9536,9552,9888,9904,9920,9936,10272,10288,10304,10320,10656,10672,10688,10704
  .long 8,24,40,56,392,408,424,440,776,792,808,824,1160,1176,1192,1208
  .long 3080,3096,3112,3128,3464,3480,3496,3512,3848,3864,3880,3896,4232,4248,4264,4280
  .long 6152,6168,6184,6200,6536,6552,6568,6584,6920,6936,6952,6968,7304,7320,7336,7352
  .long 9224,9240,9256,9272,9608,9624,9640,9656,9992,10008,10024,10040,10376,10392,10408,10424
  .long 104,120,136,152,488,504,520,536,872,888,904,920,1256,1272,1288,1304
  .long 3176,3192,3208,3224,3560,3576,3592,3608,3944,3960,3976,3992,4328,4344,4360,4376
  .long 6248,6264,6280,6296,6632,6648,6664,6680,7016,7032,7048,7064,7400,7416,7432,7448
  .long 9320,9336,9352,9368,9704,9720,9736,9752,10088,10104,10120,10136,10472,10488,10504,10520
  .long 200,216,232,248,584,600,616,632,968,984,1000,1016,1352,1368,1384,1400
  .long 3272,3288,3304,3320,3656,3672,3688,3704,4040,4056,4072,4088,4424,4440,4456,4472
  .long 6344,6360,6376,6392,6728,6744,6760,6776,7112,7128,7144,7160,7496,7512,7528,7544
  .long 9416,9432,9448,9464,9800,9816,9832,9848,10184,10200,10216,10232,10568,10584,10600,10616
  .long 296,312,328,344,680,696,712,728,1064,1080,1096,1112,1448,1464,1480,1496
  .long 3368,3384,3400,3416,3752,3768,3784,3800,4136,4152,4168,4184,4520,4536,4552,4568
  .long 6440,6456,6472,6488,6824,6840,6856,6872,7208,7224,7240,7256,7592,7608,7624,7640
  .long 9512,9528,9544,9560,9896,9912,9928,9944,10280,10296,10312,10328,10664,10680,10696,10712
  .long 64,72,80,88,448,456,464,472,832,840,848,856,1216,1224,1232,1240
  .long 3136,3144,3152,3160,3520,3528,3536,3544,3904,3912,3920,3928,4288,4296,4304,4312
  .long 6208,6216,6224,6232,6592,6600,6608,6616,6976,6984,6992,7000,7360,7368,7376,7384
  .long 9280,9288,9296,9304,9664,9672,9680,9688,10048,10056,10064,10072,10432,10440,10448,10456
  .long 160,168,176,184,544,552,560,568,928,936,944,952,1312,1320,1328,1336
  .long 3232,3240,3248,3256,3616,3624,3632,3640,4000,4008,4016,4024,4384,4392,4400,4408
  .long 6304,6312,6320,6328,6688,6696,6704,6712,7072,7080,7088,7096,7456,7464,7472,7480
  .long 9376,9384,9392,9400,9760,9768,9776,9784,10144,10152,10160,10168,10528,10536,10544,10552
  .long 256,264,272,280,640,648,656,664,1024,1032,1040,1048,1408,1416,1424,1432
  .long 3328,3336,3344,3352,3712,3720,3728,3736,4096,4104,4112,4120,4480,4488,4496,4504
  .long 6400,6408,6416,6424,6784,6792,6800,6808,7168,7176,7184,7192,7552,7560,7568,7576
  .long 9472,9480,9488,9496,9856,9864,9872,9880,10240,10248,10256,10264,10624,10632,10640,10648
  .long 352,360,368,376,736,744,752,760,1120,1128,1136,1144,1504,1512,1520,1528
  .long 3424,3432,3440,3448,3808,3816,3824,3832,4192,4200,4208,4216,4576,4584,4592,4600
  .long 6496,6504,6512,6520,6880,6888,6896,6904,7264,7272,7280,7288,7648,7656,7664,7672
  .long 9568,9576,9584,9592,9952,9960,9968,9976,10336,10344,10352,10360,10720,10728,10736,10744
  .long 0,8,16,24,384,392,400,408,768,776,784,792,1152,1160,1168,1176
  .long 3072,3080,3088,3096,3456,3464,3472,3480,3840,3848,3856,3864,4224,4232,4240,4248
  .long 6144,6152,6160,6168,6528,6536,6544,6552,6912,6920,6928,6936,7296,7304,7312,7320
  .long 9216,9224,9232,9240,9600,9608,9616,9624,9984,9992,10000,10008,10368,10376,10384,10392
  .long 96,104,112,120,480,488,496,504,864,872,880,888,1248,1256,1264,1272
  .long 3168,3176,3184,3192,3552,3560,3568,3576,3936,3944,3952,3960,4320,4328,4336,4344
  .long 6240,6248,6256,6264,6624,6632,6640,6648,7008,7016,7024,7032,7392,7400,7408,7416
  .long 9312,9320,9328,9336,9696,9704,9712,9720,10080,10088,10096,10104,10464,10472,10480,10488
  .long 192,200,208,216,576,584,592,600,960,968,976,984,1344,1352,1360,1368
  .long 3264,3272,3280,3288,3648,3656,3664,3672,4032,4040,4048,4056,4416,4424,4432,4440
  .long 6336,6344,6352,6360,6720,6728,6736,6744,7104,7112,7120,7128,7488,7496,7504,7512
  .long 9408,9416,9424,9432,9792,9800,9808,9816,10176,10184,10192,10200,10560,10568,10576,10584
  .long 288,296,304,312,672,680,688,696,1056,1064,1072,1080,1440,1448,1456,1464
  .long 3360,3368,3376,3384,3744,3752,3760,3768,4128,4136,4144,4152,4512,4520,4528,4536
  .long 6432,6440,6448,6456,6816,6824,6832,6840,7200,7208,7216,7224,7584,7592,7600,7608
  .long 9504,9512,9520,9528,9888,9896,9904,9912,10272,10280,10288,10296,10656,10664,10672,10680
  .long 32,40,48,56,416,424,432,440,800,808,816,824,1184,1192,1200,1208
  .long 3104,3112,3120,3128,3488,3496,3504,3512,3872,3880,3888,3896,4256,4264,4272,4280
  .long 6176,6184,6192,6200,6560,6568,6576,6584,6944,6952,6960,6968,7328,7336,7344,7352
  .long 9248,9256,9264,9272,9632,9640,9648,9656,10016,10024,10032,10040,10400,10408,10416,10424
  .long 128,136,144,152,512,520,528,536,896,904,912,920,1280,1288,1296,1304
  .long 3200,3208,3216,3224,3584,3592,3600,3608,3968,3976,3984,3992,4352,4360,4368,4376
  .long 6272,6280,6288,6296,6656,6664,6672,6680,7040,7048,7056,7064,7424,7432,7440,7448
  .long 9344,9352,9360,9368,9728,9736,9744,9752,10112,10120,10128,10136,10496,10504,10512,10520
  .long 224,232,240,248,608,616,624,632,992,1000,1008,1016,1376,1384,1392,1400
  .long 3296,3304,3312,3320,3680,3688,3696,3704,4064,4072,4080,4088,4448,4456,4464,4472
  .long 6368,6376,6384,6392,6752,6760,6768,6776,7136,7144,7152,7160,7520,7528,7536,7544
  .long 9440,9448,9456,9464,9824,9832,9840,9848,10208,10216,10224,10232,10592,10600,10608,10616
  .long 320,328,336,344,704,712,720,728,1088,1096,1104,1112,1472,1480,1488,1496
  .long 3392,3400,3408,3416,3776,3784,3792,3800,4160,4168,4176,4184,4544,4552,4560,4568
  .long 6464,6472,6480,6488,6848,6856,6864,6872,7232,7240,7248,7256,7616,7624,7632,7640
  .long 9536,9544,9552,9560,9920,9928,9936,9944,10304,10312,10320,10328,10688,10696,10704,10712
  .long 64,72,80,88,448,456,464,472,832,840,848,856,1216,1224,1232,1240
  .long 3136,3144,3152,3160,3520,3528,3536,3544,3904,3912,3920,3928,4288,4296,4304,4312
  .long 6208,6216,6224,6232,6592,6600,6608,6616,6976,6984,6992,7000,7360,7368,7376,7384
  .long 9280,9288,9296,9304,9664,9672,9680,9688,10048,10056,10064,10072,10432,10440,10448,10456
  .long 160,168,176,184,544,552,560,568,928,936,944,952,1312,1320,1328,1336
  .long 3232,3240,3248,3256,3616,3624,3632,3640,4000,4008,4016,4024,4384,4392,4400,4408
  .long 6304,6312,6320,6328,6688,6696,6704,6712,7072,7080,7088,7096,7456,7464,7472,7480
  .long 9376,9384,9392,9400,9760,9768,9776,9784,10144,10152,10160,10168,10528,10536,10544,10552
  .long 256,264,272,280,640,648,656,664,1024,1032,1040,1048,1408,1416,1424,1432
  .long 3328,3336,3344,3352,3712,3720,3728,3736,4096,4104,4112,4120,4480,4488,4496,4504
  .long 6400,6408,6416,6424,6784,6792,6800,6808,7168,7176,7184,7192,7552,7560,7568,7576
  .long 9472,9480,9488,9496,9856,9864,9872,9880,10240,10248,10256,10264,10624,10632,10640,10648
  .long 352,360,368,376,736,744,752,760,1120,1128,1136,1144,1504,1512,1520,1528
  .long 3424,3432,3440,3448,3808,3816,3824,3832,4192,4200,4208,4216,4576,4584,4592,4600
  .long 6496,6504,6512,6520,6880,6888,6896,6904,7264,7272,7280,7288,7648,7656,7664,7672
  .long 9568,9576,9584,9592,9952,9960,9968,9976,10336,10344,10352,10360,10720,10728,10736,10744
  .long 0,16,32,48,64,80,96,112,128,144,160,176,192,208,224,240
  .long 256,272,288,304,320,336,352,368,384,400,416,432,448,464,480,496
  .long 512,528,544,560,576,592,608,624,640,656,672,688,704,720,736,752
  .long 768,784,800,816,832,848,864,880,896,912,928,944,960,976,992,1008
  .long 10368,10384,10400,10416,10432,10448,10464,10480,10240,10256,10272,10288,10304,10320,10336,10352
  .long 10624,10640,10656,10672,10688,10704,10720,10736,10496,10512,10528,10544,10560,10576,10592,10608
  .long 10880,10896,10912,10928,10944,10960,10976,10992,10752,10768,10784,10800,10816,10832,10848,10864
  .long 11136,11152,11168,11184,11200,11216,11232,11248,11008,11024,11040,11056,11072,11088,11104,11120
  .long 20480,20496,20512,20528,20544,20560,20576,20592,20608,20624,20640,20656,20672,20688,20704,20720
  .long 20736,20752,20768,20784,20800,20816,20832,20848,20864,20880,20896,20912,20928,20944,20960,20976
  .long 20992,21008,21024,21040,21056,21072,21088,21104,21120,21136,21152,21168,21184,21200,21216,21232
  .long 21248,21264,21280,21296,21312,21328,21344,21360,21376,21392,21408,21424,21440,21456,21472,21488
  .long 30848,30864,30880,30896,30912,30928,30944,30960,30720,30736,30752,30768,30784,30800,30816,30832
  .long 31104,31120,31136,31152,31168,31184,31200,31216,30976,30992,31008,31024,31040,31056,31072,31088
  .long 31360,31376,31392,31408,31424,31440,31456,31472,31232,31248,31264,31280,31296,31312,31328,31344
  .long 31616,31632,31648,31664,31680,31696,31712,31728,31488,31504,31520,31536,31552,31568,31584,31600
  .long 1024,1040,1056,1072,1088,1104,1120,1136,1152,1168,1184,1200,1216,1232,1248,1264
  .long 1296,1280,1328,1312,1360,1344,1392,1376,1424,1408,1456,1440,1488,1472,1520,1504
  .long 1552,1536,1584,1568,1616,1600,1648,1632,1680,1664,1712,1696,1744,1728,1776,1760
  .long 1808,1792,1840,1824,1872,1856,1904,1888,1936,1920,1968,1952,2000,1984,2032,2016
  .long 11392,11408,11424,11440,11456,11472,11488,11504,11264,11280,11296,11312,11328,11344,11360,11376
  .long 11664,11648,11696,11680,11728,11712,11760,11744,11536,11520,11568,11552,11600,11584,11632,11616
  .long 11920,11904,11952,11936,11984,11968,12016,12000,11792,11776,11824,11808,11856,11840,11888,11872
  .long 12176,12160,12208,12192,12240,12224,12272,12256,12048,12032,12080,12064,12112,12096,12144,12128
  .long 21504,21520,21536,21552,21568,21584,21600,21616,21632,21648,21664,21680,21696,21712,21728,21744
  .long 21776,21760,21808,21792,21840,21824,21872,21856,21904,21888,21936,21920,21968,21952,22000,21984
  .long 22032,22016,22064,22048,22096,22080,22128,22112,22160,22144,22192,22176,22224,22208,22256,22240
  .long 22288,22272,22320,22304,22352,22336,22384,22368,22416,22400,22448,22432,22480,22464,22512,22496
  .long 31872,31888,31904,31920,31936,31952,31968,31984,31744,31760,31776,31792,31808,31824,31840,31856
  .long 32144,32128,32176,32160,32208,32192,32240,32224,32016,32000,32048,32032,32080,32064,32112,32096
  .long 32400,32384,32432,32416,32464,32448,32496,32480,32272,32256,32304,32288,32336,32320,32368,32352
  .long 32656,32640,32688,32672,32720,32704,32752,32736,32528,32512,32560,32544,32592,32576,32624,32608
  .long 2064,2048,2096,2080,2128,2112,2160,2144,2192,2176,2224,2208,2256,2240,2288,2272
  .long 2320,2304,2352,2336,2384,2368,2416,2400,2448,2432,2480,2464,2512,2496,2544,2528
  .long 2592,2608,2560,2576,2656,2672,2624,2640,2720,2736,2688,2704,2784,2800,2752,2768
  .long 2848,2864,2816,2832,2912,2928,2880,2896,2976,2992,2944,2960,3040,3056,3008,3024
  .long 12432,12416,12464,12448,12496,12480,12528,12512,12304,12288,12336,12320,12368,12352,12400,12384
  .long 12688,12672,12720,12704,12752,12736,12784,12768,12560,12544,12592,12576,12624,12608,12656,12640
  .long 12960,12976,12928,12944,13024,13040,12992,13008,12832,12848,12800,12816,12896,12912,12864,12880
  .long 13216,13232,13184,13200,13280,13296,13248,13264,13088,13104,13056,13072,13152,13168,13120,13136
  .long 22544,22528,22576,22560,22608,22592,22640,22624,22672,22656,22704,22688,22736,22720,22768,22752
  .long 22800,22784,22832,22816,22864,22848,22896,22880,22928,22912,22960,22944,22992,22976,23024,23008
  .long 23072,23088,23040,23056,23136,23152,23104,23120,23200,23216,23168,23184,23264,23280,23232,23248
  .long 23328,23344,23296,23312,23392,23408,23360,23376,23456,23472,23424,23440,23520,23536,23488,23504
  .long 32912,32896,32944,32928,32976,32960,33008,32992,32784,32768,32816,32800,32848,32832,32880,32864
  .long 33168,33152,33200,33184,33232,33216,33264,33248,33040,33024,33072,33056,33104,33088,33136,33120
  .long 33440,33456,33408,33424,33504,33520,33472,33488,33312,33328,33280,33296,33376,33392,33344,33360
  .long 33696,33712,33664,33680,33760,33776,33728,33744,33568,33584,33536,33552,33632,33648,33600,33616
  .long 3104,3120,3072,3088,3168,3184,3136,3152,3232,3248,3200,3216,3296,3312,3264,3280
  .long 3360,3376,3328,3344,3424,3440,3392,3408,3488,3504,3456,3472,3552,3568,3520,3536
  .long 3616,3632,3584,3600,3680,3696,3648,3664,3744,3760,3712,3728,3808,3824,3776,3792
  .long 3888,3872,3856,3840,3952,3936,3920,3904,4016,4000,3984,3968,4080,4064,4048,4032
  .long 13472,13488,13440,13456,13536,13552,13504,13520,13344,13360,13312,13328,13408,13424,13376,13392
  .long 13728,13744,13696,13712,13792,13808,13760,13776,13600,13616,13568,13584,13664,13680,13632,13648
  .long 13984,14000,13952,13968,14048,14064,14016,14032,13856,13872,13824,13840,13920,13936,13888,13904
  .long 14256,14240,14224,14208,14320,14304,14288,14272,14128,14112,14096,14080,14192,14176,14160,14144
  .long 23584,23600,23552,23568,23648,23664,23616,23632,23712,23728,23680,23696,23776,23792,23744,23760
  .long 23840,23856,23808,23824,23904,23920,23872,23888,23968,23984,23936,23952,24032,24048,24000,24016
  .long 24096,24112,24064,24080,24160,24176,24128,24144,24224,24240,24192,24208,24288,24304,24256,24272
  .long 24368,24352,24336,24320,24432,24416,24400,24384,24496,24480,24464,24448,24560,24544,24528,24512
  .long 33952,33968,33920,33936,34016,34032,33984,34000,33824,33840,33792,33808,33888,33904,33856,33872
  .long 34208,34224,34176,34192,34272,34288,34240,34256,34080,34096,34048,34064,34144,34160,34112,34128
  .long 34464,34480,34432,34448,34528,34544,34496,34512,34336,34352,34304,34320,34400,34416,34368,34384
  .long 34736,34720,34704,34688,34800,34784,34768,34752,34608,34592,34576,34560,34672,34656,34640,34624
  .long 4144,4128,4112,4096,4208,4192,4176,4160,4272,4256,4240,4224,4336,4320,4304,4288
  .long 4400,4384,4368,4352,4464,4448,4432,4416,4528,4512,4496,4480,4592,4576,4560,4544
  .long 4656,4640,4624,4608,4720,4704,4688,4672,4784,4768,4752,4736,4848,4832,4816,4800
  .long 4912,4896,4880,4864,4976,4960,4944,4928,5040,5024,5008,4992,5104,5088,5072,5056
  .long 14512,14496,14480,14464,14576,14560,14544,14528,14384,14368,14352,14336,14448,14432,14416,14400
  .long 14768,14752,14736,14720,14832,14816,14800,14784,14640,14624,14608,14592,14704,14688,14672,14656
  .long 15024,15008,14992,14976,15088,15072,15056,15040,14896,14880,14864,14848,14960,14944,14928,14912
  .long 15280,15264,15248,15232,15344,15328,15312,15296,15152,15136,15120,15104,15216,15200,15184,15168
  .long 24624,24608,24592,24576,24688,24672,24656,24640,24752,24736,24720,24704,24816,24800,24784,24768
  .long 24880,24864,24848,24832,24944,24928,24912,24896,25008,24992,24976,24960,25072,25056,25040,25024
  .long 25136,25120,25104,25088,25200,25184,25168,25152,25264,25248,25232,25216,25328,25312,25296,25280
  .long 25392,25376,25360,25344,25456,25440,25424,25408,25520,25504,25488,25472,25584,25568,25552,25536
  .long 34992,34976,34960,34944,35056,35040,35024,35008,34864,34848,34832,34816,34928,34912,34896,34880
  .long 35248,35232,35216,35200,35312,35296,35280,35264,35120,35104,35088,35072,35184,35168,35152,35136
  .long 35504,35488,35472,35456,35568,35552,35536,35520,35376,35360,35344,35328,35440,35424,35408,35392
  .long 35760,35744,35728,35712,35824,35808,35792,35776,35632,35616,35600,35584,35696,35680,35664,35648
  .long 5184,5200,5216,5232,5120,5136,5152,5168,5312,5328,5344,5360,5248,5264,5280,5296
  .long 5440,5456,5472,5488,5376,5392,5408,5424,5568,5584,5600,5616,5504,5520,5536,5552
  .long 5696,5712,5728,5744,5632,5648,5664,5680,5824,5840,5856,5872,5760,5776,5792,5808
  .long 5952,5968,5984,6000,5888,5904,5920,5936,6080,6096,6112,6128,6016,6032,6048,6064
  .long 15552,15568,15584,15600,15488,15504,15520,15536,15424,15440,15456,15472,15360,15376,15392,15408
  .long 15808,15824,15840,15856,15744,15760,15776,15792,15680,15696,15712,15728,15616,15632,15648,15664
  .long 16064,16080,16096,16112,16000,16016,16032,16048,15936,15952,15968,15984,15872,15888,15904,15920
  .long 16320,16336,16352,16368,16256,16272,16288,16304,16192,16208,16224,16240,16128,16144,16160,16176
  .long 25664,25680,25696,25712,25600,25616,25632,25648,25792,25808,25824,25840,25728,25744,25760,25776
  .long 25920,25936,25952,25968,25856,25872,25888,25904,26048,26064,26080,26096,25984,26000,26016,26032
  .long 26176,26192,26208,26224,26112,26128,26144,26160,26304,26320,26336,26352,26240,26256,26272,26288
  .long 26432,26448,26464,26480,26368,26384,26400,26416,26560,26576,26592,26608,26496,26512,26528,26544
  .long 36032,36048,36064,36080,35968,35984,36000,36016,35904,35920,35936,35952,35840,35856,35872,35888
  .long 36288,36304,36320,36336,36224,36240,36256,36272,36160,36176,36192,36208,36096,36112,36128,36144
  .long 36544,36560,36576,36592,36480,36496,36512,36528,36416,36432,36448,36464,36352,36368,36384,36400
  .long 36800,36816,36832,36848,36736,36752,36768,36784,36672,36688,36704,36720,36608,36624,36640,36656
  .long 6208,6224,6240,6256,6144,6160,6176,6192,6336,6352,6368,6384,6272,6288,6304,6320
  .long 6480,6464,6512,6496,6416,6400,6448,6432,6608,6592,6640,6624,6544,6528,6576,6560
  .long 6736,6720,6768,6752,6672,6656,6704,6688,6864,6848,6896,6880,6800,6784,6832,6816
  .long 6992,6976,7024,7008,6928,6912,6960,6944,7120,7104,7152,7136,7056,7040,7088,7072
  .long 16576,16592,16608,16624,16512,16528,16544,16560,16448,16464,16480,16496,16384,16400,16416,16432
  .long 16848,16832,16880,16864,16784,16768,16816,16800,16720,16704,16752,16736,16656,16640,16688,16672
  .long 17104,17088,17136,17120,17040,17024,17072,17056,16976,16960,17008,16992,16912,16896,16944,16928
  .long 17360,17344,17392,17376,17296,17280,17328,17312,17232,17216,17264,17248,17168,17152,17200,17184
  .long 26688,26704,26720,26736,26624,26640,26656,26672,26816,26832,26848,26864,26752,26768,26784,26800
  .long 26960,26944,26992,26976,26896,26880,26928,26912,27088,27072,27120,27104,27024,27008,27056,27040
  .long 27216,27200,27248,27232,27152,27136,27184,27168,27344,27328,27376,27360,27280,27264,27312,27296
  .long 27472,27456,27504,27488,27408,27392,27440,27424,27600,27584,27632,27616,27536,27520,27568,27552
  .long 37056,37072,37088,37104,36992,37008,37024,37040,36928,36944,36960,36976,36864,36880,36896,36912
  .long 37328,37312,37360,37344,37264,37248,37296,37280,37200,37184,37232,37216,37136,37120,37168,37152
  .long 37584,37568,37616,37600,37520,37504,37552,37536,37456,37440,37488,37472,37392,37376,37424,37408
  .long 37840,37824,37872,37856,37776,37760,37808,37792,37712,37696,37744,37728,37648,37632,37680,37664
  .long 7248,7232,7280,7264,7184,7168,7216,7200,7376,7360,7408,7392,7312,7296,7344,7328
  .long 7504,7488,7536,7520,7440,7424,7472,7456,7632,7616,7664,7648,7568,7552,7600,7584
  .long 7776,7792,7744,7760,7712,7728,7680,7696,7904,7920,7872,7888,7840,7856,7808,7824
  .long 8032,8048,8000,8016,7968,7984,7936,7952,8160,8176,8128,8144,8096,8112,8064,8080
  .long 17616,17600,17648,17632,17552,17536,17584,17568,17488,17472,17520,17504,17424,17408,17456,17440
  .long 17872,17856,17904,17888,17808,17792,17840,17824,17744,17728,17776,17760,17680,17664,17712,17696
  .long 18144,18160,18112,18128,18080,18096,18048,18064,18016,18032,17984,18000,17952,17968,17920,17936
  .long 18400,18416,18368,18384,18336,18352,18304,18320,18272,18288,18240,18256,18208,18224,18176,18192
  .long 27728,27712,27760,27744,27664,27648,27696,27680,27856,27840,27888,27872,27792,27776,27824,27808
  .long 27984,27968,28016,28000,27920,27904,27952,27936,28112,28096,28144,28128,28048,28032,28080,28064
  .long 28256,28272,28224,28240,28192,28208,28160,28176,28384,28400,28352,28368,28320,28336,28288,28304
  .long 28512,28528,28480,28496,28448,28464,28416,28432,28640,28656,28608,28624,28576,28592,28544,28560
  .long 38096,38080,38128,38112,38032,38016,38064,38048,37968,37952,38000,37984,37904,37888,37936,37920
  .long 38352,38336,38384,38368,38288,38272,38320,38304,38224,38208,38256,38240,38160,38144,38192,38176
  .long 38624,38640,38592,38608,38560,38576,38528,38544,38496,38512,38464,38480,38432,38448,38400,38416
  .long 38880,38896,38848,38864,38816,38832,38784,38800,38752,38768,38720,38736,38688,38704,38656,38672
  .long 8288,8304,8256,8272,8224,8240,8192,8208,8416,8432,8384,8400,8352,8368,8320,8336
  .long 8544,8560,8512,8528,8480,8496,8448,8464,8672,8688,8640,8656,8608,8624,8576,8592
  .long 8800,8816,8768,8784,8736,8752,8704,8720,8928,8944,8896,8912,8864,8880,8832,8848
  .long 9072,9056,9040,9024,9008,8992,8976,8960,9200,9184,9168,9152,9136,9120,9104,9088
  .long 18656,18672,18624,18640,18592,18608,18560,18576,18528,18544,18496,18512,18464,18480,18432,18448
  .long 18912,18928,18880,18896,18848,18864,18816,18832,18784,18800,18752,18768,18720,18736,18688,18704
  .long 19168,19184,19136,19152,19104,19120,19072,19088,19040,19056,19008,19024,18976,18992,18944,18960
  .long 19440,19424,19408,19392,19376,19360,19344,19328,19312,19296,19280,19264,19248,19232,19216,19200
  .long 28768,28784,28736,28752,28704,28720,28672,28688,28896,28912,28864,28880,28832,28848,28800,28816
  .long 29024,29040,28992,29008,28960,28976,28928,28944,29152,29168,29120,29136,29088,29104,29056,29072
  .long 29280,29296,29248,29264,29216,29232,29184,29200,29408,29424,29376,29392,29344,29360,29312,29328
  .long 29552,29536,29520,29504,29488,29472,29456,29440,29680,29664,29648,29632,29616,29600,29584,29568
  .long 39136,39152,39104,39120,39072,39088,39040,39056,39008,39024,38976,38992,38944,38960,38912,38928
  .long 39392,39408,39360,39376,39328,39344,39296,39312,39264,39280,39232,39248,39200,39216,39168,39184
  .long 39648,39664,39616,39632,39584,39600,39552,39568,39520,39536,39488,39504,39456,39472,39424,39440
  .long 39920,39904,39888,39872,39856,39840,39824,39808,39792,39776,39760,39744,39728,39712,39696,39680
  .long 9328,9312,9296,9280,9264,9248,9232,9216,9456,9440,9424,9408,9392,9376,9360,9344
  .long 9584,9568,9552,9536,9520,9504,9488,9472,9712,9696,9680,9664,9648,9632,9616,9600
  .long 9840,9824,9808,9792,9776,9760,9744,9728,9968,9952,9936,9920,9904,9888,9872,9856
  .long 10096,10080,10064,10048,10032,10016,10000,9984,10224,10208,10192,10176,10160,10144,10128,10112
  .long 19696,19680,19664,19648,19632,19616,19600,19584,19568,19552,19536,19520,19504,19488,19472,19456
  .long 19952,19936,19920,19904,19888,19872,19856,19840,19824,19808,19792,19776,19760,19744,19728,19712
  .long 20208,20192,20176,20160,20144,20128,20112,20096,20080,20064,20048,20032,20016,20000,19984,19968
  .long 20464,20448,20432,20416,20400,20384,20368,20352,20336,20320,20304,20288,20272,20256,20240,20224
  .long 29808,29792,29776,29760,29744,29728,29712,29696,29936,29920,29904,29888,29872,29856,29840,29824
  .long 30064,30048,30032,30016,30000,29984,29968,29952,30192,30176,30160,30144,30128,30112,30096,30080
  .long 30320,30304,30288,30272,30256,30240,30224,30208,30448,30432,30416,30400,30384,30368,30352,30336
  .long 30576,30560,30544,30528,30512,30496,30480,30464,30704,30688,30672,30656,30640,30624,30608,30592
  .long 40176,40160,40144,40128,40112,40096,40080,40064,40048,40032,40016,40000,39984,39968,39952,39936
  .long 40432,40416,40400,40384,40368,40352,40336,40320,40304,40288,40272,40256,40240,40224,40208,40192
  .long 40688,40672,40656,40640,40624,40608,40592,40576,40560,40544,40528,40512,40496,40480,40464,40448
  .long 40944,40928,40912,40896,40880,40864,40848,40832,40816,40800,40784,40768,40752,40736,40720,40704
  .long 0,1296,2592,3888,5184,6480,7776,9072,10368,11664,12960,14256,15552,16848,18144,19440
  .long 16,1280,2608,3872,5200,6464,7792,9056,10384,11648,12976,14240,15568,16832,18160,19424
  .long 32,1328,2560,3856,5216,6512,7744,9040,10400,11696,12928,14224,15584,16880,18112,19408
  .long 48,1312,2576,3840,5232,6496,7760,9024,10416,11680,12944,14208,15600,16864,18128,19392
  .long 0,1296,2592,3888,5184,6480,7776,9072,10368,11664,12960,14256,15552,16848,18144,19440
  .long 16,1280,2608,3872,5200,6464,7792,9056,10384,11648,12976,14240,15568,16832,18160,19424
  .long 32,1328,2560,3856,5216,6512,7744,9040,10400,11696,12928,14224,15584,16880,18112,19408
  .long 48,1312,2576,3840,5232,6496,7760,9024,10416,11680,12944,14208,15600,16864,18128,19392
  .long 0,1296,2592,3888,5184,6480,7776,9072,10368,11664,12960,14256,15552,16848,18144,19440
  .long 16,1280,2608,3872,5200,6464,7792,9056,10384,11648,12976,14240,15568,16832,18160,19424
  .long 32,1328,2560,3856,5216,6512,7744,9040,10400,11696,12928,14224,15584,16880,18112,19408
  .long 48,1312,2576,3840,5232,6496,7760,9024,10416,11680,12944,14208,15600,16864,18128,19392
  .long 0,1296,2592,3888,5184,6480,7776,9072,10368,11664,12960,14256,15552,16848,18144,19440
  .long 16,1280,2608,3872,5200,6464,7792,9056,10384,11648,12976,14240,15568,16832,18160,19424
  .long 32,1328,2560,3856,5216,6512,7744,9040,10400,11696,12928,14224,15584,16880,18112,19408
  .long 48,1312,2576,3840,5232,6496,7760,9024,10416,11680,12944,14208,15600,16864,18128,19392
  .long 64,1360,2656,3952,5120,6416,7712,9008,10432,11728,13024,14320,15488,16784,18080,19376
  .long 80,1344,2672,3936,5136,6400,7728,8992,10448,11712,13040,14304,15504,16768,18096,19360
  .long 96,1392,2624,3920,5152,6448,7680,8976,10464,11760,12992,14288,15520,16816,18048,19344
  .long 112,1376,2640,3904,5168,6432,7696,8960,10480,11744,13008,14272,15536,16800,18064,19328
  .long 64,1360,2656,3952,5120,6416,7712,9008,10432,11728,13024,14320,15488,16784,18080,19376
  .long 80,1344,2672,3936,5136,6400,7728,8992,10448,11712,13040,14304,15504,16768,18096,19360
  .long 96,1392,2624,3920,5152,6448,7680,8976,10464,11760,12992,14288,15520,16816,18048,19344
  .long 112,1376,2640,3904,5168,6432,7696,8960,10480,11744,13008,14272,15536,16800,18064,19328
  .long 64,1360,2656,3952,5120,6416,7712,9008,10432,11728,13024,14320,15488,16784,18080,19376
  .long 80,1344,2672,3936,5136,6400,7728,8992,10448,11712,13040,14304,15504,16768,18096,19360
  .long 96,1392,2624,3920,5152,6448,7680,8976,10464,11760,12992,14288,15520,16816,18048,19344
  .long 112,1376,2640,3904,5168,6432,7696,8960,10480,11744,13008,14272,15536,16800,18064,19328
  .long 64,1360,2656,3952,5120,6416,7712,9008,10432,11728,13024,14320,15488,16784,18080,19376
  .long 80,1344,2672,3936,5136,6400,7728,8992,10448,11712,13040,14304,15504,16768,18096,19360
  .long 96,1392,2624,3920,5152,6448,7680,8976,10464,11760,12992,14288,15520,16816,18048,19344
  .long 112,1376,2640,3904,5168,6432,7696,8960,10480,11744,13008,14272,15536,16800,18064,19328
  .long 128,1424,2720,4016,5312,6608,7904,9200,10240,11536,12832,14128,15424,16720,18016,19312
  .long 144,1408,2736,4000,5328,6592,7920,9184,10256,11520,12848,14112,15440,16704,18032,19296
  .long 160,1456,2688,3984,5344,6640,7872,9168,10272,11568,12800,14096,15456,16752,17984,19280
  .long 176,1440,2704,3968,5360,6624,7888,9152,10288,11552,12816,14080,15472,16736,18000,19264
  .long 128,1424,2720,4016,5312,6608,7904,9200,10240,11536,12832,14128,15424,16720,18016,19312
  .long 144,1408,2736,4000,5328,6592,7920,9184,10256,11520,12848,14112,15440,16704,18032,19296
  .long 160,1456,2688,3984,5344,6640,7872,9168,10272,11568,12800,14096,15456,16752,17984,19280
  .long 176,1440,2704,3968,5360,6624,7888,9152,10288,11552,12816,14080,15472,16736,18000,19264
  .long 128,1424,2720,4016,5312,6608,7904,9200,10240,11536,12832,14128,15424,16720,18016,19312
  .long 144,1408,2736,4000,5328,6592,7920,9184,10256,11520,12848,14112,15440,16704,18032,19296
  .long 160,1456,2688,3984,5344,6640,7872,9168,10272,11568,12800,14096,15456,16752,17984,19280
  .long 176,1440,2704,3968,5360,6624,7888,9152,10288,11552,12816,14080,15472,16736,18000,19264
  .long 128,1424,2720,4016,5312,6608,7904,9200,10240,11536,12832,14128,15424,16720,18016,19312
  .long 144,1408,2736,4000,5328,6592,7920,9184,10256,11520,12848,14112,15440,16704,18032,19296
  .long 160,1456,2688,3984,5344,6640,7872,9168,10272,11568,12800,14096,15456,16752,17984,19280
  .long 176,1440,2704,3968,5360,6624,7888,9152,10288,11552,12816,14080,15472,16736,18000,19264
  .long 192,1488,2784,4080,5248,6544,7840,9136,10304,11600,12896,14192,15360,16656,17952,19248
  .long 208,1472,2800,4064,5264,6528,7856,9120,10320,11584,12912,14176,15376,16640,17968,19232
  .long 224,1520,2752,4048,5280,6576,7808,9104,10336,11632,12864,14160,15392,16688,17920,19216
  .long 240,1504,2768,4032,5296,6560,7824,9088,10352,11616,12880,14144,15408,16672,17936,19200
  .long 192,1488,2784,4080,5248,6544,7840,9136,10304,11600,12896,14192,15360,16656,17952,19248
  .long 208,1472,2800,4064,5264,6528,7856,9120,10320,11584,12912,14176,15376,16640,17968,19232
  .long 224,1520,2752,4048,5280,6576,7808,9104,10336,11632,12864,14160,15392,16688,17920,19216
  .long 240,1504,2768,4032,5296,6560,7824,9088,10352,11616,12880,14144,15408,16672,17936,19200
  .long 192,1488,2784,4080,5248,6544,7840,9136,10304,11600,12896,14192,15360,16656,17952,19248
  .long 208,1472,2800,4064,5264,6528,7856,9120,10320,11584,12912,14176,15376,16640,17968,19232
  .long 224,1520,2752,4048,5280,6576,7808,9104,10336,11632,12864,14160,15392,16688,17920,19216
  .long 240,1504,2768,4032,5296,6560,7824,9088,10352,11616,12880,14144,15408,16672,17936,19200
  .long 192,1488,2784,4080,5248,6544,7840,9136,10304,11600,12896,14192,15360,16656,17952,19248
  .long 208,1472,2800,4064,5264,6528,7856,9120,10320,11584,12912,14176,15376,16640,17968,19232
  .long 224,1520,2752,4048,5280,6576,7808,9104,10336,11632,12864,14160,15392,16688,17920,19216
  .long 240,1504,2768,4032,5296,6560,7824,9088,10352,11616,12880,14144,15408,16672,17936,19200
.p2align 8
L_table_a:
  .long 0,16,32,48,64,80,96,112,128,144,1280,1296,1312,1328,1344,1360
  .long 1376,1392,1408,1424,2560,2576,2592,2608,2624,2640,2656,2672,2688,2704,3840,3856
  .long 3872,3888,3904,3920,3936,3952,3968,3984,5120,5136,5152,5168,5184,5200,5216,5232
  .long 5248,5264,6400,6416,6432,6448,6464,6480,6496,6512,6528,6544,7680,7696,7712,7728
  .long 65312,65328,65344,65360,65376,65392,65408,65424,66560,66576,66592,66608,66624,66640,66656,66672
  .long 66688,66704,67840,67856,67872,67888,67904,67920,67936,67952,67968,67984,69120,69136,69152,69168
  .long 69184,69200,69216,69232,69248,69264,70400,70416,70432,70448,70464,70480,70496,70512,70528,70544
  .long 71680,71696,71712,71728,71744,71760,71776,71792,71808,71824,72960,72976,72992,73008,73024,73040
  .long 130624,130640,130656,130672,130688,130704,131840,131856,131872,131888,131904,131920,131936,131952,131968,131984
  .long 133120,133136,133152,133168,133184,133200,133216,133232,133248,133264,134400,134416,134432,134448,134464,134480
  .long 134496,134512,134528,134544,135680,135696,135712,135728,135744,135760,135776,135792,135808,135824,136960,136976
  .long 136992,137008,137024,137040,137056,137072,137088,137104,138240,138256,138272,138288,138304,138320,138336,138352
  .long 188192,188208,188224,188240,188256,188272,188288,188304,189440,189456,189472,189488,189504,189520,189536,189552
  .long 189568,189584,190720,190736,190752,190768,190784,190800,190816,190832,190848,190864,192000,192016,192032,192048
  .long 192064,192080,192096,192112,192128,192144,193280,193296,193312,193328,193344,193360,193376,193392,193408,193424
  .long 194560,194576,194592,194608,194624,194640,194656,194672,194688,194704,195840,195856,195872,195888,195904,195920
  .long 7744,7760,7776,7792,7808,7824,8960,8976,8992,9008,9024,9040,9056,9072,9088,9104
  .long 10240,10256,10272,10288,10304,10320,10336,10352,10368,10384,11520,11536,11552,11568,11584,11600
  .long 11616,11632,11648,11664,12800,12816,12832,12848,12864,12880,12896,12912,12928,12944,14080,14096
  .long 14112,14128,14144,14160,14176,14192,14208,14224,15360,15376,15392,15408,15424,15440,15456,15472
  .long 73056,73072,73088,73104,74240,74256,74272,74288,74304,74320,74336,74352,74368,74384,75520,75536
  .long 75552,75568,75584,75600,75616,75632,75648,75664,76800,76816,76832,76848,76864,76880,76896,76912
  .long 76928,76944,78080,78096,78112,78128,78144,78160,78176,78192,78208,78224,79360,79376,79392,79408
  .long 79424,79440,79456,79472,79488,79504,80640,80656,80672,80688,80704,80720,80736,80752,80768,80784
  .long 138368,138384,139520,139536,139552,139568,139584,139600,139616,139632,139648,139664,140800,140816,140832,140848
  .long 140864,140880,140896,140912,140928,140944,142080,142096,142112,142128,142144,142160,142176,142192,142208,142224
  .long 143360,143376,143392,143408,143424,143440,143456,143472,143488,143504,144640,144656,144672,144688,144704,144720
  .long 144736,144752,144768,144784,145920,145936,145952,145968,145984,146000,146016,146032,146048,146064,147200,147216
  .long 195936,195952,195968,195984,197120,197136,197152,197168,197184,197200,197216,197232,197248,197264,198400,198416
  .long 198432,198448,198464,198480,198496,198512,198528,198544,199680,199696,199712,199728,199744,199760,199776,199792
  .long 199808,199824,200960,200976,200992,201008,201024,201040,201056,201072,201088,201104,202240,202256,202272,202288
  .long 202304,202320,202336,202352,202368,202384,203520,203536,203552,203568,203584,203600,203616,203632,203648,203664
  .long 15488,15504,16640,16656,16672,16688,16704,16720,16736,16752,16768,16784,17920,17936,17952,17968
  .long 17984,18000,18016,18032,18048,18064,19200,19216,19232,19248,19264,19280,19296,19312,19328,19344
  .long 20480,20496,20512,20528,20544,20560,20576,20592,20608,20624,21760,21776,21792,21808,21824,21840
  .long 21856,21872,21888,21904,23040,23056,23072,23088,23104,23120,23136,23152,23168,23184,24320,24336
  .long 81920,81936,81952,81968,81984,82000,82016,82032,82048,82064,83200,83216,83232,83248,83264,83280
  .long 83296,83312,83328,83344,84480,84496,84512,84528,84544,84560,84576,84592,84608,84624,85760,85776
  .long 85792,85808,85824,85840,85856,85872,85888,85904,87040,87056,87072,87088,87104,87120,87136,87152
  .long 87168,87184,88320,88336,88352,88368,88384,88400,88416,88432,88448,88464,89600,89616,89632,89648
  .long 147232,147248,147264,147280,147296,147312,147328,147344,148480,148496,148512,148528,148544,148560,148576,148592
  .long 148608,148624,149760,149776,149792,149808,149824,149840,149856,149872,149888,149904,151040,151056,151072,151088
  .long 151104,151120,151136,151152,151168,151184,152320,152336,152352,152368,152384,152400,152416,152432,152448,152464
  .long 153600,153616,153632,153648,153664,153680,153696,153712,153728,153744,154880,154896,154912,154928,154944,154960
  .long 204800,204816,204832,204848,204864,204880,204896,204912,204928,204944,206080,206096,206112,206128,206144,206160
  .long 206176,206192,206208,206224,207360,207376,207392,207408,207424,207440,207456,207472,207488,207504,208640,208656
  .long 208672,208688,208704,208720,208736,208752,208768,208784,209920,209936,209952,209968,209984,210000,210016,210032
  .long 210048,210064,211200,211216,211232,211248,211264,211280,211296,211312,211328,211344,212480,212496,212512,212528
  .long 24352,24368,24384,24400,24416,24432,24448,24464,25600,25616,25632,25648,25664,25680,25696,25712
  .long 25728,25744,26880,26896,26912,26928,26944,26960,26976,26992,27008,27024,28160,28176,28192,28208
  .long 28224,28240,28256,28272,28288,28304,29440,29456,29472,29488,29504,29520,29536,29552,29568,29584
  .long 30720,30736,30752,30768,30784,30800,30816,30832,30848,30864,32000,32016,32032,32048,32064,32080
  .long 89664,89680,89696,89712,89728,89744,90880,90896,90912,90928,90944,90960,90976,90992,91008,91024
  .long 92160,92176,92192,92208,92224,92240,92256,92272,92288,92304,93440,93456,93472,93488,93504,93520
  .long 93536,93552,93568,93584,94720,94736,94752,94768,94784,94800,94816,94832,94848,94864,96000,96016
  .long 96032,96048,96064,96080,96096,96112,96128,96144,97280,97296,97312,97328,97344,97360,97376,97392
  .long 154976,154992,155008,155024,156160,156176,156192,156208,156224,156240,156256,156272,156288,156304,157440,157456
  .long 157472,157488,157504,157520,157536,157552,157568,157584,158720,158736,158752,158768,158784,158800,158816,158832
  .long 158848,158864,160000,160016,160032,160048,160064,160080,160096,160112,160128,160144,161280,161296,161312,161328
  .long 161344,161360,161376,161392,161408,161424,162560,162576,162592,162608,162624,162640,162656,162672,162688,162704
  .long 212544,212560,212576,212592,212608,212624,213760,213776,213792,213808,213824,213840,213856,213872,213888,213904
  .long 215040,215056,215072,215088,215104,215120,215136,215152,215168,215184,216320,216336,216352,216368,216384,216400
  .long 216416,216432,216448,216464,217600,217616,217632,217648,217664,217680,217696,217712,217728,217744,218880,218896
  .long 218912,218928,218944,218960,218976,218992,219008,219024,220160,220176,220192,220208,220224,220240,220256,220272
  .long 32096,32112,32128,32144,33280,33296,33312,33328,33344,33360,33376,33392,33408,33424,34560,34576
  .long 34592,34608,34624,34640,34656,34672,34688,34704,35840,35856,35872,35888,35904,35920,35936,35952
  .long 35968,35984,37120,37136,37152,37168,37184,37200,37216,37232,37248,37264,38400,38416,38432,38448
  .long 38464,38480,38496,38512,38528,38544,39680,39696,39712,39728,39744,39760,39776,39792,39808,39824
  .long 97408,97424,98560,98576,98592,98608,98624,98640,98656,98672,98688,98704,99840,99856,99872,99888
  .long 99904,99920,99936,99952,99968,99984,101120,101136,101152,101168,101184,101200,101216,101232,101248,101264
  .long 102400,102416,102432,102448,102464,102480,102496,102512,102528,102544,103680,103696,103712,103728,103744,103760
  .long 103776,103792,103808,103824,104960,104976,104992,105008,105024,105040,105056,105072,105088,105104,106240,106256
  .long 163840,163856,163872,163888,163904,163920,163936,163952,163968,163984,165120,165136,165152,165168,165184,165200
  .long 165216,165232,165248,165264,166400,166416,166432,166448,166464,166480,166496,166512,166528,166544,167680,167696
  .long 167712,167728,167744,167760,167776,167792,167808,167824,168960,168976,168992,169008,169024,169040,169056,169072
  .long 169088,169104,170240,170256,170272,170288,170304,170320,170336,170352,170368,170384,171520,171536,171552,171568
  .long 220288,220304,221440,221456,221472,221488,221504,221520,221536,221552,221568,221584,222720,222736,222752,222768
  .long 222784,222800,222816,222832,222848,222864,224000,224016,224032,224048,224064,224080,224096,224112,224128,224144
  .long 225280,225296,225312,225328,225344,225360,225376,225392,225408,225424,226560,226576,226592,226608,226624,226640
  .long 226656,226672,226688,226704,227840,227856,227872,227888,227904,227920,227936,227952,227968,227984,229120,229136
  .long 40960,40976,40992,41008,41024,41040,41056,41072,41088,41104,42240,42256,42272,42288,42304,42320
  .long 42336,42352,42368,42384,43520,43536,43552,43568,43584,43600,43616,43632,43648,43664,44800,44816
  .long 44832,44848,44864,44880,44896,44912,44928,44944,46080,46096,46112,46128,46144,46160,46176,46192
  .long 46208,46224,47360,47376,47392,47408,47424,47440,47456,47472,47488,47504,48640,48656,48672,48688
  .long 106272,106288,106304,106320,106336,106352,106368,106384,107520,107536,107552,107568,107584,107600,107616,107632
  .long 107648,107664,108800,108816,108832,108848,108864,108880,108896,108912,108928,108944,110080,110096,110112,110128
  .long 110144,110160,110176,110192,110208,110224,111360,111376,111392,111408,111424,111440,111456,111472,111488,111504
  .long 112640,112656,112672,112688,112704,112720,112736,112752,112768,112784,113920,113936,113952,113968,113984,114000
  .long 171584,171600,171616,171632,171648,171664,172800,172816,172832,172848,172864,172880,172896,172912,172928,172944
  .long 174080,174096,174112,174128,174144,174160,174176,174192,174208,174224,175360,175376,175392,175408,175424,175440
  .long 175456,175472,175488,175504,176640,176656,176672,176688,176704,176720,176736,176752,176768,176784,177920,177936
  .long 177952,177968,177984,178000,178016,178032,178048,178064,179200,179216,179232,179248,179264,179280,179296,179312
  .long 229152,229168,229184,229200,229216,229232,229248,229264,230400,230416,230432,230448,230464,230480,230496,230512
  .long 230528,230544,231680,231696,231712,231728,231744,231760,231776,231792,231808,231824,232960,232976,232992,233008
  .long 233024,233040,233056,233072,233088,233104,234240,234256,234272,234288,234304,234320,234336,234352,234368,234384
  .long 235520,235536,235552,235568,235584,235600,235616,235632,235648,235664,236800,236816,236832,236848,236864,236880
  .long 48704,48720,48736,48752,48768,48784,49920,49936,49952,49968,49984,50000,50016,50032,50048,50064
  .long 51200,51216,51232,51248,51264,51280,51296,51312,51328,51344,52480,52496,52512,52528,52544,52560
  .long 52576,52592,52608,52624,53760,53776,53792,53808,53824,53840,53856,53872,53888,53904,55040,55056
  .long 55072,55088,55104,55120,55136,55152,55168,55184,56320,56336,56352,56368,56384,56400,56416,56432
  .long 114016,114032,114048,114064,115200,115216,115232,115248,115264,115280,115296,115312,115328,115344,116480,116496
  .long 116512,116528,116544,116560,116576,116592,116608,116624,117760,117776,117792,117808,117824,117840,117856,117872
  .long 117888,117904,119040,119056,119072,119088,119104,119120,119136,119152,119168,119184,120320,120336,120352,120368
  .long 120384,120400,120416,120432,120448,120464,121600,121616,121632,121648,121664,121680,121696,121712,121728,121744
  .long 179328,179344,180480,180496,180512,180528,180544,180560,180576,180592,180608,180624,181760,181776,181792,181808
  .long 181824,181840,181856,181872,181888,181904,183040,183056,183072,183088,183104,183120,183136,183152,183168,183184
  .long 184320,184336,184352,184368,184384,184400,184416,184432,184448,184464,185600,185616,185632,185648,185664,185680
  .long 185696,185712,185728,185744,186880,186896,186912,186928,186944,186960,186976,186992,187008,187024,188160,188176
  .long 236896,236912,236928,236944,238080,238096,238112,238128,238144,238160,238176,238192,238208,238224,239360,239376
  .long 239392,239408,239424,239440,239456,239472,239488,239504,240640,240656,240672,240688,240704,240720,240736,240752
  .long 240768,240784,241920,241936,241952,241968,241984,242000,242016,242032,242048,242064,243200,243216,243232,243248
  .long 243264,243280,243296,243312,243328,243344,244480,244496,244512,244528,244544,244560,244576,244592,244608,244624
  .long 56448,56464,57600,57616,57632,57648,57664,57680,57696,57712,57728,57744,58880,58896,58912,58928
  .long 58944,58960,58976,58992,59008,59024,60160,60176,60192,60208,60224,60240,60256,60272,60288,60304
  .long 61440,61456,61472,61488,61504,61520,61536,61552,61568,61584,62720,62736,62752,62768,62784,62800
  .long 62816,62832,62848,62864,64000,64016,64032,64048,64064,64080,64096,64112,64128,64144,65280,65296
  .long 122880,122896,122912,122928,122944,122960,122976,122992,123008,123024,124160,124176,124192,124208,124224,124240
  .long 124256,124272,124288,124304,125440,125456,125472,125488,125504,125520,125536,125552,125568,125584,126720,126736
  .long 126752,126768,126784,126800,126816,126832,126848,126864,128000,128016,128032,128048,128064,128080,128096,128112
  .long 128128,128144,129280,129296,129312,129328,129344,129360,129376,129392,129408,129424,130560,130576,130592,130608
  .long 188192,188208,188224,188240,188256,188272,188288,188304,189440,189456,189472,189488,189504,189520,189536,189552
  .long 189568,189584,190720,190736,190752,190768,190784,190800,190816,190832,190848,190864,192000,192016,192032,192048
  .long 192064,192080,192096,192112,192128,192144,193280,193296,193312,193328,193344,193360,193376,193392,193408,193424
  .long 194560,194576,194592,194608,194624,194640,194656,194672,194688,194704,195840,195856,195872,195888,195904,195920
  .long 0,0,0,0,0,0,0,0,0,0,0,0,0,0,0,0
  .long 0,0,0,0,0,0,0,0,0,0,0,0,0,0,0,0
  .long 0,0,0,0,0,0,0,0,0,0,0,0,0,0,0,0
  .long 0,0,0,0,0,0,0,0,0,0,0,0,0,0,0,0
  .long 0,8,16,24,480,488,496,504,960,968,976,984,1440,1448,1456,1464
  .long 3840,3848,3856,3864,4320,4328,4336,4344,4800,4808,4816,4824,5280,5288,5296,5304
  .long 7680,7688,7696,7704,8160,8168,8176,8184,8640,8648,8656,8664,9120,9128,9136,9144
  .long 11520,11528,11536,11544,12000,12008,12016,12024,12480,12488,12496,12504,12960,12968,12976,12984
  .long 40,48,56,64,520,528,536,544,1000,1008,1016,1024,1480,1488,1496,1504
  .long 3880,3888,3896,3904,4360,4368,4376,4384,4840,4848,4856,4864,5320,5328,5336,5344
  .long 7720,7728,7736,7744,8200,8208,8216,8224,8680,8688,8696,8704,9160,9168,9176,9184
  .long 11560,11568,11576,11584,12040,12048,12056,12064,12520,12528,12536,12544,13000,13008,13016,13024
  .long 80,88,96,104,560,568,576,584,1040,1048,1056,1064,1520,1528,1536,1544
  .long 3920,3928,3936,3944,4400,4408,4416,4424,4880,4888,4896,4904,5360,5368,5376,5384
  .long 7760,7768,7776,7784,8240,8248,8256,8264,8720,8728,8736,8744,9200,9208,9216,9224
  .long 11600,11608,11616,11624,12080,12088,12096,12104,12560,12568,12576,12584,13040,13048,13056,13064
  .long 120,128,136,144,600,608,616,624,1080,1088,1096,1104,1560,1568,1576,1584
  .long 3960,3968,3976,3984,4440,4448,4456,4464,4920,4928,4936,4944,5400,5408,5416,5424
  .long 7800,7808,7816,7824,8280,8288,8296,8304,8760,8768,8776,8784,9240,9248,9256,9264
  .long 11640,11648,11656,11664,12120,12128,12136,12144,12600,12608,12616,12624,13080,13088,13096,13104
  .long 160,168,176,184,640,648,656,664,1120,1128,1136,1144,1600,1608,1616,1624
  .long 4000,4008,4016,4024,4480,4488,4496,4504,4960,4968,4976,4984,5440,5448,5456,5464
  .long 7840,7848,7856,7864,8320,8328,8336,8344,8800,8808,8816,8824,9280,9288,9296,9304
  .long 11680,11688,11696,11704,12160,12168,12176,12184,12640,12648,12656,12664,13120,13128,13136,13144
  .long 200,208,216,224,680,688,696,704,1160,1168,1176,1184,1640,1648,1656,1664
  .long 4040,4048,4056,4064,4520,4528,4536,4544,5000,5008,5016,5024,5480,5488,5496,5504
  .long 7880,7888,7896,7904,8360,8368,8376,8384,8840,8848,8856,8864,9320,9328,9336,9344
  .long 11720,11728,11736,11744,12200,12208,12216,12224,12680,12688,12696,12704,13160,13168,13176,13184
  .long 240,248,256,264,720,728,736,744,1200,1208,1216,1224,1680,1688,1696,1704
  .long 4080,4088,4096,4104,4560,4568,4576,4584,5040,5048,5056,5064,5520,5528,5536,5544
  .long 7920,7928,7936,7944,8400,8408,8416,8424,8880,8888,8896,8904,9360,9368,9376,9384
  .long 11760,11768,11776,11784,12240,12248,12256,12264,12720,12728,12736,12744,13200,13208,13216,13224
  .long 280,288,296,304,760,768,776,784,1240,1248,1256,1264,1720,1728,1736,1744
  .long 4120,4128,4136,4144,4600,4608,4616,4624,5080,5088,5096,5104,5560,5568,5576,5584
  .long 7960,7968,7976,7984,8440,8448,8456,8464,8920,8928,8936,8944,9400,9408,9416,9424
  .long 11800,11808,11816,11824,12280,12288,12296,12304,12760,12768,12776,12784,13240,13248,13256,13264
  .long 320,328,336,344,800,808,816,824,1280,1288,1296,1304,1760,1768,1776,1784
  .long 4160,4168,4176,4184,4640,4648,4656,4664,5120,5128,5136,5144,5600,5608,5616,5624
  .long 8000,8008,8016,8024,8480,8488,8496,8504,8960,8968,8976,8984,9440,9448,9456,9464
  .long 11840,11848,11856,11864,12320,12328,12336,12344,12800,12808,12816,12824,13280,13288,13296,13304
  .long 360,368,376,384,840,848,856,864,1320,1328,1336,1344,1800,1808,1816,1824
  .long 4200,4208,4216,4224,4680,4688,4696,4704,5160,5168,5176,5184,5640,5648,5656,5664
  .long 8040,8048,8056,8064,8520,8528,8536,8544,9000,9008,9016,9024,9480,9488,9496,9504
  .long 11880,11888,11896,11904,12360,12368,12376,12384,12840,12848,12856,12864,13320,13328,13336,13344
  .long 400,408,416,424,880,888,896,904,1360,1368,1376,1384,1840,1848,1856,1864
  .long 4240,4248,4256,4264,4720,4728,4736,4744,5200,5208,5216,5224,5680,5688,5696,5704
  .long 8080,8088,8096,8104,8560,8568,8576,8584,9040,9048,9056,9064,9520,9528,9536,9544
  .long 11920,11928,11936,11944,12400,12408,12416,12424,12880,12888,12896,12904,13360,13368,13376,13384
  .long 440,448,456,464,920,928,936,944,1400,1408,1416,1424,1880,1888,1896,1904
  .long 4280,4288,4296,4304,4760,4768,4776,4784,5240,5248,5256,5264,5720,5728,5736,5744
  .long 8120,8128,8136,8144,8600,8608,8616,8624,9080,9088,9096,9104,9560,9568,9576,9584
  .long 11960,11968,11976,11984,12440,12448,12456,12464,12920,12928,12936,12944,13400,13408,13416,13424
  .long 32,72,112,152,512,552,592,632,992,1032,1072,1112,1472,1512,1552,1592
  .long 3872,3912,3952,3992,4352,4392,4432,4472,4832,4872,4912,4952,5312,5352,5392,5432
  .long 7712,7752,7792,7832,8192,8232,8272,8312,8672,8712,8752,8792,9152,9192,9232,9272
  .long 11552,11592,11632,11672,12032,12072,12112,12152,12512,12552,12592,12632,12992,13032,13072,13112
  .long 192,232,272,312,672,712,752,792,1152,1192,1232,1272,1632,1672,1712,1752
  .long 4032,4072,4112,4152,4512,4552,4592,4632,4992,5032,5072,5112,5472,5512,5552,5592
  .long 7872,7912,7952,7992,8352,8392,8432,8472,8832,8872,8912,8952,9312,9352,9392,9432
  .long 11712,11752,11792,11832,12192,12232,12272,12312,12672,12712,12752,12792,13152,13192,13232,13272
  .long 352,392,432,472,832,872,912,952,1312,1352,1392,1432,1792,1832,1872,1912
  .long 4192,4232,4272,4312,4672,4712,4752,4792,5152,5192,5232,5272,5632,5672,5712,5752
  .long 8032,8072,8112,8152,8512,8552,8592,8632,8992,9032,9072,9112,9472,9512,9552,9592
  .long 11872,11912,11952,11992,12352,12392,12432,12472,12832,12872,12912,12952,13312,13352,13392,13432
  .long 352,392,432,472,832,872,912,952,1312,1352,1392,1432,1792,1832,1872,1912
  .long 4192,4232,4272,4312,4672,4712,4752,4792,5152,5192,5232,5272,5632,5672,5712,5752
  .long 8032,8072,8112,8152,8512,8552,8592,8632,8992,9032,9072,9112,9472,9512,9552,9592
  .long 11872,11912,11952,11992,12352,12392,12432,12472,12832,12872,12912,12952,13312,13352,13392,13432
  .long 0,16,32,48,64,80,96,112,128,144,160,176,192,208,224,240
  .long 256,272,288,304,1280,1296,1312,1328,1344,1360,1376,1392,1408,1424,1440,1456
  .long 1472,1488,1504,1520,1536,1552,1568,1584,2560,2576,2592,2608,2624,2640,2656,2672
  .long 2688,2704,2720,2736,2752,2768,2784,2800,2816,2832,2848,2864,3840,3856,3872,3888
  .long 28288,28304,28320,28336,28352,28368,28384,28400,28416,28432,28448,28464,29440,29456,29472,29488
  .long 29504,29520,29536,29552,29568,29584,29600,29616,29632,29648,29664,29680,29696,29712,29728,29744
  .long 30720,30736,30752,30768,30784,30800,30816,30832,30848,30864,30880,30896,30912,30928,30944,30960
  .long 30976,30992,31008,31024,32000,32016,32032,32048,32064,32080,32096,32112,32128,32144,32160,32176
  .long 52672,52688,52704,52720,52736,52752,52768,52784,53760,53776,53792,53808,53824,53840,53856,53872
  .long 53888,53904,53920,53936,53952,53968,53984,54000,54016,54032,54048,54064,55040,55056,55072,55088
  .long 55104,55120,55136,55152,55168,55184,55200,55216,55232,55248,55264,55280,55296,55312,55328,55344
  .long 56320,56336,56352,56368,56384,56400,56416,56432,56448,56464,56480,56496,56512,56528,56544,56560
  .long 77056,77072,77088,77104,78080,78096,78112,78128,78144,78160,78176,78192,78208,78224,78240,78256
  .long 78272,78288,78304,78320,78336,78352,78368,78384,79360,79376,79392,79408,79424,79440,79456,79472
  .long 79488,79504,79520,79536,79552,79568,79584,79600,79616,79632,79648,79664,80640,80656,80672,80688
  .long 80704,80720,80736,80752,80768,80784,80800,80816,80832,80848,80864,80880,80896,80912,80928,80944
  .long 3904,3920,3936,3952,3968,3984,4000,4016,4032,4048,4064,4080,4096,4112,4128,4144
  .long 5120,5136,5152,5168,5184,5200,5216,5232,5248,5264,5280,5296,5312,5328,5344,5360
  .long 5376,5392,5408,5424,6400,6416,6432,6448,6464,6480,6496,6512,6528,6544,6560,6576
  .long 6592,6608,6624,6640,6656,6672,6688,6704,7680,7696,7712,7728,7744,7760,7776,7792
  .long 32192,32208,32224,32240,32256,32272,32288,32304,33280,33296,33312,33328,33344,33360,33376,33392
  .long 33408,33424,33440,33456,33472,33488,33504,33520,33536,33552,33568,33584,34560,34576,34592,34608
  .long 34624,34640,34656,34672,34688,34704,34720,34736,34752,34768,34784,34800,34816,34832,34848,34864
  .long 35840,35856,35872,35888,35904,35920,35936,35952,35968,35984,36000,36016,36032,36048,36064,36080
  .long 56576,56592,56608,56624,57600,57616,57632,57648,57664,57680,57696,57712,57728,57744,57760,57776
  .long 57792,57808,57824,57840,57856,57872,57888,57904,58880,58896,58912,58928,58944,58960,58976,58992
  .long 59008,59024,59040,59056,59072,59088,59104,59120,59136,59152,59168,59184,60160,60176,60192,60208
  .long 60224,60240,60256,60272,60288,60304,60320,60336,60352,60368,60384,60400,60416,60432,60448,60464
  .long 81920,81936,81952,81968,81984,82000,82016,82032,82048,82064,82080,82096,82112,82128,82144,82160
  .long 82176,82192,82208,82224,83200,83216,83232,83248,83264,83280,83296,83312,83328,83344,83360,83376
  .long 83392,83408,83424,83440,83456,83472,83488,83504,84480,84496,84512,84528,84544,84560,84576,84592
  .long 84608,84624,84640,84656,84672,84688,84704,84720,84736,84752,84768,84784,85760,85776,85792,85808
  .long 7808,7824,7840,7856,7872,7888,7904,7920,7936,7952,7968,7984,8960,8976,8992,9008
  .long 9024,9040,9056,9072,9088,9104,9120,9136,9152,9168,9184,9200,9216,9232,9248,9264
  .long 10240,10256,10272,10288,10304,10320,10336,10352,10368,10384,10400,10416,10432,10448,10464,10480
  .long 10496,10512,10528,10544,11520,11536,11552,11568,11584,11600,11616,11632,11648,11664,11680,11696
  .long 36096,36112,36128,36144,37120,37136,37152,37168,37184,37200,37216,37232,37248,37264,37280,37296
  .long 37312,37328,37344,37360,37376,37392,37408,37424,38400,38416,38432,38448,38464,38480,38496,38512
  .long 38528,38544,38560,38576,38592,38608,38624,38640,38656,38672,38688,38704,39680,39696,39712,39728
  .long 39744,39760,39776,39792,39808,39824,39840,39856,39872,39888,39904,39920,39936,39952,39968,39984
  .long 61440,61456,61472,61488,61504,61520,61536,61552,61568,61584,61600,61616,61632,61648,61664,61680
  .long 61696,61712,61728,61744,62720,62736,62752,62768,62784,62800,62816,62832,62848,62864,62880,62896
  .long 62912,62928,62944,62960,62976,62992,63008,63024,64000,64016,64032,64048,64064,64080,64096,64112
  .long 64128,64144,64160,64176,64192,64208,64224,64240,64256,64272,64288,64304,65280,65296,65312,65328
  .long 85824,85840,85856,85872,85888,85904,85920,85936,85952,85968,85984,86000,86016,86032,86048,86064
  .long 87040,87056,87072,87088,87104,87120,87136,87152,87168,87184,87200,87216,87232,87248,87264,87280
  .long 87296,87312,87328,87344,88320,88336,88352,88368,88384,88400,88416,88432,88448,88464,88480,88496
  .long 88512,88528,88544,88560,88576,88592,88608,88624,89600,89616,89632,89648,89664,89680,89696,89712
  .long 11712,11728,11744,11760,11776,11792,11808,11824,12800,12816,12832,12848,12864,12880,12896,12912
  .long 12928,12944,12960,12976,12992,13008,13024,13040,13056,13072,13088,13104,14080,14096,14112,14128
  .long 14144,14160,14176,14192,14208,14224,14240,14256,14272,14288,14304,14320,14336,14352,14368,14384
  .long 15360,15376,15392,15408,15424,15440,15456,15472,15488,15504,15520,15536,15552,15568,15584,15600
  .long 40960,40976,40992,41008,41024,41040,41056,41072,41088,41104,41120,41136,41152,41168,41184,41200
  .long 41216,41232,41248,41264,42240,42256,42272,42288,42304,42320,42336,42352,42368,42384,42400,42416
  .long 42432,42448,42464,42480,42496,42512,42528,42544,43520,43536,43552,43568,43584,43600,43616,43632
  .long 43648,43664,43680,43696,43712,43728,43744,43760,43776,43792,43808,43824,44800,44816,44832,44848
  .long 65344,65360,65376,65392,65408,65424,65440,65456,65472,65488,65504,65520,65536,65552,65568,65584
  .long 66560,66576,66592,66608,66624,66640,66656,66672,66688,66704,66720,66736,66752,66768,66784,66800
  .long 66816,66832,66848,66864,67840,67856,67872,67888,67904,67920,67936,67952,67968,67984,68000,68016
  .long 68032,68048,68064,68080,68096,68112,68128,68144,69120,69136,69152,69168,69184,69200,69216,69232
  .long 89728,89744,89760,89776,89792,89808,89824,89840,89856,89872,89888,89904,90880,90896,90912,90928
  .long 90944,90960,90976,90992,91008,91024,91040,91056,91072,91088,91104,91120,91136,91152,91168,91184
  .long 92160,92176,92192,92208,92224,92240,92256,92272,92288,92304,92320,92336,92352,92368,92384,92400
  .long 92416,92432,92448,92464,93440,93456,93472,93488,93504,93520,93536,93552,93568,93584,93600,93616
  .long 15616,15632,15648,15664,16640,16656,16672,16688,16704,16720,16736,16752,16768,16784,16800,16816
  .long 16832,16848,16864,16880,16896,16912,16928,16944,17920,17936,17952,17968,17984,18000,18016,18032
  .long 18048,18064,18080,18096,18112,18128,18144,18160,18176,18192,18208,18224,19200,19216,19232,19248
  .long 19264,19280,19296,19312,19328,19344,19360,19376,19392,19408,19424,19440,19456,19472,19488,19504
  .long 44864,44880,44896,44912,44928,44944,44960,44976,44992,45008,45024,45040,45056,45072,45088,45104
  .long 46080,46096,46112,46128,46144,46160,46176,46192,46208,46224,46240,46256,46272,46288,46304,46320
  .long 46336,46352,46368,46384,47360,47376,47392,47408,47424,47440,47456,47472,47488,47504,47520,47536
  .long 47552,47568,47584,47600,47616,47632,47648,47664,48640,48656,48672,48688,48704,48720,48736,48752
  .long 69248,69264,69280,69296,69312,69328,69344,69360,69376,69392,69408,69424,70400,70416,70432,70448
  .long 70464,70480,70496,70512,70528,70544,70560,70576,70592,70608,70624,70640,70656,70672,70688,70704
  .long 71680,71696,71712,71728,71744,71760,71776,71792,71808,71824,71840,71856,71872,71888,71904,71920
  .long 71936,71952,71968,71984,72960,72976,72992,73008,73024,73040,73056,73072,73088,73104,73120,73136
  .long 93632,93648,93664,93680,93696,93712,93728,93744,94720,94736,94752,94768,94784,94800,94816,94832
  .long 94848,94864,94880,94896,94912,94928,94944,94960,94976,94992,95008,95024,96000,96016,96032,96048
  .long 96064,96080,96096,96112,96128,96144,96160,96176,96192,96208,96224,96240,96256,96272,96288,96304
  .long 97280,97296,97312,97328,97344,97360,97376,97392,97408,97424,97440,97456,97472,97488,97504,97520
  .long 20480,20496,20512,20528,20544,20560,20576,20592,20608,20624,20640,20656,20672,20688,20704,20720
  .long 20736,20752,20768,20784,21760,21776,21792,21808,21824,21840,21856,21872,21888,21904,21920,21936
  .long 21952,21968,21984,22000,22016,22032,22048,22064,23040,23056,23072,23088,23104,23120,23136,23152
  .long 23168,23184,23200,23216,23232,23248,23264,23280,23296,23312,23328,23344,24320,24336,24352,24368
  .long 48768,48784,48800,48816,48832,48848,48864,48880,48896,48912,48928,48944,49920,49936,49952,49968
  .long 49984,50000,50016,50032,50048,50064,50080,50096,50112,50128,50144,50160,50176,50192,50208,50224
  .long 51200,51216,51232,51248,51264,51280,51296,51312,51328,51344,51360,51376,51392,51408,51424,51440
  .long 51456,51472,51488,51504,52480,52496,52512,52528,52544,52560,52576,52592,52608,52624,52640,52656
  .long 73152,73168,73184,73200,73216,73232,73248,73264,74240,74256,74272,74288,74304,74320,74336,74352
  .long 74368,74384,74400,74416,74432,74448,74464,74480,74496,74512,74528,74544,75520,75536,75552,75568
  .long 75584,75600,75616,75632,75648,75664,75680,75696,75712,75728,75744,75760,75776,75792,75808,75824
  .long 76800,76816,76832,76848,76864,76880,76896,76912,76928,76944,76960,76976,76992,77008,77024,77040
  .long 97536,97552,97568,97584,98560,98576,98592,98608,98624,98640,98656,98672,98688,98704,98720,98736
  .long 98752,98768,98784,98800,98816,98832,98848,98864,99840,99856,99872,99888,99904,99920,99936,99952
  .long 99968,99984,100000,100016,100032,100048,100064,100080,100096,100112,100128,100144,101120,101136,101152,101168
  .long 101184,101200,101216,101232,101248,101264,101280,101296,101312,101328,101344,101360,101376,101392,101408,101424
  .long 24384,24400,24416,24432,24448,24464,24480,24496,24512,24528,24544,24560,24576,24592,24608,24624
  .long 25600,25616,25632,25648,25664,25680,25696,25712,25728,25744,25760,25776,25792,25808,25824,25840
  .long 25856,25872,25888,25904,26880,26896,26912,26928,26944,26960,26976,26992,27008,27024,27040,27056
  .long 27072,27088,27104,27120,27136,27152,27168,27184,28160,28176,28192,28208,28224,28240,28256,28272
  .long 52672,52688,52704,52720,52736,52752,52768,52784,53760,53776,53792,53808,53824,53840,53856,53872
  .long 53888,53904,53920,53936,53952,53968,53984,54000,54016,54032,54048,54064,55040,55056,55072,55088
  .long 55104,55120,55136,55152,55168,55184,55200,55216,55232,55248,55264,55280,55296,55312,55328,55344
  .long 56320,56336,56352,56368,56384,56400,56416,56432,56448,56464,56480,56496,56512,56528,56544,56560
  .long 77056,77072,77088,77104,78080,78096,78112,78128,78144,78160,78176,78192,78208,78224,78240,78256
  .long 78272,78288,78304,78320,78336,78352,78368,78384,79360,79376,79392,79408,79424,79440,79456,79472
  .long 79488,79504,79520,79536,79552,79568,79584,79600,79616,79632,79648,79664,80640,80656,80672,80688
  .long 80704,80720,80736,80752,80768,80784,80800,80816,80832,80848,80864,80880,80896,80912,80928,80944
  .long 0,0,0,0,0,0,0,0,0,0,0,0,0,0,0,0
  .long 0,0,0,0,0,0,0,0,0,0,0,0,0,0,0,0
  .long 0,0,0,0,0,0,0,0,0,0,0,0,0,0,0,0
  .long 0,0,0,0,0,0,0,0,0,0,0,0,0,0,0,0
  .long 0,8,16,24,320,328,336,344,640,648,656,664,960,968,976,984
  .long 1280,1288,1296,1304,1600,1608,1616,1624,1920,1928,1936,1944,2240,2248,2256,2264
  .long 2560,2568,2576,2584,2880,2888,2896,2904,3200,3208,3216,3224,3520,3528,3536,3544
  .long 3840,3848,3856,3864,4160,4168,4176,4184,4480,4488,4496,4504,4800,4808,4816,4824
  .long 32,40,48,56,352,360,368,376,672,680,688,696,992,1000,1008,1016
  .long 1312,1320,1328,1336,1632,1640,1648,1656,1952,1960,1968,1976,2272,2280,2288,2296
  .long 2592,2600,2608,2616,2912,2920,2928,2936,3232,3240,3248,3256,3552,3560,3568,3576
  .long 3872,3880,3888,3896,4192,4200,4208,4216,4512,4520,4528,4536,4832,4840,4848,4856
  .long 64,72,80,88,384,392,400,408,704,712,720,728,1024,1032,1040,1048
  .long 1344,1352,1360,1368,1664,1672,1680,1688,1984,1992,2000,2008,2304,2312,2320,2328
  .long 2624,2632,2640,2648,2944,2952,2960,2968,3264,3272,3280,3288,3584,3592,3600,3608
  .long 3904,3912,3920,3928,4224,4232,4240,4248,4544,4552,4560,4568,4864,4872,4880,4888
  .long 96,104,112,120,416,424,432,440,736,744,752,760,1056,1064,1072,1080
  .long 1376,1384,1392,1400,1696,1704,1712,1720,2016,2024,2032,2040,2336,2344,2352,2360
  .long 2656,2664,2672,2680,2976,2984,2992,3000,3296,3304,3312,3320,3616,3624,3632,3640
  .long 3936,3944,3952,3960,4256,4264,4272,4280,4576,4584,4592,4600,4896,4904,4912,4920
  .long 5120,5128,5136,5144,5440,5448,5456,5464,5760,5768,5776,5784,6080,6088,6096,6104
  .long 5120,5128,5136,5144,5440,5448,5456,5464,5760,5768,5776,5784,6080,6088,6096,6104
  .long 5120,5128,5136,5144,5440,5448,5456,5464,5760,5768,5776,5784,6080,6088,6096,6104
  .long 5120,5128,5136,5144,5440,5448,5456,5464,5760,5768,5776,5784,6080,6088,6096,6104
  .long 5152,5160,5168,5176,5472,5480,5488,5496,5792,5800,5808,5816,6112,6120,6128,6136
  .long 5152,5160,5168,5176,5472,5480,5488,5496,5792,5800,5808,5816,6112,6120,6128,6136
  .long 5152,5160,5168,5176,5472,5480,5488,5496,5792,5800,5808,5816,6112,6120,6128,6136
  .long 5152,5160,5168,5176,5472,5480,5488,5496,5792,5800,5808,5816,6112,6120,6128,6136
  .long 5184,5192,5200,5208,5504,5512,5520,5528,5824,5832,5840,5848,6144,6152,6160,6168
  .long 5184,5192,5200,5208,5504,5512,5520,5528,5824,5832,5840,5848,6144,6152,6160,6168
  .long 5184,5192,5200,5208,5504,5512,5520,5528,5824,5832,5840,5848,6144,6152,6160,6168
  .long 5184,5192,5200,5208,5504,5512,5520,5528,5824,5832,5840,5848,6144,6152,6160,6168
  .long 5216,5224,5232,5240,5536,5544,5552,5560,5856,5864,5872,5880,6176,6184,6192,6200
  .long 5216,5224,5232,5240,5536,5544,5552,5560,5856,5864,5872,5880,6176,6184,6192,6200
  .long 5216,5224,5232,5240,5536,5544,5552,5560,5856,5864,5872,5880,6176,6184,6192,6200
  .long 5216,5224,5232,5240,5536,5544,5552,5560,5856,5864,5872,5880,6176,6184,6192,6200
.section .rodata,"a"
.p2align 6
.amdhsa_kernel concat_heads__linear_attn_block__memory_aug_recurrent_mem_tr__prompt_kernel
  .amdhsa_next_free_vgpr 512
  .amdhsa_next_free_sgpr 102
  .amdhsa_accum_offset 256
  .amdhsa_group_segment_fixed_size 0
  .amdhsa_kernarg_size 104
  .amdhsa_user_sgpr_count 2
  .amdhsa_user_sgpr_kernarg_segment_ptr 1
  .amdhsa_system_sgpr_workgroup_id_x 1
.end_amdhsa_kernel
```
